```python
import torch

def _softmax(x, axis=-1):
    return torch.softmax(x, dim=axis)
def _gelu(x):
    return torch.nn.functional.gelu(x, approximate="tanh")
def _silu(x):
    return torch.nn.functional.silu(x)
def _sigmoid(x):
    return torch.sigmoid(x)
def _layernorm(x, axis=-1, eps=1e-5):
    m = x.mean(dim=axis, keepdim=True)
    v = x.var(dim=axis, keepdim=True, unbiased=False)
    return (x - m) / torch.sqrt(v + eps)
def _scatter_add(tgt, idx, src, axis=0):
    return tgt.clone().index_add_(axis, idx, src)
def _segment_sum(src, seg, n):
    out = torch.zeros((n,) + src.shape[1:], dtype=src.dtype)
    return out.index_add_(0, seg, src)
def _pad(x, pw):
    flat = tuple(v for pair in reversed(pw) for v in pair)
    return torch.nn.functional.pad(x, flat)

kernel_name = 'interleave_layers__grouped_kv_mqa__ssm_conv_h3__prompt'

def setup_inputs():

    _w = (lambda a: (lambda t: t.to(torch.bfloat16) if t.is_floating_point() else t)(torch.as_tensor(a)))
    def _A_setup():
        B, S, D, H = 1, 2048, 576, 32
        Dh = D // H
        return {
            "x": _w((lambda *s: torch.randn(*s, dtype=torch.bfloat16) * 0.05)(B, S, D)),
            "wq": _w((lambda *s: torch.randn(*s, dtype=torch.bfloat16) * 0.05)(D, H * Dh)),
            "wk": _w((lambda *s: torch.randn(*s, dtype=torch.bfloat16) * 0.05)(D, Dh)),
            "wv": _w((lambda *s: torch.randn(*s, dtype=torch.bfloat16) * 0.05)(D, Dh)),
            "wo": _w((lambda *s: torch.randn(*s, dtype=torch.bfloat16) * 0.05)(H * Dh, D)),
        }
    _A_in = _A_setup()

    def _B_setup():
        B, S, D = 1, 2048, 576
        ks = 4
        return {
            "q": _w((lambda *s: torch.randn(*s, dtype=torch.bfloat16) * 0.05)(B, S, D)),
            "k": _w((lambda *s: torch.randn(*s, dtype=torch.bfloat16) * 0.4)(B, S, D)),
            "v": _w((lambda *s: torch.randn(*s, dtype=torch.bfloat16) * 0.4)(B, S, D)),
            "shift_k": _w((lambda *s: torch.randn(*s, dtype=torch.bfloat16) * 0.4)(D, ks) * 0.5),
            "ssm_k": _w((lambda *s: torch.randn(*s, dtype=torch.bfloat16) * 0.8)(D, S) * (1.0 / S ** 0.5)),
            "ssm_D": _w((lambda *s: torch.randn(*s, dtype=torch.bfloat16) * 0.4)(D)),
        }
    _B_in = _B_setup()

    return {
        "A_x": _A_in["x"],
        "A_wq": _A_in["wq"],
        "A_wk": _A_in["wk"],
        "A_wv": _A_in["wv"],
        "A_wo": _A_in["wo"],
        "B_q": _B_in["q"],
        "B_k": _B_in["k"],
        "B_v": _B_in["v"],
        "B_shift_k": _B_in["shift_k"],
        "B_ssm_k": _B_in["ssm_k"],
        "B_ssm_D": _B_in["ssm_D"],
    }

def reference(A_x, A_wq, A_wk, A_wv, A_wo, B_q, B_k, B_v, B_shift_k, B_ssm_k, B_ssm_D):
    def _A_ref(x, wq, wk, wv, wo):
        B, S, D = x.shape
        H = 32
        Dh = D // H
        q = (lambda x, *d: x.permute(*d))((x @ wq).reshape(B, S, H, Dh), 0, 2, 1, 3)
        k = x @ wk
        v = x @ wv
        scores = torch.einsum("bhqd,bkd->bhqk", q, k) * (Dh ** -0.5)
        p = _softmax(scores, axis=-1)
        o = torch.einsum("bhqk,bkd->bhqd", p, v)
        return (lambda x, *d: x.permute(*d))(o, 0, 2, 1, 3).reshape(B, S, H * Dh) @ wo

    def _B_ref(q, k, v, shift_k, ssm_k, ssm_D):
        B, S, D = q.shape
        ks = shift_k.shape[-1]
        k_pad = _pad(k, ((0, 0), (ks - 1, 0), (0, 0)))
        k_shift = torch.zeros_like(k)
        for t in range(ks):
            k_shift = k_shift + k_pad[:, t:t + S, :] * shift_k[:, ks - 1 - t][None, None, :]
        kv = k_shift * v
        L = 2 * S
        kv_pad = _pad(kv, ((0, 0), (0, S), (0, 0)))
        kf_pad = _pad(ssm_k, ((0, 0), (0, S)))
        kv_f = (lambda x, axes=(-2,-1): torch.fft.rfft2(x.float(), dim=axes))(kv_pad[:, None, :, :], axes=(1, 2))
        kf_f = (lambda x, axes=(-2,-1): torch.fft.rfft2(x.float(), dim=axes))(kf_pad[:, None, :], axes=(1, 2))
        kf_f = (lambda x, *d: x.permute(*d))(kf_f, 1, 2, 0)
        y_f = kv_f * kf_f[None, :, :, :]
        y = (lambda x, s, axes=(-2,-1): torch.fft.irfft2(x, s=s, dim=axes).to(torch.bfloat16))(y_f, (1, L), axes=(1, 2))[:, 0, :S, :]
        y = y + kv * ssm_D[None, None, :]
        return q * y

    x = A_x
    x = x + _A_ref(_layernorm(x, axis=-1), A_wq, A_wk, A_wv, A_wo)
    x = x + _B_ref(_layernorm(x, axis=-1), B_k, B_v, B_shift_k, B_ssm_k, B_ssm_D)
    x = x + _A_ref(_layernorm(x, axis=-1), A_wq, A_wk, A_wv, A_wo)
    x = x + _B_ref(_layernorm(x, axis=-1), B_k, B_v, B_shift_k, B_ssm_k, B_ssm_D)
    return x
```

```asm
; @launch grid=(256,1,1) block=(768,1,1) lds=158912
.amdgcn_target "amdgcn-amd-amdhsa--gfx950"
.text
.globl interleave_layers__grouped_kv_mqa__ssm_conv_h3__prompt_kernel
.p2align 8
.type interleave_layers__grouped_kv_mqa__ssm_conv_h3__prompt_kernel,@function
interleave_layers__grouped_kv_mqa__ssm_conv_h3__prompt_kernel:
s_cmp_ge_u32 s2, 256
s_cbranch_scc1 M_exit
s_load_dwordx8 s[4:11], s[0:1], 0
s_load_dwordx2 s[12:13], s[0:1], 32
s_load_dwordx8 s[16:23], s[0:1], 48
s_load_dwordx8 s[24:31], s[0:1], 80
s_and_b32 s40, s2, 7
s_lshl_b32 s40, s40, 1
s_lshr_b32 s41, s2, 3
s_and_b32 s41, s41, 1
s_or_b32 s40, s40, s41
s_and_b32 s2, s2, 0xf0
s_or_b32 s2, s2, s40
v_lshrrev_b32 v2, 6, v0
s_nop 0
v_readfirstlane_b32 s3, v2
s_waitcnt lgkmcnt(0)
s_cmp_lg_u32 s2, 0
s_cbranch_scc1 M_nn
s_cmp_lg_u32 s3, 11
s_cbranch_scc1 M_nn
s_memrealtime s[40:41]
s_waitcnt lgkmcnt(0)
s_or_b32 s40, s40, 0x100
v_mov_b32 v26, s40
v_mov_b32 v27, s41
v_mov_b32 v25, 7192576
s_mov_b64 exec, 1
global_store_dwordx2 v25, v[26:27], s[30:31] sc1
s_waitcnt vmcnt(0)
v_mov_b32 v25, 0
global_store_dwordx2 v25, v[26:27], s[28:29] sc1
s_mov_b64 exec, -1
M_nn:
v_and_b32 v1, 63, v0
s_cmp_eq_u32 s3, 8
s_cbranch_scc1 PREP_w8
s_cmp_gt_u32 s3, 8
s_cbranch_scc1 PREP_w9
s_lshl_b32 s40, s2, 3
s_add_u32 s40, s40, s3
s_mul_i32 s40, s40, 1152
s_add_u32 s42, s4, s40
s_addc_u32 s43, s5, 0
v_lshlrev_b32 v2, 4, v1
v_lshlrev_b32 v3, 1, v1
global_load_dwordx4 v[4:7], v2, s[42:43]
global_load_ushort v8, v3, s[42:43] offset:1024
s_barrier
s_mov_b32 s44, s16
s_mov_b32 s45, s17
s_mov_b32 s46, 2359296
s_mov_b32 s47, 0x00020000
s_mov_b32 s48, s18
s_mov_b32 s49, s19
s_mov_b32 s50, 2359296
s_mov_b32 s51, 0x00020000
v_lshrrev_b32 v81, 3, v0
v_and_b32 v80, 7, v0
s_lshl_b32 s40, s2, 3
v_add_u32 v82, s40, v80
v_mul_u32_u24 v82, 1152, v82
v_lshl_add_u32 v82, v81, 4, v82
buffer_load_dwordx4 v[56:59], v82, s[44:47], 0 offen
buffer_load_dwordx4 v[60:63], v82, s[48:51], 0 offen
s_waitcnt vmcnt(2)
v_lshlrev_b32 v10, 16, v4
v_and_b32 v11, 0xffff0000, v4
v_lshlrev_b32 v12, 16, v5
v_and_b32 v13, 0xffff0000, v5
v_lshlrev_b32 v14, 16, v6
v_and_b32 v15, 0xffff0000, v6
v_lshlrev_b32 v16, 16, v7
v_and_b32 v17, 0xffff0000, v7
v_lshlrev_b32 v18, 16, v8
v_pk_add_f32 v[30:31], v[10:11], v[12:13]
v_pk_add_f32 v[32:33], v[14:15], v[16:17]
v_pk_add_f32 v[30:31], v[30:31], v[32:33]
v_add_f32 v30, v30, v31
v_add_f32 v30, v30, v18
s_nop 1
v_add_f32_dpp v30, v30, v30 row_ror:8 row_mask:0xf bank_mask:0xf
s_nop 1
v_add_f32_dpp v30, v30, v30 row_ror:4 row_mask:0xf bank_mask:0xf
s_nop 1
v_add_f32_dpp v30, v30, v30 row_ror:2 row_mask:0xf bank_mask:0xf
s_nop 1
v_add_f32_dpp v30, v30, v30 row_ror:1 row_mask:0xf bank_mask:0xf
v_mov_b32 v38, v30
s_nop 1
v_permlane16_swap_b32 v30, v38
v_add_f32 v30, v30, v38
v_mov_b32 v38, v30
s_nop 1
v_permlane32_swap_b32 v30, v38
v_add_f32 v30, v30, v38
v_mul_f32 v30, 0x3ae38e39, v30
v_pk_add_f32 v[20:21], v[10:11], v[30:31] op_sel_hi:[1,0] neg_lo:[0,1] neg_hi:[0,1]
v_pk_add_f32 v[22:23], v[12:13], v[30:31] op_sel_hi:[1,0] neg_lo:[0,1] neg_hi:[0,1]
v_pk_add_f32 v[24:25], v[14:15], v[30:31] op_sel_hi:[1,0] neg_lo:[0,1] neg_hi:[0,1]
v_pk_add_f32 v[26:27], v[16:17], v[30:31] op_sel_hi:[1,0] neg_lo:[0,1] neg_hi:[0,1]
v_sub_f32 v28, v18, v30
v_pk_mul_f32 v[32:33], v[20:21], v[20:21]
v_pk_fma_f32 v[32:33], v[22:23], v[22:23], v[32:33]
v_pk_fma_f32 v[32:33], v[24:25], v[24:25], v[32:33]
v_pk_fma_f32 v[32:33], v[26:27], v[26:27], v[32:33]
v_cvt_pk_bf16_f32 v34, v30, v30
v_add_f32 v32, v32, v33
v_fmac_f32 v32, v28, v28
v_and_b32 v34, 0xffff0000, v34
s_nop 0
v_add_f32_dpp v32, v32, v32 row_ror:8 row_mask:0xf bank_mask:0xf
s_nop 1
v_add_f32_dpp v32, v32, v32 row_ror:4 row_mask:0xf bank_mask:0xf
s_nop 1
v_add_f32_dpp v32, v32, v32 row_ror:2 row_mask:0xf bank_mask:0xf
s_nop 1
v_add_f32_dpp v32, v32, v32 row_ror:1 row_mask:0xf bank_mask:0xf
v_mov_b32 v38, v32
s_nop 1
v_permlane16_swap_b32 v32, v38
v_add_f32 v32, v32, v38
v_mov_b32 v38, v32
s_nop 1
v_permlane32_swap_b32 v32, v38
v_add_f32 v32, v32, v38
v_pk_add_f32 v[20:21], v[10:11], v[34:35] op_sel_hi:[1,0] neg_lo:[0,1] neg_hi:[0,1]
v_pk_add_f32 v[22:23], v[12:13], v[34:35] op_sel_hi:[1,0] neg_lo:[0,1] neg_hi:[0,1]
v_pk_add_f32 v[24:25], v[14:15], v[34:35] op_sel_hi:[1,0] neg_lo:[0,1] neg_hi:[0,1]
v_pk_add_f32 v[26:27], v[16:17], v[34:35] op_sel_hi:[1,0] neg_lo:[0,1] neg_hi:[0,1]
v_sub_f32 v28, v18, v34
v_mul_f32 v32, 0x3ae38e39, v32
v_cvt_pk_bf16_f32 v32, v32, v32
v_and_b32 v32, 0xffff0000, v32
v_add_f32 v32, 0x3727c5ac, v32
v_cvt_pk_bf16_f32 v32, v32, v32
v_and_b32 v32, 0xffff0000, v32
v_sqrt_f32 v32, v32
v_cvt_pk_bf16_f32 v36, v20, v21
v_cvt_pk_bf16_f32 v37, v22, v23
v_cvt_pk_bf16_f32 v38, v24, v25
v_cvt_pk_bf16_f32 v39, v26, v27
v_cvt_pk_bf16_f32 v32, v32, v32
v_and_b32 v32, 0xffff0000, v32
v_cvt_pk_bf16_f32 v28, v28, v28
v_rcp_f32 v30, v32
v_lshlrev_b32 v20, 16, v36
v_and_b32 v21, 0xffff0000, v36
v_lshlrev_b32 v22, 16, v37
v_and_b32 v23, 0xffff0000, v37
v_lshlrev_b32 v24, 16, v38
v_and_b32 v25, 0xffff0000, v38
v_lshlrev_b32 v26, 16, v39
v_and_b32 v27, 0xffff0000, v39
v_and_b32 v28, 0xffff0000, v28
v_pk_mul_f32 v[20:21], v[20:21], v[30:31] op_sel_hi:[1,0]
v_pk_mul_f32 v[22:23], v[22:23], v[30:31] op_sel_hi:[1,0]
v_pk_mul_f32 v[24:25], v[24:25], v[30:31] op_sel_hi:[1,0]
v_pk_mul_f32 v[26:27], v[26:27], v[30:31] op_sel_hi:[1,0]
v_mul_f32 v28, v28, v30
v_cvt_pk_bf16_f32 v40, v20, v21
v_cvt_pk_bf16_f32 v41, v22, v23
v_cvt_pk_bf16_f32 v42, v24, v25
v_cvt_pk_bf16_f32 v43, v26, v27
v_cvt_pk_bf16_f32 v88, v28, v28
s_and_b32 s52, s2, 1
s_lshl_b32 s52, s52, 3
s_add_u32 s52, s52, s3
s_lshl_b32 s52, s52, 4
v_lshrrev_b32 v30, 2, v1
v_lshlrev_b32 v30, 10, v30
v_and_b32 v31, 3, v1
v_lshl_add_u32 v30, v31, 8, v30
v_add_u32 v30, s52, v30
v_lshrrev_b32 v31, 3, v1
v_lshlrev_b32 v31, 8, v31
v_and_b32 v32, 7, v1
v_lshl_add_u32 v31, v32, 1, v31
v_add_u32 v31, s52, v31
v_add_u32 v31, 16384, v31
ds_write_b128 v30, v[40:43] offset:20480
ds_write_b16 v31, v88 offset:20480
s_waitcnt lgkmcnt(0)
s_barrier
s_mul_i32 s40, s3, 21846
s_lshr_b32 s40, s40, 16
s_mul_i32 s41, s40, 3
s_sub_u32 s41, s3, s41
v_and_b32 v2, 15, v1
v_lshrrev_b32 v3, 4, v1
v_lshlrev_b32 v4, 1, v2
v_mov_b32 v6, 49424
v_mov_b32 v7, 70928
s_cmp_eq_u32 s41, 1
s_cbranch_scc0 KV_aa
v_mov_b32 v6, v7
KV_aa:
s_cmp_eq_u32 s41, 2
s_cbranch_scc0 KV_ba
v_mov_b32 v6, 49456
v_mov_b32 v7, 70956
v_cmp_gt_u32 vcc, 2, v2
s_nop 1
v_cndmask_b32 v6, v7, v6, vcc
v_and_b32 v4, 6, v4
KV_ba:
v_add_u32 v4, v4, v6
v_mul_u32_u24 v6, 288, v3
v_add_u32 v4, v4, v6
s_mul_i32 s42, s40, 6
s_mul_i32 s43, s42, 1152
v_add_u32 v4, s43, v4
s_lshl_b32 s43, s42, 10
v_lshl_add_u32 v5, v1, 4, s43
s_cmp_eq_u32 s41, 0
s_cbranch_scc0 KV_swapa
ds_read_b128 v[140:143], v5 offset:20480
ds_read_u16 v92, v4 offset:0
ds_read_u16 v93, v4 offset:36
ds_read_u16 v94, v4 offset:72
ds_read_u16 v95, v4 offset:108
ds_read_u16 v96, v4 offset:144
ds_read_u16 v97, v4 offset:180
ds_read_u16 v98, v4 offset:216
ds_read_u16 v99, v4 offset:252
ds_read_b128 v[144:147], v5 offset:21504
ds_read_u16 v100, v4 offset:1152
ds_read_u16 v101, v4 offset:1188
ds_read_u16 v102, v4 offset:1224
ds_read_u16 v103, v4 offset:1260
ds_read_u16 v104, v4 offset:1296
s_waitcnt lgkmcnt(6)
v_lshl_or_b32 v92, v93, 16, v92
v_lshl_or_b32 v93, v95, 16, v94
v_lshl_or_b32 v94, v97, 16, v96
v_lshl_or_b32 v95, v99, 16, v98
ds_read_u16 v105, v4 offset:1332
ds_read_u16 v106, v4 offset:1368
ds_read_u16 v107, v4 offset:1404
v_mfma_f32_16x16x32_bf16 v[8:11], v[92:95], v[140:143], 0
ds_read_b128 v[148:151], v5 offset:22528
ds_read_u16 v108, v4 offset:2304
ds_read_u16 v109, v4 offset:2340
ds_read_u16 v110, v4 offset:2376
ds_read_u16 v111, v4 offset:2412
ds_read_u16 v112, v4 offset:2448
s_waitcnt lgkmcnt(6)
v_lshl_or_b32 v100, v101, 16, v100
v_lshl_or_b32 v101, v103, 16, v102
v_lshl_or_b32 v102, v105, 16, v104
v_lshl_or_b32 v103, v107, 16, v106
ds_read_u16 v113, v4 offset:2484
ds_read_u16 v114, v4 offset:2520
ds_read_u16 v115, v4 offset:2556
v_mfma_f32_16x16x32_bf16 v[8:11], v[100:103], v[144:147], v[8:11]
ds_read_b128 v[152:155], v5 offset:23552
ds_read_u16 v116, v4 offset:3456
ds_read_u16 v117, v4 offset:3492
ds_read_u16 v118, v4 offset:3528
ds_read_u16 v119, v4 offset:3564
ds_read_u16 v120, v4 offset:3600
s_waitcnt lgkmcnt(6)
v_lshl_or_b32 v108, v109, 16, v108
v_lshl_or_b32 v109, v111, 16, v110
v_lshl_or_b32 v110, v113, 16, v112
v_lshl_or_b32 v111, v115, 16, v114
ds_read_u16 v121, v4 offset:3636
ds_read_u16 v122, v4 offset:3672
ds_read_u16 v123, v4 offset:3708
v_mfma_f32_16x16x32_bf16 v[8:11], v[108:111], v[148:151], v[8:11]
ds_read_b128 v[156:159], v5 offset:24576
ds_read_u16 v124, v4 offset:4608
ds_read_u16 v125, v4 offset:4644
ds_read_u16 v126, v4 offset:4680
ds_read_u16 v127, v4 offset:4716
ds_read_u16 v128, v4 offset:4752
s_waitcnt lgkmcnt(6)
v_lshl_or_b32 v116, v117, 16, v116
v_lshl_or_b32 v117, v119, 16, v118
v_lshl_or_b32 v118, v121, 16, v120
v_lshl_or_b32 v119, v123, 16, v122
ds_read_u16 v129, v4 offset:4788
ds_read_u16 v130, v4 offset:4824
ds_read_u16 v131, v4 offset:4860
v_mfma_f32_16x16x32_bf16 v[8:11], v[116:119], v[152:155], v[8:11]
ds_read_b128 v[160:163], v5 offset:25600
ds_read_u16 v132, v4 offset:5760
ds_read_u16 v133, v4 offset:5796
ds_read_u16 v134, v4 offset:5832
ds_read_u16 v135, v4 offset:5868
ds_read_u16 v136, v4 offset:5904
s_waitcnt lgkmcnt(6)
v_lshl_or_b32 v124, v125, 16, v124
v_lshl_or_b32 v125, v127, 16, v126
v_lshl_or_b32 v126, v129, 16, v128
v_lshl_or_b32 v127, v131, 16, v130
ds_read_u16 v137, v4 offset:5940
ds_read_u16 v138, v4 offset:5976
ds_read_u16 v139, v4 offset:6012
v_mfma_f32_16x16x32_bf16 v[8:11], v[124:127], v[156:159], v[8:11]
s_waitcnt lgkmcnt(0)
v_lshl_or_b32 v132, v133, 16, v132
v_lshl_or_b32 v133, v135, 16, v134
v_lshl_or_b32 v134, v137, 16, v136
v_lshl_or_b32 v135, v139, 16, v138
s_nop 1
v_mfma_f32_16x16x32_bf16 v[8:11], v[132:135], v[160:163], v[8:11]
s_branch KV_donea
KV_swapa:
ds_read_b128 v[140:143], v5 offset:20480
ds_read_u16 v92, v4 offset:0
ds_read_u16 v93, v4 offset:36
ds_read_u16 v94, v4 offset:72
ds_read_u16 v95, v4 offset:108
ds_read_u16 v96, v4 offset:144
ds_read_u16 v97, v4 offset:180
ds_read_u16 v98, v4 offset:216
ds_read_u16 v99, v4 offset:252
ds_read_b128 v[144:147], v5 offset:21504
ds_read_u16 v100, v4 offset:1152
ds_read_u16 v101, v4 offset:1188
ds_read_u16 v102, v4 offset:1224
ds_read_u16 v103, v4 offset:1260
ds_read_u16 v104, v4 offset:1296
s_waitcnt lgkmcnt(6)
v_lshl_or_b32 v92, v93, 16, v92
v_lshl_or_b32 v93, v95, 16, v94
v_lshl_or_b32 v94, v97, 16, v96
v_lshl_or_b32 v95, v99, 16, v98
ds_read_u16 v105, v4 offset:1332
ds_read_u16 v106, v4 offset:1368
ds_read_u16 v107, v4 offset:1404
v_mfma_f32_16x16x32_bf16 v[8:11], v[140:143], v[92:95], 0
ds_read_b128 v[148:151], v5 offset:22528
ds_read_u16 v108, v4 offset:2304
ds_read_u16 v109, v4 offset:2340
ds_read_u16 v110, v4 offset:2376
ds_read_u16 v111, v4 offset:2412
ds_read_u16 v112, v4 offset:2448
s_waitcnt lgkmcnt(6)
v_lshl_or_b32 v100, v101, 16, v100
v_lshl_or_b32 v101, v103, 16, v102
v_lshl_or_b32 v102, v105, 16, v104
v_lshl_or_b32 v103, v107, 16, v106
ds_read_u16 v113, v4 offset:2484
ds_read_u16 v114, v4 offset:2520
ds_read_u16 v115, v4 offset:2556
v_mfma_f32_16x16x32_bf16 v[8:11], v[144:147], v[100:103], v[8:11]
ds_read_b128 v[152:155], v5 offset:23552
ds_read_u16 v116, v4 offset:3456
ds_read_u16 v117, v4 offset:3492
ds_read_u16 v118, v4 offset:3528
ds_read_u16 v119, v4 offset:3564
ds_read_u16 v120, v4 offset:3600
s_waitcnt lgkmcnt(6)
v_lshl_or_b32 v108, v109, 16, v108
v_lshl_or_b32 v109, v111, 16, v110
v_lshl_or_b32 v110, v113, 16, v112
v_lshl_or_b32 v111, v115, 16, v114
ds_read_u16 v121, v4 offset:3636
ds_read_u16 v122, v4 offset:3672
ds_read_u16 v123, v4 offset:3708
v_mfma_f32_16x16x32_bf16 v[8:11], v[148:151], v[108:111], v[8:11]
ds_read_b128 v[156:159], v5 offset:24576
ds_read_u16 v124, v4 offset:4608
ds_read_u16 v125, v4 offset:4644
ds_read_u16 v126, v4 offset:4680
ds_read_u16 v127, v4 offset:4716
ds_read_u16 v128, v4 offset:4752
s_waitcnt lgkmcnt(6)
v_lshl_or_b32 v116, v117, 16, v116
v_lshl_or_b32 v117, v119, 16, v118
v_lshl_or_b32 v118, v121, 16, v120
v_lshl_or_b32 v119, v123, 16, v122
ds_read_u16 v129, v4 offset:4788
ds_read_u16 v130, v4 offset:4824
ds_read_u16 v131, v4 offset:4860
v_mfma_f32_16x16x32_bf16 v[8:11], v[152:155], v[116:119], v[8:11]
ds_read_b128 v[160:163], v5 offset:25600
ds_read_u16 v132, v4 offset:5760
ds_read_u16 v133, v4 offset:5796
ds_read_u16 v134, v4 offset:5832
ds_read_u16 v135, v4 offset:5868
ds_read_u16 v136, v4 offset:5904
s_waitcnt lgkmcnt(6)
v_lshl_or_b32 v124, v125, 16, v124
v_lshl_or_b32 v125, v127, 16, v126
v_lshl_or_b32 v126, v129, 16, v128
v_lshl_or_b32 v127, v131, 16, v130
ds_read_u16 v137, v4 offset:5940
ds_read_u16 v138, v4 offset:5976
ds_read_u16 v139, v4 offset:6012
v_mfma_f32_16x16x32_bf16 v[8:11], v[156:159], v[124:127], v[8:11]
s_waitcnt lgkmcnt(0)
v_lshl_or_b32 v132, v133, 16, v132
v_lshl_or_b32 v133, v135, 16, v134
v_lshl_or_b32 v134, v137, 16, v136
v_lshl_or_b32 v135, v139, 16, v138
s_nop 1
v_mfma_f32_16x16x32_bf16 v[8:11], v[160:163], v[132:135], v[8:11]
KV_donea:
s_lshl_b32 s43, s3, 10
v_lshl_add_u32 v6, v1, 4, s43
s_nop 5
ds_write_b128 v6, v[8:11] offset:2048
s_waitcnt lgkmcnt(0)
s_barrier
s_waitcnt vmcnt(0)
v_mul_u32_u24 v86, 1168, v80
v_lshl_add_u32 v86, v81, 4, v86
v_add_u32 v86, 98576, v86
ds_write_b128 v86, v[56:59] offset:3504
s_cmp_lt_u32 s3, 3
s_cbranch_scc1 PREP_noxc
v_lshlrev_b32 v2, 4, v1
s_sub_u32 s50, s3, 3
s_lshl_b32 s50, s50, 10
v_add_u32 v3, s50, v2
ds_read_b128 v[8:11], v3 offset:20480
ds_read_b128 v[12:15], v3 offset:25600
ds_read_b128 v[16:19], v3 offset:30720
s_cmp_ge_u32 s3, 6
s_cbranch_scc1 PREP_x3
ds_read_b128 v[20:23], v3 offset:35840
PREP_x3:
s_lshr_b32 s51, s2, 1
s_mul_i32 s51, s51, 18432
s_add_u32 s51, s51, 0x200000
s_add_u32 s51, s51, s50
s_add_u32 s54, s30, s51
s_addc_u32 s55, s31, 0
s_and_b32 s56, s2, 1
s_cmp_eq_u32 s56, 0
s_mov_b32 s57, 0xff00ff00
s_cselect_b32 s57, 0x00ff00ff, s57
s_waitcnt lgkmcnt(0)
s_mov_b32 exec_lo, s57
s_mov_b32 exec_hi, s57
global_store_dwordx4 v2, v[8:11], s[54:55] sc1
s_add_u32 s54, s54, 5120
s_addc_u32 s55, s55, 0
global_store_dwordx4 v2, v[12:15], s[54:55] sc1
s_add_u32 s54, s54, 5120
s_addc_u32 s55, s55, 0
global_store_dwordx4 v2, v[16:19], s[54:55] sc1
s_add_u32 s54, s54, 5120
s_addc_u32 s55, s55, 0
s_cmp_ge_u32 s3, 6
s_cbranch_scc1 PREP_x4
global_store_dwordx4 v2, v[20:23], s[54:55] sc1
PREP_x4:
s_mov_b64 exec, -1
PREP_noxc:
s_cmp_ge_u32 s3, 3
s_cbranch_scc1 PREP_nokv
ds_read_b128 v[24:27], v6 offset:5120
ds_read_b128 v[28:31], v6 offset:8192
s_waitcnt lgkmcnt(0)
v_add_f32 v8, v8, v24
v_add_f32 v8, v8, v28
v_add_f32 v9, v9, v25
v_add_f32 v9, v9, v29
v_add_f32 v10, v10, v26
v_add_f32 v10, v10, v30
v_add_f32 v11, v11, v27
v_add_f32 v11, v11, v31
s_mov_b32 s60, s3
s_lshr_b32 s61, s2, 1
s_and_b32 s62, s2, 1
v_and_b32 v12, 15, v1
v_lshrrev_b32 v13, 4, v1
v_cvt_pk_bf16_f32 v16, v8, v9
v_cvt_pk_bf16_f32 v17, v10, v11
s_cmp_eq_u32 s60, 0
s_cbranch_scc0 KVS_prep_1
s_lshr_b32 s64, s61, 1
s_lshl_b32 s64, s64, 10
s_and_b32 s65, s61, 1
s_lshl_b32 s65, s65, 8
s_add_u32 s64, s64, s65
s_add_u32 s64, s64, 0x680000
v_lshrrev_b32 v14, 1, v13
v_lshlrev_b32 v14, 9, v14
v_lshl_add_u32 v14, v12, 4, v14
v_and_b32 v15, 1, v13
v_lshl_add_u32 v14, v15, 3, v14
v_add_u32 v14, s64, v14
v_mul_f32 v15, v8, v8
v_fmac_f32 v15, v9, v9
v_fmac_f32 v15, v10, v10
v_fmac_f32 v15, v11, v11
v_mov_b32 v8, v15
s_nop 1
v_permlane16_swap_b32 v15, v8
v_add_f32 v15, v15, v8
v_mov_b32 v8, v15
s_nop 1
v_permlane32_swap_b32 v15, v8
v_add_f32 v15, v15, v8
v_lshrrev_b32 v9, 3, v12
v_cmp_eq_u32 vcc, s62, v9
s_nop 1
v_cndmask_b32 v15, 0, v15, vcc
s_nop 1
v_max_f32_dpp v15, v15, v15 row_ror:8 row_mask:0xf bank_mask:0xf
s_nop 1
v_max_f32_dpp v15, v15, v15 row_ror:4 row_mask:0xf bank_mask:0xf
s_nop 1
v_max_f32_dpp v15, v15, v15 row_ror:2 row_mask:0xf bank_mask:0xf
s_nop 1
v_max_f32_dpp v15, v15, v15 row_ror:1 row_mask:0xf bank_mask:0xf
s_mov_b64 exec, vcc
global_store_dwordx2 v14, v[16:17], s[30:31] sc1
s_mov_b64 exec, 1
s_lshl_b32 s64, s2, 2
s_add_u32 s64, s64, 0x6d8000
v_mov_b32 v14, s64
global_store_dword v14, v15, s[30:31] sc1
s_mov_b64 exec, -1
s_branch KVS_prep_end
KVS_prep_1:
s_mul_i32 s64, s61, 608
s_add_u32 s64, s64, 0x6b0000
v_and_b32 v15, 1, v13
v_mul_u32_u24 v14, 304, v15
v_lshrrev_b32 v15, 1, v13
v_lshl_add_u32 v14, v15, 3, v14
v_add_u32 v14, s64, v14
v_cmp_eq_u32 vcc, s62, v15
s_cmp_eq_u32 s60, 1
s_cbranch_scc0 KVS_prep_2
v_lshl_add_u32 v14, v12, 4, v14
s_mov_b64 exec, vcc
global_store_dwordx2 v14, v[16:17], s[30:31] sc1
s_mov_b64 exec, -1
s_branch KVS_prep_end
KVS_prep_2:
s_mov_b64 s[66:67], vcc
v_add_u32 v15, 14, v12
v_lshl_add_u32 v14, v15, 4, v14
v_and_b32 v15, 14, v12
v_cmp_eq_u32 vcc, 2, v15
s_and_b64 exec, vcc, s[66:67]
global_store_dwordx2 v14, v[16:17], s[30:31] sc1
s_mov_b64 exec, -1
s_lshr_b32 s64, s61, 4
s_lshl_b32 s64, s64, 10
s_lshr_b32 s65, s61, 2
s_and_b32 s65, s65, 3
s_lshl_b32 s65, s65, 2
s_add_u32 s64, s64, s65
s_and_b32 s65, s61, 3
s_lshl_b32 s65, s65, 8
s_add_u32 s64, s64, s65
s_add_u32 s64, s64, 0x6a0000
v_lshlrev_b32 v14, 6, v13
v_lshl_add_u32 v14, v12, 1, v14
v_add_u32 v14, s64, v14
v_mul_f32 v15, v8, v8
v_mul_f32 v8, v9, v9
v_max_f32 v15, v15, v8
v_mul_f32 v8, v10, v10
v_max_f32 v15, v15, v8
v_mul_f32 v8, v11, v11
v_max_f32 v15, v15, v8
v_add_f32 v15, v15, v15
v_cmp_gt_u32 vcc, 2, v12
s_and_b64 s[66:67], vcc, s[66:67]
v_cndmask_b32 v15, 0, v15, s[66:67]
s_nop 1
v_max_f32_dpp v15, v15, v15 row_ror:8 row_mask:0xf bank_mask:0xf
s_nop 1
v_max_f32_dpp v15, v15, v15 row_ror:4 row_mask:0xf bank_mask:0xf
s_nop 1
v_max_f32_dpp v15, v15, v15 row_ror:2 row_mask:0xf bank_mask:0xf
s_nop 1
v_max_f32_dpp v15, v15, v15 row_ror:1 row_mask:0xf bank_mask:0xf
v_mov_b32 v8, v15
s_nop 1
v_permlane16_swap_b32 v15, v8
v_max_f32 v15, v15, v8
v_mov_b32 v8, v15
s_nop 1
v_permlane32_swap_b32 v15, v8
v_max_f32 v15, v15, v8
s_mov_b64 exec, s[66:67]
global_store_short v14, v16, s[30:31] sc1
global_store_short_d16_hi v14, v16, s[30:31] offset:16 sc1
global_store_short v14, v17, s[30:31] offset:32 sc1
global_store_short_d16_hi v14, v17, s[30:31] offset:48 sc1
s_mov_b64 exec, 1
s_lshl_b32 s64, s2, 2
s_add_u32 s64, s64, 0x6d8400
v_mov_b32 v14, s64
global_store_dword v14, v15, s[30:31] sc1
s_mov_b64 exec, -1
KVS_prep_end:
PREP_nokv:
s_waitcnt lgkmcnt(0)
s_barrier
s_waitcnt vmcnt(0) lgkmcnt(0)
v_mov_b32 v120, 158864
v_mov_b32 v121, 1
v_mov_b32 v124, 158872
ds_read_b64 v[122:123], v124
s_mov_b64 exec, 1
ds_add_rtn_u32 v124, v120, v121
s_mov_b64 exec, -1
s_waitcnt lgkmcnt(0)
v_readfirstlane_b32 s50, v124
v_readfirstlane_b32 s14, v122
v_readfirstlane_b32 s15, v123
s_cmp_eq_u32 s50, 10
s_cbranch_scc0 ARR_a
s_add_u32 s60, s14, 48
s_and_b32 s61, s15, 0xffff
s_lshl_b32 s61, s61, 8
s_lshl_b32 s47, s2, 3
s_add_u32 s47, s47, 0x6f0000
s_mov_b64 exec, 0xff
v_mul_u32_u24 v120, 2048, v1
v_add_u32 v120, s47, v120
v_mov_b32 v122, s60
v_mov_b32 v123, s61
global_store_dwordx2 v120, v[122:123], s[30:31] sc1
s_mov_b64 exec, -1
ARR_a:
ds_read_b128 v[44:47], v86 offset:0
ds_read_b128 v[48:51], v86 offset:1168
ds_read_b128 v[52:55], v86 offset:2336
v_lshlrev_b32 v85, 6, v81
v_add_u32 v85, 111424, v85
ds_read_b128 v[64:67], v85 offset:0
ds_read_b128 v[68:71], v85 offset:16
ds_read_b128 v[72:75], v85 offset:32
ds_read_b128 v[76:79], v85 offset:48
s_waitcnt lgkmcnt(0)
s_mov_b32 s52, 0x05040100
s_mov_b32 s53, 0x07060302
v_perm_b32 v10, v52, v56, s52
v_perm_b32 v11, v44, v48, s52
v_dot2_f32_bf16 v12, v10, v64, 0
v_dot2_f32_bf16 v12, v11, v65, v12
v_lshlrev_b32 v10, 16, v60
s_nop 1
v_mul_f32 v12, v12, v10
v_perm_b32 v10, v52, v56, s53
v_perm_b32 v11, v44, v48, s53
v_dot2_f32_bf16 v13, v10, v66, 0
v_dot2_f32_bf16 v13, v11, v67, v13
v_and_b32 v10, 0xffff0000, v60
s_nop 1
v_mul_f32 v13, v13, v10
v_perm_b32 v10, v53, v57, s52
v_perm_b32 v11, v45, v49, s52
v_dot2_f32_bf16 v14, v10, v68, 0
v_dot2_f32_bf16 v14, v11, v69, v14
v_lshlrev_b32 v10, 16, v61
s_nop 1
v_mul_f32 v14, v14, v10
v_perm_b32 v10, v53, v57, s53
v_perm_b32 v11, v45, v49, s53
v_dot2_f32_bf16 v15, v10, v70, 0
v_dot2_f32_bf16 v15, v11, v71, v15
v_and_b32 v10, 0xffff0000, v61
s_nop 1
v_mul_f32 v15, v15, v10
v_perm_b32 v10, v54, v58, s52
v_perm_b32 v11, v46, v50, s52
v_dot2_f32_bf16 v16, v10, v72, 0
v_dot2_f32_bf16 v16, v11, v73, v16
v_lshlrev_b32 v10, 16, v62
s_nop 1
v_mul_f32 v16, v16, v10
v_perm_b32 v10, v54, v58, s53
v_perm_b32 v11, v46, v50, s53
v_dot2_f32_bf16 v17, v10, v74, 0
v_dot2_f32_bf16 v17, v11, v75, v17
v_and_b32 v10, 0xffff0000, v62
s_nop 1
v_mul_f32 v17, v17, v10
v_perm_b32 v10, v55, v59, s52
v_perm_b32 v11, v47, v51, s52
v_dot2_f32_bf16 v18, v10, v76, 0
v_dot2_f32_bf16 v18, v11, v77, v18
v_lshlrev_b32 v10, 16, v63
s_nop 1
v_mul_f32 v18, v18, v10
v_perm_b32 v10, v55, v59, s53
v_perm_b32 v11, v47, v51, s53
v_dot2_f32_bf16 v19, v10, v78, 0
v_dot2_f32_bf16 v19, v11, v79, v19
v_and_b32 v10, 0xffff0000, v63
s_nop 1
v_mul_f32 v19, v19, v10
v_cvt_pk_bf16_f32 v20, v12, v13
v_cvt_pk_bf16_f32 v21, v14, v15
v_cvt_pk_bf16_f32 v22, v16, v17
v_cvt_pk_bf16_f32 v23, v18, v19
v_mul_u32_u24 v24, 144, v81
v_sub_u32 v25, 7, v80
v_lshl_add_u32 v24, v25, 1, v24
ds_write_b16 v24, v20 offset:38912
ds_write_b16_d16_hi v24, v20 offset:38928
ds_write_b16 v24, v21 offset:38944
ds_write_b16_d16_hi v24, v21 offset:38960
ds_write_b16 v24, v22 offset:38976
ds_write_b16_d16_hi v24, v22 offset:38992
ds_write_b16 v24, v23 offset:39008
ds_write_b16_d16_hi v24, v23 offset:39024
s_waitcnt lgkmcnt(0)
s_barrier
v_lshrrev_b32 v14, 3, v0
v_lshlrev_b32 v15, 4, v0
v_lshl_add_u32 v14, v14, 4, v15
ds_read_b128 v[16:19], v14 offset:38912
s_sub_u32 s44, 255, s2
s_mul_i32 s44, s44, 9216
s_add_u32 s44, s44, 0x700000
v_add_u32 v15, s44, v15
s_waitcnt lgkmcnt(0)
global_store_dwordx4 v15, v[16:19], s[30:31] sc1
s_branch PH_END
PREP_w8:
v_mbcnt_lo_u32_b32 v165, -1, 0
v_mbcnt_hi_u32_b32 v165, -1, v165
v_mov_b32 v104, 0
v_mov_b32 v105, 0
v_mov_b32 v106, 0
v_mov_b32 v107, 0
v_lshlrev_b32 v161, 4, v165
ds_write_b128 v161, v[104:107]
v_add_u32 v160, 158848, v161
s_mov_b64 exec, 0xf
ds_write_b128 v160, v[104:107]
s_mov_b64 exec, -1
v_lshlrev_b32 v160, 3, v165
v_mov_b32 v104, 1
s_mov_b64 exec, 0xf
ds_write_b32 v160, v104 offset:4
v_mov_b32 v104, 2
s_mov_b64 exec, 1
ds_write_b32 v160, v104 offset:64
s_mov_b64 exec, -1
v_mov_b32 v104, 0xff800000
v_mov_b32 v105, 0xff800000
v_mov_b32 v106, 0xff800000
v_mov_b32 v107, 0xff800000
ds_write_b128 v161, v[104:107] offset:1024
s_waitcnt lgkmcnt(0)
s_barrier
s_mov_b32 s44, s16
s_mov_b32 s45, s17
s_mov_b32 s46, 2359296
s_mov_b32 s47, 0x00020000
s_mov_b32 s48, s18
s_mov_b32 s49, s19
s_mov_b32 s50, 2359296
s_mov_b32 s51, 0x00020000
v_lshrrev_b32 v81, 3, v0
v_and_b32 v80, 7, v0
s_lshl_b32 s40, s2, 3
v_add_u32 v82, s40, v80
v_mul_u32_u24 v82, 1152, v82
v_lshl_add_u32 v82, v81, 4, v82
buffer_load_dwordx4 v[56:59], v82, s[44:47], 0 offen
buffer_load_dwordx4 v[60:63], v82, s[48:51], 0 offen
s_barrier
s_mul_i32 s40, s3, 21846
s_lshr_b32 s40, s40, 16
s_mul_i32 s41, s40, 3
s_sub_u32 s41, s3, s41
v_and_b32 v2, 15, v1
v_lshrrev_b32 v3, 4, v1
v_lshlrev_b32 v4, 1, v2
v_mov_b32 v6, 49424
v_mov_b32 v7, 70928
s_cmp_eq_u32 s41, 1
s_cbranch_scc0 KV_ab
v_mov_b32 v6, v7
KV_ab:
s_cmp_eq_u32 s41, 2
s_cbranch_scc0 KV_bb
v_mov_b32 v6, 49456
v_mov_b32 v7, 70956
v_cmp_gt_u32 vcc, 2, v2
s_nop 1
v_cndmask_b32 v6, v7, v6, vcc
v_and_b32 v4, 6, v4
KV_bb:
v_add_u32 v4, v4, v6
v_mul_u32_u24 v6, 288, v3
v_add_u32 v4, v4, v6
s_mul_i32 s42, s40, 6
s_mul_i32 s43, s42, 1152
v_add_u32 v4, s43, v4
s_lshl_b32 s43, s42, 10
v_lshl_add_u32 v5, v1, 4, s43
s_cmp_eq_u32 s41, 0
s_cbranch_scc0 KV_swapb
ds_read_b128 v[140:143], v5 offset:20480
ds_read_u16 v92, v4 offset:0
ds_read_u16 v93, v4 offset:36
ds_read_u16 v94, v4 offset:72
ds_read_u16 v95, v4 offset:108
ds_read_u16 v96, v4 offset:144
ds_read_u16 v97, v4 offset:180
ds_read_u16 v98, v4 offset:216
ds_read_u16 v99, v4 offset:252
ds_read_b128 v[144:147], v5 offset:21504
ds_read_u16 v100, v4 offset:1152
ds_read_u16 v101, v4 offset:1188
ds_read_u16 v102, v4 offset:1224
ds_read_u16 v103, v4 offset:1260
ds_read_u16 v104, v4 offset:1296
s_waitcnt lgkmcnt(6)
v_lshl_or_b32 v92, v93, 16, v92
v_lshl_or_b32 v93, v95, 16, v94
v_lshl_or_b32 v94, v97, 16, v96
v_lshl_or_b32 v95, v99, 16, v98
ds_read_u16 v105, v4 offset:1332
ds_read_u16 v106, v4 offset:1368
ds_read_u16 v107, v4 offset:1404
v_mfma_f32_16x16x32_bf16 v[8:11], v[92:95], v[140:143], 0
ds_read_b128 v[148:151], v5 offset:22528
ds_read_u16 v108, v4 offset:2304
ds_read_u16 v109, v4 offset:2340
ds_read_u16 v110, v4 offset:2376
ds_read_u16 v111, v4 offset:2412
ds_read_u16 v112, v4 offset:2448
s_waitcnt lgkmcnt(6)
v_lshl_or_b32 v100, v101, 16, v100
v_lshl_or_b32 v101, v103, 16, v102
v_lshl_or_b32 v102, v105, 16, v104
v_lshl_or_b32 v103, v107, 16, v106
ds_read_u16 v113, v4 offset:2484
ds_read_u16 v114, v4 offset:2520
ds_read_u16 v115, v4 offset:2556
v_mfma_f32_16x16x32_bf16 v[8:11], v[100:103], v[144:147], v[8:11]
ds_read_b128 v[152:155], v5 offset:23552
ds_read_u16 v116, v4 offset:3456
ds_read_u16 v117, v4 offset:3492
ds_read_u16 v118, v4 offset:3528
ds_read_u16 v119, v4 offset:3564
ds_read_u16 v120, v4 offset:3600
s_waitcnt lgkmcnt(6)
v_lshl_or_b32 v108, v109, 16, v108
v_lshl_or_b32 v109, v111, 16, v110
v_lshl_or_b32 v110, v113, 16, v112
v_lshl_or_b32 v111, v115, 16, v114
ds_read_u16 v121, v4 offset:3636
ds_read_u16 v122, v4 offset:3672
ds_read_u16 v123, v4 offset:3708
v_mfma_f32_16x16x32_bf16 v[8:11], v[108:111], v[148:151], v[8:11]
ds_read_b128 v[156:159], v5 offset:24576
ds_read_u16 v124, v4 offset:4608
ds_read_u16 v125, v4 offset:4644
ds_read_u16 v126, v4 offset:4680
ds_read_u16 v127, v4 offset:4716
ds_read_u16 v128, v4 offset:4752
s_waitcnt lgkmcnt(6)
v_lshl_or_b32 v116, v117, 16, v116
v_lshl_or_b32 v117, v119, 16, v118
v_lshl_or_b32 v118, v121, 16, v120
v_lshl_or_b32 v119, v123, 16, v122
ds_read_u16 v129, v4 offset:4788
ds_read_u16 v130, v4 offset:4824
ds_read_u16 v131, v4 offset:4860
v_mfma_f32_16x16x32_bf16 v[8:11], v[116:119], v[152:155], v[8:11]
ds_read_b128 v[160:163], v5 offset:25600
ds_read_u16 v132, v4 offset:5760
ds_read_u16 v133, v4 offset:5796
ds_read_u16 v134, v4 offset:5832
ds_read_u16 v135, v4 offset:5868
ds_read_u16 v136, v4 offset:5904
s_waitcnt lgkmcnt(6)
v_lshl_or_b32 v124, v125, 16, v124
v_lshl_or_b32 v125, v127, 16, v126
v_lshl_or_b32 v126, v129, 16, v128
v_lshl_or_b32 v127, v131, 16, v130
ds_read_u16 v137, v4 offset:5940
ds_read_u16 v138, v4 offset:5976
ds_read_u16 v139, v4 offset:6012
v_mfma_f32_16x16x32_bf16 v[8:11], v[124:127], v[156:159], v[8:11]
s_waitcnt lgkmcnt(0)
v_lshl_or_b32 v132, v133, 16, v132
v_lshl_or_b32 v133, v135, 16, v134
v_lshl_or_b32 v134, v137, 16, v136
v_lshl_or_b32 v135, v139, 16, v138
s_nop 1
v_mfma_f32_16x16x32_bf16 v[8:11], v[132:135], v[160:163], v[8:11]
s_branch KV_doneb
KV_swapb:
ds_read_b128 v[140:143], v5 offset:20480
ds_read_u16 v92, v4 offset:0
ds_read_u16 v93, v4 offset:36
ds_read_u16 v94, v4 offset:72
ds_read_u16 v95, v4 offset:108
ds_read_u16 v96, v4 offset:144
ds_read_u16 v97, v4 offset:180
ds_read_u16 v98, v4 offset:216
ds_read_u16 v99, v4 offset:252
ds_read_b128 v[144:147], v5 offset:21504
ds_read_u16 v100, v4 offset:1152
ds_read_u16 v101, v4 offset:1188
ds_read_u16 v102, v4 offset:1224
ds_read_u16 v103, v4 offset:1260
ds_read_u16 v104, v4 offset:1296
s_waitcnt lgkmcnt(6)
v_lshl_or_b32 v92, v93, 16, v92
v_lshl_or_b32 v93, v95, 16, v94
v_lshl_or_b32 v94, v97, 16, v96
v_lshl_or_b32 v95, v99, 16, v98
ds_read_u16 v105, v4 offset:1332
ds_read_u16 v106, v4 offset:1368
ds_read_u16 v107, v4 offset:1404
v_mfma_f32_16x16x32_bf16 v[8:11], v[140:143], v[92:95], 0
ds_read_b128 v[148:151], v5 offset:22528
ds_read_u16 v108, v4 offset:2304
ds_read_u16 v109, v4 offset:2340
ds_read_u16 v110, v4 offset:2376
ds_read_u16 v111, v4 offset:2412
ds_read_u16 v112, v4 offset:2448
s_waitcnt lgkmcnt(6)
v_lshl_or_b32 v100, v101, 16, v100
v_lshl_or_b32 v101, v103, 16, v102
v_lshl_or_b32 v102, v105, 16, v104
v_lshl_or_b32 v103, v107, 16, v106
ds_read_u16 v113, v4 offset:2484
ds_read_u16 v114, v4 offset:2520
ds_read_u16 v115, v4 offset:2556
v_mfma_f32_16x16x32_bf16 v[8:11], v[144:147], v[100:103], v[8:11]
ds_read_b128 v[152:155], v5 offset:23552
ds_read_u16 v116, v4 offset:3456
ds_read_u16 v117, v4 offset:3492
ds_read_u16 v118, v4 offset:3528
ds_read_u16 v119, v4 offset:3564
ds_read_u16 v120, v4 offset:3600
s_waitcnt lgkmcnt(6)
v_lshl_or_b32 v108, v109, 16, v108
v_lshl_or_b32 v109, v111, 16, v110
v_lshl_or_b32 v110, v113, 16, v112
v_lshl_or_b32 v111, v115, 16, v114
ds_read_u16 v121, v4 offset:3636
ds_read_u16 v122, v4 offset:3672
ds_read_u16 v123, v4 offset:3708
v_mfma_f32_16x16x32_bf16 v[8:11], v[148:151], v[108:111], v[8:11]
ds_read_b128 v[156:159], v5 offset:24576
ds_read_u16 v124, v4 offset:4608
ds_read_u16 v125, v4 offset:4644
ds_read_u16 v126, v4 offset:4680
ds_read_u16 v127, v4 offset:4716
ds_read_u16 v128, v4 offset:4752
s_waitcnt lgkmcnt(6)
v_lshl_or_b32 v116, v117, 16, v116
v_lshl_or_b32 v117, v119, 16, v118
v_lshl_or_b32 v118, v121, 16, v120
v_lshl_or_b32 v119, v123, 16, v122
ds_read_u16 v129, v4 offset:4788
ds_read_u16 v130, v4 offset:4824
ds_read_u16 v131, v4 offset:4860
v_mfma_f32_16x16x32_bf16 v[8:11], v[152:155], v[116:119], v[8:11]
ds_read_b128 v[160:163], v5 offset:25600
ds_read_u16 v132, v4 offset:5760
ds_read_u16 v133, v4 offset:5796
ds_read_u16 v134, v4 offset:5832
ds_read_u16 v135, v4 offset:5868
ds_read_u16 v136, v4 offset:5904
s_waitcnt lgkmcnt(6)
v_lshl_or_b32 v124, v125, 16, v124
v_lshl_or_b32 v125, v127, 16, v126
v_lshl_or_b32 v126, v129, 16, v128
v_lshl_or_b32 v127, v131, 16, v130
ds_read_u16 v137, v4 offset:5940
ds_read_u16 v138, v4 offset:5976
ds_read_u16 v139, v4 offset:6012
v_mfma_f32_16x16x32_bf16 v[8:11], v[156:159], v[124:127], v[8:11]
s_waitcnt lgkmcnt(0)
v_lshl_or_b32 v132, v133, 16, v132
v_lshl_or_b32 v133, v135, 16, v134
v_lshl_or_b32 v134, v137, 16, v136
v_lshl_or_b32 v135, v139, 16, v138
s_nop 1
v_mfma_f32_16x16x32_bf16 v[8:11], v[160:163], v[132:135], v[8:11]
KV_doneb:
s_lshl_b32 s43, s3, 10
v_lshl_add_u32 v6, v1, 4, s43
s_nop 5
ds_write_b128 v6, v[8:11] offset:2048
s_waitcnt lgkmcnt(0)
s_barrier
s_waitcnt vmcnt(0)
v_mul_u32_u24 v86, 1168, v80
v_lshl_add_u32 v86, v81, 4, v86
v_add_u32 v86, 98576, v86
ds_write_b128 v86, v[56:59] offset:3504
s_waitcnt lgkmcnt(0)
s_barrier
ds_read_b128 v[44:47], v86 offset:0
ds_read_b128 v[48:51], v86 offset:1168
ds_read_b128 v[52:55], v86 offset:2336
v_lshlrev_b32 v85, 6, v81
v_add_u32 v85, 111424, v85
ds_read_b128 v[64:67], v85 offset:0
ds_read_b128 v[68:71], v85 offset:16
ds_read_b128 v[72:75], v85 offset:32
ds_read_b128 v[76:79], v85 offset:48
s_waitcnt lgkmcnt(0)
s_mov_b32 s52, 0x05040100
s_mov_b32 s53, 0x07060302
v_perm_b32 v10, v52, v56, s52
v_perm_b32 v11, v44, v48, s52
v_dot2_f32_bf16 v12, v10, v64, 0
v_dot2_f32_bf16 v12, v11, v65, v12
v_lshlrev_b32 v10, 16, v60
s_nop 1
v_mul_f32 v12, v12, v10
v_perm_b32 v10, v52, v56, s53
v_perm_b32 v11, v44, v48, s53
v_dot2_f32_bf16 v13, v10, v66, 0
v_dot2_f32_bf16 v13, v11, v67, v13
v_and_b32 v10, 0xffff0000, v60
s_nop 1
v_mul_f32 v13, v13, v10
v_perm_b32 v10, v53, v57, s52
v_perm_b32 v11, v45, v49, s52
v_dot2_f32_bf16 v14, v10, v68, 0
v_dot2_f32_bf16 v14, v11, v69, v14
v_lshlrev_b32 v10, 16, v61
s_nop 1
v_mul_f32 v14, v14, v10
v_perm_b32 v10, v53, v57, s53
v_perm_b32 v11, v45, v49, s53
v_dot2_f32_bf16 v15, v10, v70, 0
v_dot2_f32_bf16 v15, v11, v71, v15
v_and_b32 v10, 0xffff0000, v61
s_nop 1
v_mul_f32 v15, v15, v10
v_perm_b32 v10, v54, v58, s52
v_perm_b32 v11, v46, v50, s52
v_dot2_f32_bf16 v16, v10, v72, 0
v_dot2_f32_bf16 v16, v11, v73, v16
v_lshlrev_b32 v10, 16, v62
s_nop 1
v_mul_f32 v16, v16, v10
v_perm_b32 v10, v54, v58, s53
v_perm_b32 v11, v46, v50, s53
v_dot2_f32_bf16 v17, v10, v74, 0
v_dot2_f32_bf16 v17, v11, v75, v17
v_and_b32 v10, 0xffff0000, v62
s_nop 1
v_mul_f32 v17, v17, v10
v_perm_b32 v10, v55, v59, s52
v_perm_b32 v11, v47, v51, s52
v_dot2_f32_bf16 v18, v10, v76, 0
v_dot2_f32_bf16 v18, v11, v77, v18
v_lshlrev_b32 v10, 16, v63
s_nop 1
v_mul_f32 v18, v18, v10
v_perm_b32 v10, v55, v59, s53
v_perm_b32 v11, v47, v51, s53
v_dot2_f32_bf16 v19, v10, v78, 0
v_dot2_f32_bf16 v19, v11, v79, v19
v_and_b32 v10, 0xffff0000, v63
s_nop 1
v_mul_f32 v19, v19, v10
v_cvt_pk_bf16_f32 v20, v12, v13
v_cvt_pk_bf16_f32 v21, v14, v15
v_cvt_pk_bf16_f32 v22, v16, v17
v_cvt_pk_bf16_f32 v23, v18, v19
v_mul_u32_u24 v24, 144, v81
v_sub_u32 v25, 7, v80
v_lshl_add_u32 v24, v25, 1, v24
ds_write_b16 v24, v20 offset:38912
ds_write_b16_d16_hi v24, v20 offset:38928
ds_write_b16 v24, v21 offset:38944
ds_write_b16_d16_hi v24, v21 offset:38960
ds_write_b16 v24, v22 offset:38976
ds_write_b16_d16_hi v24, v22 offset:38992
ds_write_b16 v24, v23 offset:39008
ds_write_b16_d16_hi v24, v23 offset:39024
s_waitcnt lgkmcnt(0)
s_barrier
v_lshrrev_b32 v14, 3, v0
v_lshlrev_b32 v15, 4, v0
v_lshl_add_u32 v14, v14, 4, v15
ds_read_b128 v[16:19], v14 offset:38912
s_sub_u32 s44, 255, s2
s_mul_i32 s44, s44, 9216
s_add_u32 s44, s44, 0x700000
v_add_u32 v15, s44, v15
s_waitcnt lgkmcnt(0)
global_store_dwordx4 v15, v[16:19], s[30:31] sc1
s_branch PH_END
PREP_w9:
s_setprio 3
v_lshlrev_b32 v2, 4, v1
s_mov_b32 s44, s8
s_mov_b32 s45, s9
s_mov_b32 s46, 20736
s_mov_b32 s47, 0x00020000
s_mov_b32 s48, s10
s_mov_b32 s49, s11
s_mov_b32 s50, 20736
s_mov_b32 s51, 0x00020000
s_lshr_b32 s52, s2, 3
s_mul_i32 s53, s52, 9363
s_lshr_b32 s53, s53, 16
s_mul_i32 s53, s53, 7
s_sub_u32 s52, s52, s53
s_add_u32 s53, s52, 0
s_cmp_ge_u32 s53, 7
s_cselect_b32 s54, 7, 0
s_sub_u32 s53, s53, s54
s_lshl_b32 s53, s53, 10
v_add_u32 v64, s53, v2
s_add_u32 s53, s52, 1
s_cmp_ge_u32 s53, 7
s_cselect_b32 s54, 7, 0
s_sub_u32 s53, s53, s54
s_lshl_b32 s53, s53, 10
v_add_u32 v65, s53, v2
s_add_u32 s53, s52, 2
s_cmp_ge_u32 s53, 7
s_cselect_b32 s54, 7, 0
s_sub_u32 s53, s53, s54
s_lshl_b32 s53, s53, 10
v_add_u32 v66, s53, v2
s_add_u32 s53, s52, 3
s_cmp_ge_u32 s53, 7
s_cselect_b32 s54, 7, 0
s_sub_u32 s53, s53, s54
s_lshl_b32 s53, s53, 10
v_add_u32 v67, s53, v2
s_add_u32 s53, s52, 4
s_cmp_ge_u32 s53, 7
s_cselect_b32 s54, 7, 0
s_sub_u32 s53, s53, s54
s_lshl_b32 s53, s53, 10
v_add_u32 v68, s53, v2
s_add_u32 s53, s52, 5
s_cmp_ge_u32 s53, 7
s_cselect_b32 s54, 7, 0
s_sub_u32 s53, s53, s54
s_lshl_b32 s53, s53, 10
v_add_u32 v69, s53, v2
s_add_u32 s53, s52, 6
s_cmp_ge_u32 s53, 7
s_cselect_b32 s54, 7, 0
s_sub_u32 s53, s53, s54
s_lshl_b32 s53, s53, 10
v_add_u32 v70, s53, v2
s_cmp_lg_u32 s3, 9
s_cbranch_scc1 PREP_wr9
s_mov_b32 s55, 0
buffer_load_dwordx4 v[4:7], v64, s[44:47], s55 offen
buffer_load_dwordx4 v[8:11], v65, s[44:47], s55 offen
buffer_load_dwordx4 v[12:15], v66, s[44:47], s55 offen
buffer_load_dwordx4 v[16:19], v67, s[44:47], s55 offen
buffer_load_dwordx4 v[20:23], v68, s[44:47], s55 offen
buffer_load_dwordx4 v[24:27], v69, s[44:47], s55 offen
buffer_load_dwordx4 v[28:31], v70, s[44:47], s55 offen
s_mov_b32 s55, 7168
buffer_load_dwordx4 v[32:35], v64, s[44:47], s55 offen
buffer_load_dwordx4 v[36:39], v65, s[44:47], s55 offen
buffer_load_dwordx4 v[40:43], v66, s[44:47], s55 offen
buffer_load_dwordx4 v[44:47], v67, s[44:47], s55 offen
buffer_load_dwordx4 v[48:51], v68, s[44:47], s55 offen
buffer_load_dwordx4 v[52:55], v69, s[44:47], s55 offen
buffer_load_dwordx4 v[56:59], v70, s[44:47], s55 offen
s_barrier
s_mov_b32 s44, s16
s_mov_b32 s45, s17
s_mov_b32 s46, 2359296
s_mov_b32 s47, 0x00020000
s_lshl_b32 s40, s2, 3
s_add_u32 s40, s40, s3
s_sub_u32 s40, s40, 12
s_mul_i32 s40, s40, 1152
v_lshl_add_u32 v116, v1, 4, s40
buffer_load_dwordx4 v[100:103], v116, s[44:47], 0 offen
v_add_u32 v117, 1024, v116
s_mov_b64 exec, 0xff
buffer_load_dwordx4 v[104:107], v117, s[44:47], 0 offen
s_mov_b64 exec, -1
s_sub_u32 s41, s3, 9
s_mul_i32 s41, s41, 1536
v_lshl_add_u32 v117, v1, 4, s41
global_load_dwordx4 v[108:111], v117, s[20:21]
s_mov_b64 exec, 0xffffffff
global_load_dwordx4 v[112:115], v117, s[20:21] offset:1024
s_mov_b64 exec, -1
s_waitcnt vmcnt(17)
ds_write_b128 v64, v[4:7] offset:49424
s_waitcnt vmcnt(16)
ds_write_b128 v65, v[8:11] offset:49424
s_waitcnt vmcnt(15)
ds_write_b128 v66, v[12:15] offset:49424
s_waitcnt vmcnt(14)
ds_write_b128 v67, v[16:19] offset:49424
s_waitcnt vmcnt(13)
ds_write_b128 v68, v[20:23] offset:49424
s_waitcnt vmcnt(12)
ds_write_b128 v69, v[24:27] offset:49424
s_waitcnt vmcnt(11)
ds_write_b128 v70, v[28:31] offset:49424
s_waitcnt vmcnt(10)
ds_write_b128 v64, v[32:35] offset:56592
s_waitcnt vmcnt(9)
ds_write_b128 v65, v[36:39] offset:56592
s_waitcnt vmcnt(8)
ds_write_b128 v66, v[40:43] offset:56592
s_waitcnt vmcnt(7)
ds_write_b128 v67, v[44:47] offset:56592
s_waitcnt vmcnt(6)
ds_write_b128 v68, v[48:51] offset:56592
s_waitcnt vmcnt(5)
ds_write_b128 v69, v[52:55] offset:56592
s_waitcnt vmcnt(4)
ds_write_b128 v70, v[56:59] offset:56592
s_branch PREP_wrd
PREP_wr9:
s_cmp_lg_u32 s3, 10
s_cbranch_scc1 PREP_wr10
s_mov_b32 s55, 14336
buffer_load_dwordx4 v[4:7], v64, s[44:47], s55 offen
buffer_load_dwordx4 v[8:11], v65, s[44:47], s55 offen
buffer_load_dwordx4 v[12:15], v66, s[44:47], s55 offen
buffer_load_dwordx4 v[16:19], v67, s[44:47], s55 offen
buffer_load_dwordx4 v[20:23], v68, s[44:47], s55 offen
buffer_load_dwordx4 v[24:27], v69, s[44:47], s55 offen
buffer_load_dwordx4 v[28:31], v70, s[44:47], s55 offen
s_mov_b32 s55, 0
buffer_load_dwordx4 v[32:35], v64, s[48:51], s55 offen
buffer_load_dwordx4 v[36:39], v65, s[48:51], s55 offen
buffer_load_dwordx4 v[40:43], v66, s[48:51], s55 offen
buffer_load_dwordx4 v[44:47], v67, s[48:51], s55 offen
buffer_load_dwordx4 v[48:51], v68, s[48:51], s55 offen
buffer_load_dwordx4 v[52:55], v69, s[48:51], s55 offen
buffer_load_dwordx4 v[56:59], v70, s[48:51], s55 offen
s_barrier
s_mov_b32 s44, s16
s_mov_b32 s45, s17
s_mov_b32 s46, 2359296
s_mov_b32 s47, 0x00020000
s_lshl_b32 s40, s2, 3
s_add_u32 s40, s40, s3
s_sub_u32 s40, s40, 12
s_mul_i32 s40, s40, 1152
v_lshl_add_u32 v116, v1, 4, s40
buffer_load_dwordx4 v[100:103], v116, s[44:47], 0 offen
v_add_u32 v117, 1024, v116
s_mov_b64 exec, 0xff
buffer_load_dwordx4 v[104:107], v117, s[44:47], 0 offen
s_mov_b64 exec, -1
s_sub_u32 s41, s3, 9
s_mul_i32 s41, s41, 1536
v_lshl_add_u32 v117, v1, 4, s41
global_load_dwordx4 v[108:111], v117, s[20:21]
s_mov_b64 exec, 0xffffffff
global_load_dwordx4 v[112:115], v117, s[20:21] offset:1024
s_mov_b64 exec, -1
s_waitcnt vmcnt(17)
v_add_u32 v3, 63760, v64
ds_write_b128 v3, v[4:7]
s_waitcnt vmcnt(16)
v_add_u32 v3, 63760, v65
ds_write_b128 v3, v[8:11]
s_waitcnt vmcnt(15)
v_add_u32 v3, 63760, v66
ds_write_b128 v3, v[12:15]
s_waitcnt vmcnt(14)
v_add_u32 v3, 63760, v67
ds_write_b128 v3, v[16:19]
s_waitcnt vmcnt(13)
v_add_u32 v3, 63760, v68
ds_write_b128 v3, v[20:23]
s_waitcnt vmcnt(12)
v_add_u32 v3, 63760, v69
ds_write_b128 v3, v[24:27]
s_waitcnt vmcnt(11)
v_add_u32 v3, 63760, v70
ds_write_b128 v3, v[28:31]
s_waitcnt vmcnt(10)
v_add_u32 v3, 70928, v64
ds_write_b128 v3, v[32:35]
s_waitcnt vmcnt(9)
v_add_u32 v3, 70928, v65
ds_write_b128 v3, v[36:39]
s_waitcnt vmcnt(8)
v_add_u32 v3, 70928, v66
ds_write_b128 v3, v[40:43]
s_waitcnt vmcnt(7)
v_add_u32 v3, 70928, v67
ds_write_b128 v3, v[44:47]
s_waitcnt vmcnt(6)
v_add_u32 v3, 70928, v68
ds_write_b128 v3, v[48:51]
s_waitcnt vmcnt(5)
v_add_u32 v3, 70928, v69
ds_write_b128 v3, v[52:55]
s_waitcnt vmcnt(4)
v_add_u32 v3, 70928, v70
ds_write_b128 v3, v[56:59]
s_branch PREP_wrd
PREP_wr10:
s_mov_b32 s55, 7168
buffer_load_dwordx4 v[4:7], v64, s[48:51], s55 offen
buffer_load_dwordx4 v[8:11], v65, s[48:51], s55 offen
buffer_load_dwordx4 v[12:15], v66, s[48:51], s55 offen
buffer_load_dwordx4 v[16:19], v67, s[48:51], s55 offen
buffer_load_dwordx4 v[20:23], v68, s[48:51], s55 offen
buffer_load_dwordx4 v[24:27], v69, s[48:51], s55 offen
buffer_load_dwordx4 v[28:31], v70, s[48:51], s55 offen
s_mov_b32 s55, 14336
buffer_load_dwordx4 v[32:35], v64, s[48:51], s55 offen
buffer_load_dwordx4 v[36:39], v65, s[48:51], s55 offen
buffer_load_dwordx4 v[40:43], v66, s[48:51], s55 offen
buffer_load_dwordx4 v[44:47], v67, s[48:51], s55 offen
buffer_load_dwordx4 v[48:51], v68, s[48:51], s55 offen
buffer_load_dwordx4 v[52:55], v69, s[48:51], s55 offen
buffer_load_dwordx4 v[56:59], v70, s[48:51], s55 offen
s_barrier
s_mov_b32 s44, s16
s_mov_b32 s45, s17
s_mov_b32 s46, 2359296
s_mov_b32 s47, 0x00020000
s_lshl_b32 s40, s2, 3
s_add_u32 s40, s40, s3
s_sub_u32 s40, s40, 12
s_mul_i32 s40, s40, 1152
v_lshl_add_u32 v116, v1, 4, s40
buffer_load_dwordx4 v[100:103], v116, s[44:47], 0 offen
v_add_u32 v117, 1024, v116
s_mov_b64 exec, 0xff
buffer_load_dwordx4 v[104:107], v117, s[44:47], 0 offen
s_mov_b64 exec, -1
s_sub_u32 s41, s3, 9
s_mul_i32 s41, s41, 1536
v_lshl_add_u32 v117, v1, 4, s41
global_load_dwordx4 v[108:111], v117, s[20:21]
s_mov_b64 exec, 0xffffffff
global_load_dwordx4 v[112:115], v117, s[20:21] offset:1024
s_mov_b64 exec, -1
s_waitcnt vmcnt(17)
v_add_u32 v3, 78096, v64
ds_write_b128 v3, v[4:7]
s_waitcnt vmcnt(16)
v_add_u32 v3, 78096, v65
ds_write_b128 v3, v[8:11]
s_waitcnt vmcnt(15)
v_add_u32 v3, 78096, v66
ds_write_b128 v3, v[12:15]
s_waitcnt vmcnt(14)
v_add_u32 v3, 78096, v67
ds_write_b128 v3, v[16:19]
s_waitcnt vmcnt(13)
v_add_u32 v3, 78096, v68
ds_write_b128 v3, v[20:23]
s_waitcnt vmcnt(12)
v_add_u32 v3, 78096, v69
ds_write_b128 v3, v[24:27]
s_waitcnt vmcnt(11)
v_add_u32 v3, 78096, v70
ds_write_b128 v3, v[28:31]
s_waitcnt vmcnt(10)
v_add_u32 v3, 85264, v64
ds_write_b128 v3, v[32:35]
s_waitcnt vmcnt(9)
v_add_u32 v3, 85264, v65
ds_write_b128 v3, v[36:39]
s_waitcnt vmcnt(8)
v_add_u32 v3, 85264, v66
ds_write_b128 v3, v[40:43]
s_waitcnt vmcnt(7)
v_add_u32 v3, 85264, v67
ds_write_b128 v3, v[44:47]
s_waitcnt vmcnt(6)
v_add_u32 v3, 85264, v68
ds_write_b128 v3, v[48:51]
s_waitcnt vmcnt(5)
v_add_u32 v3, 85264, v69
ds_write_b128 v3, v[52:55]
s_waitcnt vmcnt(4)
v_add_u32 v3, 85264, v70
ds_write_b128 v3, v[56:59]
PREP_wrd:
s_waitcnt lgkmcnt(0)
s_barrier
v_lshrrev_b32 v130, 1, v1
v_and_b32 v131, 1, v1
s_mov_b32 s64, -1
s_mov_b32 s65, -1
s_cmp_ge_u32 s2, 96
s_cbranch_scc1 R2_b
s_sub_u32 s56, s2, 0
s_mul_i32 s56, s56, 6
s_add_u32 s56, s56, s3
s_sub_u32 s56, s56, 9
s_lshl_b32 s64, s56, 10
s_add_u32 s64, s64, 0x0
s_cmp_ge_u32 s56, 72
s_cbranch_scc1 R2_a0
s_lshr_b32 s58, s56, 2
s_and_b32 s57, s56, 1
s_lshl_b32 s59, s56, 3
s_and_b32 s59, s59, 16
s_add_u32 s57, s57, s59
s_branch R2_a20
R2_a0:
s_sub_u32 s56, s56, 72
s_mul_i32 s58, s56, 2341
s_lshr_b32 s58, s58, 16
s_mul_i32 s57, s58, 28
s_sub_u32 s57, s56, s57
s_add_u32 s57, s57, 2
s_cmp_ge_u32 s57, 16
s_cselect_b32 s59, 2, 0
s_add_u32 s57, s57, s59
R2_a20:
s_mul_i32 s64, s57, 18
s_add_u32 s64, s64, s58
s_lshl_b32 s64, s64, 10
s_add_u32 s64, s64, 0x0
s_mul_i32 s57, s57, 36
s_mul_i32 s58, s58, 36864
s_add_u32 s57, s57, s58
v_mul_u32_u24 v132, 1152, v130
v_lshl_add_u32 v132, v131, 4, v132
v_add_u32 v132, s57, v132
global_load_dwordx4 v[136:139], v132, s[6:7]
s_sub_u32 s56, s2, 0
s_mul_i32 s56, s56, 6
s_add_u32 s56, s56, s3
s_sub_u32 s56, s56, 6
s_lshl_b32 s65, s56, 10
s_add_u32 s65, s65, 0x0
s_cmp_ge_u32 s56, 72
s_cbranch_scc1 R2_a1
s_lshr_b32 s58, s56, 2
s_and_b32 s57, s56, 1
s_lshl_b32 s59, s56, 3
s_and_b32 s59, s59, 16
s_add_u32 s57, s57, s59
s_branch R2_a21
R2_a1:
s_sub_u32 s56, s56, 72
s_mul_i32 s58, s56, 2341
s_lshr_b32 s58, s58, 16
s_mul_i32 s57, s58, 28
s_sub_u32 s57, s56, s57
s_add_u32 s57, s57, 2
s_cmp_ge_u32 s57, 16
s_cselect_b32 s59, 2, 0
s_add_u32 s57, s57, s59
R2_a21:
s_mul_i32 s65, s57, 18
s_add_u32 s65, s65, s58
s_lshl_b32 s65, s65, 10
s_add_u32 s65, s65, 0x0
s_mul_i32 s57, s57, 36
s_mul_i32 s58, s58, 36864
s_add_u32 s57, s57, s58
v_mul_u32_u24 v132, 1152, v130
v_lshl_add_u32 v132, v131, 4, v132
v_add_u32 v132, s57, v132
global_load_dwordx4 v[144:147], v132, s[6:7]
s_branch R2_end
R2_b:
s_cmp_ge_u32 s2, 192
s_cbranch_scc1 R2_c
s_sub_u32 s56, s2, 96
s_mul_i32 s56, s56, 6
s_add_u32 s56, s56, s3
s_sub_u32 s56, s56, 9
s_lshl_b32 s64, s56, 10
s_add_u32 s64, s64, 0xa2000
s_mul_i32 s57, s56, 1821
s_lshr_b32 s57, s57, 16
s_mul_i32 s58, s57, 36
s_sub_u32 s58, s56, s58
s_mul_i32 s57, s57, 41472
s_lshl_b32 s58, s58, 5
s_add_u32 s57, s57, s58
v_lshrrev_b32 v132, 4, v130
v_mul_u32_u24 v132, 18, v132
v_and_b32 v133, 15, v130
v_add_u32 v132, v132, v133
v_mul_u32_u24 v132, 1152, v132
v_lshl_add_u32 v132, v131, 4, v132
v_add_u32 v132, s57, v132
global_load_dwordx4 v[136:139], v132, s[12:13]
s_sub_u32 s56, s2, 96
s_mul_i32 s56, s56, 6
s_add_u32 s56, s56, s3
s_sub_u32 s56, s56, 6
s_lshl_b32 s65, s56, 10
s_add_u32 s65, s65, 0xa2000
s_mul_i32 s57, s56, 1821
s_lshr_b32 s57, s57, 16
s_mul_i32 s58, s57, 36
s_sub_u32 s58, s56, s58
s_mul_i32 s57, s57, 41472
s_lshl_b32 s58, s58, 5
s_add_u32 s57, s57, s58
v_lshrrev_b32 v132, 4, v130
v_mul_u32_u24 v132, 18, v132
v_and_b32 v133, 15, v130
v_add_u32 v132, v132, v133
v_mul_u32_u24 v132, 1152, v132
v_lshl_add_u32 v132, v131, 4, v132
v_add_u32 v132, s57, v132
global_load_dwordx4 v[144:147], v132, s[12:13]
s_branch R2_end
R2_c:
s_cmp_ge_u32 s2, 204
s_cbranch_scc1 R2_d
s_sub_u32 s56, s2, 192
s_mul_i32 s56, s56, 6
s_add_u32 s56, s56, s3
s_sub_u32 s56, s56, 9
s_lshl_b32 s64, s56, 10
s_add_u32 s64, s64, 0x90000
s_cmp_ge_u32 s56, 36
s_cselect_b32 s59, 1, 0
s_cselect_b32 s58, 36, 0
s_sub_u32 s58, s56, s58
s_and_b32 s57, s58, 1
s_lshl_b32 s57, s57, 1
s_add_u32 s57, s57, s59
s_lshr_b32 s58, s58, 1
s_mul_i32 s64, s57, 18
s_add_u32 s64, s64, s58
s_lshl_b32 s64, s64, 10
s_add_u32 s64, s64, 0x90000
s_mul_i32 s57, s57, 288
s_mul_i32 s58, s58, 36864
s_add_u32 s57, s57, s58
s_add_u32 s57, s57, 32
v_mul_u32_u24 v132, 1152, v130
v_mul_u32_u24 v133, 144, v131
v_add3_u32 v132, v132, v133, s57
global_load_dword v136, v132, s[6:7] offset:0
global_load_dword v137, v132, s[6:7] offset:36
global_load_dword v138, v132, s[6:7] offset:72
global_load_dword v139, v132, s[6:7] offset:108
s_sub_u32 s56, s2, 192
s_mul_i32 s56, s56, 6
s_add_u32 s56, s56, s3
s_sub_u32 s56, s56, 6
s_lshl_b32 s65, s56, 10
s_add_u32 s65, s65, 0x90000
s_cmp_ge_u32 s56, 36
s_cselect_b32 s59, 1, 0
s_cselect_b32 s58, 36, 0
s_sub_u32 s58, s56, s58
s_and_b32 s57, s58, 1
s_lshl_b32 s57, s57, 1
s_add_u32 s57, s57, s59
s_lshr_b32 s58, s58, 1
s_mul_i32 s65, s57, 18
s_add_u32 s65, s65, s58
s_lshl_b32 s65, s65, 10
s_add_u32 s65, s65, 0x90000
s_mul_i32 s57, s57, 288
s_mul_i32 s58, s58, 36864
s_add_u32 s57, s57, s58
s_add_u32 s57, s57, 32
v_mul_u32_u24 v132, 1152, v130
v_mul_u32_u24 v133, 144, v131
v_add3_u32 v132, v132, v133, s57
global_load_dword v144, v132, s[6:7] offset:0
global_load_dword v145, v132, s[6:7] offset:36
global_load_dword v146, v132, s[6:7] offset:72
global_load_dword v147, v132, s[6:7] offset:108
s_branch R2_end
R2_d:
s_cmp_ge_u32 s2, 216
s_cbranch_scc1 R2_e
s_sub_u32 s56, s2, 204
s_mul_i32 s56, s56, 6
s_add_u32 s56, s56, s3
s_sub_u32 s56, s56, 9
s_lshl_b32 s64, s56, 10
s_add_u32 s64, s64, 0x132000
s_mul_i32 s57, s56, 1821
s_lshr_b32 s57, s57, 16
s_mul_i32 s58, s57, 36
s_sub_u32 s58, s56, s58
s_mul_i32 s57, s57, 331776
s_lshl_b32 s58, s58, 5
s_add_u32 s57, s57, s58
s_add_u32 s57, s57, 18432
v_lshrrev_b32 v132, 1, v130
v_mul_u32_u24 v132, 18, v132
v_and_b32 v133, 1, v130
v_add_u32 v132, v132, v133
v_mul_u32_u24 v132, 1152, v132
v_lshl_add_u32 v132, v131, 4, v132
v_add_u32 v132, s57, v132
global_load_dwordx4 v[136:139], v132, s[12:13]
s_sub_u32 s56, s2, 204
s_mul_i32 s56, s56, 6
s_add_u32 s56, s56, s3
s_sub_u32 s56, s56, 6
s_lshl_b32 s65, s56, 10
s_add_u32 s65, s65, 0x132000
s_mul_i32 s57, s56, 1821
s_lshr_b32 s57, s57, 16
s_mul_i32 s58, s57, 36
s_sub_u32 s58, s56, s58
s_mul_i32 s57, s57, 331776
s_lshl_b32 s58, s58, 5
s_add_u32 s57, s57, s58
s_add_u32 s57, s57, 18432
v_lshrrev_b32 v132, 1, v130
v_mul_u32_u24 v132, 18, v132
v_and_b32 v133, 1, v130
v_add_u32 v132, v132, v133
v_mul_u32_u24 v132, 1152, v132
v_lshl_add_u32 v132, v131, 4, v132
v_add_u32 v132, s57, v132
global_load_dwordx4 v[144:147], v132, s[12:13]
s_branch R2_end
R2_e:
s_cmp_ge_u32 s2, 225
s_cbranch_scc1 R2_end
s_sub_u32 s56, s2, 216
s_mul_i32 s56, s56, 6
s_add_u32 s56, s56, s3
s_sub_u32 s56, s56, 9
s_lshl_b32 s64, s56, 10
s_add_u32 s64, s64, 0x144000
s_mul_i32 s57, s56, 3641
s_lshr_b32 s57, s57, 16
s_mul_i32 s58, s57, 18
s_sub_u32 s58, s56, s58
s_mul_i32 s58, s58, 1152
v_mul_u32_u24 v132, 36, v130
s_cmp_eq_u32 s57, 2
s_cbranch_scc1 R2_e20
s_cmp_eq_u32 s57, 1
s_cselect_b32 s60, s10, s8
s_cselect_b32 s61, s11, s9
s_mov_b32 s57, s58
v_lshl_add_u32 v132, v131, 4, v132
v_add_u32 v132, s57, v132
global_load_dwordx4 v[136:139], v132, s[60:61]
s_branch R2_e30
R2_e20:
v_mov_b32 v136, 0
v_mov_b32 v137, 0
v_mov_b32 v138, 0
v_mov_b32 v139, 0
v_add_u32 v132, s58, v132
s_mov_b32 exec_lo, 0x55555555
s_mov_b32 exec_hi, 0x55555555
global_load_dword v136, v132, s[8:9] offset:32
global_load_dword v137, v132, s[10:11] offset:32
s_mov_b64 exec, -1
R2_e30:
s_sub_u32 s56, s2, 216
s_mul_i32 s56, s56, 6
s_add_u32 s56, s56, s3
s_sub_u32 s56, s56, 6
s_lshl_b32 s65, s56, 10
s_add_u32 s65, s65, 0x144000
s_mul_i32 s57, s56, 3641
s_lshr_b32 s57, s57, 16
s_mul_i32 s58, s57, 18
s_sub_u32 s58, s56, s58
s_mul_i32 s58, s58, 1152
v_mul_u32_u24 v132, 36, v130
s_cmp_eq_u32 s57, 2
s_cbranch_scc1 R2_e21
s_cmp_eq_u32 s57, 1
s_cselect_b32 s60, s10, s8
s_cselect_b32 s61, s11, s9
s_mov_b32 s57, s58
v_lshl_add_u32 v132, v131, 4, v132
v_add_u32 v132, s57, v132
global_load_dwordx4 v[144:147], v132, s[60:61]
s_branch R2_e31
R2_e21:
v_mov_b32 v144, 0
v_mov_b32 v145, 0
v_mov_b32 v146, 0
v_mov_b32 v147, 0
v_add_u32 v132, s58, v132
s_mov_b32 exec_lo, 0x55555555
s_mov_b32 exec_hi, 0x55555555
global_load_dword v144, v132, s[8:9] offset:32
global_load_dword v145, v132, s[10:11] offset:32
s_mov_b64 exec, -1
R2_e31:
R2_end:
s_barrier
s_waitcnt vmcnt(0)
s_cmp_eq_u32 s64, -1
s_cbranch_scc1 R2_stw90
s_sub_u32 s56, s3, 9
s_lshl_b32 s56, s56, 10
s_add_u32 s56, s56, 92432
v_lshl_add_u32 v132, v1, 4, s56
ds_write_b128 v132, v[136:139]
v_lshrrev_b32 v133, 4, v1
v_lshlrev_b32 v133, 8, v133
v_bfe_u32 v134, v1, 2, 2
v_lshl_add_u32 v133, v134, 5, v133
v_and_b32 v134, 3, v1
v_lshl_add_u32 v133, v134, 3, v133
v_add_u32 v133, s56, v133
s_waitcnt lgkmcnt(0)
ds_read_b64_tr_b16 v[140:141], v133
ds_read_b64_tr_b16 v[142:143], v133 offset:128
v_lshlrev_b32 v132, 4, v1
v_add_u32 v132, s64, v132
s_waitcnt lgkmcnt(0)
global_store_dwordx4 v132, v[140:143], s[30:31] sc1
R2_stw90:
s_cmp_eq_u32 s65, -1
s_cbranch_scc1 R2_stw91
s_sub_u32 s56, s3, 6
s_lshl_b32 s56, s56, 10
s_add_u32 s56, s56, 92432
v_lshl_add_u32 v132, v1, 4, s56
ds_write_b128 v132, v[144:147]
v_lshrrev_b32 v133, 4, v1
v_lshlrev_b32 v133, 8, v133
v_bfe_u32 v134, v1, 2, 2
v_lshl_add_u32 v133, v134, 5, v133
v_and_b32 v134, 3, v1
v_lshl_add_u32 v133, v134, 3, v133
v_add_u32 v133, s56, v133
s_waitcnt lgkmcnt(0)
ds_read_b64_tr_b16 v[148:149], v133
ds_read_b64_tr_b16 v[150:151], v133 offset:128
v_lshlrev_b32 v132, 4, v1
v_add_u32 v132, s65, v132
s_waitcnt lgkmcnt(0)
global_store_dwordx4 v132, v[148:151], s[30:31] sc1
R2_stw91:
v_mov_b32 v20, 0x3f803f80
v_mov_b32 v21, 0x3f803f80
s_lshr_b32 s40, s2, 1
s_mul_i32 s40, s40, 608
s_and_b32 s41, s2, 1
s_lshl_b32 s41, s41, 3
s_add_u32 s40, s40, s41
s_add_u32 s40, s40, 0x6b0120
v_mul_u32_u24 v23, 304, v1
v_add_u32 v23, s40, v23
s_mov_b64 exec, 3
global_store_dwordx2 v23, v[20:21], s[30:31] sc1
s_mov_b64 exec, -1
s_lshr_b32 s40, s2, 1
s_mul_i32 s40, s40, 608
s_and_b32 s41, s2, 1
s_lshl_b32 s41, s41, 3
s_add_u32 s40, s40, s41
s_add_u32 s40, s40, 0x6c4120
v_mul_u32_u24 v23, 304, v1
v_add_u32 v23, s40, v23
s_mov_b64 exec, 3
global_store_dwordx2 v23, v[20:21], s[30:31] sc1
s_mov_b64 exec, -1
s_branch PREP_nononce
s_cmp_lg_u32 s2, 0
s_cbranch_scc1 PREP_nononce
s_cmp_lg_u32 s3, 11
s_cbranch_scc1 PREP_nononce
s_memrealtime s[40:41]
s_waitcnt lgkmcnt(0)
s_or_b32 s40, s40, 0x100
v_mov_b32 v26, s40
v_mov_b32 v27, s41
v_mov_b32 v25, 7192576
s_mov_b64 exec, 1
global_store_dwordx2 v25, v[26:27], s[30:31] sc1
v_mov_b32 v25, 0
global_store_dwordx2 v25, v[26:27], s[28:29] sc1
s_mov_b64 exec, -1
PREP_nononce:
s_cmp_lg_u32 s3, 10
s_cbranch_scc1 PH_nskip
s_mov_b32 s52, 0
v_mov_b32 v120, 0
PH_np:
global_load_dwordx2 v[122:123], v120, s[28:29] sc1
s_waitcnt vmcnt(0)
v_cmp_eq_u32 vcc, 0, v122
s_cbranch_vccz PH_nok
s_add_u32 s52, s52, 1
s_cmp_gt_u32 s52, 20000
s_cbranch_scc1 PH_nok
s_branch PH_np
PH_nok:
v_mov_b32 v120, 158872
ds_write_b64 v120, v[122:123]
PH_nskip:
s_sub_u32 s41, s3, 9
s_mul_i32 s40, s41, 1168
s_add_u32 s40, s40, 98576
v_lshl_add_u32 v116, v1, 4, s40
ds_write_b128 v116, v[100:103]
s_mov_b64 exec, 0xff
ds_write_b128 v116, v[104:107] offset:1024
s_mov_b64 exec, -1
s_mul_i32 s41, s41, 1536
s_add_u32 s41, s41, 111424
v_lshl_add_u32 v117, v1, 4, s41
ds_write_b128 v117, v[108:111]
s_mov_b64 exec, 0xffffffff
ds_write_b128 v117, v[112:115] offset:1024
s_mov_b64 exec, -1
s_waitcnt lgkmcnt(0)
s_barrier
s_waitcnt vmcnt(0) lgkmcnt(0)
v_mov_b32 v120, 158864
v_mov_b32 v121, 1
v_mov_b32 v124, 158872
ds_read_b64 v[122:123], v124
s_mov_b64 exec, 1
ds_add_rtn_u32 v124, v120, v121
s_mov_b64 exec, -1
s_waitcnt lgkmcnt(0)
v_readfirstlane_b32 s50, v124
v_readfirstlane_b32 s14, v122
v_readfirstlane_b32 s15, v123
s_cmp_eq_u32 s50, 10
s_cbranch_scc0 ARR_b
s_add_u32 s60, s14, 48
s_and_b32 s61, s15, 0xffff
s_lshl_b32 s61, s61, 8
s_lshl_b32 s47, s2, 3
s_add_u32 s47, s47, 0x6f0000
s_mov_b64 exec, 0xff
v_mul_u32_u24 v120, 2048, v1
v_add_u32 v120, s47, v120
v_mov_b32 v122, s60
v_mov_b32 v123, s61
global_store_dwordx2 v120, v[122:123], s[30:31] sc1
s_mov_b64 exec, -1
ARR_b:
s_cmp_lt_u32 s2, 12
s_cselect_b32 s50, s2, -1
s_sub_u32 s51, s2, 192
s_cmp_lt_u32 s51, 6
s_cbranch_scc0 QS_a
s_add_u32 s50, s51, 12
QS_a:
s_cmp_eq_u32 s50, -1
s_cbranch_scc1 QS_skip
v_mov_b32 v120, 158896
v_mov_b32 v121, 1
s_mov_b64 exec, 1
ds_add_rtn_u32 v124, v120, v121
s_mov_b64 exec, -1
s_waitcnt lgkmcnt(0)
v_readfirstlane_b32 s51, v124
s_cmp_eq_u32 s51, 2
s_cbranch_scc0 QS_skip
s_add_u32 s60, s14, 96
s_and_b32 s61, s15, 0xffff
s_lshl_b32 s61, s61, 8
s_lshl_b32 s50, s50, 3
s_add_u32 s50, s50, 0x6db800
s_mov_b64 exec, 0xff
v_lshlrev_b32 v120, 8, v1
v_add_u32 v120, s50, v120
v_mov_b32 v122, s60
v_mov_b32 v123, s61
global_store_dwordx2 v120, v[122:123], s[30:31] sc1
s_mov_b64 exec, -1
QS_skip:
s_barrier
PREP_end:
s_branch PH_END
PH_END:
s_setprio 0
v_mbcnt_lo_u32_b32 v1, -1, 0
v_mbcnt_hi_u32_b32 v1, -1, v1
s_cmp_gt_u32 s3, 8
s_cbranch_scc1 PH_norc
s_waitcnt vmcnt(0) lgkmcnt(0)
v_mov_b32 v2, 158892
v_mov_b32 v3, 1
v_mov_b32 v6, 158872
ds_read_b64 v[8:9], v6
s_mov_b64 exec, 1
ds_add_rtn_u32 v4, v2, v3
s_mov_b64 exec, -1
s_waitcnt lgkmcnt(0)
v_readfirstlane_b32 s50, v4
v_readfirstlane_b32 s14, v8
v_readfirstlane_b32 s15, v9
s_cmp_eq_u32 s50, 8
s_cbranch_scc0 PH_norc
s_add_u32 s60, s14, 80
s_and_b32 s61, s15, 0xffff
s_lshl_b32 s61, s61, 8
s_lshl_b32 s47, s2, 3
s_add_u32 s47, s47, 0x6db000
v_mov_b32 v2, s47
v_mov_b32 v4, s60
v_mov_b32 v5, s61
s_mov_b64 exec, 1
global_store_dwordx2 v2, v[4:5], s[30:31] sc1
s_mov_b64 exec, -1
PH_norc:
s_mov_b32 s33, 0
s_mul_i32 s34, s33, 0x240000
s_add_u32 s34, s34, 0x200000
s_mul_i32 s35, s33, 0x10000
s_add_u32 s35, s35, 0x680000
s_mul_i32 s36, s33, 0x4000
s_add_u32 s36, s36, 0x6a0000
s_mul_i32 s37, s33, 0x14000
s_add_u32 s37, s37, 0x6b0000
s_mul_i32 s38, s33, 0x800
s_add_u32 s38, s38, 0x6d8000
s_mul_i32 s39, s33, 0x900000
s_add_u32 s39, s39, 0xe00000
s_cmp_eq_u32 s3, 8
s_cbranch_scc1 H0_ph0
s_cmp_eq_u32 s3, 9
s_cbranch_scc1 H1_ph0
s_cmp_eq_u32 s3, 10
s_cbranch_scc1 H2_ph0
s_cmp_eq_u32 s3, 11
s_cbranch_scc1 H3_ph0
PH_wait:
s_mov_b32 s33, 0
s_mul_i32 s34, s33, 0x240000
s_add_u32 s34, s34, 0x200000
s_mul_i32 s35, s33, 0x10000
s_add_u32 s35, s35, 0x680000
s_mul_i32 s36, s33, 0x4000
s_add_u32 s36, s36, 0x6a0000
s_mul_i32 s37, s33, 0x14000
s_add_u32 s37, s37, 0x6b0000
s_mul_i32 s38, s33, 0x800
s_add_u32 s38, s38, 0x6d8000
s_mul_i32 s39, s33, 0x900000
s_add_u32 s39, s39, 0xe00000
s_mov_b32 s52, 0
PH_gb_re:
v_mov_b32 v2, 158868
ds_read_b32 v3, v2
s_waitcnt lgkmcnt(0)
v_cmp_ne_u32 vcc, 1, v3
s_cbranch_vccz PH_gb_ok
s_add_u32 s52, s52, 1
s_cmp_gt_u32 s52, 200000
s_cbranch_scc1 PH_gb_ok
s_sleep 4
s_branch PH_gb_re
PH_gb_ok:
s_cmp_eq_u32 s3, 8
s_cbranch_scc1 L_h0
s_cmp_eq_u32 s3, 9
s_cbranch_scc1 L_h1
s_cmp_eq_u32 s3, 10
s_cbranch_scc1 L_h2
s_cmp_eq_u32 s3, 11
s_cbranch_scc1 L_h3
v_mov_b32 v157, 0
s_mov_b32 s52, 0
s_mov_b32 s60, 0x01010101
A_hi_re:
ds_read_b32 v160, v157 offset:528
s_waitcnt lgkmcnt(0)
v_cmp_ne_u32 vcc, s60, v160
s_cbranch_vccz A_hi_ok
s_add_u32 s52, s52, 1
s_cmp_gt_u32 s52, 200000
s_cbranch_scc1 A_hi_ok
s_sleep 1
s_branch A_hi_re
A_hi_ok:
A_kv:
v_mbcnt_lo_u32_b32 v165, -1, 0
v_mbcnt_hi_u32_b32 v165, -1, v165
s_lshl_b32 s50, s3, 13
s_add_u32 s50, s50, s35
s_add_u32 s54, s30, s50
s_addc_u32 s55, s31, 0
s_lshl_b32 s50, s3, 10
s_add_u32 s50, s50, s36
v_lshlrev_b32 v165, 4, v165
v_add_u32 v161, s50, v165
s_mul_i32 s50, s3, 9728
s_add_u32 s50, s50, s37
s_add_u32 s56, s30, s50
s_addc_u32 s57, s31, 0
s_mul_i32 s58, s3, 10240
s_add_u32 s58, s58, 59392
global_load_dwordx4 v[120:123], v161, s[30:31]
global_load_dwordx4 v[0:3], v165, s[54:55] offset:0
s_add_u32 m0, s58, 0
s_nop 0
global_load_lds_dwordx4 v165, s[56:57]
s_add_u32 m0, s58, 1024
s_add_u32 s56, s56, 1024
s_addc_u32 s57, s57, 0
global_load_lds_dwordx4 v165, s[56:57]
global_load_dwordx4 v[4:7], v165, s[54:55] offset:1024
s_add_u32 m0, s58, 2048
s_add_u32 s56, s56, 1024
s_addc_u32 s57, s57, 0
global_load_lds_dwordx4 v165, s[56:57]
global_load_dwordx4 v[8:11], v165, s[54:55] offset:2048
s_add_u32 m0, s58, 3072
s_add_u32 s56, s56, 1024
s_addc_u32 s57, s57, 0
global_load_lds_dwordx4 v165, s[56:57]
v_mov_b32 v162, s3
v_mov_b32 v160, 0x80
ds_write_b8 v162, v160 offset:512
v_lshrrev_b32 v166, 4, v165
s_mov_b32 s44, -1
s_mov_b32 s45, 0
s_mov_b32 s46, 0
s_mov_b32 s47, -1
s_mov_b32 s52, 0
s_lshr_b32 s59, s3, 2
v_mov_b32 v40, 0
v_mov_b32 v41, 0
v_mov_b32 v42, 0
v_mov_b32 v43, 0
v_mov_b32 v44, 0
v_mov_b32 v45, 0
v_mov_b32 v46, 0
v_mov_b32 v47, 0
v_mov_b32 v48, 0
v_mov_b32 v49, 0
v_mov_b32 v50, 0
v_mov_b32 v51, 0
v_mov_b32 v52, 0
v_mov_b32 v53, 0
v_mov_b32 v54, 0
v_mov_b32 v55, 0
v_mov_b32 v56, 0
v_mov_b32 v57, 0
v_mov_b32 v58, 0
v_mov_b32 v59, 0
v_mov_b32 v60, 0
v_mov_b32 v61, 0
v_mov_b32 v62, 0
v_mov_b32 v63, 0
v_mov_b32 v64, 0
v_mov_b32 v65, 0
v_mov_b32 v66, 0
v_mov_b32 v67, 0
v_mov_b32 v68, 0
v_mov_b32 v69, 0
v_mov_b32 v70, 0
v_mov_b32 v71, 0
v_mov_b32 v72, 0
v_mov_b32 v73, 0
v_mov_b32 v74, 0
v_mov_b32 v75, 0
v_mov_b32 v76, 0
v_mov_b32 v77, 0
v_mov_b32 v78, 0
v_mov_b32 v79, 0
v_mov_b32 v80, 0
v_mov_b32 v81, 0
v_mov_b32 v82, 0
v_mov_b32 v83, 0
v_mov_b32 v84, 0
v_mov_b32 v85, 0
v_mov_b32 v86, 0
v_mov_b32 v87, 0
v_mov_b32 v88, 0
v_mov_b32 v89, 0
v_mov_b32 v90, 0
v_mov_b32 v91, 0
v_mov_b32 v92, 0
v_mov_b32 v93, 0
v_mov_b32 v94, 0
v_mov_b32 v95, 0
v_mov_b32 v96, 0
v_mov_b32 v97, 0
v_mov_b32 v98, 0
v_mov_b32 v99, 0
v_mov_b32 v100, 0
v_mov_b32 v101, 0
v_mov_b32 v102, 0
v_mov_b32 v103, 0
v_and_b32 v163, 31, v166
v_min_u32 v163, 18, v163
v_lshlrev_b32 v163, 4, v163
v_lshrrev_b32 v160, 5, v166
v_mul_u32_u24 v161, 304, v160
v_add3_u32 v163, v163, v161, s58
s_mul_i32 s50, s3, 2560
s_add_u32 s50, s50, 38912
v_add_u32 v167, s50, v165
v_mul_u32_u24 v160, 504, v160
v_sub_u32 v164, v167, v160
v_and_b32 v166, 31, v166
v_lshlrev_b32 v166, 2, v166
v_mov_b32 v157, 0
v_mov_b32 v159, 0
v_mov_b32 v160, 0x3f803f80
A_g0_re:
ds_read_b32 v161, v157 offset:0
s_waitcnt lgkmcnt(0)
v_cmp_eq_u32 vcc, 0, v161
s_cbranch_vccz A_g0_ok
s_add_u32 s52, s52, 1
s_cmp_gt_u32 s52, 200000
s_cbranch_scc1 A_g0_ok
s_sleep 1
s_branch A_g0_re
A_g0_ok:
ds_read_b128 v[152:155], v165 offset:2048
ds_read_b32 v104, v166 offset:10240
s_waitcnt vmcnt(4)
v_mov_b32 v32, v120
v_mov_b32 v33, v160
v_mov_b32 v34, v121
v_mov_b32 v35, v160
v_mov_b32 v36, v122
v_mov_b32 v37, v160
v_mov_b32 v38, v123
v_mov_b32 v39, v160
s_mov_b32 exec_lo, 0x13ffff
s_mov_b32 exec_hi, 0x13ffff
ds_read_b128 v[40:43], v163 offset:0
ds_read_b128 v[44:47], v163 offset:608
s_mov_b64 exec, -1
v_cmp_ne_u32 vcc, 1, v161
s_mov_b32 s40, 0
s_waitcnt lgkmcnt(0)
v_cndmask_b32 v156, 0, v104, s[44:45]
v_cndmask_b32 v158, 0, v104, s[46:47]
s_cbranch_vccnz A_slow0
v_mfma_f32_32x32x16_bf16 v[104:119], v[0:3], v[152:155], 0
v_mfma_f32_32x32x8_bf16 v[104:119], v[32:33], v[156:157], v[104:119]
s_nop 11
global_load_dwordx4 v[12:15], v165, s[54:55] offset:3072
s_add_u32 m0, s58, 4096
s_add_u32 s56, s56, 1024
s_addc_u32 s57, s57, 0
global_load_lds_dwordx4 v165, s[56:57]
v_exp_f32 v104, v104
v_exp_f32 v105, v105
v_exp_f32 v106, v106
v_exp_f32 v107, v107
v_exp_f32 v108, v108
v_exp_f32 v109, v109
s_waitcnt vmcnt(4)
s_mov_b32 exec_lo, 0x13ffff
s_mov_b32 exec_hi, 0x13ffff
ds_read_b128 v[48:51], v163 offset:1216
ds_read_b128 v[52:55], v163 offset:1824
s_mov_b64 exec, -1
v_mfma_f32_32x32x16_bf16 v[120:135], v[4:7], v[152:155], 0
v_exp_f32 v110, v110
v_exp_f32 v111, v111
v_exp_f32 v112, v112
v_exp_f32 v113, v113
v_mfma_f32_32x32x8_bf16 v[120:135], v[32:33], v[158:159], v[120:135]
v_cvt_pk_bf16_f32 v104, v104, v105
v_cvt_pk_bf16_f32 v105, v106, v107
v_cvt_pk_bf16_f32 v106, v108, v109
v_cvt_pk_bf16_f32 v107, v110, v111
v_exp_f32 v114, v114
v_exp_f32 v115, v115
v_exp_f32 v116, v116
v_exp_f32 v117, v117
v_mfma_f32_32x32x16_bf16 v[136:151], v[40:43], v[104:107], 0
v_exp_f32 v118, v118
v_exp_f32 v119, v119
v_cvt_pk_bf16_f32 v108, v112, v113
v_cvt_pk_bf16_f32 v109, v114, v115
v_cvt_pk_bf16_f32 v110, v116, v117
v_cvt_pk_bf16_f32 v111, v118, v119
s_add_u32 s54, s54, 4096
s_addc_u32 s55, s55, 0
global_load_dwordx4 v[16:19], v165, s[54:55] offset:0
s_add_u32 m0, s58, 5120
s_add_u32 s56, s56, 1024
s_addc_u32 s57, s57, 0
global_load_lds_dwordx4 v165, s[56:57]
v_exp_f32 v120, v120
v_exp_f32 v121, v121
v_mfma_f32_32x32x16_bf16 v[136:151], v[44:47], v[108:111], v[136:151]
v_exp_f32 v122, v122
v_exp_f32 v123, v123
v_exp_f32 v124, v124
v_exp_f32 v125, v125
s_waitcnt vmcnt(4)
s_mov_b32 exec_lo, 0x13ffff
s_mov_b32 exec_hi, 0x13ffff
ds_read_b128 v[56:59], v163 offset:2432
ds_read_b128 v[60:63], v163 offset:3040
s_mov_b64 exec, -1
v_mfma_f32_32x32x16_bf16 v[104:119], v[8:11], v[152:155], 0
v_exp_f32 v126, v126
v_exp_f32 v127, v127
v_exp_f32 v128, v128
v_exp_f32 v129, v129
v_mfma_f32_32x32x8_bf16 v[104:119], v[34:35], v[156:157], v[104:119]
v_cvt_pk_bf16_f32 v120, v120, v121
v_cvt_pk_bf16_f32 v121, v122, v123
v_cvt_pk_bf16_f32 v122, v124, v125
v_cvt_pk_bf16_f32 v123, v126, v127
v_exp_f32 v130, v130
v_exp_f32 v131, v131
v_exp_f32 v132, v132
v_exp_f32 v133, v133
s_waitcnt lgkmcnt(2)
v_mfma_f32_32x32x16_bf16 v[136:151], v[48:51], v[120:123], v[136:151]
v_exp_f32 v134, v134
v_exp_f32 v135, v135
v_cvt_pk_bf16_f32 v124, v128, v129
v_cvt_pk_bf16_f32 v125, v130, v131
v_cvt_pk_bf16_f32 v126, v132, v133
v_cvt_pk_bf16_f32 v127, v134, v135
global_load_dwordx4 v[20:23], v165, s[54:55] offset:1024
s_add_u32 m0, s58, 6144
s_add_u32 s56, s56, 1024
s_addc_u32 s57, s57, 0
global_load_lds_dwordx4 v165, s[56:57]
s_add_u32 m0, s58, 7168
s_add_u32 s56, s56, 1024
s_addc_u32 s57, s57, 0
global_load_lds_dwordx4 v165, s[56:57]
v_exp_f32 v104, v104
v_exp_f32 v105, v105
v_mfma_f32_32x32x16_bf16 v[136:151], v[52:55], v[124:127], v[136:151]
v_exp_f32 v106, v106
v_exp_f32 v107, v107
v_exp_f32 v108, v108
v_exp_f32 v109, v109
s_waitcnt vmcnt(5)
s_mov_b32 exec_lo, 0x13ffff
s_mov_b32 exec_hi, 0x13ffff
ds_read_b128 v[64:67], v163 offset:3648
ds_read_b128 v[68:71], v163 offset:4256
s_mov_b64 exec, -1
v_mfma_f32_32x32x16_bf16 v[120:135], v[12:15], v[152:155], 0
v_exp_f32 v110, v110
v_exp_f32 v111, v111
v_exp_f32 v112, v112
v_exp_f32 v113, v113
v_mfma_f32_32x32x8_bf16 v[120:135], v[34:35], v[158:159], v[120:135]
v_cvt_pk_bf16_f32 v104, v104, v105
v_cvt_pk_bf16_f32 v105, v106, v107
v_cvt_pk_bf16_f32 v106, v108, v109
v_cvt_pk_bf16_f32 v107, v110, v111
v_exp_f32 v114, v114
v_exp_f32 v115, v115
v_exp_f32 v116, v116
v_exp_f32 v117, v117
s_waitcnt lgkmcnt(2)
v_mfma_f32_32x32x16_bf16 v[136:151], v[56:59], v[104:107], v[136:151]
v_exp_f32 v118, v118
v_exp_f32 v119, v119
v_cvt_pk_bf16_f32 v108, v112, v113
v_cvt_pk_bf16_f32 v109, v114, v115
v_cvt_pk_bf16_f32 v110, v116, v117
v_cvt_pk_bf16_f32 v111, v118, v119
global_load_dwordx4 v[24:27], v165, s[54:55] offset:2048
s_add_u32 m0, s58, 8192
s_add_u32 s56, s56, 1024
s_addc_u32 s57, s57, 0
global_load_lds_dwordx4 v165, s[56:57]
v_exp_f32 v120, v120
v_exp_f32 v121, v121
v_mfma_f32_32x32x16_bf16 v[136:151], v[60:63], v[108:111], v[136:151]
v_exp_f32 v122, v122
v_exp_f32 v123, v123
v_exp_f32 v124, v124
v_exp_f32 v125, v125
s_waitcnt vmcnt(5)
s_mov_b32 exec_lo, 0x13ffff
s_mov_b32 exec_hi, 0x13ffff
ds_read_b128 v[72:75], v163 offset:4864
ds_read_b128 v[76:79], v163 offset:5472
s_mov_b64 exec, -1
v_mfma_f32_32x32x16_bf16 v[104:119], v[16:19], v[152:155], 0
v_exp_f32 v126, v126
v_exp_f32 v127, v127
v_exp_f32 v128, v128
v_exp_f32 v129, v129
v_mfma_f32_32x32x8_bf16 v[104:119], v[36:37], v[156:157], v[104:119]
v_cvt_pk_bf16_f32 v120, v120, v121
v_cvt_pk_bf16_f32 v121, v122, v123
v_cvt_pk_bf16_f32 v122, v124, v125
v_cvt_pk_bf16_f32 v123, v126, v127
v_exp_f32 v130, v130
v_exp_f32 v131, v131
v_exp_f32 v132, v132
v_exp_f32 v133, v133
s_waitcnt lgkmcnt(2)
v_mfma_f32_32x32x16_bf16 v[136:151], v[64:67], v[120:123], v[136:151]
v_exp_f32 v134, v134
v_exp_f32 v135, v135
v_cvt_pk_bf16_f32 v124, v128, v129
v_cvt_pk_bf16_f32 v125, v130, v131
v_cvt_pk_bf16_f32 v126, v132, v133
v_cvt_pk_bf16_f32 v127, v134, v135
global_load_dwordx4 v[28:31], v165, s[54:55] offset:3072
s_add_u32 m0, s58, 9216
s_add_u32 s56, s56, 1024
s_addc_u32 s57, s57, 0
global_load_lds_dwordx4 v165, s[56:57]
v_exp_f32 v104, v104
v_exp_f32 v105, v105
v_mfma_f32_32x32x16_bf16 v[136:151], v[68:71], v[124:127], v[136:151]
v_exp_f32 v106, v106
v_exp_f32 v107, v107
v_exp_f32 v108, v108
v_exp_f32 v109, v109
s_waitcnt vmcnt(4)
s_mov_b32 exec_lo, 0x13ffff
s_mov_b32 exec_hi, 0x13ffff
ds_read_b128 v[80:83], v163 offset:6080
ds_read_b128 v[84:87], v163 offset:6688
s_mov_b64 exec, -1
v_mfma_f32_32x32x16_bf16 v[120:135], v[20:23], v[152:155], 0
v_exp_f32 v110, v110
v_exp_f32 v111, v111
v_exp_f32 v112, v112
v_exp_f32 v113, v113
v_mfma_f32_32x32x8_bf16 v[120:135], v[36:37], v[158:159], v[120:135]
v_cvt_pk_bf16_f32 v104, v104, v105
v_cvt_pk_bf16_f32 v105, v106, v107
v_cvt_pk_bf16_f32 v106, v108, v109
v_cvt_pk_bf16_f32 v107, v110, v111
v_exp_f32 v114, v114
v_exp_f32 v115, v115
v_exp_f32 v116, v116
v_exp_f32 v117, v117
s_waitcnt lgkmcnt(2)
v_mfma_f32_32x32x16_bf16 v[136:151], v[72:75], v[104:107], v[136:151]
v_exp_f32 v118, v118
v_exp_f32 v119, v119
v_cvt_pk_bf16_f32 v108, v112, v113
v_cvt_pk_bf16_f32 v109, v114, v115
v_cvt_pk_bf16_f32 v110, v116, v117
v_cvt_pk_bf16_f32 v111, v118, v119
v_exp_f32 v120, v120
v_exp_f32 v121, v121
v_mfma_f32_32x32x16_bf16 v[136:151], v[76:79], v[108:111], v[136:151]
v_exp_f32 v122, v122
v_exp_f32 v123, v123
v_exp_f32 v124, v124
v_exp_f32 v125, v125
s_waitcnt vmcnt(2)
s_mov_b32 exec_lo, 0x13ffff
s_mov_b32 exec_hi, 0x13ffff
ds_read_b128 v[88:91], v163 offset:7296
ds_read_b128 v[92:95], v163 offset:7904
s_mov_b64 exec, -1
v_mfma_f32_32x32x16_bf16 v[104:119], v[24:27], v[152:155], 0
v_exp_f32 v126, v126
v_exp_f32 v127, v127
v_exp_f32 v128, v128
v_exp_f32 v129, v129
v_mfma_f32_32x32x8_bf16 v[104:119], v[38:39], v[156:157], v[104:119]
v_cvt_pk_bf16_f32 v120, v120, v121
v_cvt_pk_bf16_f32 v121, v122, v123
v_cvt_pk_bf16_f32 v122, v124, v125
v_cvt_pk_bf16_f32 v123, v126, v127
v_exp_f32 v130, v130
ds_read_b64 v[160:161], v157 offset:8
v_exp_f32 v131, v131
v_exp_f32 v132, v132
v_exp_f32 v133, v133
s_waitcnt lgkmcnt(2)
v_mfma_f32_32x32x16_bf16 v[136:151], v[80:83], v[120:123], v[136:151]
v_exp_f32 v134, v134
v_exp_f32 v135, v135
v_cvt_pk_bf16_f32 v124, v128, v129
v_cvt_pk_bf16_f32 v125, v130, v131
v_cvt_pk_bf16_f32 v126, v132, v133
v_cvt_pk_bf16_f32 v127, v134, v135
v_exp_f32 v104, v104
v_exp_f32 v105, v105
v_mfma_f32_32x32x16_bf16 v[136:151], v[84:87], v[124:127], v[136:151]
v_exp_f32 v106, v106
s_waitcnt lgkmcnt(0)
v_exp_f32 v107, v107
v_lshl_add_u32 v160, v161, 2, v160
v_exp_f32 v108, v108
v_exp_f32 v109, v109
s_waitcnt vmcnt(0)
s_mov_b32 exec_lo, 0x13ffff
s_mov_b32 exec_hi, 0x13ffff
ds_read_b128 v[96:99], v163 offset:8512
ds_read_b128 v[100:103], v163 offset:9120
s_mov_b64 exec, -1
v_mfma_f32_32x32x16_bf16 v[120:135], v[28:31], v[152:155], 0
v_exp_f32 v110, v110
v_exp_f32 v111, v111
v_exp_f32 v112, v112
v_exp_f32 v113, v113
v_cmp_ne_u32 vcc, 5, v160
v_mfma_f32_32x32x8_bf16 v[120:135], v[38:39], v[158:159], v[120:135]
A_chk0:
s_cbranch_vccnz A_hand0
v_cvt_pk_bf16_f32 v104, v104, v105
v_cvt_pk_bf16_f32 v105, v106, v107
v_cvt_pk_bf16_f32 v106, v108, v109
v_cvt_pk_bf16_f32 v107, v110, v111
v_exp_f32 v114, v114
ds_read_b128 v[152:155], v165 offset:3072
v_exp_f32 v115, v115
ds_read_b32 v161, v166 offset:10368
v_exp_f32 v116, v116
v_exp_f32 v117, v117
s_waitcnt lgkmcnt(2)
v_mfma_f32_32x32x16_bf16 v[136:151], v[88:91], v[104:107], v[136:151]
v_exp_f32 v118, v118
v_exp_f32 v119, v119
v_cvt_pk_bf16_f32 v108, v112, v113
v_cvt_pk_bf16_f32 v109, v114, v115
v_cvt_pk_bf16_f32 v110, v116, v117
v_cvt_pk_bf16_f32 v111, v118, v119
v_exp_f32 v120, v120
v_exp_f32 v121, v121
s_waitcnt lgkmcnt(0)
v_mfma_f32_32x32x16_bf16 v[136:151], v[92:95], v[108:111], v[136:151]
v_exp_f32 v122, v122
v_cndmask_b32 v156, 0, v161, s[44:45]
v_exp_f32 v123, v123
v_cndmask_b32 v158, 0, v161, s[46:47]
v_exp_f32 v124, v124
v_exp_f32 v125, v125
v_mfma_f32_32x32x16_bf16 v[104:119], v[0:3], v[152:155], 0
v_exp_f32 v126, v126
v_exp_f32 v127, v127
v_exp_f32 v128, v128
v_exp_f32 v129, v129
v_mfma_f32_32x32x8_bf16 v[104:119], v[32:33], v[156:157], v[104:119]
v_cvt_pk_bf16_f32 v120, v120, v121
v_cvt_pk_bf16_f32 v121, v122, v123
v_cvt_pk_bf16_f32 v122, v124, v125
v_cvt_pk_bf16_f32 v123, v126, v127
v_exp_f32 v130, v130
v_exp_f32 v131, v131
v_exp_f32 v132, v132
v_exp_f32 v133, v133
s_waitcnt lgkmcnt(0)
v_mfma_f32_32x32x16_bf16 v[136:151], v[96:99], v[120:123], v[136:151]
v_xor_b32 v163, 4, v162
v_exp_f32 v134, v134
ds_write_b8 v162, v33 offset:520
v_exp_f32 v135, v135
v_cvt_pk_bf16_f32 v124, v128, v129
v_cvt_pk_bf16_f32 v125, v130, v131
v_cvt_pk_bf16_f32 v126, v132, v133
v_cvt_pk_bf16_f32 v127, v134, v135
v_exp_f32 v104, v104
ds_read_u8 v160, v163 offset:256
v_exp_f32 v105, v105
v_mfma_f32_32x32x16_bf16 v[136:151], v[100:103], v[124:127], v[136:151]
v_exp_f32 v106, v106
v_exp_f32 v107, v107
v_exp_f32 v108, v108
s_waitcnt lgkmcnt(0)
v_exp_f32 v109, v109
v_add_u32 v160, 0x80, v160
v_mfma_f32_32x32x16_bf16 v[120:135], v[4:7], v[152:155], 0
v_exp_f32 v110, v110
v_exp_f32 v111, v111
v_readfirstlane_b32 s50, v160
v_exp_f32 v112, v112
s_setprio 0
s_cmp_eq_u32 s50, 0
s_cbranch_scc1 A_dp1
s_setprio 1
s_cmp_eq_u32 s50, 0x80
s_cbranch_scc1 A_dp1
s_setprio 2
A_dp1:
v_exp_f32 v113, v113
v_mfma_f32_32x32x8_bf16 v[120:135], v[32:33], v[158:159], v[120:135]
v_cvt_pk_bf16_f32 v104, v104, v105
v_cvt_pk_bf16_f32 v105, v106, v107
v_cvt_pk_bf16_f32 v106, v108, v109
v_cvt_pk_bf16_f32 v107, v110, v111
v_exp_f32 v114, v114
ds_write_b128 v167, v[136:139] offset:0
v_exp_f32 v115, v115
ds_write_b128 v167, v[140:143] offset:1024
v_exp_f32 v116, v116
ds_write_b64 v164, v[144:145] offset:2048
v_exp_f32 v117, v117
ds_write_b8 v162, v33 offset:256
v_mfma_f32_32x32x16_bf16 v[136:151], v[40:43], v[104:107], 0
v_exp_f32 v118, v118
v_exp_f32 v119, v119
v_cvt_pk_bf16_f32 v108, v112, v113
v_cvt_pk_bf16_f32 v109, v114, v115
v_cvt_pk_bf16_f32 v110, v116, v117
v_cvt_pk_bf16_f32 v111, v118, v119
v_exp_f32 v120, v120
v_exp_f32 v121, v121
v_mfma_f32_32x32x16_bf16 v[136:151], v[44:47], v[108:111], v[136:151]
v_exp_f32 v122, v122
v_exp_f32 v123, v123
v_exp_f32 v124, v124
v_exp_f32 v125, v125
v_mfma_f32_32x32x16_bf16 v[104:119], v[8:11], v[152:155], 0
v_exp_f32 v126, v126
v_exp_f32 v127, v127
v_exp_f32 v128, v128
v_exp_f32 v129, v129
v_mfma_f32_32x32x8_bf16 v[104:119], v[34:35], v[156:157], v[104:119]
v_cvt_pk_bf16_f32 v120, v120, v121
v_cvt_pk_bf16_f32 v121, v122, v123
v_cvt_pk_bf16_f32 v122, v124, v125
v_cvt_pk_bf16_f32 v123, v126, v127
v_exp_f32 v130, v130
v_exp_f32 v131, v131
v_exp_f32 v132, v132
v_exp_f32 v133, v133
v_mfma_f32_32x32x16_bf16 v[136:151], v[48:51], v[120:123], v[136:151]
v_exp_f32 v134, v134
v_exp_f32 v135, v135
v_cvt_pk_bf16_f32 v124, v128, v129
v_cvt_pk_bf16_f32 v125, v130, v131
v_cvt_pk_bf16_f32 v126, v132, v133
v_cvt_pk_bf16_f32 v127, v134, v135
v_exp_f32 v104, v104
v_exp_f32 v105, v105
v_mfma_f32_32x32x16_bf16 v[136:151], v[52:55], v[124:127], v[136:151]
v_exp_f32 v106, v106
v_exp_f32 v107, v107
v_exp_f32 v108, v108
v_exp_f32 v109, v109
v_mfma_f32_32x32x16_bf16 v[120:135], v[12:15], v[152:155], 0
v_exp_f32 v110, v110
v_exp_f32 v111, v111
v_exp_f32 v112, v112
v_exp_f32 v113, v113
v_mfma_f32_32x32x8_bf16 v[120:135], v[34:35], v[158:159], v[120:135]
v_cvt_pk_bf16_f32 v104, v104, v105
v_cvt_pk_bf16_f32 v105, v106, v107
v_cvt_pk_bf16_f32 v106, v108, v109
v_cvt_pk_bf16_f32 v107, v110, v111
v_exp_f32 v114, v114
v_exp_f32 v115, v115
v_exp_f32 v116, v116
v_exp_f32 v117, v117
v_mfma_f32_32x32x16_bf16 v[136:151], v[56:59], v[104:107], v[136:151]
v_exp_f32 v118, v118
v_exp_f32 v119, v119
v_cvt_pk_bf16_f32 v108, v112, v113
v_cvt_pk_bf16_f32 v109, v114, v115
v_cvt_pk_bf16_f32 v110, v116, v117
v_cvt_pk_bf16_f32 v111, v118, v119
v_exp_f32 v120, v120
v_exp_f32 v121, v121
v_mfma_f32_32x32x16_bf16 v[136:151], v[60:63], v[108:111], v[136:151]
v_exp_f32 v122, v122
v_exp_f32 v123, v123
v_exp_f32 v124, v124
v_exp_f32 v125, v125
v_mfma_f32_32x32x16_bf16 v[104:119], v[16:19], v[152:155], 0
v_exp_f32 v126, v126
v_exp_f32 v127, v127
v_exp_f32 v128, v128
v_exp_f32 v129, v129
v_mfma_f32_32x32x8_bf16 v[104:119], v[36:37], v[156:157], v[104:119]
v_cvt_pk_bf16_f32 v120, v120, v121
v_cvt_pk_bf16_f32 v121, v122, v123
v_cvt_pk_bf16_f32 v122, v124, v125
v_cvt_pk_bf16_f32 v123, v126, v127
v_exp_f32 v130, v130
v_exp_f32 v131, v131
v_exp_f32 v132, v132
v_exp_f32 v133, v133
v_mfma_f32_32x32x16_bf16 v[136:151], v[64:67], v[120:123], v[136:151]
v_exp_f32 v134, v134
v_exp_f32 v135, v135
v_cvt_pk_bf16_f32 v124, v128, v129
v_cvt_pk_bf16_f32 v125, v130, v131
v_cvt_pk_bf16_f32 v126, v132, v133
v_cvt_pk_bf16_f32 v127, v134, v135
v_exp_f32 v104, v104
v_exp_f32 v105, v105
v_mfma_f32_32x32x16_bf16 v[136:151], v[68:71], v[124:127], v[136:151]
v_exp_f32 v106, v106
v_exp_f32 v107, v107
v_exp_f32 v108, v108
v_exp_f32 v109, v109
v_mfma_f32_32x32x16_bf16 v[120:135], v[20:23], v[152:155], 0
v_exp_f32 v110, v110
v_exp_f32 v111, v111
v_exp_f32 v112, v112
v_exp_f32 v113, v113
v_mfma_f32_32x32x8_bf16 v[120:135], v[36:37], v[158:159], v[120:135]
v_cvt_pk_bf16_f32 v104, v104, v105
v_cvt_pk_bf16_f32 v105, v106, v107
v_cvt_pk_bf16_f32 v106, v108, v109
v_cvt_pk_bf16_f32 v107, v110, v111
v_exp_f32 v114, v114
v_exp_f32 v115, v115
v_exp_f32 v116, v116
v_exp_f32 v117, v117
v_mfma_f32_32x32x16_bf16 v[136:151], v[72:75], v[104:107], v[136:151]
v_exp_f32 v118, v118
v_exp_f32 v119, v119
v_cvt_pk_bf16_f32 v108, v112, v113
v_cvt_pk_bf16_f32 v109, v114, v115
v_cvt_pk_bf16_f32 v110, v116, v117
v_cvt_pk_bf16_f32 v111, v118, v119
v_exp_f32 v120, v120
v_exp_f32 v121, v121
v_mfma_f32_32x32x16_bf16 v[136:151], v[76:79], v[108:111], v[136:151]
v_exp_f32 v122, v122
v_exp_f32 v123, v123
v_exp_f32 v124, v124
v_exp_f32 v125, v125
v_mfma_f32_32x32x16_bf16 v[104:119], v[24:27], v[152:155], 0
v_exp_f32 v126, v126
v_exp_f32 v127, v127
v_exp_f32 v128, v128
v_exp_f32 v129, v129
v_mfma_f32_32x32x8_bf16 v[104:119], v[38:39], v[156:157], v[104:119]
v_cvt_pk_bf16_f32 v120, v120, v121
v_cvt_pk_bf16_f32 v121, v122, v123
v_cvt_pk_bf16_f32 v122, v124, v125
v_cvt_pk_bf16_f32 v123, v126, v127
v_exp_f32 v130, v130
ds_read_b64 v[160:161], v157 offset:16
v_exp_f32 v131, v131
v_exp_f32 v132, v132
v_exp_f32 v133, v133
v_mfma_f32_32x32x16_bf16 v[136:151], v[80:83], v[120:123], v[136:151]
v_exp_f32 v134, v134
v_exp_f32 v135, v135
v_cvt_pk_bf16_f32 v124, v128, v129
v_cvt_pk_bf16_f32 v125, v130, v131
v_cvt_pk_bf16_f32 v126, v132, v133
v_cvt_pk_bf16_f32 v127, v134, v135
v_exp_f32 v104, v104
v_exp_f32 v105, v105
v_mfma_f32_32x32x16_bf16 v[136:151], v[84:87], v[124:127], v[136:151]
v_exp_f32 v106, v106
s_waitcnt lgkmcnt(0)
v_exp_f32 v107, v107
v_lshl_add_u32 v160, v161, 2, v160
v_exp_f32 v108, v108
v_exp_f32 v109, v109
v_mfma_f32_32x32x16_bf16 v[120:135], v[28:31], v[152:155], 0
v_exp_f32 v110, v110
v_exp_f32 v111, v111
v_exp_f32 v112, v112
v_exp_f32 v113, v113
v_cmp_ne_u32 vcc, 5, v160
v_mfma_f32_32x32x8_bf16 v[120:135], v[38:39], v[158:159], v[120:135]
A_chk1:
s_cbranch_vccnz A_hand1
v_cvt_pk_bf16_f32 v104, v104, v105
v_cvt_pk_bf16_f32 v105, v106, v107
v_cvt_pk_bf16_f32 v106, v108, v109
v_cvt_pk_bf16_f32 v107, v110, v111
v_exp_f32 v114, v114
ds_read_b128 v[152:155], v165 offset:4096
v_exp_f32 v115, v115
ds_read_b32 v161, v166 offset:10496
v_exp_f32 v116, v116
v_exp_f32 v117, v117
v_mfma_f32_32x32x16_bf16 v[136:151], v[88:91], v[104:107], v[136:151]
v_exp_f32 v118, v118
v_exp_f32 v119, v119
v_cvt_pk_bf16_f32 v108, v112, v113
v_cvt_pk_bf16_f32 v109, v114, v115
v_cvt_pk_bf16_f32 v110, v116, v117
v_cvt_pk_bf16_f32 v111, v118, v119
v_exp_f32 v120, v120
v_exp_f32 v121, v121
s_waitcnt lgkmcnt(0)
v_mfma_f32_32x32x16_bf16 v[136:151], v[92:95], v[108:111], v[136:151]
v_exp_f32 v122, v122
v_cndmask_b32 v156, 0, v161, s[44:45]
v_exp_f32 v123, v123
v_cndmask_b32 v158, 0, v161, s[46:47]
v_exp_f32 v124, v124
v_exp_f32 v125, v125
v_mfma_f32_32x32x16_bf16 v[104:119], v[0:3], v[152:155], 0
v_exp_f32 v126, v126
v_exp_f32 v127, v127
v_exp_f32 v128, v128
v_exp_f32 v129, v129
v_mfma_f32_32x32x8_bf16 v[104:119], v[32:33], v[156:157], v[104:119]
v_cvt_pk_bf16_f32 v120, v120, v121
v_cvt_pk_bf16_f32 v121, v122, v123
v_cvt_pk_bf16_f32 v122, v124, v125
v_cvt_pk_bf16_f32 v123, v126, v127
v_exp_f32 v130, v130
v_exp_f32 v131, v131
v_exp_f32 v132, v132
v_exp_f32 v133, v133
v_mfma_f32_32x32x16_bf16 v[136:151], v[96:99], v[120:123], v[136:151]
v_exp_f32 v134, v134
v_exp_f32 v135, v135
v_cvt_pk_bf16_f32 v124, v128, v129
v_cvt_pk_bf16_f32 v125, v130, v131
v_cvt_pk_bf16_f32 v126, v132, v133
v_cvt_pk_bf16_f32 v127, v134, v135
v_exp_f32 v104, v104
ds_read_u8 v160, v163 offset:264
v_exp_f32 v105, v105
ds_read_u8 v161, v163 offset:256
v_mfma_f32_32x32x16_bf16 v[136:151], v[100:103], v[124:127], v[136:151]
v_exp_f32 v106, v106
v_exp_f32 v107, v107
v_exp_f32 v108, v108
s_waitcnt lgkmcnt(0)
v_exp_f32 v109, v109
v_add_u32 v160, v160, v161
v_mfma_f32_32x32x16_bf16 v[120:135], v[4:7], v[152:155], 0
v_exp_f32 v110, v110
v_exp_f32 v111, v111
v_readfirstlane_b32 s50, v160
v_exp_f32 v112, v112
s_setprio 0
s_cmp_eq_u32 s50, 0
s_cbranch_scc1 A_dp2
s_setprio 1
s_cmp_eq_u32 s50, 0x80
s_cbranch_scc1 A_dp2
s_setprio 2
A_dp2:
v_exp_f32 v113, v113
v_mfma_f32_32x32x8_bf16 v[120:135], v[32:33], v[158:159], v[120:135]
v_cvt_pk_bf16_f32 v104, v104, v105
v_cvt_pk_bf16_f32 v105, v106, v107
v_cvt_pk_bf16_f32 v106, v108, v109
v_cvt_pk_bf16_f32 v107, v110, v111
v_exp_f32 v114, v114
ds_write_b128 v167, v[136:139] offset:20480
v_exp_f32 v115, v115
ds_write_b128 v167, v[140:143] offset:21504
v_exp_f32 v116, v116
ds_write_b64 v164, v[144:145] offset:22528
v_exp_f32 v117, v117
ds_write_b8 v162, v33 offset:264
v_mfma_f32_32x32x16_bf16 v[136:151], v[40:43], v[104:107], 0
v_exp_f32 v118, v118
v_exp_f32 v119, v119
v_cvt_pk_bf16_f32 v108, v112, v113
v_cvt_pk_bf16_f32 v109, v114, v115
v_cvt_pk_bf16_f32 v110, v116, v117
v_cvt_pk_bf16_f32 v111, v118, v119
v_exp_f32 v120, v120
v_exp_f32 v121, v121
v_mfma_f32_32x32x16_bf16 v[136:151], v[44:47], v[108:111], v[136:151]
v_exp_f32 v122, v122
v_exp_f32 v123, v123
v_exp_f32 v124, v124
v_exp_f32 v125, v125
v_mfma_f32_32x32x16_bf16 v[104:119], v[8:11], v[152:155], 0
v_exp_f32 v126, v126
v_exp_f32 v127, v127
v_exp_f32 v128, v128
v_exp_f32 v129, v129
v_mfma_f32_32x32x8_bf16 v[104:119], v[34:35], v[156:157], v[104:119]
v_cvt_pk_bf16_f32 v120, v120, v121
v_cvt_pk_bf16_f32 v121, v122, v123
v_cvt_pk_bf16_f32 v122, v124, v125
v_cvt_pk_bf16_f32 v123, v126, v127
v_exp_f32 v130, v130
v_exp_f32 v131, v131
v_exp_f32 v132, v132
v_exp_f32 v133, v133
v_mfma_f32_32x32x16_bf16 v[136:151], v[48:51], v[120:123], v[136:151]
v_exp_f32 v134, v134
v_exp_f32 v135, v135
v_cvt_pk_bf16_f32 v124, v128, v129
v_cvt_pk_bf16_f32 v125, v130, v131
v_cvt_pk_bf16_f32 v126, v132, v133
v_cvt_pk_bf16_f32 v127, v134, v135
v_exp_f32 v104, v104
v_exp_f32 v105, v105
v_mfma_f32_32x32x16_bf16 v[136:151], v[52:55], v[124:127], v[136:151]
v_exp_f32 v106, v106
v_exp_f32 v107, v107
v_exp_f32 v108, v108
v_exp_f32 v109, v109
v_mfma_f32_32x32x16_bf16 v[120:135], v[12:15], v[152:155], 0
v_exp_f32 v110, v110
v_exp_f32 v111, v111
v_exp_f32 v112, v112
v_exp_f32 v113, v113
v_mfma_f32_32x32x8_bf16 v[120:135], v[34:35], v[158:159], v[120:135]
v_cvt_pk_bf16_f32 v104, v104, v105
v_cvt_pk_bf16_f32 v105, v106, v107
v_cvt_pk_bf16_f32 v106, v108, v109
v_cvt_pk_bf16_f32 v107, v110, v111
v_exp_f32 v114, v114
v_exp_f32 v115, v115
v_exp_f32 v116, v116
v_exp_f32 v117, v117
v_mfma_f32_32x32x16_bf16 v[136:151], v[56:59], v[104:107], v[136:151]
v_exp_f32 v118, v118
v_exp_f32 v119, v119
v_cvt_pk_bf16_f32 v108, v112, v113
v_cvt_pk_bf16_f32 v109, v114, v115
v_cvt_pk_bf16_f32 v110, v116, v117
v_cvt_pk_bf16_f32 v111, v118, v119
v_exp_f32 v120, v120
v_exp_f32 v121, v121
v_mfma_f32_32x32x16_bf16 v[136:151], v[60:63], v[108:111], v[136:151]
v_exp_f32 v122, v122
v_exp_f32 v123, v123
v_exp_f32 v124, v124
v_exp_f32 v125, v125
v_mfma_f32_32x32x16_bf16 v[104:119], v[16:19], v[152:155], 0
v_exp_f32 v126, v126
v_exp_f32 v127, v127
v_exp_f32 v128, v128
v_exp_f32 v129, v129
v_mfma_f32_32x32x8_bf16 v[104:119], v[36:37], v[156:157], v[104:119]
v_cvt_pk_bf16_f32 v120, v120, v121
v_cvt_pk_bf16_f32 v121, v122, v123
v_cvt_pk_bf16_f32 v122, v124, v125
v_cvt_pk_bf16_f32 v123, v126, v127
v_exp_f32 v130, v130
v_exp_f32 v131, v131
v_exp_f32 v132, v132
v_exp_f32 v133, v133
v_mfma_f32_32x32x16_bf16 v[136:151], v[64:67], v[120:123], v[136:151]
v_exp_f32 v134, v134
v_exp_f32 v135, v135
v_cvt_pk_bf16_f32 v124, v128, v129
v_cvt_pk_bf16_f32 v125, v130, v131
v_cvt_pk_bf16_f32 v126, v132, v133
v_cvt_pk_bf16_f32 v127, v134, v135
v_exp_f32 v104, v104
v_exp_f32 v105, v105
v_mfma_f32_32x32x16_bf16 v[136:151], v[68:71], v[124:127], v[136:151]
v_exp_f32 v106, v106
v_exp_f32 v107, v107
v_exp_f32 v108, v108
v_exp_f32 v109, v109
v_mfma_f32_32x32x16_bf16 v[120:135], v[20:23], v[152:155], 0
v_exp_f32 v110, v110
v_exp_f32 v111, v111
v_exp_f32 v112, v112
v_exp_f32 v113, v113
v_mfma_f32_32x32x8_bf16 v[120:135], v[36:37], v[158:159], v[120:135]
v_cvt_pk_bf16_f32 v104, v104, v105
v_cvt_pk_bf16_f32 v105, v106, v107
v_cvt_pk_bf16_f32 v106, v108, v109
v_cvt_pk_bf16_f32 v107, v110, v111
v_exp_f32 v114, v114
v_exp_f32 v115, v115
v_exp_f32 v116, v116
v_exp_f32 v117, v117
v_mfma_f32_32x32x16_bf16 v[136:151], v[72:75], v[104:107], v[136:151]
v_exp_f32 v118, v118
v_exp_f32 v119, v119
v_cvt_pk_bf16_f32 v108, v112, v113
v_cvt_pk_bf16_f32 v109, v114, v115
v_cvt_pk_bf16_f32 v110, v116, v117
v_cvt_pk_bf16_f32 v111, v118, v119
v_exp_f32 v120, v120
v_exp_f32 v121, v121
v_mfma_f32_32x32x16_bf16 v[136:151], v[76:79], v[108:111], v[136:151]
v_exp_f32 v122, v122
v_exp_f32 v123, v123
v_exp_f32 v124, v124
v_exp_f32 v125, v125
v_mfma_f32_32x32x16_bf16 v[104:119], v[24:27], v[152:155], 0
v_exp_f32 v126, v126
v_exp_f32 v127, v127
v_exp_f32 v128, v128
v_exp_f32 v129, v129
v_mfma_f32_32x32x8_bf16 v[104:119], v[38:39], v[156:157], v[104:119]
v_cvt_pk_bf16_f32 v120, v120, v121
v_cvt_pk_bf16_f32 v121, v122, v123
v_cvt_pk_bf16_f32 v122, v124, v125
v_cvt_pk_bf16_f32 v123, v126, v127
v_exp_f32 v130, v130
ds_read_b64 v[160:161], v157 offset:24
v_exp_f32 v131, v131
v_exp_f32 v132, v132
v_exp_f32 v133, v133
v_mfma_f32_32x32x16_bf16 v[136:151], v[80:83], v[120:123], v[136:151]
v_exp_f32 v134, v134
v_exp_f32 v135, v135
v_cvt_pk_bf16_f32 v124, v128, v129
v_cvt_pk_bf16_f32 v125, v130, v131
v_cvt_pk_bf16_f32 v126, v132, v133
v_cvt_pk_bf16_f32 v127, v134, v135
v_exp_f32 v104, v104
v_exp_f32 v105, v105
v_mfma_f32_32x32x16_bf16 v[136:151], v[84:87], v[124:127], v[136:151]
v_exp_f32 v106, v106
s_waitcnt lgkmcnt(0)
v_exp_f32 v107, v107
v_lshl_add_u32 v160, v161, 2, v160
v_exp_f32 v108, v108
v_exp_f32 v109, v109
v_mfma_f32_32x32x16_bf16 v[120:135], v[28:31], v[152:155], 0
v_exp_f32 v110, v110
v_exp_f32 v111, v111
v_exp_f32 v112, v112
v_exp_f32 v113, v113
v_cmp_ne_u32 vcc, 5, v160
v_mfma_f32_32x32x8_bf16 v[120:135], v[38:39], v[158:159], v[120:135]
A_chk2:
s_cbranch_vccnz A_hand2
v_cvt_pk_bf16_f32 v104, v104, v105
v_cvt_pk_bf16_f32 v105, v106, v107
v_cvt_pk_bf16_f32 v106, v108, v109
v_cvt_pk_bf16_f32 v107, v110, v111
v_exp_f32 v114, v114
ds_read_b128 v[152:155], v165 offset:5120
v_exp_f32 v115, v115
ds_read_b32 v161, v166 offset:10624
v_exp_f32 v116, v116
v_exp_f32 v117, v117
v_mfma_f32_32x32x16_bf16 v[136:151], v[88:91], v[104:107], v[136:151]
v_exp_f32 v118, v118
v_exp_f32 v119, v119
v_cvt_pk_bf16_f32 v108, v112, v113
v_cvt_pk_bf16_f32 v109, v114, v115
v_cvt_pk_bf16_f32 v110, v116, v117
v_cvt_pk_bf16_f32 v111, v118, v119
v_exp_f32 v120, v120
v_exp_f32 v121, v121
s_waitcnt lgkmcnt(0)
v_mfma_f32_32x32x16_bf16 v[136:151], v[92:95], v[108:111], v[136:151]
v_exp_f32 v122, v122
v_cndmask_b32 v156, 0, v161, s[44:45]
v_exp_f32 v123, v123
v_cndmask_b32 v158, 0, v161, s[46:47]
v_exp_f32 v124, v124
v_exp_f32 v125, v125
v_mfma_f32_32x32x16_bf16 v[104:119], v[0:3], v[152:155], 0
v_exp_f32 v126, v126
v_exp_f32 v127, v127
v_exp_f32 v128, v128
v_exp_f32 v129, v129
v_mfma_f32_32x32x8_bf16 v[104:119], v[32:33], v[156:157], v[104:119]
v_cvt_pk_bf16_f32 v120, v120, v121
v_cvt_pk_bf16_f32 v121, v122, v123
v_cvt_pk_bf16_f32 v122, v124, v125
v_cvt_pk_bf16_f32 v123, v126, v127
v_exp_f32 v130, v130
v_exp_f32 v131, v131
v_exp_f32 v132, v132
v_exp_f32 v133, v133
v_mfma_f32_32x32x16_bf16 v[136:151], v[96:99], v[120:123], v[136:151]
v_exp_f32 v134, v134
v_exp_f32 v135, v135
v_cvt_pk_bf16_f32 v124, v128, v129
v_cvt_pk_bf16_f32 v125, v130, v131
v_cvt_pk_bf16_f32 v126, v132, v133
v_cvt_pk_bf16_f32 v127, v134, v135
v_exp_f32 v104, v104
ds_read_u8 v160, v163 offset:272
v_exp_f32 v105, v105
ds_read_u8 v161, v163 offset:264
v_mfma_f32_32x32x16_bf16 v[136:151], v[100:103], v[124:127], v[136:151]
v_exp_f32 v106, v106
v_exp_f32 v107, v107
v_exp_f32 v108, v108
s_waitcnt lgkmcnt(0)
v_exp_f32 v109, v109
v_add_u32 v160, v160, v161
v_mfma_f32_32x32x16_bf16 v[120:135], v[4:7], v[152:155], 0
v_exp_f32 v110, v110
v_exp_f32 v111, v111
v_readfirstlane_b32 s50, v160
v_exp_f32 v112, v112
s_setprio 0
s_cmp_eq_u32 s50, 0
s_cbranch_scc1 A_dp3
s_setprio 1
s_cmp_eq_u32 s50, 0x80
s_cbranch_scc1 A_dp3
s_setprio 2
A_dp3:
v_exp_f32 v113, v113
v_mfma_f32_32x32x8_bf16 v[120:135], v[32:33], v[158:159], v[120:135]
v_cvt_pk_bf16_f32 v104, v104, v105
v_cvt_pk_bf16_f32 v105, v106, v107
v_cvt_pk_bf16_f32 v106, v108, v109
v_cvt_pk_bf16_f32 v107, v110, v111
v_exp_f32 v114, v114
ds_write_b128 v167, v[136:139] offset:40960
v_exp_f32 v115, v115
ds_write_b128 v167, v[140:143] offset:41984
v_exp_f32 v116, v116
ds_write_b64 v164, v[144:145] offset:43008
v_exp_f32 v117, v117
ds_write_b8 v162, v33 offset:272
v_mfma_f32_32x32x16_bf16 v[136:151], v[40:43], v[104:107], 0
v_exp_f32 v118, v118
v_exp_f32 v119, v119
v_cvt_pk_bf16_f32 v108, v112, v113
v_cvt_pk_bf16_f32 v109, v114, v115
v_cvt_pk_bf16_f32 v110, v116, v117
v_cvt_pk_bf16_f32 v111, v118, v119
v_exp_f32 v120, v120
v_exp_f32 v121, v121
v_mfma_f32_32x32x16_bf16 v[136:151], v[44:47], v[108:111], v[136:151]
v_exp_f32 v122, v122
v_exp_f32 v123, v123
v_exp_f32 v124, v124
v_exp_f32 v125, v125
v_mfma_f32_32x32x16_bf16 v[104:119], v[8:11], v[152:155], 0
v_exp_f32 v126, v126
v_exp_f32 v127, v127
v_exp_f32 v128, v128
v_exp_f32 v129, v129
v_mfma_f32_32x32x8_bf16 v[104:119], v[34:35], v[156:157], v[104:119]
v_cvt_pk_bf16_f32 v120, v120, v121
v_cvt_pk_bf16_f32 v121, v122, v123
v_cvt_pk_bf16_f32 v122, v124, v125
v_cvt_pk_bf16_f32 v123, v126, v127
v_exp_f32 v130, v130
v_exp_f32 v131, v131
v_exp_f32 v132, v132
v_exp_f32 v133, v133
v_mfma_f32_32x32x16_bf16 v[136:151], v[48:51], v[120:123], v[136:151]
v_exp_f32 v134, v134
v_exp_f32 v135, v135
v_cvt_pk_bf16_f32 v124, v128, v129
v_cvt_pk_bf16_f32 v125, v130, v131
v_cvt_pk_bf16_f32 v126, v132, v133
v_cvt_pk_bf16_f32 v127, v134, v135
v_exp_f32 v104, v104
v_exp_f32 v105, v105
v_mfma_f32_32x32x16_bf16 v[136:151], v[52:55], v[124:127], v[136:151]
v_exp_f32 v106, v106
v_exp_f32 v107, v107
v_exp_f32 v108, v108
v_exp_f32 v109, v109
v_mfma_f32_32x32x16_bf16 v[120:135], v[12:15], v[152:155], 0
v_exp_f32 v110, v110
v_exp_f32 v111, v111
v_exp_f32 v112, v112
v_exp_f32 v113, v113
v_mfma_f32_32x32x8_bf16 v[120:135], v[34:35], v[158:159], v[120:135]
v_cvt_pk_bf16_f32 v104, v104, v105
v_cvt_pk_bf16_f32 v105, v106, v107
v_cvt_pk_bf16_f32 v106, v108, v109
v_cvt_pk_bf16_f32 v107, v110, v111
v_exp_f32 v114, v114
v_exp_f32 v115, v115
v_exp_f32 v116, v116
v_exp_f32 v117, v117
v_mfma_f32_32x32x16_bf16 v[136:151], v[56:59], v[104:107], v[136:151]
v_exp_f32 v118, v118
v_exp_f32 v119, v119
v_cvt_pk_bf16_f32 v108, v112, v113
v_cvt_pk_bf16_f32 v109, v114, v115
v_cvt_pk_bf16_f32 v110, v116, v117
v_cvt_pk_bf16_f32 v111, v118, v119
v_exp_f32 v120, v120
v_exp_f32 v121, v121
v_mfma_f32_32x32x16_bf16 v[136:151], v[60:63], v[108:111], v[136:151]
v_exp_f32 v122, v122
v_exp_f32 v123, v123
v_exp_f32 v124, v124
v_exp_f32 v125, v125
v_mfma_f32_32x32x16_bf16 v[104:119], v[16:19], v[152:155], 0
v_exp_f32 v126, v126
v_exp_f32 v127, v127
v_exp_f32 v128, v128
v_exp_f32 v129, v129
v_mfma_f32_32x32x8_bf16 v[104:119], v[36:37], v[156:157], v[104:119]
v_cvt_pk_bf16_f32 v120, v120, v121
v_cvt_pk_bf16_f32 v121, v122, v123
v_cvt_pk_bf16_f32 v122, v124, v125
v_cvt_pk_bf16_f32 v123, v126, v127
v_exp_f32 v130, v130
v_exp_f32 v131, v131
v_exp_f32 v132, v132
v_exp_f32 v133, v133
v_mfma_f32_32x32x16_bf16 v[136:151], v[64:67], v[120:123], v[136:151]
v_exp_f32 v134, v134
v_exp_f32 v135, v135
v_cvt_pk_bf16_f32 v124, v128, v129
v_cvt_pk_bf16_f32 v125, v130, v131
v_cvt_pk_bf16_f32 v126, v132, v133
v_cvt_pk_bf16_f32 v127, v134, v135
v_exp_f32 v104, v104
v_exp_f32 v105, v105
v_mfma_f32_32x32x16_bf16 v[136:151], v[68:71], v[124:127], v[136:151]
v_exp_f32 v106, v106
v_exp_f32 v107, v107
v_exp_f32 v108, v108
v_exp_f32 v109, v109
v_mfma_f32_32x32x16_bf16 v[120:135], v[20:23], v[152:155], 0
v_exp_f32 v110, v110
v_exp_f32 v111, v111
v_exp_f32 v112, v112
v_exp_f32 v113, v113
v_mfma_f32_32x32x8_bf16 v[120:135], v[36:37], v[158:159], v[120:135]
v_cvt_pk_bf16_f32 v104, v104, v105
v_cvt_pk_bf16_f32 v105, v106, v107
v_cvt_pk_bf16_f32 v106, v108, v109
v_cvt_pk_bf16_f32 v107, v110, v111
v_exp_f32 v114, v114
v_exp_f32 v115, v115
v_exp_f32 v116, v116
v_exp_f32 v117, v117
v_mfma_f32_32x32x16_bf16 v[136:151], v[72:75], v[104:107], v[136:151]
v_exp_f32 v118, v118
v_exp_f32 v119, v119
v_cvt_pk_bf16_f32 v108, v112, v113
v_cvt_pk_bf16_f32 v109, v114, v115
v_cvt_pk_bf16_f32 v110, v116, v117
v_cvt_pk_bf16_f32 v111, v118, v119
v_exp_f32 v120, v120
v_exp_f32 v121, v121
v_mfma_f32_32x32x16_bf16 v[136:151], v[76:79], v[108:111], v[136:151]
v_exp_f32 v122, v122
v_exp_f32 v123, v123
v_exp_f32 v124, v124
v_exp_f32 v125, v125
v_mfma_f32_32x32x16_bf16 v[104:119], v[24:27], v[152:155], 0
v_exp_f32 v126, v126
v_exp_f32 v127, v127
v_exp_f32 v128, v128
v_exp_f32 v129, v129
v_mfma_f32_32x32x8_bf16 v[104:119], v[38:39], v[156:157], v[104:119]
v_cvt_pk_bf16_f32 v120, v120, v121
v_cvt_pk_bf16_f32 v121, v122, v123
v_cvt_pk_bf16_f32 v122, v124, v125
v_cvt_pk_bf16_f32 v123, v126, v127
v_exp_f32 v130, v130
ds_read_b64 v[160:161], v157 offset:32
v_exp_f32 v131, v131
v_exp_f32 v132, v132
v_exp_f32 v133, v133
v_mfma_f32_32x32x16_bf16 v[136:151], v[80:83], v[120:123], v[136:151]
v_exp_f32 v134, v134
v_exp_f32 v135, v135
v_cvt_pk_bf16_f32 v124, v128, v129
v_cvt_pk_bf16_f32 v125, v130, v131
v_cvt_pk_bf16_f32 v126, v132, v133
v_cvt_pk_bf16_f32 v127, v134, v135
v_exp_f32 v104, v104
v_exp_f32 v105, v105
v_mfma_f32_32x32x16_bf16 v[136:151], v[84:87], v[124:127], v[136:151]
v_exp_f32 v106, v106
s_waitcnt lgkmcnt(0)
v_exp_f32 v107, v107
v_lshl_add_u32 v160, v161, 2, v160
v_exp_f32 v108, v108
v_exp_f32 v109, v109
v_mfma_f32_32x32x16_bf16 v[120:135], v[28:31], v[152:155], 0
v_exp_f32 v110, v110
v_exp_f32 v111, v111
v_exp_f32 v112, v112
v_exp_f32 v113, v113
v_cmp_ne_u32 vcc, 5, v160
v_mfma_f32_32x32x8_bf16 v[120:135], v[38:39], v[158:159], v[120:135]
A_chk3:
s_cbranch_vccnz A_hand3
v_cvt_pk_bf16_f32 v104, v104, v105
v_cvt_pk_bf16_f32 v105, v106, v107
v_cvt_pk_bf16_f32 v106, v108, v109
v_cvt_pk_bf16_f32 v107, v110, v111
v_exp_f32 v114, v114
ds_read_b128 v[152:155], v165 offset:6144
v_exp_f32 v115, v115
ds_read_b32 v161, v166 offset:10752
v_exp_f32 v116, v116
v_exp_f32 v117, v117
v_mfma_f32_32x32x16_bf16 v[136:151], v[88:91], v[104:107], v[136:151]
v_exp_f32 v118, v118
v_exp_f32 v119, v119
v_cvt_pk_bf16_f32 v108, v112, v113
v_cvt_pk_bf16_f32 v109, v114, v115
v_cvt_pk_bf16_f32 v110, v116, v117
v_cvt_pk_bf16_f32 v111, v118, v119
v_exp_f32 v120, v120
v_exp_f32 v121, v121
s_waitcnt lgkmcnt(0)
v_mfma_f32_32x32x16_bf16 v[136:151], v[92:95], v[108:111], v[136:151]
v_exp_f32 v122, v122
v_cndmask_b32 v156, 0, v161, s[44:45]
v_exp_f32 v123, v123
v_cndmask_b32 v158, 0, v161, s[46:47]
v_exp_f32 v124, v124
v_exp_f32 v125, v125
v_mfma_f32_32x32x16_bf16 v[104:119], v[0:3], v[152:155], 0
v_exp_f32 v126, v126
v_exp_f32 v127, v127
v_exp_f32 v128, v128
v_exp_f32 v129, v129
v_mfma_f32_32x32x8_bf16 v[104:119], v[32:33], v[156:157], v[104:119]
v_cvt_pk_bf16_f32 v120, v120, v121
v_cvt_pk_bf16_f32 v121, v122, v123
v_cvt_pk_bf16_f32 v122, v124, v125
v_cvt_pk_bf16_f32 v123, v126, v127
v_exp_f32 v130, v130
v_exp_f32 v131, v131
v_exp_f32 v132, v132
v_exp_f32 v133, v133
v_mfma_f32_32x32x16_bf16 v[136:151], v[96:99], v[120:123], v[136:151]
v_exp_f32 v134, v134
v_exp_f32 v135, v135
v_cvt_pk_bf16_f32 v124, v128, v129
v_cvt_pk_bf16_f32 v125, v130, v131
v_cvt_pk_bf16_f32 v126, v132, v133
v_cvt_pk_bf16_f32 v127, v134, v135
v_exp_f32 v104, v104
ds_read_u8 v160, v163 offset:280
v_exp_f32 v105, v105
ds_read_u8 v161, v163 offset:272
v_mfma_f32_32x32x16_bf16 v[136:151], v[100:103], v[124:127], v[136:151]
v_exp_f32 v106, v106
v_exp_f32 v107, v107
v_exp_f32 v108, v108
s_waitcnt lgkmcnt(0)
v_exp_f32 v109, v109
v_add_u32 v160, v160, v161
v_mfma_f32_32x32x16_bf16 v[120:135], v[4:7], v[152:155], 0
v_exp_f32 v110, v110
v_exp_f32 v111, v111
v_readfirstlane_b32 s50, v160
v_exp_f32 v112, v112
s_setprio 0
s_cmp_eq_u32 s50, 0
s_cbranch_scc1 A_dp4
s_setprio 1
s_cmp_eq_u32 s50, 0x80
s_cbranch_scc1 A_dp4
s_setprio 2
A_dp4:
v_exp_f32 v113, v113
v_mfma_f32_32x32x8_bf16 v[120:135], v[32:33], v[158:159], v[120:135]
v_cvt_pk_bf16_f32 v104, v104, v105
v_cvt_pk_bf16_f32 v105, v106, v107
v_cvt_pk_bf16_f32 v106, v108, v109
v_cvt_pk_bf16_f32 v107, v110, v111
v_exp_f32 v114, v114
ds_write_b128 v167, v[136:139] offset:0
v_exp_f32 v115, v115
ds_write_b128 v167, v[140:143] offset:1024
v_exp_f32 v116, v116
ds_write_b64 v164, v[144:145] offset:2048
v_exp_f32 v117, v117
ds_write_b8 v162, v33 offset:280
v_mfma_f32_32x32x16_bf16 v[136:151], v[40:43], v[104:107], 0
v_exp_f32 v118, v118
v_exp_f32 v119, v119
v_cvt_pk_bf16_f32 v108, v112, v113
v_cvt_pk_bf16_f32 v109, v114, v115
v_cvt_pk_bf16_f32 v110, v116, v117
v_cvt_pk_bf16_f32 v111, v118, v119
v_exp_f32 v120, v120
v_exp_f32 v121, v121
v_mfma_f32_32x32x16_bf16 v[136:151], v[44:47], v[108:111], v[136:151]
v_exp_f32 v122, v122
v_exp_f32 v123, v123
v_exp_f32 v124, v124
v_exp_f32 v125, v125
v_mfma_f32_32x32x16_bf16 v[104:119], v[8:11], v[152:155], 0
v_exp_f32 v126, v126
v_exp_f32 v127, v127
v_exp_f32 v128, v128
v_exp_f32 v129, v129
v_mfma_f32_32x32x8_bf16 v[104:119], v[34:35], v[156:157], v[104:119]
v_cvt_pk_bf16_f32 v120, v120, v121
v_cvt_pk_bf16_f32 v121, v122, v123
v_cvt_pk_bf16_f32 v122, v124, v125
v_cvt_pk_bf16_f32 v123, v126, v127
v_exp_f32 v130, v130
v_exp_f32 v131, v131
v_exp_f32 v132, v132
v_exp_f32 v133, v133
v_mfma_f32_32x32x16_bf16 v[136:151], v[48:51], v[120:123], v[136:151]
v_exp_f32 v134, v134
v_exp_f32 v135, v135
v_cvt_pk_bf16_f32 v124, v128, v129
v_cvt_pk_bf16_f32 v125, v130, v131
v_cvt_pk_bf16_f32 v126, v132, v133
v_cvt_pk_bf16_f32 v127, v134, v135
v_exp_f32 v104, v104
v_exp_f32 v105, v105
v_mfma_f32_32x32x16_bf16 v[136:151], v[52:55], v[124:127], v[136:151]
v_exp_f32 v106, v106
v_exp_f32 v107, v107
v_exp_f32 v108, v108
v_exp_f32 v109, v109
v_mfma_f32_32x32x16_bf16 v[120:135], v[12:15], v[152:155], 0
v_exp_f32 v110, v110
v_exp_f32 v111, v111
v_exp_f32 v112, v112
v_exp_f32 v113, v113
v_mfma_f32_32x32x8_bf16 v[120:135], v[34:35], v[158:159], v[120:135]
v_cvt_pk_bf16_f32 v104, v104, v105
v_cvt_pk_bf16_f32 v105, v106, v107
v_cvt_pk_bf16_f32 v106, v108, v109
v_cvt_pk_bf16_f32 v107, v110, v111
v_exp_f32 v114, v114
v_exp_f32 v115, v115
v_exp_f32 v116, v116
v_exp_f32 v117, v117
v_mfma_f32_32x32x16_bf16 v[136:151], v[56:59], v[104:107], v[136:151]
v_exp_f32 v118, v118
v_exp_f32 v119, v119
v_cvt_pk_bf16_f32 v108, v112, v113
v_cvt_pk_bf16_f32 v109, v114, v115
v_cvt_pk_bf16_f32 v110, v116, v117
v_cvt_pk_bf16_f32 v111, v118, v119
v_exp_f32 v120, v120
v_exp_f32 v121, v121
v_mfma_f32_32x32x16_bf16 v[136:151], v[60:63], v[108:111], v[136:151]
v_exp_f32 v122, v122
v_exp_f32 v123, v123
v_exp_f32 v124, v124
v_exp_f32 v125, v125
v_mfma_f32_32x32x16_bf16 v[104:119], v[16:19], v[152:155], 0
v_exp_f32 v126, v126
v_exp_f32 v127, v127
v_exp_f32 v128, v128
v_exp_f32 v129, v129
v_mfma_f32_32x32x8_bf16 v[104:119], v[36:37], v[156:157], v[104:119]
v_cvt_pk_bf16_f32 v120, v120, v121
v_cvt_pk_bf16_f32 v121, v122, v123
v_cvt_pk_bf16_f32 v122, v124, v125
v_cvt_pk_bf16_f32 v123, v126, v127
v_exp_f32 v130, v130
v_exp_f32 v131, v131
v_exp_f32 v132, v132
v_exp_f32 v133, v133
v_mfma_f32_32x32x16_bf16 v[136:151], v[64:67], v[120:123], v[136:151]
v_exp_f32 v134, v134
v_exp_f32 v135, v135
v_cvt_pk_bf16_f32 v124, v128, v129
v_cvt_pk_bf16_f32 v125, v130, v131
v_cvt_pk_bf16_f32 v126, v132, v133
v_cvt_pk_bf16_f32 v127, v134, v135
v_exp_f32 v104, v104
v_exp_f32 v105, v105
v_mfma_f32_32x32x16_bf16 v[136:151], v[68:71], v[124:127], v[136:151]
v_exp_f32 v106, v106
v_exp_f32 v107, v107
v_exp_f32 v108, v108
v_exp_f32 v109, v109
v_mfma_f32_32x32x16_bf16 v[120:135], v[20:23], v[152:155], 0
v_exp_f32 v110, v110
v_exp_f32 v111, v111
v_exp_f32 v112, v112
v_exp_f32 v113, v113
v_mfma_f32_32x32x8_bf16 v[120:135], v[36:37], v[158:159], v[120:135]
v_cvt_pk_bf16_f32 v104, v104, v105
v_cvt_pk_bf16_f32 v105, v106, v107
v_cvt_pk_bf16_f32 v106, v108, v109
v_cvt_pk_bf16_f32 v107, v110, v111
v_exp_f32 v114, v114
v_exp_f32 v115, v115
v_exp_f32 v116, v116
v_exp_f32 v117, v117
v_mfma_f32_32x32x16_bf16 v[136:151], v[72:75], v[104:107], v[136:151]
v_exp_f32 v118, v118
v_exp_f32 v119, v119
v_cvt_pk_bf16_f32 v108, v112, v113
v_cvt_pk_bf16_f32 v109, v114, v115
v_cvt_pk_bf16_f32 v110, v116, v117
v_cvt_pk_bf16_f32 v111, v118, v119
v_exp_f32 v120, v120
v_exp_f32 v121, v121
v_mfma_f32_32x32x16_bf16 v[136:151], v[76:79], v[108:111], v[136:151]
v_exp_f32 v122, v122
v_exp_f32 v123, v123
v_exp_f32 v124, v124
v_exp_f32 v125, v125
v_mfma_f32_32x32x16_bf16 v[104:119], v[24:27], v[152:155], 0
v_exp_f32 v126, v126
v_exp_f32 v127, v127
v_exp_f32 v128, v128
v_exp_f32 v129, v129
v_mfma_f32_32x32x8_bf16 v[104:119], v[38:39], v[156:157], v[104:119]
v_cvt_pk_bf16_f32 v120, v120, v121
v_cvt_pk_bf16_f32 v121, v122, v123
v_cvt_pk_bf16_f32 v122, v124, v125
v_cvt_pk_bf16_f32 v123, v126, v127
v_exp_f32 v130, v130
ds_read_b64 v[160:161], v157 offset:40
v_exp_f32 v131, v131
v_exp_f32 v132, v132
v_exp_f32 v133, v133
v_mfma_f32_32x32x16_bf16 v[136:151], v[80:83], v[120:123], v[136:151]
v_exp_f32 v134, v134
v_exp_f32 v135, v135
v_cvt_pk_bf16_f32 v124, v128, v129
v_cvt_pk_bf16_f32 v125, v130, v131
v_cvt_pk_bf16_f32 v126, v132, v133
v_cvt_pk_bf16_f32 v127, v134, v135
v_exp_f32 v104, v104
v_exp_f32 v105, v105
v_mfma_f32_32x32x16_bf16 v[136:151], v[84:87], v[124:127], v[136:151]
v_exp_f32 v106, v106
s_waitcnt lgkmcnt(0)
v_exp_f32 v107, v107
v_lshl_add_u32 v160, v161, 2, v160
v_exp_f32 v108, v108
v_exp_f32 v109, v109
v_mfma_f32_32x32x16_bf16 v[120:135], v[28:31], v[152:155], 0
v_exp_f32 v110, v110
v_exp_f32 v111, v111
v_exp_f32 v112, v112
v_exp_f32 v113, v113
v_cmp_ne_u32 vcc, 5, v160
v_mfma_f32_32x32x8_bf16 v[120:135], v[38:39], v[158:159], v[120:135]
A_chk4:
s_cbranch_vccnz A_hand4
v_cvt_pk_bf16_f32 v104, v104, v105
v_cvt_pk_bf16_f32 v105, v106, v107
v_cvt_pk_bf16_f32 v106, v108, v109
v_cvt_pk_bf16_f32 v107, v110, v111
v_exp_f32 v114, v114
ds_read_b128 v[152:155], v165 offset:7168
v_exp_f32 v115, v115
ds_read_b32 v161, v166 offset:10880
v_exp_f32 v116, v116
v_exp_f32 v117, v117
v_mfma_f32_32x32x16_bf16 v[136:151], v[88:91], v[104:107], v[136:151]
v_exp_f32 v118, v118
v_exp_f32 v119, v119
v_cvt_pk_bf16_f32 v108, v112, v113
v_cvt_pk_bf16_f32 v109, v114, v115
v_cvt_pk_bf16_f32 v110, v116, v117
v_cvt_pk_bf16_f32 v111, v118, v119
v_exp_f32 v120, v120
v_exp_f32 v121, v121
s_waitcnt lgkmcnt(0)
v_mfma_f32_32x32x16_bf16 v[136:151], v[92:95], v[108:111], v[136:151]
v_exp_f32 v122, v122
v_cndmask_b32 v156, 0, v161, s[44:45]
v_exp_f32 v123, v123
v_cndmask_b32 v158, 0, v161, s[46:47]
v_exp_f32 v124, v124
v_exp_f32 v125, v125
v_mfma_f32_32x32x16_bf16 v[104:119], v[0:3], v[152:155], 0
v_exp_f32 v126, v126
v_exp_f32 v127, v127
v_exp_f32 v128, v128
v_exp_f32 v129, v129
v_mfma_f32_32x32x8_bf16 v[104:119], v[32:33], v[156:157], v[104:119]
v_cvt_pk_bf16_f32 v120, v120, v121
v_cvt_pk_bf16_f32 v121, v122, v123
v_cvt_pk_bf16_f32 v122, v124, v125
v_cvt_pk_bf16_f32 v123, v126, v127
v_exp_f32 v130, v130
v_exp_f32 v131, v131
v_exp_f32 v132, v132
v_exp_f32 v133, v133
v_mfma_f32_32x32x16_bf16 v[136:151], v[96:99], v[120:123], v[136:151]
v_exp_f32 v134, v134
v_exp_f32 v135, v135
v_cvt_pk_bf16_f32 v124, v128, v129
v_cvt_pk_bf16_f32 v125, v130, v131
v_cvt_pk_bf16_f32 v126, v132, v133
v_cvt_pk_bf16_f32 v127, v134, v135
v_exp_f32 v104, v104
ds_read_u8 v160, v163 offset:288
v_exp_f32 v105, v105
ds_read_u8 v161, v163 offset:280
v_mfma_f32_32x32x16_bf16 v[136:151], v[100:103], v[124:127], v[136:151]
v_exp_f32 v106, v106
v_exp_f32 v107, v107
v_exp_f32 v108, v108
s_waitcnt lgkmcnt(0)
v_exp_f32 v109, v109
v_add_u32 v160, v160, v161
v_mfma_f32_32x32x16_bf16 v[120:135], v[4:7], v[152:155], 0
v_exp_f32 v110, v110
v_exp_f32 v111, v111
v_readfirstlane_b32 s50, v160
v_exp_f32 v112, v112
s_setprio 0
s_cmp_eq_u32 s50, 0
s_cbranch_scc1 A_dp5
s_setprio 1
s_cmp_eq_u32 s50, 0x80
s_cbranch_scc1 A_dp5
s_setprio 2
A_dp5:
v_exp_f32 v113, v113
v_mfma_f32_32x32x8_bf16 v[120:135], v[32:33], v[158:159], v[120:135]
v_cvt_pk_bf16_f32 v104, v104, v105
v_cvt_pk_bf16_f32 v105, v106, v107
v_cvt_pk_bf16_f32 v106, v108, v109
v_cvt_pk_bf16_f32 v107, v110, v111
v_exp_f32 v114, v114
ds_write_b128 v167, v[136:139] offset:20480
v_exp_f32 v115, v115
ds_write_b128 v167, v[140:143] offset:21504
v_exp_f32 v116, v116
ds_write_b64 v164, v[144:145] offset:22528
v_exp_f32 v117, v117
ds_write_b8 v162, v33 offset:288
v_mfma_f32_32x32x16_bf16 v[136:151], v[40:43], v[104:107], 0
v_exp_f32 v118, v118
v_exp_f32 v119, v119
v_cvt_pk_bf16_f32 v108, v112, v113
v_cvt_pk_bf16_f32 v109, v114, v115
v_cvt_pk_bf16_f32 v110, v116, v117
v_cvt_pk_bf16_f32 v111, v118, v119
v_exp_f32 v120, v120
v_exp_f32 v121, v121
v_mfma_f32_32x32x16_bf16 v[136:151], v[44:47], v[108:111], v[136:151]
v_exp_f32 v122, v122
v_exp_f32 v123, v123
v_exp_f32 v124, v124
v_exp_f32 v125, v125
v_mfma_f32_32x32x16_bf16 v[104:119], v[8:11], v[152:155], 0
v_exp_f32 v126, v126
v_exp_f32 v127, v127
v_exp_f32 v128, v128
v_exp_f32 v129, v129
v_mfma_f32_32x32x8_bf16 v[104:119], v[34:35], v[156:157], v[104:119]
v_cvt_pk_bf16_f32 v120, v120, v121
v_cvt_pk_bf16_f32 v121, v122, v123
v_cvt_pk_bf16_f32 v122, v124, v125
v_cvt_pk_bf16_f32 v123, v126, v127
v_exp_f32 v130, v130
v_exp_f32 v131, v131
v_exp_f32 v132, v132
v_exp_f32 v133, v133
v_mfma_f32_32x32x16_bf16 v[136:151], v[48:51], v[120:123], v[136:151]
v_exp_f32 v134, v134
v_exp_f32 v135, v135
v_cvt_pk_bf16_f32 v124, v128, v129
v_cvt_pk_bf16_f32 v125, v130, v131
v_cvt_pk_bf16_f32 v126, v132, v133
v_cvt_pk_bf16_f32 v127, v134, v135
v_exp_f32 v104, v104
v_exp_f32 v105, v105
v_mfma_f32_32x32x16_bf16 v[136:151], v[52:55], v[124:127], v[136:151]
v_exp_f32 v106, v106
v_exp_f32 v107, v107
v_exp_f32 v108, v108
v_exp_f32 v109, v109
v_mfma_f32_32x32x16_bf16 v[120:135], v[12:15], v[152:155], 0
v_exp_f32 v110, v110
v_exp_f32 v111, v111
v_exp_f32 v112, v112
v_exp_f32 v113, v113
v_mfma_f32_32x32x8_bf16 v[120:135], v[34:35], v[158:159], v[120:135]
v_cvt_pk_bf16_f32 v104, v104, v105
v_cvt_pk_bf16_f32 v105, v106, v107
v_cvt_pk_bf16_f32 v106, v108, v109
v_cvt_pk_bf16_f32 v107, v110, v111
v_exp_f32 v114, v114
v_exp_f32 v115, v115
v_exp_f32 v116, v116
v_exp_f32 v117, v117
v_mfma_f32_32x32x16_bf16 v[136:151], v[56:59], v[104:107], v[136:151]
v_exp_f32 v118, v118
v_exp_f32 v119, v119
v_cvt_pk_bf16_f32 v108, v112, v113
v_cvt_pk_bf16_f32 v109, v114, v115
v_cvt_pk_bf16_f32 v110, v116, v117
v_cvt_pk_bf16_f32 v111, v118, v119
v_exp_f32 v120, v120
v_exp_f32 v121, v121
v_mfma_f32_32x32x16_bf16 v[136:151], v[60:63], v[108:111], v[136:151]
v_exp_f32 v122, v122
v_exp_f32 v123, v123
v_exp_f32 v124, v124
v_exp_f32 v125, v125
v_mfma_f32_32x32x16_bf16 v[104:119], v[16:19], v[152:155], 0
v_exp_f32 v126, v126
v_exp_f32 v127, v127
v_exp_f32 v128, v128
v_exp_f32 v129, v129
v_mfma_f32_32x32x8_bf16 v[104:119], v[36:37], v[156:157], v[104:119]
v_cvt_pk_bf16_f32 v120, v120, v121
v_cvt_pk_bf16_f32 v121, v122, v123
v_cvt_pk_bf16_f32 v122, v124, v125
v_cvt_pk_bf16_f32 v123, v126, v127
v_exp_f32 v130, v130
v_exp_f32 v131, v131
v_exp_f32 v132, v132
v_exp_f32 v133, v133
v_mfma_f32_32x32x16_bf16 v[136:151], v[64:67], v[120:123], v[136:151]
v_exp_f32 v134, v134
v_exp_f32 v135, v135
v_cvt_pk_bf16_f32 v124, v128, v129
v_cvt_pk_bf16_f32 v125, v130, v131
v_cvt_pk_bf16_f32 v126, v132, v133
v_cvt_pk_bf16_f32 v127, v134, v135
v_exp_f32 v104, v104
v_exp_f32 v105, v105
v_mfma_f32_32x32x16_bf16 v[136:151], v[68:71], v[124:127], v[136:151]
v_exp_f32 v106, v106
v_exp_f32 v107, v107
v_exp_f32 v108, v108
v_exp_f32 v109, v109
v_mfma_f32_32x32x16_bf16 v[120:135], v[20:23], v[152:155], 0
v_exp_f32 v110, v110
v_exp_f32 v111, v111
v_exp_f32 v112, v112
v_exp_f32 v113, v113
v_mfma_f32_32x32x8_bf16 v[120:135], v[36:37], v[158:159], v[120:135]
v_cvt_pk_bf16_f32 v104, v104, v105
v_cvt_pk_bf16_f32 v105, v106, v107
v_cvt_pk_bf16_f32 v106, v108, v109
v_cvt_pk_bf16_f32 v107, v110, v111
v_exp_f32 v114, v114
v_exp_f32 v115, v115
v_exp_f32 v116, v116
v_exp_f32 v117, v117
v_mfma_f32_32x32x16_bf16 v[136:151], v[72:75], v[104:107], v[136:151]
v_exp_f32 v118, v118
v_exp_f32 v119, v119
v_cvt_pk_bf16_f32 v108, v112, v113
v_cvt_pk_bf16_f32 v109, v114, v115
v_cvt_pk_bf16_f32 v110, v116, v117
v_cvt_pk_bf16_f32 v111, v118, v119
v_exp_f32 v120, v120
v_exp_f32 v121, v121
v_mfma_f32_32x32x16_bf16 v[136:151], v[76:79], v[108:111], v[136:151]
v_exp_f32 v122, v122
v_exp_f32 v123, v123
v_exp_f32 v124, v124
v_exp_f32 v125, v125
v_mfma_f32_32x32x16_bf16 v[104:119], v[24:27], v[152:155], 0
v_exp_f32 v126, v126
v_exp_f32 v127, v127
v_exp_f32 v128, v128
v_exp_f32 v129, v129
v_mfma_f32_32x32x8_bf16 v[104:119], v[38:39], v[156:157], v[104:119]
v_cvt_pk_bf16_f32 v120, v120, v121
v_cvt_pk_bf16_f32 v121, v122, v123
v_cvt_pk_bf16_f32 v122, v124, v125
v_cvt_pk_bf16_f32 v123, v126, v127
v_exp_f32 v130, v130
ds_read_b64 v[160:161], v157 offset:48
v_exp_f32 v131, v131
v_exp_f32 v132, v132
v_exp_f32 v133, v133
v_mfma_f32_32x32x16_bf16 v[136:151], v[80:83], v[120:123], v[136:151]
v_exp_f32 v134, v134
v_exp_f32 v135, v135
v_cvt_pk_bf16_f32 v124, v128, v129
v_cvt_pk_bf16_f32 v125, v130, v131
v_cvt_pk_bf16_f32 v126, v132, v133
v_cvt_pk_bf16_f32 v127, v134, v135
v_exp_f32 v104, v104
v_exp_f32 v105, v105
v_mfma_f32_32x32x16_bf16 v[136:151], v[84:87], v[124:127], v[136:151]
v_exp_f32 v106, v106
s_waitcnt lgkmcnt(0)
v_exp_f32 v107, v107
v_lshl_add_u32 v160, v161, 2, v160
v_exp_f32 v108, v108
v_exp_f32 v109, v109
v_mfma_f32_32x32x16_bf16 v[120:135], v[28:31], v[152:155], 0
v_exp_f32 v110, v110
v_exp_f32 v111, v111
v_exp_f32 v112, v112
v_exp_f32 v113, v113
v_cmp_ne_u32 vcc, 5, v160
v_mfma_f32_32x32x8_bf16 v[120:135], v[38:39], v[158:159], v[120:135]
A_chk5:
s_cbranch_vccnz A_hand5
v_cvt_pk_bf16_f32 v104, v104, v105
v_cvt_pk_bf16_f32 v105, v106, v107
v_cvt_pk_bf16_f32 v106, v108, v109
v_cvt_pk_bf16_f32 v107, v110, v111
v_exp_f32 v114, v114
ds_read_b128 v[152:155], v165 offset:8192
v_exp_f32 v115, v115
ds_read_b32 v161, v166 offset:11008
v_exp_f32 v116, v116
v_exp_f32 v117, v117
v_mfma_f32_32x32x16_bf16 v[136:151], v[88:91], v[104:107], v[136:151]
v_exp_f32 v118, v118
v_exp_f32 v119, v119
v_cvt_pk_bf16_f32 v108, v112, v113
v_cvt_pk_bf16_f32 v109, v114, v115
v_cvt_pk_bf16_f32 v110, v116, v117
v_cvt_pk_bf16_f32 v111, v118, v119
v_exp_f32 v120, v120
v_exp_f32 v121, v121
s_waitcnt lgkmcnt(0)
v_mfma_f32_32x32x16_bf16 v[136:151], v[92:95], v[108:111], v[136:151]
v_exp_f32 v122, v122
v_cndmask_b32 v156, 0, v161, s[44:45]
v_exp_f32 v123, v123
v_cndmask_b32 v158, 0, v161, s[46:47]
v_exp_f32 v124, v124
v_exp_f32 v125, v125
v_mfma_f32_32x32x16_bf16 v[104:119], v[0:3], v[152:155], 0
v_exp_f32 v126, v126
v_exp_f32 v127, v127
v_exp_f32 v128, v128
v_exp_f32 v129, v129
v_mfma_f32_32x32x8_bf16 v[104:119], v[32:33], v[156:157], v[104:119]
v_cvt_pk_bf16_f32 v120, v120, v121
v_cvt_pk_bf16_f32 v121, v122, v123
v_cvt_pk_bf16_f32 v122, v124, v125
v_cvt_pk_bf16_f32 v123, v126, v127
v_exp_f32 v130, v130
v_exp_f32 v131, v131
v_exp_f32 v132, v132
v_exp_f32 v133, v133
v_mfma_f32_32x32x16_bf16 v[136:151], v[96:99], v[120:123], v[136:151]
v_exp_f32 v134, v134
v_exp_f32 v135, v135
v_cvt_pk_bf16_f32 v124, v128, v129
v_cvt_pk_bf16_f32 v125, v130, v131
v_cvt_pk_bf16_f32 v126, v132, v133
v_cvt_pk_bf16_f32 v127, v134, v135
v_exp_f32 v104, v104
ds_read_u8 v160, v163 offset:296
v_exp_f32 v105, v105
ds_read_u8 v161, v163 offset:288
v_mfma_f32_32x32x16_bf16 v[136:151], v[100:103], v[124:127], v[136:151]
v_exp_f32 v106, v106
v_exp_f32 v107, v107
v_exp_f32 v108, v108
s_waitcnt lgkmcnt(0)
v_exp_f32 v109, v109
v_add_u32 v160, v160, v161
v_mfma_f32_32x32x16_bf16 v[120:135], v[4:7], v[152:155], 0
v_exp_f32 v110, v110
v_exp_f32 v111, v111
v_readfirstlane_b32 s50, v160
v_exp_f32 v112, v112
s_setprio 0
s_cmp_eq_u32 s50, 0
s_cbranch_scc1 A_dp6
s_setprio 1
s_cmp_eq_u32 s50, 0x80
s_cbranch_scc1 A_dp6
s_setprio 2
A_dp6:
v_exp_f32 v113, v113
v_mfma_f32_32x32x8_bf16 v[120:135], v[32:33], v[158:159], v[120:135]
v_cvt_pk_bf16_f32 v104, v104, v105
v_cvt_pk_bf16_f32 v105, v106, v107
v_cvt_pk_bf16_f32 v106, v108, v109
v_cvt_pk_bf16_f32 v107, v110, v111
v_exp_f32 v114, v114
ds_write_b128 v167, v[136:139] offset:40960
v_exp_f32 v115, v115
ds_write_b128 v167, v[140:143] offset:41984
v_exp_f32 v116, v116
ds_write_b64 v164, v[144:145] offset:43008
v_exp_f32 v117, v117
ds_write_b8 v162, v33 offset:296
v_mfma_f32_32x32x16_bf16 v[136:151], v[40:43], v[104:107], 0
v_exp_f32 v118, v118
v_exp_f32 v119, v119
v_cvt_pk_bf16_f32 v108, v112, v113
v_cvt_pk_bf16_f32 v109, v114, v115
v_cvt_pk_bf16_f32 v110, v116, v117
v_cvt_pk_bf16_f32 v111, v118, v119
v_exp_f32 v120, v120
v_exp_f32 v121, v121
v_mfma_f32_32x32x16_bf16 v[136:151], v[44:47], v[108:111], v[136:151]
v_exp_f32 v122, v122
v_exp_f32 v123, v123
v_exp_f32 v124, v124
v_exp_f32 v125, v125
v_mfma_f32_32x32x16_bf16 v[104:119], v[8:11], v[152:155], 0
v_exp_f32 v126, v126
v_exp_f32 v127, v127
v_exp_f32 v128, v128
v_exp_f32 v129, v129
v_mfma_f32_32x32x8_bf16 v[104:119], v[34:35], v[156:157], v[104:119]
v_cvt_pk_bf16_f32 v120, v120, v121
v_cvt_pk_bf16_f32 v121, v122, v123
v_cvt_pk_bf16_f32 v122, v124, v125
v_cvt_pk_bf16_f32 v123, v126, v127
v_exp_f32 v130, v130
v_exp_f32 v131, v131
v_exp_f32 v132, v132
v_exp_f32 v133, v133
v_mfma_f32_32x32x16_bf16 v[136:151], v[48:51], v[120:123], v[136:151]
v_exp_f32 v134, v134
v_exp_f32 v135, v135
v_cvt_pk_bf16_f32 v124, v128, v129
v_cvt_pk_bf16_f32 v125, v130, v131
v_cvt_pk_bf16_f32 v126, v132, v133
v_cvt_pk_bf16_f32 v127, v134, v135
v_exp_f32 v104, v104
v_exp_f32 v105, v105
v_mfma_f32_32x32x16_bf16 v[136:151], v[52:55], v[124:127], v[136:151]
v_exp_f32 v106, v106
v_exp_f32 v107, v107
v_exp_f32 v108, v108
v_exp_f32 v109, v109
v_mfma_f32_32x32x16_bf16 v[120:135], v[12:15], v[152:155], 0
v_exp_f32 v110, v110
v_exp_f32 v111, v111
v_exp_f32 v112, v112
v_exp_f32 v113, v113
v_mfma_f32_32x32x8_bf16 v[120:135], v[34:35], v[158:159], v[120:135]
v_cvt_pk_bf16_f32 v104, v104, v105
v_cvt_pk_bf16_f32 v105, v106, v107
v_cvt_pk_bf16_f32 v106, v108, v109
v_cvt_pk_bf16_f32 v107, v110, v111
v_exp_f32 v114, v114
v_exp_f32 v115, v115
v_exp_f32 v116, v116
v_exp_f32 v117, v117
v_mfma_f32_32x32x16_bf16 v[136:151], v[56:59], v[104:107], v[136:151]
v_exp_f32 v118, v118
v_exp_f32 v119, v119
v_cvt_pk_bf16_f32 v108, v112, v113
v_cvt_pk_bf16_f32 v109, v114, v115
v_cvt_pk_bf16_f32 v110, v116, v117
v_cvt_pk_bf16_f32 v111, v118, v119
v_exp_f32 v120, v120
v_exp_f32 v121, v121
v_mfma_f32_32x32x16_bf16 v[136:151], v[60:63], v[108:111], v[136:151]
v_exp_f32 v122, v122
v_exp_f32 v123, v123
v_exp_f32 v124, v124
v_exp_f32 v125, v125
v_mfma_f32_32x32x16_bf16 v[104:119], v[16:19], v[152:155], 0
v_exp_f32 v126, v126
v_exp_f32 v127, v127
v_exp_f32 v128, v128
v_exp_f32 v129, v129
v_mfma_f32_32x32x8_bf16 v[104:119], v[36:37], v[156:157], v[104:119]
v_cvt_pk_bf16_f32 v120, v120, v121
v_cvt_pk_bf16_f32 v121, v122, v123
v_cvt_pk_bf16_f32 v122, v124, v125
v_cvt_pk_bf16_f32 v123, v126, v127
v_exp_f32 v130, v130
v_exp_f32 v131, v131
v_exp_f32 v132, v132
v_exp_f32 v133, v133
v_mfma_f32_32x32x16_bf16 v[136:151], v[64:67], v[120:123], v[136:151]
v_exp_f32 v134, v134
v_exp_f32 v135, v135
v_cvt_pk_bf16_f32 v124, v128, v129
v_cvt_pk_bf16_f32 v125, v130, v131
v_cvt_pk_bf16_f32 v126, v132, v133
v_cvt_pk_bf16_f32 v127, v134, v135
v_exp_f32 v104, v104
v_exp_f32 v105, v105
v_mfma_f32_32x32x16_bf16 v[136:151], v[68:71], v[124:127], v[136:151]
v_exp_f32 v106, v106
v_exp_f32 v107, v107
v_exp_f32 v108, v108
v_exp_f32 v109, v109
v_mfma_f32_32x32x16_bf16 v[120:135], v[20:23], v[152:155], 0
v_exp_f32 v110, v110
v_exp_f32 v111, v111
v_exp_f32 v112, v112
v_exp_f32 v113, v113
v_mfma_f32_32x32x8_bf16 v[120:135], v[36:37], v[158:159], v[120:135]
v_cvt_pk_bf16_f32 v104, v104, v105
v_cvt_pk_bf16_f32 v105, v106, v107
v_cvt_pk_bf16_f32 v106, v108, v109
v_cvt_pk_bf16_f32 v107, v110, v111
v_exp_f32 v114, v114
v_exp_f32 v115, v115
v_exp_f32 v116, v116
v_exp_f32 v117, v117
v_mfma_f32_32x32x16_bf16 v[136:151], v[72:75], v[104:107], v[136:151]
v_exp_f32 v118, v118
v_exp_f32 v119, v119
v_cvt_pk_bf16_f32 v108, v112, v113
v_cvt_pk_bf16_f32 v109, v114, v115
v_cvt_pk_bf16_f32 v110, v116, v117
v_cvt_pk_bf16_f32 v111, v118, v119
v_exp_f32 v120, v120
v_exp_f32 v121, v121
v_mfma_f32_32x32x16_bf16 v[136:151], v[76:79], v[108:111], v[136:151]
v_exp_f32 v122, v122
v_exp_f32 v123, v123
v_exp_f32 v124, v124
v_exp_f32 v125, v125
v_mfma_f32_32x32x16_bf16 v[104:119], v[24:27], v[152:155], 0
v_exp_f32 v126, v126
v_exp_f32 v127, v127
v_exp_f32 v128, v128
v_exp_f32 v129, v129
v_mfma_f32_32x32x8_bf16 v[104:119], v[38:39], v[156:157], v[104:119]
v_cvt_pk_bf16_f32 v120, v120, v121
v_cvt_pk_bf16_f32 v121, v122, v123
v_cvt_pk_bf16_f32 v122, v124, v125
v_cvt_pk_bf16_f32 v123, v126, v127
v_exp_f32 v130, v130
ds_read_b64 v[160:161], v157 offset:56
v_exp_f32 v131, v131
v_exp_f32 v132, v132
v_exp_f32 v133, v133
v_mfma_f32_32x32x16_bf16 v[136:151], v[80:83], v[120:123], v[136:151]
v_exp_f32 v134, v134
v_exp_f32 v135, v135
v_cvt_pk_bf16_f32 v124, v128, v129
v_cvt_pk_bf16_f32 v125, v130, v131
v_cvt_pk_bf16_f32 v126, v132, v133
v_cvt_pk_bf16_f32 v127, v134, v135
v_exp_f32 v104, v104
v_exp_f32 v105, v105
v_mfma_f32_32x32x16_bf16 v[136:151], v[84:87], v[124:127], v[136:151]
v_exp_f32 v106, v106
s_waitcnt lgkmcnt(0)
v_exp_f32 v107, v107
v_lshl_add_u32 v160, v161, 2, v160
v_exp_f32 v108, v108
v_exp_f32 v109, v109
v_mfma_f32_32x32x16_bf16 v[120:135], v[28:31], v[152:155], 0
v_exp_f32 v110, v110
v_exp_f32 v111, v111
v_exp_f32 v112, v112
v_exp_f32 v113, v113
v_cmp_ne_u32 vcc, 5, v160
v_mfma_f32_32x32x8_bf16 v[120:135], v[38:39], v[158:159], v[120:135]
A_chk6:
s_cbranch_vccnz A_hand6
v_cvt_pk_bf16_f32 v104, v104, v105
v_cvt_pk_bf16_f32 v105, v106, v107
v_cvt_pk_bf16_f32 v106, v108, v109
v_cvt_pk_bf16_f32 v107, v110, v111
v_exp_f32 v114, v114
ds_read_b128 v[152:155], v165 offset:9216
v_exp_f32 v115, v115
ds_read_b32 v161, v166 offset:11136
v_exp_f32 v116, v116
v_exp_f32 v117, v117
v_mfma_f32_32x32x16_bf16 v[136:151], v[88:91], v[104:107], v[136:151]
v_exp_f32 v118, v118
v_exp_f32 v119, v119
v_cvt_pk_bf16_f32 v108, v112, v113
v_cvt_pk_bf16_f32 v109, v114, v115
v_cvt_pk_bf16_f32 v110, v116, v117
v_cvt_pk_bf16_f32 v111, v118, v119
v_exp_f32 v120, v120
v_exp_f32 v121, v121
s_waitcnt lgkmcnt(0)
v_mfma_f32_32x32x16_bf16 v[136:151], v[92:95], v[108:111], v[136:151]
v_exp_f32 v122, v122
v_cndmask_b32 v156, 0, v161, s[44:45]
v_exp_f32 v123, v123
v_cndmask_b32 v158, 0, v161, s[46:47]
v_exp_f32 v124, v124
v_exp_f32 v125, v125
v_mfma_f32_32x32x16_bf16 v[104:119], v[0:3], v[152:155], 0
v_exp_f32 v126, v126
v_exp_f32 v127, v127
v_exp_f32 v128, v128
v_exp_f32 v129, v129
v_mfma_f32_32x32x8_bf16 v[104:119], v[32:33], v[156:157], v[104:119]
v_cvt_pk_bf16_f32 v120, v120, v121
v_cvt_pk_bf16_f32 v121, v122, v123
v_cvt_pk_bf16_f32 v122, v124, v125
v_cvt_pk_bf16_f32 v123, v126, v127
v_exp_f32 v130, v130
v_exp_f32 v131, v131
v_exp_f32 v132, v132
v_exp_f32 v133, v133
v_mfma_f32_32x32x16_bf16 v[136:151], v[96:99], v[120:123], v[136:151]
v_exp_f32 v134, v134
v_exp_f32 v135, v135
v_cvt_pk_bf16_f32 v124, v128, v129
v_cvt_pk_bf16_f32 v125, v130, v131
v_cvt_pk_bf16_f32 v126, v132, v133
v_cvt_pk_bf16_f32 v127, v134, v135
v_exp_f32 v104, v104
ds_read_u8 v160, v163 offset:304
v_exp_f32 v105, v105
ds_read_u8 v161, v163 offset:296
v_mfma_f32_32x32x16_bf16 v[136:151], v[100:103], v[124:127], v[136:151]
v_exp_f32 v106, v106
v_exp_f32 v107, v107
v_exp_f32 v108, v108
s_waitcnt lgkmcnt(0)
v_exp_f32 v109, v109
v_add_u32 v160, v160, v161
v_mfma_f32_32x32x16_bf16 v[120:135], v[4:7], v[152:155], 0
v_exp_f32 v110, v110
v_exp_f32 v111, v111
v_readfirstlane_b32 s50, v160
v_exp_f32 v112, v112
s_setprio 0
s_cmp_eq_u32 s50, 0
s_cbranch_scc1 A_dp7
s_setprio 1
s_cmp_eq_u32 s50, 0x80
s_cbranch_scc1 A_dp7
s_setprio 2
A_dp7:
v_exp_f32 v113, v113
v_mfma_f32_32x32x8_bf16 v[120:135], v[32:33], v[158:159], v[120:135]
v_cvt_pk_bf16_f32 v104, v104, v105
v_cvt_pk_bf16_f32 v105, v106, v107
v_cvt_pk_bf16_f32 v106, v108, v109
v_cvt_pk_bf16_f32 v107, v110, v111
v_exp_f32 v114, v114
ds_write_b128 v167, v[136:139] offset:0
v_exp_f32 v115, v115
ds_write_b128 v167, v[140:143] offset:1024
v_exp_f32 v116, v116
ds_write_b64 v164, v[144:145] offset:2048
v_exp_f32 v117, v117
ds_write_b8 v162, v33 offset:304
v_mfma_f32_32x32x16_bf16 v[136:151], v[40:43], v[104:107], 0
v_exp_f32 v118, v118
v_exp_f32 v119, v119
v_cvt_pk_bf16_f32 v108, v112, v113
v_cvt_pk_bf16_f32 v109, v114, v115
v_cvt_pk_bf16_f32 v110, v116, v117
v_cvt_pk_bf16_f32 v111, v118, v119
v_exp_f32 v120, v120
v_exp_f32 v121, v121
v_mfma_f32_32x32x16_bf16 v[136:151], v[44:47], v[108:111], v[136:151]
v_exp_f32 v122, v122
v_exp_f32 v123, v123
v_exp_f32 v124, v124
v_exp_f32 v125, v125
v_mfma_f32_32x32x16_bf16 v[104:119], v[8:11], v[152:155], 0
v_exp_f32 v126, v126
v_exp_f32 v127, v127
v_exp_f32 v128, v128
v_exp_f32 v129, v129
v_mfma_f32_32x32x8_bf16 v[104:119], v[34:35], v[156:157], v[104:119]
v_cvt_pk_bf16_f32 v120, v120, v121
v_cvt_pk_bf16_f32 v121, v122, v123
v_cvt_pk_bf16_f32 v122, v124, v125
v_cvt_pk_bf16_f32 v123, v126, v127
v_exp_f32 v130, v130
v_exp_f32 v131, v131
v_exp_f32 v132, v132
v_exp_f32 v133, v133
v_mfma_f32_32x32x16_bf16 v[136:151], v[48:51], v[120:123], v[136:151]
v_exp_f32 v134, v134
v_exp_f32 v135, v135
v_cvt_pk_bf16_f32 v124, v128, v129
v_cvt_pk_bf16_f32 v125, v130, v131
v_cvt_pk_bf16_f32 v126, v132, v133
v_cvt_pk_bf16_f32 v127, v134, v135
v_exp_f32 v104, v104
v_exp_f32 v105, v105
v_mfma_f32_32x32x16_bf16 v[136:151], v[52:55], v[124:127], v[136:151]
v_exp_f32 v106, v106
v_exp_f32 v107, v107
v_exp_f32 v108, v108
v_exp_f32 v109, v109
v_mfma_f32_32x32x16_bf16 v[120:135], v[12:15], v[152:155], 0
v_exp_f32 v110, v110
v_exp_f32 v111, v111
v_exp_f32 v112, v112
v_exp_f32 v113, v113
v_mfma_f32_32x32x8_bf16 v[120:135], v[34:35], v[158:159], v[120:135]
v_cvt_pk_bf16_f32 v104, v104, v105
v_cvt_pk_bf16_f32 v105, v106, v107
v_cvt_pk_bf16_f32 v106, v108, v109
v_cvt_pk_bf16_f32 v107, v110, v111
v_exp_f32 v114, v114
v_exp_f32 v115, v115
v_exp_f32 v116, v116
v_exp_f32 v117, v117
v_mfma_f32_32x32x16_bf16 v[136:151], v[56:59], v[104:107], v[136:151]
v_exp_f32 v118, v118
v_exp_f32 v119, v119
v_cvt_pk_bf16_f32 v108, v112, v113
v_cvt_pk_bf16_f32 v109, v114, v115
v_cvt_pk_bf16_f32 v110, v116, v117
v_cvt_pk_bf16_f32 v111, v118, v119
v_exp_f32 v120, v120
v_exp_f32 v121, v121
v_mfma_f32_32x32x16_bf16 v[136:151], v[60:63], v[108:111], v[136:151]
v_exp_f32 v122, v122
v_exp_f32 v123, v123
v_exp_f32 v124, v124
v_exp_f32 v125, v125
v_mfma_f32_32x32x16_bf16 v[104:119], v[16:19], v[152:155], 0
v_exp_f32 v126, v126
v_exp_f32 v127, v127
v_exp_f32 v128, v128
v_exp_f32 v129, v129
v_mfma_f32_32x32x8_bf16 v[104:119], v[36:37], v[156:157], v[104:119]
v_cvt_pk_bf16_f32 v120, v120, v121
v_cvt_pk_bf16_f32 v121, v122, v123
v_cvt_pk_bf16_f32 v122, v124, v125
v_cvt_pk_bf16_f32 v123, v126, v127
v_exp_f32 v130, v130
v_exp_f32 v131, v131
v_exp_f32 v132, v132
v_exp_f32 v133, v133
v_mfma_f32_32x32x16_bf16 v[136:151], v[64:67], v[120:123], v[136:151]
v_exp_f32 v134, v134
v_exp_f32 v135, v135
v_cvt_pk_bf16_f32 v124, v128, v129
v_cvt_pk_bf16_f32 v125, v130, v131
v_cvt_pk_bf16_f32 v126, v132, v133
v_cvt_pk_bf16_f32 v127, v134, v135
v_exp_f32 v104, v104
v_exp_f32 v105, v105
v_mfma_f32_32x32x16_bf16 v[136:151], v[68:71], v[124:127], v[136:151]
v_exp_f32 v106, v106
v_exp_f32 v107, v107
v_exp_f32 v108, v108
v_exp_f32 v109, v109
v_mfma_f32_32x32x16_bf16 v[120:135], v[20:23], v[152:155], 0
v_exp_f32 v110, v110
v_exp_f32 v111, v111
v_exp_f32 v112, v112
v_exp_f32 v113, v113
v_mfma_f32_32x32x8_bf16 v[120:135], v[36:37], v[158:159], v[120:135]
v_cvt_pk_bf16_f32 v104, v104, v105
v_cvt_pk_bf16_f32 v105, v106, v107
v_cvt_pk_bf16_f32 v106, v108, v109
v_cvt_pk_bf16_f32 v107, v110, v111
v_exp_f32 v114, v114
v_exp_f32 v115, v115
v_exp_f32 v116, v116
v_exp_f32 v117, v117
v_mfma_f32_32x32x16_bf16 v[136:151], v[72:75], v[104:107], v[136:151]
v_exp_f32 v118, v118
v_exp_f32 v119, v119
v_cvt_pk_bf16_f32 v108, v112, v113
v_cvt_pk_bf16_f32 v109, v114, v115
v_cvt_pk_bf16_f32 v110, v116, v117
v_cvt_pk_bf16_f32 v111, v118, v119
v_exp_f32 v120, v120
v_exp_f32 v121, v121
v_mfma_f32_32x32x16_bf16 v[136:151], v[76:79], v[108:111], v[136:151]
v_exp_f32 v122, v122
v_exp_f32 v123, v123
v_exp_f32 v124, v124
v_exp_f32 v125, v125
v_mfma_f32_32x32x16_bf16 v[104:119], v[24:27], v[152:155], 0
v_exp_f32 v126, v126
v_exp_f32 v127, v127
v_exp_f32 v128, v128
v_exp_f32 v129, v129
v_mfma_f32_32x32x8_bf16 v[104:119], v[38:39], v[156:157], v[104:119]
v_cvt_pk_bf16_f32 v120, v120, v121
v_cvt_pk_bf16_f32 v121, v122, v123
v_cvt_pk_bf16_f32 v122, v124, v125
v_cvt_pk_bf16_f32 v123, v126, v127
v_exp_f32 v130, v130
ds_read_b64 v[160:161], v157 offset:64
v_exp_f32 v131, v131
v_exp_f32 v132, v132
v_exp_f32 v133, v133
v_mfma_f32_32x32x16_bf16 v[136:151], v[80:83], v[120:123], v[136:151]
v_exp_f32 v134, v134
v_exp_f32 v135, v135
v_cvt_pk_bf16_f32 v124, v128, v129
v_cvt_pk_bf16_f32 v125, v130, v131
v_cvt_pk_bf16_f32 v126, v132, v133
v_cvt_pk_bf16_f32 v127, v134, v135
v_exp_f32 v104, v104
v_exp_f32 v105, v105
v_mfma_f32_32x32x16_bf16 v[136:151], v[84:87], v[124:127], v[136:151]
v_exp_f32 v106, v106
s_waitcnt lgkmcnt(0)
v_exp_f32 v107, v107
v_lshl_add_u32 v160, v161, 2, v160
v_exp_f32 v108, v108
v_exp_f32 v109, v109
v_mfma_f32_32x32x16_bf16 v[120:135], v[28:31], v[152:155], 0
v_exp_f32 v110, v110
v_exp_f32 v111, v111
v_exp_f32 v112, v112
v_exp_f32 v113, v113
v_cmp_ne_u32 vcc, 5, v160
v_mfma_f32_32x32x8_bf16 v[120:135], v[38:39], v[158:159], v[120:135]
A_chk7:
s_cbranch_vccnz A_hand7
s_branch A_drain7
A_drain7:
s_waitcnt lgkmcnt(0)
ds_write_b8 v162, v33 offset:520
s_mov_b32 s61, 1
v_cvt_pk_bf16_f32 v104, v104, v105
v_cvt_pk_bf16_f32 v105, v106, v107
v_cvt_pk_bf16_f32 v106, v108, v109
v_cvt_pk_bf16_f32 v107, v110, v111
v_exp_f32 v114, v114
v_mbcnt_lo_u32_b32 v0, -1, 0
v_exp_f32 v115, v115
v_mbcnt_hi_u32_b32 v0, -1, v0
v_exp_f32 v116, v116
v_lshlrev_b32 v1, 4, v0
v_exp_f32 v117, v117
v_and_b32 v2, 15, v0
v_mfma_f32_32x32x16_bf16 v[136:151], v[88:91], v[104:107], v[136:151]
v_exp_f32 v118, v118
v_lshrrev_b32 v3, 4, v0
v_exp_f32 v119, v119
v_lshrrev_b32 v5, 1, v3
v_cvt_pk_bf16_f32 v108, v112, v113
v_cvt_pk_bf16_f32 v109, v114, v115
v_cvt_pk_bf16_f32 v110, v116, v117
v_cvt_pk_bf16_f32 v111, v118, v119
v_exp_f32 v120, v120
v_lshlrev_b32 v5, 8, v5
v_exp_f32 v121, v121
v_lshl_add_u32 v5, v2, 4, v5
v_mfma_f32_32x32x16_bf16 v[136:151], v[92:95], v[108:111], v[136:151]
v_exp_f32 v122, v122
v_and_b32 v4, 1, v3
v_exp_f32 v123, v123
v_lshlrev_b32 v4, 10, v4
v_exp_f32 v124, v124
v_add_u32 v4, v4, v5
v_exp_f32 v125, v125
v_add_u32 v5, 2048, v5
v_exp_f32 v126, v126
v_exp_f32 v127, v127
v_exp_f32 v128, v128
v_exp_f32 v129, v129
v_cvt_pk_bf16_f32 v120, v120, v121
v_cvt_pk_bf16_f32 v121, v122, v123
v_cvt_pk_bf16_f32 v122, v124, v125
v_cvt_pk_bf16_f32 v123, v126, v127
v_exp_f32 v130, v130
v_exp_f32 v131, v131
v_exp_f32 v132, v132
v_exp_f32 v133, v133
v_mfma_f32_32x32x16_bf16 v[136:151], v[96:99], v[120:123], v[136:151]
v_exp_f32 v134, v134
v_exp_f32 v135, v135
v_cvt_pk_bf16_f32 v124, v128, v129
v_cvt_pk_bf16_f32 v125, v130, v131
v_cvt_pk_bf16_f32 v126, v132, v133
v_cvt_pk_bf16_f32 v127, v134, v135
s_nop 1
v_mfma_f32_32x32x16_bf16 v[136:151], v[100:103], v[124:127], v[136:151]
s_branch A_dynflush
A_drain:
s_waitcnt lgkmcnt(0)
ds_write_b8 v162, v33 offset:520
s_mov_b32 s61, 0
v_cvt_pk_bf16_f32 v104, v104, v105
v_cvt_pk_bf16_f32 v105, v106, v107
v_cvt_pk_bf16_f32 v106, v108, v109
v_cvt_pk_bf16_f32 v107, v110, v111
v_exp_f32 v114, v114
v_exp_f32 v115, v115
v_exp_f32 v116, v116
v_exp_f32 v117, v117
v_mfma_f32_32x32x16_bf16 v[136:151], v[88:91], v[104:107], v[136:151]
v_exp_f32 v118, v118
v_exp_f32 v119, v119
v_cvt_pk_bf16_f32 v108, v112, v113
v_cvt_pk_bf16_f32 v109, v114, v115
v_cvt_pk_bf16_f32 v110, v116, v117
v_cvt_pk_bf16_f32 v111, v118, v119
v_exp_f32 v120, v120
v_exp_f32 v121, v121
v_mfma_f32_32x32x16_bf16 v[136:151], v[92:95], v[108:111], v[136:151]
v_exp_f32 v122, v122
v_exp_f32 v123, v123
v_exp_f32 v124, v124
v_exp_f32 v125, v125
v_exp_f32 v126, v126
v_exp_f32 v127, v127
v_exp_f32 v128, v128
v_exp_f32 v129, v129
v_cvt_pk_bf16_f32 v120, v120, v121
v_cvt_pk_bf16_f32 v121, v122, v123
v_cvt_pk_bf16_f32 v122, v124, v125
v_cvt_pk_bf16_f32 v123, v126, v127
v_exp_f32 v130, v130
v_exp_f32 v131, v131
v_exp_f32 v132, v132
v_exp_f32 v133, v133
v_mfma_f32_32x32x16_bf16 v[136:151], v[96:99], v[120:123], v[136:151]
v_exp_f32 v134, v134
v_exp_f32 v135, v135
v_cvt_pk_bf16_f32 v124, v128, v129
v_cvt_pk_bf16_f32 v125, v130, v131
v_cvt_pk_bf16_f32 v126, v132, v133
v_cvt_pk_bf16_f32 v127, v134, v135
s_nop 1
v_mfma_f32_32x32x16_bf16 v[136:151], v[100:103], v[124:127], v[136:151]
A_dynflush:
s_mul_i32 s50, s40, 43691
s_lshr_b32 s50, s50, 17
s_mul_i32 s50, s50, 3
s_sub_u32 s50, s40, s50
s_mul_i32 s50, s50, 20480
v_add_u32 v160, s50, v167
v_add_u32 v161, s50, v164
s_nop 4
ds_write_b128 v160, v[136:139]
ds_write_b128 v160, v[140:143] offset:1024
ds_write_b64 v161, v[144:145] offset:2048
s_lshl_b32 s50, s40, 3
v_add_u32 v160, s50, v162
v_mov_b32 v161, 1
ds_write_b8 v160, v33 offset:256
s_add_u32 s40, s40, 1
s_cmp_lt_u32 s40, 8
s_cbranch_scc1 A_slowloop
v_mov_b32 v160, 600
s_mov_b64 exec, 1
ds_add_rtn_u32 v163, v160, v161
s_mov_b64 exec, -1
s_waitcnt lgkmcnt(0)
v_readfirstlane_b32 s50, v163
s_cmp_eq_u32 s50, 7
s_cbranch_scc0 A_done
s_cmp_eq_u32 s61, 1
s_cbranch_scc1 A_haveaddr
s_waitcnt vmcnt(0)
v_mbcnt_lo_u32_b32 v0, -1, 0
v_mbcnt_hi_u32_b32 v0, -1, v0
v_lshlrev_b32 v1, 4, v0
v_and_b32 v2, 15, v0
v_lshrrev_b32 v3, 4, v0
v_lshrrev_b32 v5, 1, v3
v_lshlrev_b32 v5, 8, v5
v_lshl_add_u32 v5, v2, 4, v5
v_and_b32 v4, 1, v3
v_lshlrev_b32 v4, 10, v4
v_add_u32 v4, v4, v5
v_add_u32 v5, 2048, v5
A_haveaddr:
v_add_u32 v6, 59392, v4
v_add_u32 v7, 59392, v5
ds_read_b128 v[8:11], v6 offset:0
ds_read_b128 v[12:15], v6 offset:512
ds_read_b128 v[16:19], v7 offset:0
ds_read_b128 v[24:27], v6 offset:2560
ds_read_b128 v[28:31], v6 offset:3072
ds_read_b128 v[32:35], v7 offset:2560
ds_read_b128 v[36:39], v6 offset:5120
ds_read_b128 v[40:43], v6 offset:5632
ds_read_b128 v[44:47], v7 offset:5120
ds_read_b128 v[48:51], v6 offset:7680
ds_read_b128 v[52:55], v6 offset:8192
ds_read_b128 v[56:59], v7 offset:7680
ds_read_b128 v[60:63], v6 offset:10240
ds_read_b128 v[64:67], v6 offset:10752
ds_read_b128 v[68:71], v7 offset:10240
s_waitcnt lgkmcnt(9)
v_pk_add_f32 v[8:9], v[8:9], v[24:25]
v_pk_add_f32 v[10:11], v[10:11], v[26:27]
v_pk_add_f32 v[12:13], v[12:13], v[28:29]
v_pk_add_f32 v[14:15], v[14:15], v[30:31]
v_pk_add_f32 v[16:17], v[16:17], v[32:33]
v_add_f32 v18, v18, v34
ds_read_b128 v[24:27], v6 offset:12800
ds_read_b128 v[28:31], v6 offset:13312
ds_read_b128 v[32:35], v7 offset:12800
s_waitcnt lgkmcnt(9)
v_pk_add_f32 v[8:9], v[8:9], v[36:37]
v_pk_add_f32 v[10:11], v[10:11], v[38:39]
v_pk_add_f32 v[12:13], v[12:13], v[40:41]
v_pk_add_f32 v[14:15], v[14:15], v[42:43]
v_pk_add_f32 v[16:17], v[16:17], v[44:45]
v_add_f32 v18, v18, v46
ds_read_b128 v[36:39], v6 offset:15360
ds_read_b128 v[40:43], v6 offset:15872
ds_read_b128 v[44:47], v7 offset:15360
s_waitcnt lgkmcnt(9)
v_pk_add_f32 v[8:9], v[8:9], v[48:49]
v_pk_add_f32 v[10:11], v[10:11], v[50:51]
v_pk_add_f32 v[12:13], v[12:13], v[52:53]
v_pk_add_f32 v[14:15], v[14:15], v[54:55]
v_pk_add_f32 v[16:17], v[16:17], v[56:57]
v_add_f32 v18, v18, v58
ds_read_b128 v[48:51], v6 offset:17920
ds_read_b128 v[52:55], v6 offset:18432
ds_read_b128 v[56:59], v7 offset:17920
s_waitcnt lgkmcnt(9)
v_pk_add_f32 v[8:9], v[8:9], v[60:61]
v_pk_add_f32 v[10:11], v[10:11], v[62:63]
v_pk_add_f32 v[12:13], v[12:13], v[64:65]
v_pk_add_f32 v[14:15], v[14:15], v[66:67]
v_pk_add_f32 v[16:17], v[16:17], v[68:69]
v_add_f32 v18, v18, v70
s_waitcnt lgkmcnt(6)
v_pk_add_f32 v[8:9], v[8:9], v[24:25]
v_pk_add_f32 v[10:11], v[10:11], v[26:27]
v_pk_add_f32 v[12:13], v[12:13], v[28:29]
v_pk_add_f32 v[14:15], v[14:15], v[30:31]
v_pk_add_f32 v[16:17], v[16:17], v[32:33]
v_add_f32 v18, v18, v34
s_waitcnt lgkmcnt(3)
v_pk_add_f32 v[8:9], v[8:9], v[36:37]
v_pk_add_f32 v[10:11], v[10:11], v[38:39]
v_pk_add_f32 v[12:13], v[12:13], v[40:41]
v_pk_add_f32 v[14:15], v[14:15], v[42:43]
v_pk_add_f32 v[16:17], v[16:17], v[44:45]
v_add_f32 v18, v18, v46
s_waitcnt lgkmcnt(0)
v_pk_add_f32 v[8:9], v[8:9], v[48:49]
v_pk_add_f32 v[10:11], v[10:11], v[50:51]
v_pk_add_f32 v[12:13], v[12:13], v[52:53]
v_pk_add_f32 v[14:15], v[14:15], v[54:55]
v_pk_add_f32 v[16:17], v[16:17], v[56:57]
v_add_f32 v18, v18, v58
v_rcp_f32 v18, v18
s_nop 0
v_mul_f32 v8, v8, v18
v_mul_f32 v9, v9, v18
v_mul_f32 v10, v10, v18
v_mul_f32 v11, v11, v18
v_mul_f32 v12, v12, v18
v_mul_f32 v13, v13, v18
v_mul_f32 v14, v14, v18
v_mul_f32 v15, v15, v18
v_mul_f32 v16, v16, v18
v_mul_f32 v17, v17, v18
v_cvt_pk_bf16_f32 v20, v8, v9
v_cvt_pk_bf16_f32 v21, v10, v11
v_cvt_pk_bf16_f32 v22, v12, v13
v_cvt_pk_bf16_f32 v23, v14, v15
v_cvt_pk_bf16_f32 v19, v16, v17
ds_write_b128 v1, v[20:23] offset:18432
v_lshlrev_b32 v6, 4, v2
v_lshrrev_b32 v7, 1, v3
v_lshl_add_u32 v6, v7, 2, v6
s_mov_b32 exec_lo, 0xffff
s_mov_b32 exec_hi, 0xffff
ds_write_b32 v6, v19 offset:20232
s_mov_b64 exec, 1
v_mov_b32 v6, 92
v_mov_b32 v7, 1
ds_write_b32 v6, v7
s_mov_b64 exec, -1
s_branch A_done
A_slowloop:
s_lshl_b32 s50, s40, 3
v_mov_b32 v163, s50
A_sg_re:
ds_read_b32 v161, v163 offset:0
s_waitcnt lgkmcnt(0)
v_cmp_eq_u32 vcc, 0, v161
s_cbranch_vccz A_sg_ok
s_add_u32 s52, s52, 1
s_cmp_gt_u32 s52, 200000
s_cbranch_scc1 A_sg_ok
s_sleep 1
s_branch A_sg_re
A_sg_ok:
s_lshl_b32 s50, s40, 10
v_add_u32 v160, s50, v165
ds_read_b128 v[152:155], v160 offset:2048
s_lshl_b32 s50, s40, 7
v_add_u32 v160, s50, v166
ds_read_b32 v161, v160 offset:10240
s_waitcnt lgkmcnt(0)
v_cndmask_b32 v156, 0, v161, s[44:45]
v_cndmask_b32 v158, 0, v161, s[46:47]
s_branch A_slowgo
A_slow0:
global_load_dwordx4 v[12:15], v165, s[54:55] offset:3072
s_add_u32 m0, s58, 4096
s_add_u32 s56, s56, 1024
s_addc_u32 s57, s57, 0
global_load_lds_dwordx4 v165, s[56:57]
s_add_u32 s54, s54, 4096
s_addc_u32 s55, s55, 0
global_load_dwordx4 v[16:19], v165, s[54:55] offset:0
s_add_u32 m0, s58, 5120
s_add_u32 s56, s56, 1024
s_addc_u32 s57, s57, 0
global_load_lds_dwordx4 v165, s[56:57]
global_load_dwordx4 v[20:23], v165, s[54:55] offset:1024
s_add_u32 m0, s58, 6144
s_add_u32 s56, s56, 1024
s_addc_u32 s57, s57, 0
global_load_lds_dwordx4 v165, s[56:57]
s_add_u32 m0, s58, 7168
s_add_u32 s56, s56, 1024
s_addc_u32 s57, s57, 0
global_load_lds_dwordx4 v165, s[56:57]
global_load_dwordx4 v[24:27], v165, s[54:55] offset:2048
s_add_u32 m0, s58, 8192
s_add_u32 s56, s56, 1024
s_addc_u32 s57, s57, 0
global_load_lds_dwordx4 v165, s[56:57]
global_load_dwordx4 v[28:31], v165, s[54:55] offset:3072
s_add_u32 m0, s58, 9216
s_add_u32 s56, s56, 1024
s_addc_u32 s57, s57, 0
global_load_lds_dwordx4 v165, s[56:57]
s_waitcnt vmcnt(0)
s_mov_b32 exec_lo, 0x13ffff
s_mov_b32 exec_hi, 0x13ffff
ds_read_b128 v[48:51], v163 offset:1216
ds_read_b128 v[52:55], v163 offset:1824
s_mov_b64 exec, -1
s_mov_b32 exec_lo, 0x13ffff
s_mov_b32 exec_hi, 0x13ffff
ds_read_b128 v[56:59], v163 offset:2432
ds_read_b128 v[60:63], v163 offset:3040
s_mov_b64 exec, -1
s_mov_b32 exec_lo, 0x13ffff
s_mov_b32 exec_hi, 0x13ffff
ds_read_b128 v[64:67], v163 offset:3648
ds_read_b128 v[68:71], v163 offset:4256
s_mov_b64 exec, -1
s_mov_b32 exec_lo, 0x13ffff
s_mov_b32 exec_hi, 0x13ffff
ds_read_b128 v[72:75], v163 offset:4864
ds_read_b128 v[76:79], v163 offset:5472
s_mov_b64 exec, -1
s_mov_b32 exec_lo, 0x13ffff
s_mov_b32 exec_hi, 0x13ffff
ds_read_b128 v[80:83], v163 offset:6080
ds_read_b128 v[84:87], v163 offset:6688
s_mov_b64 exec, -1
s_mov_b32 exec_lo, 0x13ffff
s_mov_b32 exec_hi, 0x13ffff
ds_read_b128 v[88:91], v163 offset:7296
ds_read_b128 v[92:95], v163 offset:7904
s_mov_b64 exec, -1
s_mov_b32 exec_lo, 0x13ffff
s_mov_b32 exec_hi, 0x13ffff
ds_read_b128 v[96:99], v163 offset:8512
ds_read_b128 v[100:103], v163 offset:9120
s_mov_b64 exec, -1
s_waitcnt lgkmcnt(0)
ds_write_b8 v162, v33 offset:520
A_slowgo:
s_mov_b32 s61, 0
v_mov_b32 v160, 0xff800000
v_mfma_f32_32x32x16_bf16 v[104:119], v[0:3], v[152:155], 0
v_mfma_f32_32x32x8_bf16 v[104:119], v[32:33], v[156:157], v[104:119]
s_nop 11
v_max3_f32 v160, v160, v104, v105
v_max3_f32 v160, v160, v106, v107
v_max3_f32 v160, v160, v108, v109
v_max3_f32 v160, v160, v110, v111
v_max3_f32 v160, v160, v112, v113
v_max3_f32 v160, v160, v114, v115
v_max3_f32 v160, v160, v116, v117
v_max3_f32 v160, v160, v118, v119
v_mfma_f32_32x32x16_bf16 v[104:119], v[4:7], v[152:155], 0
v_mfma_f32_32x32x8_bf16 v[104:119], v[32:33], v[158:159], v[104:119]
s_nop 11
v_max3_f32 v160, v160, v104, v105
v_max3_f32 v160, v160, v106, v107
v_max3_f32 v160, v160, v108, v109
v_max3_f32 v160, v160, v110, v111
v_max3_f32 v160, v160, v112, v113
v_max3_f32 v160, v160, v114, v115
v_max3_f32 v160, v160, v116, v117
v_max3_f32 v160, v160, v118, v119
v_mfma_f32_32x32x16_bf16 v[104:119], v[8:11], v[152:155], 0
v_mfma_f32_32x32x8_bf16 v[104:119], v[34:35], v[156:157], v[104:119]
s_nop 11
v_max3_f32 v160, v160, v104, v105
v_max3_f32 v160, v160, v106, v107
v_max3_f32 v160, v160, v108, v109
v_max3_f32 v160, v160, v110, v111
v_max3_f32 v160, v160, v112, v113
v_max3_f32 v160, v160, v114, v115
v_max3_f32 v160, v160, v116, v117
v_max3_f32 v160, v160, v118, v119
v_mfma_f32_32x32x16_bf16 v[104:119], v[12:15], v[152:155], 0
v_mfma_f32_32x32x8_bf16 v[104:119], v[34:35], v[158:159], v[104:119]
s_nop 11
v_max3_f32 v160, v160, v104, v105
v_max3_f32 v160, v160, v106, v107
v_max3_f32 v160, v160, v108, v109
v_max3_f32 v160, v160, v110, v111
v_max3_f32 v160, v160, v112, v113
v_max3_f32 v160, v160, v114, v115
v_max3_f32 v160, v160, v116, v117
v_max3_f32 v160, v160, v118, v119
v_mfma_f32_32x32x16_bf16 v[104:119], v[16:19], v[152:155], 0
v_mfma_f32_32x32x8_bf16 v[104:119], v[36:37], v[156:157], v[104:119]
s_nop 11
v_max3_f32 v160, v160, v104, v105
v_max3_f32 v160, v160, v106, v107
v_max3_f32 v160, v160, v108, v109
v_max3_f32 v160, v160, v110, v111
v_max3_f32 v160, v160, v112, v113
v_max3_f32 v160, v160, v114, v115
v_max3_f32 v160, v160, v116, v117
v_max3_f32 v160, v160, v118, v119
v_mfma_f32_32x32x16_bf16 v[104:119], v[20:23], v[152:155], 0
v_mfma_f32_32x32x8_bf16 v[104:119], v[36:37], v[158:159], v[104:119]
s_nop 11
v_max3_f32 v160, v160, v104, v105
v_max3_f32 v160, v160, v106, v107
v_max3_f32 v160, v160, v108, v109
v_max3_f32 v160, v160, v110, v111
v_max3_f32 v160, v160, v112, v113
v_max3_f32 v160, v160, v114, v115
v_max3_f32 v160, v160, v116, v117
v_max3_f32 v160, v160, v118, v119
v_mfma_f32_32x32x16_bf16 v[104:119], v[24:27], v[152:155], 0
v_mfma_f32_32x32x8_bf16 v[104:119], v[38:39], v[156:157], v[104:119]
s_nop 11
v_max3_f32 v160, v160, v104, v105
v_max3_f32 v160, v160, v106, v107
v_max3_f32 v160, v160, v108, v109
v_max3_f32 v160, v160, v110, v111
v_max3_f32 v160, v160, v112, v113
v_max3_f32 v160, v160, v114, v115
v_max3_f32 v160, v160, v116, v117
v_max3_f32 v160, v160, v118, v119
v_mfma_f32_32x32x16_bf16 v[104:119], v[28:31], v[152:155], 0
v_mfma_f32_32x32x8_bf16 v[104:119], v[38:39], v[158:159], v[104:119]
s_nop 11
v_max3_f32 v160, v160, v104, v105
v_max3_f32 v160, v160, v106, v107
v_max3_f32 v160, v160, v108, v109
v_max3_f32 v160, v160, v110, v111
v_max3_f32 v160, v160, v112, v113
v_max3_f32 v160, v160, v114, v115
v_max3_f32 v160, v160, v116, v117
v_max3_f32 v160, v160, v118, v119
v_mov_b32 v161, v160
s_nop 1
v_permlane32_swap_b32 v160, v161
v_max_f32 v160, v160, v161
s_lshl_b32 s50, s40, 7
v_add_u32 v161, s50, v166
ds_max_f32 v161, v160 offset:1024
s_lshl_b32 s50, s40, 2
v_mov_b32 v163, s50
v_mov_b32 v160, 1
s_mov_b64 exec, 1
ds_add_u32 v163, v160 offset:608
s_mov_b64 exec, -1
A_sm_re:
ds_read_b32 v160, v163 offset:608
s_waitcnt lgkmcnt(0)
v_cmp_ne_u32 vcc, 8, v160
s_cbranch_vccz A_sm_ok
s_add_u32 s52, s52, 1
s_cmp_gt_u32 s52, 200000
s_cbranch_scc1 A_sm_ok
s_sleep 1
s_branch A_sm_re
A_sm_ok:
ds_read_b32 v160, v161 offset:1024
s_waitcnt lgkmcnt(0)
v_cvt_pk_bf16_f32 v161, v160, v160
v_and_b32 v161, 0xffff0000, v161
v_sub_f32 v163, v160, v161
v_cvt_pk_bf16_f32 v161, v161, v163
v_xor_b32 v161, 0x80008000, v161
v_cndmask_b32 v157, 0, v161, s[44:45]
v_cndmask_b32 v159, 0, v161, s[46:47]
v_mfma_f32_32x32x16_bf16 v[104:119], v[0:3], v[152:155], 0
v_mfma_f32_32x32x8_bf16 v[104:119], v[32:33], v[156:157], v[104:119]
s_nop 11
v_exp_f32 v104, v104
v_exp_f32 v105, v105
v_exp_f32 v106, v106
v_exp_f32 v107, v107
v_exp_f32 v108, v108
v_exp_f32 v109, v109
v_exp_f32 v110, v110
v_exp_f32 v111, v111
v_exp_f32 v112, v112
v_exp_f32 v113, v113
v_exp_f32 v114, v114
v_exp_f32 v115, v115
v_exp_f32 v116, v116
v_exp_f32 v117, v117
v_exp_f32 v118, v118
v_exp_f32 v119, v119
v_cvt_pk_bf16_f32 v104, v104, v105
v_cvt_pk_bf16_f32 v105, v106, v107
v_cvt_pk_bf16_f32 v106, v108, v109
v_cvt_pk_bf16_f32 v107, v110, v111
v_cvt_pk_bf16_f32 v108, v112, v113
v_cvt_pk_bf16_f32 v109, v114, v115
v_cvt_pk_bf16_f32 v110, v116, v117
v_cvt_pk_bf16_f32 v111, v118, v119
v_mfma_f32_32x32x16_bf16 v[136:151], v[40:43], v[104:107], 0
s_nop 0
v_mfma_f32_32x32x16_bf16 v[136:151], v[44:47], v[108:111], v[136:151]
v_mfma_f32_32x32x16_bf16 v[104:119], v[4:7], v[152:155], 0
v_mfma_f32_32x32x8_bf16 v[104:119], v[32:33], v[158:159], v[104:119]
s_nop 11
v_exp_f32 v104, v104
v_exp_f32 v105, v105
v_exp_f32 v106, v106
v_exp_f32 v107, v107
v_exp_f32 v108, v108
v_exp_f32 v109, v109
v_exp_f32 v110, v110
v_exp_f32 v111, v111
v_exp_f32 v112, v112
v_exp_f32 v113, v113
v_exp_f32 v114, v114
v_exp_f32 v115, v115
v_exp_f32 v116, v116
v_exp_f32 v117, v117
v_exp_f32 v118, v118
v_exp_f32 v119, v119
v_cvt_pk_bf16_f32 v104, v104, v105
v_cvt_pk_bf16_f32 v105, v106, v107
v_cvt_pk_bf16_f32 v106, v108, v109
v_cvt_pk_bf16_f32 v107, v110, v111
v_cvt_pk_bf16_f32 v108, v112, v113
v_cvt_pk_bf16_f32 v109, v114, v115
v_cvt_pk_bf16_f32 v110, v116, v117
v_cvt_pk_bf16_f32 v111, v118, v119
v_mfma_f32_32x32x16_bf16 v[136:151], v[48:51], v[104:107], v[136:151]
s_nop 0
v_mfma_f32_32x32x16_bf16 v[136:151], v[52:55], v[108:111], v[136:151]
v_mfma_f32_32x32x16_bf16 v[104:119], v[8:11], v[152:155], 0
v_mfma_f32_32x32x8_bf16 v[104:119], v[34:35], v[156:157], v[104:119]
s_nop 11
v_exp_f32 v104, v104
v_exp_f32 v105, v105
v_exp_f32 v106, v106
v_exp_f32 v107, v107
v_exp_f32 v108, v108
v_exp_f32 v109, v109
v_exp_f32 v110, v110
v_exp_f32 v111, v111
v_exp_f32 v112, v112
v_exp_f32 v113, v113
v_exp_f32 v114, v114
v_exp_f32 v115, v115
v_exp_f32 v116, v116
v_exp_f32 v117, v117
v_exp_f32 v118, v118
v_exp_f32 v119, v119
v_cvt_pk_bf16_f32 v104, v104, v105
v_cvt_pk_bf16_f32 v105, v106, v107
v_cvt_pk_bf16_f32 v106, v108, v109
v_cvt_pk_bf16_f32 v107, v110, v111
v_cvt_pk_bf16_f32 v108, v112, v113
v_cvt_pk_bf16_f32 v109, v114, v115
v_cvt_pk_bf16_f32 v110, v116, v117
v_cvt_pk_bf16_f32 v111, v118, v119
v_mfma_f32_32x32x16_bf16 v[136:151], v[56:59], v[104:107], v[136:151]
s_nop 0
v_mfma_f32_32x32x16_bf16 v[136:151], v[60:63], v[108:111], v[136:151]
v_mfma_f32_32x32x16_bf16 v[104:119], v[12:15], v[152:155], 0
v_mfma_f32_32x32x8_bf16 v[104:119], v[34:35], v[158:159], v[104:119]
s_nop 11
v_exp_f32 v104, v104
v_exp_f32 v105, v105
v_exp_f32 v106, v106
v_exp_f32 v107, v107
v_exp_f32 v108, v108
v_exp_f32 v109, v109
v_exp_f32 v110, v110
v_exp_f32 v111, v111
v_exp_f32 v112, v112
v_exp_f32 v113, v113
v_exp_f32 v114, v114
v_exp_f32 v115, v115
v_exp_f32 v116, v116
v_exp_f32 v117, v117
v_exp_f32 v118, v118
v_exp_f32 v119, v119
v_cvt_pk_bf16_f32 v104, v104, v105
v_cvt_pk_bf16_f32 v105, v106, v107
v_cvt_pk_bf16_f32 v106, v108, v109
v_cvt_pk_bf16_f32 v107, v110, v111
v_cvt_pk_bf16_f32 v108, v112, v113
v_cvt_pk_bf16_f32 v109, v114, v115
v_cvt_pk_bf16_f32 v110, v116, v117
v_cvt_pk_bf16_f32 v111, v118, v119
v_mfma_f32_32x32x16_bf16 v[136:151], v[64:67], v[104:107], v[136:151]
s_nop 0
v_mfma_f32_32x32x16_bf16 v[136:151], v[68:71], v[108:111], v[136:151]
v_mfma_f32_32x32x16_bf16 v[104:119], v[16:19], v[152:155], 0
v_mfma_f32_32x32x8_bf16 v[104:119], v[36:37], v[156:157], v[104:119]
s_nop 11
v_exp_f32 v104, v104
v_exp_f32 v105, v105
v_exp_f32 v106, v106
v_exp_f32 v107, v107
v_exp_f32 v108, v108
v_exp_f32 v109, v109
v_exp_f32 v110, v110
v_exp_f32 v111, v111
v_exp_f32 v112, v112
v_exp_f32 v113, v113
v_exp_f32 v114, v114
v_exp_f32 v115, v115
v_exp_f32 v116, v116
v_exp_f32 v117, v117
v_exp_f32 v118, v118
v_exp_f32 v119, v119
v_cvt_pk_bf16_f32 v104, v104, v105
v_cvt_pk_bf16_f32 v105, v106, v107
v_cvt_pk_bf16_f32 v106, v108, v109
v_cvt_pk_bf16_f32 v107, v110, v111
v_cvt_pk_bf16_f32 v108, v112, v113
v_cvt_pk_bf16_f32 v109, v114, v115
v_cvt_pk_bf16_f32 v110, v116, v117
v_cvt_pk_bf16_f32 v111, v118, v119
v_mfma_f32_32x32x16_bf16 v[136:151], v[72:75], v[104:107], v[136:151]
s_nop 0
v_mfma_f32_32x32x16_bf16 v[136:151], v[76:79], v[108:111], v[136:151]
v_mfma_f32_32x32x16_bf16 v[104:119], v[20:23], v[152:155], 0
v_mfma_f32_32x32x8_bf16 v[104:119], v[36:37], v[158:159], v[104:119]
s_nop 11
v_exp_f32 v104, v104
v_exp_f32 v105, v105
v_exp_f32 v106, v106
v_exp_f32 v107, v107
v_exp_f32 v108, v108
v_exp_f32 v109, v109
v_exp_f32 v110, v110
v_exp_f32 v111, v111
v_exp_f32 v112, v112
v_exp_f32 v113, v113
v_exp_f32 v114, v114
v_exp_f32 v115, v115
v_exp_f32 v116, v116
v_exp_f32 v117, v117
v_exp_f32 v118, v118
v_exp_f32 v119, v119
v_cvt_pk_bf16_f32 v104, v104, v105
v_cvt_pk_bf16_f32 v105, v106, v107
v_cvt_pk_bf16_f32 v106, v108, v109
v_cvt_pk_bf16_f32 v107, v110, v111
v_cvt_pk_bf16_f32 v108, v112, v113
v_cvt_pk_bf16_f32 v109, v114, v115
v_cvt_pk_bf16_f32 v110, v116, v117
v_cvt_pk_bf16_f32 v111, v118, v119
v_mfma_f32_32x32x16_bf16 v[136:151], v[80:83], v[104:107], v[136:151]
s_nop 0
v_mfma_f32_32x32x16_bf16 v[136:151], v[84:87], v[108:111], v[136:151]
v_mfma_f32_32x32x16_bf16 v[104:119], v[24:27], v[152:155], 0
v_mfma_f32_32x32x8_bf16 v[104:119], v[38:39], v[156:157], v[104:119]
s_nop 11
v_exp_f32 v104, v104
v_exp_f32 v105, v105
v_exp_f32 v106, v106
v_exp_f32 v107, v107
v_exp_f32 v108, v108
v_exp_f32 v109, v109
v_exp_f32 v110, v110
v_exp_f32 v111, v111
v_exp_f32 v112, v112
v_exp_f32 v113, v113
v_exp_f32 v114, v114
v_exp_f32 v115, v115
v_exp_f32 v116, v116
v_exp_f32 v117, v117
v_exp_f32 v118, v118
v_exp_f32 v119, v119
v_cvt_pk_bf16_f32 v104, v104, v105
v_cvt_pk_bf16_f32 v105, v106, v107
v_cvt_pk_bf16_f32 v106, v108, v109
v_cvt_pk_bf16_f32 v107, v110, v111
v_cvt_pk_bf16_f32 v108, v112, v113
v_cvt_pk_bf16_f32 v109, v114, v115
v_cvt_pk_bf16_f32 v110, v116, v117
v_cvt_pk_bf16_f32 v111, v118, v119
v_mfma_f32_32x32x16_bf16 v[136:151], v[88:91], v[104:107], v[136:151]
s_nop 0
v_mfma_f32_32x32x16_bf16 v[136:151], v[92:95], v[108:111], v[136:151]
v_mfma_f32_32x32x16_bf16 v[104:119], v[28:31], v[152:155], 0
v_mfma_f32_32x32x8_bf16 v[104:119], v[38:39], v[158:159], v[104:119]
s_nop 11
v_exp_f32 v104, v104
v_exp_f32 v105, v105
v_exp_f32 v106, v106
v_exp_f32 v107, v107
v_exp_f32 v108, v108
v_exp_f32 v109, v109
v_exp_f32 v110, v110
v_exp_f32 v111, v111
v_exp_f32 v112, v112
v_exp_f32 v113, v113
v_exp_f32 v114, v114
v_exp_f32 v115, v115
v_exp_f32 v116, v116
v_exp_f32 v117, v117
v_exp_f32 v118, v118
v_exp_f32 v119, v119
v_cvt_pk_bf16_f32 v104, v104, v105
v_cvt_pk_bf16_f32 v105, v106, v107
v_cvt_pk_bf16_f32 v106, v108, v109
v_cvt_pk_bf16_f32 v107, v110, v111
v_cvt_pk_bf16_f32 v108, v112, v113
v_cvt_pk_bf16_f32 v109, v114, v115
v_cvt_pk_bf16_f32 v110, v116, v117
v_cvt_pk_bf16_f32 v111, v118, v119
v_mfma_f32_32x32x16_bf16 v[136:151], v[96:99], v[104:107], v[136:151]
s_nop 0
v_mfma_f32_32x32x16_bf16 v[136:151], v[100:103], v[108:111], v[136:151]
v_mov_b32 v157, 0
v_mov_b32 v159, 0
s_lshl_b32 s50, s40, 3
v_mov_b32 v163, s50
A_sb_re:
ds_read_b32 v161, v163 offset:12
s_waitcnt lgkmcnt(0)
v_cmp_ne_u32 vcc, 1, v161
s_cbranch_vccz A_sb_ok
s_add_u32 s52, s52, 1
s_cmp_gt_u32 s52, 200000
s_cbranch_scc1 A_sb_ok
s_sleep 1
s_branch A_sb_re
A_sb_ok:
s_branch A_dynflush
A_hand0:
s_mov_b32 s40, 0
v_cmp_eq_u32 vcc, 6, v160
s_cbranch_vccnz A_drain
s_add_u32 s52, s52, 1
s_cmp_gt_u32 s52, 200000
s_cbranch_scc1 A_drain
s_sleep 1
ds_read_b64 v[160:161], v157 offset:8
s_waitcnt lgkmcnt(0)
v_lshl_add_u32 v160, v161, 2, v160
v_cmp_ne_u32 vcc, 5, v160
s_branch A_chk0
A_hand1:
s_mov_b32 s40, 1
v_cmp_eq_u32 vcc, 6, v160
s_cbranch_vccnz A_drain
s_add_u32 s52, s52, 1
s_cmp_gt_u32 s52, 200000
s_cbranch_scc1 A_drain
s_sleep 1
ds_read_b64 v[160:161], v157 offset:16
s_waitcnt lgkmcnt(0)
v_lshl_add_u32 v160, v161, 2, v160
v_cmp_ne_u32 vcc, 5, v160
s_branch A_chk1
A_hand2:
s_mov_b32 s40, 2
v_cmp_eq_u32 vcc, 6, v160
s_cbranch_vccnz A_drain
s_add_u32 s52, s52, 1
s_cmp_gt_u32 s52, 200000
s_cbranch_scc1 A_drain
s_sleep 1
ds_read_b64 v[160:161], v157 offset:24
s_waitcnt lgkmcnt(0)
v_lshl_add_u32 v160, v161, 2, v160
v_cmp_ne_u32 vcc, 5, v160
s_branch A_chk2
A_hand3:
s_mov_b32 s40, 3
v_cmp_eq_u32 vcc, 6, v160
s_cbranch_vccnz A_drain
s_add_u32 s52, s52, 1
s_cmp_gt_u32 s52, 200000
s_cbranch_scc1 A_drain
s_sleep 1
ds_read_b64 v[160:161], v157 offset:32
s_waitcnt lgkmcnt(0)
v_lshl_add_u32 v160, v161, 2, v160
v_cmp_ne_u32 vcc, 5, v160
s_branch A_chk3
A_hand4:
s_mov_b32 s40, 4
v_cmp_eq_u32 vcc, 6, v160
s_cbranch_vccnz A_drain
s_add_u32 s52, s52, 1
s_cmp_gt_u32 s52, 200000
s_cbranch_scc1 A_drain
s_sleep 1
ds_read_b64 v[160:161], v157 offset:40
s_waitcnt lgkmcnt(0)
v_lshl_add_u32 v160, v161, 2, v160
v_cmp_ne_u32 vcc, 5, v160
s_branch A_chk4
A_hand5:
s_mov_b32 s40, 5
v_cmp_eq_u32 vcc, 6, v160
s_cbranch_vccnz A_drain
s_add_u32 s52, s52, 1
s_cmp_gt_u32 s52, 200000
s_cbranch_scc1 A_drain
s_sleep 1
ds_read_b64 v[160:161], v157 offset:48
s_waitcnt lgkmcnt(0)
v_lshl_add_u32 v160, v161, 2, v160
v_cmp_ne_u32 vcc, 5, v160
s_branch A_chk5
A_hand6:
s_mov_b32 s40, 6
v_cmp_eq_u32 vcc, 6, v160
s_cbranch_vccnz A_drain
s_add_u32 s52, s52, 1
s_cmp_gt_u32 s52, 200000
s_cbranch_scc1 A_drain
s_sleep 1
ds_read_b64 v[160:161], v157 offset:56
s_waitcnt lgkmcnt(0)
v_lshl_add_u32 v160, v161, 2, v160
v_cmp_ne_u32 vcc, 5, v160
s_branch A_chk6
A_hand7:
s_mov_b32 s40, 7
v_cmp_eq_u32 vcc, 6, v160
s_cbranch_vccnz A_drain7
s_add_u32 s52, s52, 1
s_cmp_gt_u32 s52, 200000
s_cbranch_scc1 A_drain7
s_sleep 1
ds_read_b64 v[160:161], v157 offset:64
s_waitcnt lgkmcnt(0)
v_lshl_add_u32 v160, v161, 2, v160
v_cmp_ne_u32 vcc, 5, v160
s_branch A_chk7
A_done:
s_waitcnt vmcnt(0)
v_mbcnt_lo_u32_b32 v1, -1, 0
v_mbcnt_hi_u32_b32 v1, -1, v1
s_cmp_lg_u32 s3, 0
s_cbranch_scc1 Y_skip
v_lshlrev_b32 v30, 4, v1
s_cmp_eq_u32 s33, 1
s_cbranch_scc1 Y_nopoll
s_add_u32 s50, s30, 0x6dc000
s_addc_u32 s51, s31, 0
s_load_dwordx2 s[60:61], s[50:51], 0
v_add_u32 v31, 0x6de000, v30
v_add_u32 v33, 4096, v31
s_waitcnt lgkmcnt(0)
s_add_u32 s60, s60, 1
s_and_b32 s61, s61, 0xffff
s_lshl_b32 s61, s61, 8
s_mov_b32 s53, 0
Y_poll:
global_load_dwordx4 v[104:107], v31, s[30:31] offset:0 sc1
global_load_dwordx4 v[108:111], v31, s[30:31] offset:1024 sc1
global_load_dwordx4 v[112:115], v31, s[30:31] offset:2048 sc1
global_load_dwordx4 v[116:119], v31, s[30:31] offset:3072 sc1
s_mov_b64 exec, 0xffffffff
global_load_dwordx4 v[120:123], v33, s[30:31] sc1
s_mov_b64 exec, -1
v_mov_b32 v32, 0
s_waitcnt vmcnt(0)
v_bitop3_b32 v32, v104, s60, v32 bitop3:0xbe
v_bitop3_b32 v32, v105, s61, v32 bitop3:0xbe
v_bitop3_b32 v32, v106, s60, v32 bitop3:0xbe
v_bitop3_b32 v32, v107, s61, v32 bitop3:0xbe
v_bitop3_b32 v32, v108, s60, v32 bitop3:0xbe
v_bitop3_b32 v32, v109, s61, v32 bitop3:0xbe
v_bitop3_b32 v32, v110, s60, v32 bitop3:0xbe
v_bitop3_b32 v32, v111, s61, v32 bitop3:0xbe
v_bitop3_b32 v32, v112, s60, v32 bitop3:0xbe
v_bitop3_b32 v32, v113, s61, v32 bitop3:0xbe
v_bitop3_b32 v32, v114, s60, v32 bitop3:0xbe
v_bitop3_b32 v32, v115, s61, v32 bitop3:0xbe
v_bitop3_b32 v32, v116, s60, v32 bitop3:0xbe
v_bitop3_b32 v32, v117, s61, v32 bitop3:0xbe
v_bitop3_b32 v32, v118, s60, v32 bitop3:0xbe
v_bitop3_b32 v32, v119, s61, v32 bitop3:0xbe
s_mov_b64 exec, 0xffffffff
v_bitop3_b32 v32, v120, s60, v32 bitop3:0xbe
v_bitop3_b32 v32, v121, s61, v32 bitop3:0xbe
v_bitop3_b32 v32, v122, s60, v32 bitop3:0xbe
v_bitop3_b32 v32, v123, s61, v32 bitop3:0xbe
s_mov_b64 exec, -1
v_cmp_ne_u32 vcc, 0, v32
s_cbranch_vccz Y_nopoll
s_add_u32 s53, s53, 1
s_cmp_gt_u32 s53, 20000
s_cbranch_scc1 Y_nopoll
s_sleep 2
s_branch Y_poll
Y_nopoll:
s_mul_i32 s50, s2, 9216
s_add_u32 s50, s50, 0x940000
s_add_u32 s54, s30, s50
s_addc_u32 s55, s31, 0
global_load_dwordx4 v[104:107], v30, s[54:55] offset:0 sc1
global_load_dwordx4 v[108:111], v30, s[54:55] offset:1024 sc1
global_load_dwordx4 v[112:115], v30, s[54:55] offset:2048 sc1
global_load_dwordx4 v[116:119], v30, s[54:55] offset:3072 sc1
s_add_u32 s54, s54, 4096
s_addc_u32 s55, s55, 0
global_load_dwordx4 v[120:123], v30, s[54:55] offset:0 sc1
global_load_dwordx4 v[124:127], v30, s[54:55] offset:1024 sc1
global_load_dwordx4 v[128:131], v30, s[54:55] offset:2048 sc1
global_load_dwordx4 v[132:135], v30, s[54:55] offset:3072 sc1
s_add_u32 s54, s54, 4096
s_addc_u32 s55, s55, 0
global_load_dwordx4 v[136:139], v30, s[54:55] offset:0 sc1
v_lshlrev_b32 v31, 1, v1
v_add_u32 v31, 149504, v31
s_waitcnt vmcnt(8)
ds_write_b16 v31, v104 offset:0
ds_write_b16_d16_hi v31, v104 offset:1168
ds_write_b16 v31, v105 offset:2336
ds_write_b16_d16_hi v31, v105 offset:3504
ds_write_b16 v31, v106 offset:4672
ds_write_b16_d16_hi v31, v106 offset:5840
ds_write_b16 v31, v107 offset:7008
ds_write_b16_d16_hi v31, v107 offset:8176
s_waitcnt lgkmcnt(0)
s_waitcnt vmcnt(7)
ds_write_b16 v31, v108 offset:128
ds_write_b16_d16_hi v31, v108 offset:1296
ds_write_b16 v31, v109 offset:2464
ds_write_b16_d16_hi v31, v109 offset:3632
ds_write_b16 v31, v110 offset:4800
ds_write_b16_d16_hi v31, v110 offset:5968
ds_write_b16 v31, v111 offset:7136
ds_write_b16_d16_hi v31, v111 offset:8304
s_waitcnt lgkmcnt(0)
s_waitcnt vmcnt(6)
ds_write_b16 v31, v112 offset:256
ds_write_b16_d16_hi v31, v112 offset:1424
ds_write_b16 v31, v113 offset:2592
ds_write_b16_d16_hi v31, v113 offset:3760
ds_write_b16 v31, v114 offset:4928
ds_write_b16_d16_hi v31, v114 offset:6096
ds_write_b16 v31, v115 offset:7264
ds_write_b16_d16_hi v31, v115 offset:8432
s_waitcnt lgkmcnt(0)
s_waitcnt vmcnt(5)
ds_write_b16 v31, v116 offset:384
ds_write_b16_d16_hi v31, v116 offset:1552
ds_write_b16 v31, v117 offset:2720
ds_write_b16_d16_hi v31, v117 offset:3888
ds_write_b16 v31, v118 offset:5056
ds_write_b16_d16_hi v31, v118 offset:6224
ds_write_b16 v31, v119 offset:7392
ds_write_b16_d16_hi v31, v119 offset:8560
s_waitcnt lgkmcnt(0)
s_waitcnt vmcnt(4)
ds_write_b16 v31, v120 offset:512
ds_write_b16_d16_hi v31, v120 offset:1680
ds_write_b16 v31, v121 offset:2848
ds_write_b16_d16_hi v31, v121 offset:4016
ds_write_b16 v31, v122 offset:5184
ds_write_b16_d16_hi v31, v122 offset:6352
ds_write_b16 v31, v123 offset:7520
ds_write_b16_d16_hi v31, v123 offset:8688
s_waitcnt lgkmcnt(0)
s_waitcnt vmcnt(3)
ds_write_b16 v31, v124 offset:640
ds_write_b16_d16_hi v31, v124 offset:1808
ds_write_b16 v31, v125 offset:2976
ds_write_b16_d16_hi v31, v125 offset:4144
ds_write_b16 v31, v126 offset:5312
ds_write_b16_d16_hi v31, v126 offset:6480
ds_write_b16 v31, v127 offset:7648
ds_write_b16_d16_hi v31, v127 offset:8816
s_waitcnt lgkmcnt(0)
s_waitcnt vmcnt(2)
ds_write_b16 v31, v128 offset:768
ds_write_b16_d16_hi v31, v128 offset:1936
ds_write_b16 v31, v129 offset:3104
ds_write_b16_d16_hi v31, v129 offset:4272
ds_write_b16 v31, v130 offset:5440
ds_write_b16_d16_hi v31, v130 offset:6608
ds_write_b16 v31, v131 offset:7776
ds_write_b16_d16_hi v31, v131 offset:8944
s_waitcnt lgkmcnt(0)
s_waitcnt vmcnt(1)
ds_write_b16 v31, v132 offset:896
ds_write_b16_d16_hi v31, v132 offset:2064
ds_write_b16 v31, v133 offset:3232
ds_write_b16_d16_hi v31, v133 offset:4400
ds_write_b16 v31, v134 offset:5568
ds_write_b16_d16_hi v31, v134 offset:6736
ds_write_b16 v31, v135 offset:7904
ds_write_b16_d16_hi v31, v135 offset:9072
s_waitcnt lgkmcnt(0)
s_waitcnt vmcnt(0)
ds_write_b16 v31, v136 offset:1024
ds_write_b16_d16_hi v31, v136 offset:2192
ds_write_b16 v31, v137 offset:3360
ds_write_b16_d16_hi v31, v137 offset:4528
ds_write_b16 v31, v138 offset:5696
ds_write_b16_d16_hi v31, v138 offset:6864
ds_write_b16 v31, v139 offset:8032
ds_write_b16_d16_hi v31, v139 offset:9200
s_waitcnt lgkmcnt(0)
Y_skip:
s_lshl_b32 s40, s2, 3
s_add_u32 s40, s40, s3
s_mul_i32 s40, s40, 1152
s_add_u32 s42, s30, 0xb80000
s_addc_u32 s43, s31, 0
s_cmp_eq_u32 s33, 0
s_cselect_b32 s42, s4, s42
s_cselect_b32 s43, s5, s43
s_add_u32 s42, s42, s40
s_addc_u32 s43, s43, 0
v_lshlrev_b32 v2, 4, v1
v_lshlrev_b32 v3, 1, v1
global_load_dwordx4 v[4:7], v2, s[42:43]
global_load_ushort v8, v3, s[42:43] offset:1024
s_cmp_ge_u32 s3, 3
s_cbranch_scc1 KVP_skip
s_mul_i32 s62, s3, 18432
s_add_u32 s62, s62, 0x144000
s_add_u32 s64, s30, s62
s_addc_u32 s65, s31, 0
v_lshlrev_b32 v79, 4, v1
global_load_dwordx4 v[80:83], v79, s[64:65] offset:0
global_load_dwordx4 v[84:87], v79, s[64:65] offset:1024
global_load_dwordx4 v[88:91], v79, s[64:65] offset:2048
global_load_dwordx4 v[92:95], v79, s[64:65] offset:3072
s_add_u32 s64, s64, 4096
s_addc_u32 s65, s65, 0
global_load_dwordx4 v[96:99], v79, s[64:65] offset:0
global_load_dwordx4 v[100:103], v79, s[64:65] offset:1024
global_load_dwordx4 v[104:107], v79, s[64:65] offset:2048
global_load_dwordx4 v[108:111], v79, s[64:65] offset:3072
s_add_u32 s64, s64, 4096
s_addc_u32 s65, s65, 0
global_load_dwordx4 v[112:115], v79, s[64:65] offset:0
global_load_dwordx4 v[116:119], v79, s[64:65] offset:1024
global_load_dwordx4 v[120:123], v79, s[64:65] offset:2048
global_load_dwordx4 v[124:127], v79, s[64:65] offset:3072
s_add_u32 s64, s64, 4096
s_addc_u32 s65, s65, 0
global_load_dwordx4 v[128:131], v79, s[64:65] offset:0
global_load_dwordx4 v[132:135], v79, s[64:65] offset:1024
global_load_dwordx4 v[136:139], v79, s[64:65] offset:2048
global_load_dwordx4 v[140:143], v79, s[64:65] offset:3072
s_add_u32 s64, s64, 4096
s_addc_u32 s65, s65, 0
global_load_dwordx4 v[144:147], v79, s[64:65] offset:0
global_load_dwordx4 v[148:151], v79, s[64:65] offset:1024
KVP_skip:
s_add_u32 s46, s30, 0xb80000
s_addc_u32 s47, s31, 0
s_cmp_eq_u32 s33, 0
s_cselect_b32 s46, s46, s26
s_cselect_b32 s47, s47, s27
s_add_u32 s46, s46, s40
s_addc_u32 s47, s47, 0
s_mul_i32 s48, s3, 2320
s_add_u32 s48, s48, 100352
v_lshl_add_u32 v20, v1, 5, s48
v_lshl_add_u32 v21, v1, 2, s48
s_mov_b32 s49, 0xfffff000
s_cmp_ge_u32 s3, 3
s_cbranch_scc1 EP_w0
s_waitcnt vmcnt(18)
s_branch EP_w1
EP_w0:
s_waitcnt vmcnt(0)
EP_w1:
v_lshlrev_b32 v24, 16, v4
v_and_b32 v25, 0xffff0000, v4
v_lshlrev_b32 v26, 16, v5
v_and_b32 v27, 0xffff0000, v5
v_lshlrev_b32 v28, 16, v6
v_and_b32 v29, 0xffff0000, v6
v_lshlrev_b32 v30, 16, v7
v_and_b32 v31, 0xffff0000, v7
v_lshlrev_b32 v32, 16, v8
s_mul_i32 s50, s3, 1168
s_add_u32 s50, s50, 149504
v_lshl_add_u32 v22, v1, 4, s50
v_lshl_add_u32 v23, v1, 1, s50
s_waitcnt lgkmcnt(0)
s_barrier
ds_read_b128 v[12:15], v22
ds_read_u16 v16, v23 offset:1024
ds_read_b128 v[152:155], v20 offset:18560
ds_read_b128 v[156:159], v20 offset:18576
ds_read_b32 v160, v21 offset:20608
ds_read_b128 v[34:37], v20
ds_read_b128 v[38:41], v20 offset:16
ds_read_b32 v42, v21 offset:2048
s_waitcnt lgkmcnt(3)
v_lshlrev_b32 v62, 16, v12
v_and_b32 v63, 0xffff0000, v12
v_lshlrev_b32 v64, 16, v13
v_and_b32 v65, 0xffff0000, v13
v_lshlrev_b32 v66, 16, v14
v_and_b32 v67, 0xffff0000, v14
v_lshlrev_b32 v68, 16, v15
v_and_b32 v69, 0xffff0000, v15
v_lshlrev_b32 v70, 16, v16
v_and_b32 v152, s49, v152
v_and_b32 v153, s49, v153
v_and_b32 v154, s49, v154
v_and_b32 v155, s49, v155
v_and_b32 v156, s49, v156
v_and_b32 v157, s49, v157
v_and_b32 v158, s49, v158
v_and_b32 v159, s49, v159
v_and_b32 v160, s49, v160
s_waitcnt lgkmcnt(0)
v_pk_add_f32 v[34:35], v[34:35], v[152:153]
v_pk_add_f32 v[36:37], v[36:37], v[154:155]
v_pk_add_f32 v[38:39], v[38:39], v[156:157]
v_pk_add_f32 v[40:41], v[40:41], v[158:159]
v_add_f32 v42, v42, v160
v_cvt_pk_bf16_f32 v44, v34, v35
v_cvt_pk_bf16_f32 v45, v36, v37
v_cvt_pk_bf16_f32 v46, v38, v39
v_cvt_pk_bf16_f32 v47, v40, v41
v_cvt_pk_bf16_f32 v42, v42, v42
v_lshlrev_b32 v34, 16, v44
v_and_b32 v35, 0xffff0000, v44
v_lshlrev_b32 v36, 16, v45
v_and_b32 v37, 0xffff0000, v45
v_lshlrev_b32 v38, 16, v46
v_and_b32 v39, 0xffff0000, v46
v_lshlrev_b32 v40, 16, v47
v_and_b32 v41, 0xffff0000, v47
v_and_b32 v42, 0xffff0000, v42
v_pk_add_f32 v[24:25], v[24:25], v[34:35]
v_pk_add_f32 v[26:27], v[26:27], v[36:37]
v_pk_add_f32 v[28:29], v[28:29], v[38:39]
v_pk_add_f32 v[30:31], v[30:31], v[40:41]
v_add_f32 v32, v32, v42
v_cvt_pk_bf16_f32 v44, v24, v25
v_cvt_pk_bf16_f32 v45, v26, v27
v_cvt_pk_bf16_f32 v46, v28, v29
v_cvt_pk_bf16_f32 v47, v30, v31
v_cvt_pk_bf16_f32 v32, v32, v32
v_lshlrev_b32 v24, 16, v44
v_and_b32 v25, 0xffff0000, v44
v_lshlrev_b32 v26, 16, v45
v_and_b32 v27, 0xffff0000, v45
v_lshlrev_b32 v28, 16, v46
v_and_b32 v29, 0xffff0000, v46
v_lshlrev_b32 v30, 16, v47
v_and_b32 v31, 0xffff0000, v47
v_and_b32 v32, 0xffff0000, v32
v_pk_add_f32 v[44:45], v[24:25], v[26:27]
v_pk_add_f32 v[46:47], v[28:29], v[30:31]
v_pk_add_f32 v[44:45], v[44:45], v[46:47]
v_add_f32 v44, v44, v45
v_add_f32 v44, v44, v32
s_nop 1
v_add_f32_dpp v44, v44, v44 row_ror:8 row_mask:0xf bank_mask:0xf
s_nop 1
v_add_f32_dpp v44, v44, v44 row_ror:4 row_mask:0xf bank_mask:0xf
s_nop 1
v_add_f32_dpp v44, v44, v44 row_ror:2 row_mask:0xf bank_mask:0xf
s_nop 1
v_add_f32_dpp v44, v44, v44 row_ror:1 row_mask:0xf bank_mask:0xf
v_mov_b32 v52, v44
s_nop 1
v_permlane16_swap_b32 v44, v52
v_add_f32 v44, v44, v52
v_mov_b32 v52, v44
s_nop 1
v_permlane32_swap_b32 v44, v52
v_add_f32 v44, v44, v52
v_mul_f32 v44, 0x3ae38e39, v44
v_pk_add_f32 v[34:35], v[24:25], v[44:45] op_sel_hi:[1,0] neg_lo:[0,1] neg_hi:[0,1]
v_pk_add_f32 v[36:37], v[26:27], v[44:45] op_sel_hi:[1,0] neg_lo:[0,1] neg_hi:[0,1]
v_pk_add_f32 v[38:39], v[28:29], v[44:45] op_sel_hi:[1,0] neg_lo:[0,1] neg_hi:[0,1]
v_pk_add_f32 v[40:41], v[30:31], v[44:45] op_sel_hi:[1,0] neg_lo:[0,1] neg_hi:[0,1]
v_sub_f32 v42, v32, v44
v_pk_mul_f32 v[46:47], v[34:35], v[34:35]
v_pk_fma_f32 v[46:47], v[36:37], v[36:37], v[46:47]
v_pk_fma_f32 v[46:47], v[38:39], v[38:39], v[46:47]
v_pk_fma_f32 v[46:47], v[40:41], v[40:41], v[46:47]
v_cvt_pk_bf16_f32 v48, v44, v44
v_add_f32 v46, v46, v47
v_fmac_f32 v46, v42, v42
v_and_b32 v48, 0xffff0000, v48
s_nop 0
v_add_f32_dpp v46, v46, v46 row_ror:8 row_mask:0xf bank_mask:0xf
s_nop 1
v_add_f32_dpp v46, v46, v46 row_ror:4 row_mask:0xf bank_mask:0xf
s_nop 1
v_add_f32_dpp v46, v46, v46 row_ror:2 row_mask:0xf bank_mask:0xf
s_nop 1
v_add_f32_dpp v46, v46, v46 row_ror:1 row_mask:0xf bank_mask:0xf
v_mov_b32 v52, v46
s_nop 1
v_permlane16_swap_b32 v46, v52
v_add_f32 v46, v46, v52
v_mov_b32 v52, v46
s_nop 1
v_permlane32_swap_b32 v46, v52
v_add_f32 v46, v46, v52
v_pk_add_f32 v[34:35], v[24:25], v[48:49] op_sel_hi:[1,0] neg_lo:[0,1] neg_hi:[0,1]
v_pk_add_f32 v[36:37], v[26:27], v[48:49] op_sel_hi:[1,0] neg_lo:[0,1] neg_hi:[0,1]
v_pk_add_f32 v[38:39], v[28:29], v[48:49] op_sel_hi:[1,0] neg_lo:[0,1] neg_hi:[0,1]
v_pk_add_f32 v[40:41], v[30:31], v[48:49] op_sel_hi:[1,0] neg_lo:[0,1] neg_hi:[0,1]
v_sub_f32 v42, v32, v48
v_mul_f32 v46, 0x3ae38e39, v46
v_cvt_pk_bf16_f32 v46, v46, v46
v_and_b32 v46, 0xffff0000, v46
v_add_f32 v46, 0x3727c5ac, v46
v_cvt_pk_bf16_f32 v46, v46, v46
v_and_b32 v46, 0xffff0000, v46
v_sqrt_f32 v46, v46
v_cvt_pk_bf16_f32 v50, v34, v35
v_cvt_pk_bf16_f32 v51, v36, v37
v_cvt_pk_bf16_f32 v52, v38, v39
v_cvt_pk_bf16_f32 v53, v40, v41
v_cvt_pk_bf16_f32 v46, v46, v46
v_and_b32 v46, 0xffff0000, v46
v_cvt_pk_bf16_f32 v42, v42, v42
v_rcp_f32 v44, v46
v_lshlrev_b32 v34, 16, v50
v_and_b32 v35, 0xffff0000, v50
v_lshlrev_b32 v36, 16, v51
v_and_b32 v37, 0xffff0000, v51
v_lshlrev_b32 v38, 16, v52
v_and_b32 v39, 0xffff0000, v52
v_lshlrev_b32 v40, 16, v53
v_and_b32 v41, 0xffff0000, v53
v_and_b32 v42, 0xffff0000, v42
v_pk_mul_f32 v[34:35], v[34:35], v[44:45] op_sel_hi:[1,0]
v_pk_mul_f32 v[36:37], v[36:37], v[44:45] op_sel_hi:[1,0]
v_pk_mul_f32 v[38:39], v[38:39], v[44:45] op_sel_hi:[1,0]
v_pk_mul_f32 v[40:41], v[40:41], v[44:45] op_sel_hi:[1,0]
v_mul_f32 v42, v42, v44
v_cvt_pk_bf16_f32 v44, v34, v35
v_cvt_pk_bf16_f32 v45, v36, v37
v_cvt_pk_bf16_f32 v46, v38, v39
v_cvt_pk_bf16_f32 v47, v40, v41
v_cvt_pk_bf16_f32 v42, v42, v42
v_lshlrev_b32 v34, 16, v44
v_and_b32 v35, 0xffff0000, v44
v_lshlrev_b32 v36, 16, v45
v_and_b32 v37, 0xffff0000, v45
v_lshlrev_b32 v38, 16, v46
v_and_b32 v39, 0xffff0000, v46
v_lshlrev_b32 v40, 16, v47
v_and_b32 v41, 0xffff0000, v47
v_and_b32 v42, 0xffff0000, v42
v_pk_mul_f32 v[34:35], v[34:35], v[62:63]
v_pk_mul_f32 v[36:37], v[36:37], v[64:65]
v_pk_mul_f32 v[38:39], v[38:39], v[66:67]
v_pk_mul_f32 v[40:41], v[40:41], v[68:69]
v_mul_f32 v42, v42, v70
v_cvt_pk_bf16_f32 v44, v34, v35
v_cvt_pk_bf16_f32 v45, v36, v37
v_cvt_pk_bf16_f32 v46, v38, v39
v_cvt_pk_bf16_f32 v47, v40, v41
v_cvt_pk_bf16_f32 v42, v42, v42
v_lshlrev_b32 v34, 16, v44
v_and_b32 v35, 0xffff0000, v44
v_lshlrev_b32 v36, 16, v45
v_and_b32 v37, 0xffff0000, v45
v_lshlrev_b32 v38, 16, v46
v_and_b32 v39, 0xffff0000, v46
v_lshlrev_b32 v40, 16, v47
v_and_b32 v41, 0xffff0000, v47
v_and_b32 v42, 0xffff0000, v42
v_pk_add_f32 v[24:25], v[24:25], v[34:35]
v_pk_add_f32 v[26:27], v[26:27], v[36:37]
v_pk_add_f32 v[28:29], v[28:29], v[38:39]
v_pk_add_f32 v[30:31], v[30:31], v[40:41]
v_add_f32 v32, v32, v42
v_cvt_pk_bf16_f32 v56, v24, v25
v_cvt_pk_bf16_f32 v57, v26, v27
v_cvt_pk_bf16_f32 v58, v28, v29
v_cvt_pk_bf16_f32 v59, v30, v31
v_cvt_pk_bf16_f32 v60, v32, v32
global_store_dwordx4 v2, v[56:59], s[46:47]
global_store_short v3, v60, s[46:47] offset:1024
s_cmp_eq_u32 s33, 1
s_cbranch_scc1 L_fin
v_lshlrev_b32 v24, 16, v56
v_and_b32 v25, 0xffff0000, v56
v_lshlrev_b32 v26, 16, v57
v_and_b32 v27, 0xffff0000, v57
v_lshlrev_b32 v28, 16, v58
v_and_b32 v29, 0xffff0000, v58
v_lshlrev_b32 v30, 16, v59
v_and_b32 v31, 0xffff0000, v59
v_lshlrev_b32 v32, 16, v60
v_pk_add_f32 v[44:45], v[24:25], v[26:27]
v_pk_add_f32 v[46:47], v[28:29], v[30:31]
v_pk_add_f32 v[44:45], v[44:45], v[46:47]
v_add_f32 v44, v44, v45
v_add_f32 v44, v44, v32
s_nop 1
v_add_f32_dpp v44, v44, v44 row_ror:8 row_mask:0xf bank_mask:0xf
s_nop 1
v_add_f32_dpp v44, v44, v44 row_ror:4 row_mask:0xf bank_mask:0xf
s_nop 1
v_add_f32_dpp v44, v44, v44 row_ror:2 row_mask:0xf bank_mask:0xf
s_nop 1
v_add_f32_dpp v44, v44, v44 row_ror:1 row_mask:0xf bank_mask:0xf
v_mov_b32 v52, v44
s_nop 1
v_permlane16_swap_b32 v44, v52
v_add_f32 v44, v44, v52
v_mov_b32 v52, v44
s_nop 1
v_permlane32_swap_b32 v44, v52
v_add_f32 v44, v44, v52
v_mul_f32 v44, 0x3ae38e39, v44
v_pk_add_f32 v[34:35], v[24:25], v[44:45] op_sel_hi:[1,0] neg_lo:[0,1] neg_hi:[0,1]
v_pk_add_f32 v[36:37], v[26:27], v[44:45] op_sel_hi:[1,0] neg_lo:[0,1] neg_hi:[0,1]
v_pk_add_f32 v[38:39], v[28:29], v[44:45] op_sel_hi:[1,0] neg_lo:[0,1] neg_hi:[0,1]
v_pk_add_f32 v[40:41], v[30:31], v[44:45] op_sel_hi:[1,0] neg_lo:[0,1] neg_hi:[0,1]
v_sub_f32 v42, v32, v44
v_pk_mul_f32 v[46:47], v[34:35], v[34:35]
v_pk_fma_f32 v[46:47], v[36:37], v[36:37], v[46:47]
v_pk_fma_f32 v[46:47], v[38:39], v[38:39], v[46:47]
v_pk_fma_f32 v[46:47], v[40:41], v[40:41], v[46:47]
v_cvt_pk_bf16_f32 v48, v44, v44
v_add_f32 v46, v46, v47
v_fmac_f32 v46, v42, v42
v_and_b32 v48, 0xffff0000, v48
s_nop 0
v_add_f32_dpp v46, v46, v46 row_ror:8 row_mask:0xf bank_mask:0xf
s_nop 1
v_add_f32_dpp v46, v46, v46 row_ror:4 row_mask:0xf bank_mask:0xf
s_nop 1
v_add_f32_dpp v46, v46, v46 row_ror:2 row_mask:0xf bank_mask:0xf
s_nop 1
v_add_f32_dpp v46, v46, v46 row_ror:1 row_mask:0xf bank_mask:0xf
v_mov_b32 v52, v46
s_nop 1
v_permlane16_swap_b32 v46, v52
v_add_f32 v46, v46, v52
v_mov_b32 v52, v46
s_nop 1
v_permlane32_swap_b32 v46, v52
v_add_f32 v46, v46, v52
v_pk_add_f32 v[34:35], v[24:25], v[48:49] op_sel_hi:[1,0] neg_lo:[0,1] neg_hi:[0,1]
v_pk_add_f32 v[36:37], v[26:27], v[48:49] op_sel_hi:[1,0] neg_lo:[0,1] neg_hi:[0,1]
v_pk_add_f32 v[38:39], v[28:29], v[48:49] op_sel_hi:[1,0] neg_lo:[0,1] neg_hi:[0,1]
v_pk_add_f32 v[40:41], v[30:31], v[48:49] op_sel_hi:[1,0] neg_lo:[0,1] neg_hi:[0,1]
v_sub_f32 v42, v32, v48
v_mul_f32 v46, 0x3ae38e39, v46
v_cvt_pk_bf16_f32 v46, v46, v46
v_and_b32 v46, 0xffff0000, v46
v_add_f32 v46, 0x3727c5ac, v46
v_cvt_pk_bf16_f32 v46, v46, v46
v_and_b32 v46, 0xffff0000, v46
v_sqrt_f32 v46, v46
v_cvt_pk_bf16_f32 v50, v34, v35
v_cvt_pk_bf16_f32 v51, v36, v37
v_cvt_pk_bf16_f32 v52, v38, v39
v_cvt_pk_bf16_f32 v53, v40, v41
v_cvt_pk_bf16_f32 v46, v46, v46
v_and_b32 v46, 0xffff0000, v46
v_cvt_pk_bf16_f32 v42, v42, v42
v_rcp_f32 v44, v46
v_lshlrev_b32 v34, 16, v50
v_and_b32 v35, 0xffff0000, v50
v_lshlrev_b32 v36, 16, v51
v_and_b32 v37, 0xffff0000, v51
v_lshlrev_b32 v38, 16, v52
v_and_b32 v39, 0xffff0000, v52
v_lshlrev_b32 v40, 16, v53
v_and_b32 v41, 0xffff0000, v53
v_and_b32 v42, 0xffff0000, v42
v_pk_mul_f32 v[34:35], v[34:35], v[44:45] op_sel_hi:[1,0]
v_pk_mul_f32 v[36:37], v[36:37], v[44:45] op_sel_hi:[1,0]
v_pk_mul_f32 v[38:39], v[38:39], v[44:45] op_sel_hi:[1,0]
v_pk_mul_f32 v[40:41], v[40:41], v[44:45] op_sel_hi:[1,0]
v_mul_f32 v42, v42, v44
v_cvt_pk_bf16_f32 v72, v34, v35
v_cvt_pk_bf16_f32 v73, v36, v37
v_cvt_pk_bf16_f32 v74, v38, v39
v_cvt_pk_bf16_f32 v75, v40, v41
v_cvt_pk_bf16_f32 v76, v42, v42
s_and_b32 s52, s2, 1
s_lshl_b32 s52, s52, 3
s_add_u32 s52, s52, s3
s_lshl_b32 s52, s52, 4
v_lshrrev_b32 v44, 2, v1
v_lshlrev_b32 v44, 10, v44
v_and_b32 v45, 3, v1
v_lshl_add_u32 v44, v45, 8, v44
v_add_u32 v44, s52, v44
v_lshrrev_b32 v45, 3, v1
v_lshlrev_b32 v45, 8, v45
v_and_b32 v46, 7, v1
v_lshl_add_u32 v45, v46, 1, v45
v_add_u32 v45, s52, v45
v_add_u32 v45, 16384, v45
ds_write_b128 v44, v[72:75] offset:20480
ds_write_b16 v45, v76 offset:20480
s_waitcnt lgkmcnt(0)
s_barrier
s_add_u32 s50, s30, 0x6dc000
s_addc_u32 s51, s31, 0
s_load_dwordx2 s[14:15], s[50:51], 0
s_cmp_ge_u32 s3, 3
s_cbranch_scc1 T_rest
s_cmp_eq_u32 s3, 0
s_cbranch_scc0 KVL_swap
ds_read_b128 v[44:47], v79 offset:20480
ds_read_b128 v[48:51], v79 offset:21504
ds_read_b128 v[52:55], v79 offset:22528
ds_read_b128 v[56:59], v79 offset:23552
ds_read_b128 v[60:63], v79 offset:24576
ds_read_b128 v[64:67], v79 offset:25600
s_waitcnt vmcnt(0)
s_waitcnt lgkmcnt(0)
v_mfma_f32_16x16x32_bf16 v[8:11], v[80:83], v[44:47], 0
ds_read_b128 v[44:47], v79 offset:26624
s_waitcnt lgkmcnt(5)
v_mfma_f32_16x16x32_bf16 v[8:11], v[84:87], v[48:51], v[8:11]
ds_read_b128 v[48:51], v79 offset:27648
s_waitcnt lgkmcnt(5)
v_mfma_f32_16x16x32_bf16 v[8:11], v[88:91], v[52:55], v[8:11]
ds_read_b128 v[52:55], v79 offset:28672
s_waitcnt lgkmcnt(5)
v_mfma_f32_16x16x32_bf16 v[8:11], v[92:95], v[56:59], v[8:11]
ds_read_b128 v[56:59], v79 offset:29696
s_waitcnt lgkmcnt(5)
v_mfma_f32_16x16x32_bf16 v[8:11], v[96:99], v[60:63], v[8:11]
ds_read_b128 v[60:63], v79 offset:30720
s_waitcnt lgkmcnt(5)
v_mfma_f32_16x16x32_bf16 v[8:11], v[100:103], v[64:67], v[8:11]
ds_read_b128 v[64:67], v79 offset:31744
s_waitcnt lgkmcnt(5)
v_mfma_f32_16x16x32_bf16 v[8:11], v[104:107], v[44:47], v[8:11]
ds_read_b128 v[44:47], v79 offset:32768
s_waitcnt lgkmcnt(5)
v_mfma_f32_16x16x32_bf16 v[8:11], v[108:111], v[48:51], v[8:11]
ds_read_b128 v[48:51], v79 offset:33792
s_waitcnt lgkmcnt(5)
v_mfma_f32_16x16x32_bf16 v[8:11], v[112:115], v[52:55], v[8:11]
ds_read_b128 v[52:55], v79 offset:34816
s_waitcnt lgkmcnt(5)
v_mfma_f32_16x16x32_bf16 v[8:11], v[116:119], v[56:59], v[8:11]
ds_read_b128 v[56:59], v79 offset:35840
s_waitcnt lgkmcnt(5)
v_mfma_f32_16x16x32_bf16 v[8:11], v[120:123], v[60:63], v[8:11]
ds_read_b128 v[60:63], v79 offset:36864
s_waitcnt lgkmcnt(5)
v_mfma_f32_16x16x32_bf16 v[8:11], v[124:127], v[64:67], v[8:11]
ds_read_b128 v[64:67], v79 offset:37888
s_waitcnt lgkmcnt(5)
v_mfma_f32_16x16x32_bf16 v[8:11], v[128:131], v[44:47], v[8:11]
s_waitcnt lgkmcnt(4)
v_mfma_f32_16x16x32_bf16 v[8:11], v[132:135], v[48:51], v[8:11]
s_waitcnt lgkmcnt(3)
v_mfma_f32_16x16x32_bf16 v[8:11], v[136:139], v[52:55], v[8:11]
s_waitcnt lgkmcnt(2)
v_mfma_f32_16x16x32_bf16 v[8:11], v[140:143], v[56:59], v[8:11]
s_waitcnt lgkmcnt(1)
v_mfma_f32_16x16x32_bf16 v[8:11], v[144:147], v[60:63], v[8:11]
s_waitcnt lgkmcnt(0)
v_mfma_f32_16x16x32_bf16 v[8:11], v[148:151], v[64:67], v[8:11]
s_branch KVL_done
KVL_swap:
ds_read_b128 v[44:47], v79 offset:20480
ds_read_b128 v[48:51], v79 offset:21504
ds_read_b128 v[52:55], v79 offset:22528
ds_read_b128 v[56:59], v79 offset:23552
ds_read_b128 v[60:63], v79 offset:24576
ds_read_b128 v[64:67], v79 offset:25600
s_waitcnt vmcnt(0)
s_waitcnt lgkmcnt(0)
v_mfma_f32_16x16x32_bf16 v[8:11], v[44:47], v[80:83], 0
ds_read_b128 v[44:47], v79 offset:26624
s_waitcnt lgkmcnt(5)
v_mfma_f32_16x16x32_bf16 v[8:11], v[48:51], v[84:87], v[8:11]
ds_read_b128 v[48:51], v79 offset:27648
s_waitcnt lgkmcnt(5)
v_mfma_f32_16x16x32_bf16 v[8:11], v[52:55], v[88:91], v[8:11]
ds_read_b128 v[52:55], v79 offset:28672
s_waitcnt lgkmcnt(5)
v_mfma_f32_16x16x32_bf16 v[8:11], v[56:59], v[92:95], v[8:11]
ds_read_b128 v[56:59], v79 offset:29696
s_waitcnt lgkmcnt(5)
v_mfma_f32_16x16x32_bf16 v[8:11], v[60:63], v[96:99], v[8:11]
ds_read_b128 v[60:63], v79 offset:30720
s_waitcnt lgkmcnt(5)
v_mfma_f32_16x16x32_bf16 v[8:11], v[64:67], v[100:103], v[8:11]
ds_read_b128 v[64:67], v79 offset:31744
s_waitcnt lgkmcnt(5)
v_mfma_f32_16x16x32_bf16 v[8:11], v[44:47], v[104:107], v[8:11]
ds_read_b128 v[44:47], v79 offset:32768
s_waitcnt lgkmcnt(5)
v_mfma_f32_16x16x32_bf16 v[8:11], v[48:51], v[108:111], v[8:11]
ds_read_b128 v[48:51], v79 offset:33792
s_waitcnt lgkmcnt(5)
v_mfma_f32_16x16x32_bf16 v[8:11], v[52:55], v[112:115], v[8:11]
ds_read_b128 v[52:55], v79 offset:34816
s_waitcnt lgkmcnt(5)
v_mfma_f32_16x16x32_bf16 v[8:11], v[56:59], v[116:119], v[8:11]
ds_read_b128 v[56:59], v79 offset:35840
s_waitcnt lgkmcnt(5)
v_mfma_f32_16x16x32_bf16 v[8:11], v[60:63], v[120:123], v[8:11]
ds_read_b128 v[60:63], v79 offset:36864
s_waitcnt lgkmcnt(5)
v_mfma_f32_16x16x32_bf16 v[8:11], v[64:67], v[124:127], v[8:11]
ds_read_b128 v[64:67], v79 offset:37888
s_waitcnt lgkmcnt(5)
v_mfma_f32_16x16x32_bf16 v[8:11], v[44:47], v[128:131], v[8:11]
s_waitcnt lgkmcnt(4)
v_mfma_f32_16x16x32_bf16 v[8:11], v[48:51], v[132:135], v[8:11]
s_waitcnt lgkmcnt(3)
v_mfma_f32_16x16x32_bf16 v[8:11], v[52:55], v[136:139], v[8:11]
s_waitcnt lgkmcnt(2)
v_mfma_f32_16x16x32_bf16 v[8:11], v[56:59], v[140:143], v[8:11]
s_waitcnt lgkmcnt(1)
v_mfma_f32_16x16x32_bf16 v[8:11], v[60:63], v[144:147], v[8:11]
s_waitcnt lgkmcnt(0)
v_mfma_f32_16x16x32_bf16 v[8:11], v[64:67], v[148:151], v[8:11]
KVL_done:
s_mov_b32 s66, s3
s_lshr_b32 s67, s2, 1
s_and_b32 s68, s2, 1
v_and_b32 v12, 15, v1
v_lshrrev_b32 v13, 4, v1
s_nop 2
v_cvt_pk_bf16_f32 v16, v8, v9
v_cvt_pk_bf16_f32 v17, v10, v11
s_cmp_eq_u32 s66, 0
s_cbranch_scc0 KVS_L0_1
s_lshr_b32 s70, s67, 1
s_lshl_b32 s70, s70, 10
s_and_b32 s71, s67, 1
s_lshl_b32 s71, s71, 8
s_add_u32 s70, s70, s71
s_add_u32 s70, s70, 0x690000
v_lshrrev_b32 v14, 1, v13
v_lshlrev_b32 v14, 9, v14
v_lshl_add_u32 v14, v12, 4, v14
v_and_b32 v15, 1, v13
v_lshl_add_u32 v14, v15, 3, v14
v_add_u32 v14, s70, v14
v_mul_f32 v15, v8, v8
v_fmac_f32 v15, v9, v9
v_fmac_f32 v15, v10, v10
v_fmac_f32 v15, v11, v11
v_mov_b32 v8, v15
s_nop 1
v_permlane16_swap_b32 v15, v8
v_add_f32 v15, v15, v8
v_mov_b32 v8, v15
s_nop 1
v_permlane32_swap_b32 v15, v8
v_add_f32 v15, v15, v8
v_lshrrev_b32 v9, 3, v12
v_cmp_eq_u32 vcc, s68, v9
s_nop 1
v_cndmask_b32 v15, 0, v15, vcc
s_nop 1
v_max_f32_dpp v15, v15, v15 row_ror:8 row_mask:0xf bank_mask:0xf
s_nop 1
v_max_f32_dpp v15, v15, v15 row_ror:4 row_mask:0xf bank_mask:0xf
s_nop 1
v_max_f32_dpp v15, v15, v15 row_ror:2 row_mask:0xf bank_mask:0xf
s_nop 1
v_max_f32_dpp v15, v15, v15 row_ror:1 row_mask:0xf bank_mask:0xf
s_mov_b64 exec, vcc
global_store_dwordx2 v14, v[16:17], s[30:31] sc1
s_mov_b64 exec, 1
s_lshl_b32 s70, s2, 2
s_add_u32 s70, s70, 0x6d8800
v_mov_b32 v14, s70
global_store_dword v14, v15, s[30:31] sc1
s_mov_b64 exec, -1
s_branch KVS_L0_end
KVS_L0_1:
s_mul_i32 s70, s67, 608
s_add_u32 s70, s70, 0x6c4000
v_and_b32 v15, 1, v13
v_mul_u32_u24 v14, 304, v15
v_lshrrev_b32 v15, 1, v13
v_lshl_add_u32 v14, v15, 3, v14
v_add_u32 v14, s70, v14
v_cmp_eq_u32 vcc, s68, v15
s_cmp_eq_u32 s66, 1
s_cbranch_scc0 KVS_L0_2
v_lshl_add_u32 v14, v12, 4, v14
s_mov_b64 exec, vcc
global_store_dwordx2 v14, v[16:17], s[30:31] sc1
s_mov_b64 exec, -1
s_branch KVS_L0_end
KVS_L0_2:
s_mov_b64 s[72:73], vcc
v_add_u32 v15, 14, v12
v_lshl_add_u32 v14, v15, 4, v14
v_and_b32 v15, 14, v12
v_cmp_eq_u32 vcc, 2, v15
s_and_b64 exec, vcc, s[72:73]
global_store_dwordx2 v14, v[16:17], s[30:31] sc1
s_mov_b64 exec, -1
s_lshr_b32 s70, s67, 4
s_lshl_b32 s70, s70, 10
s_lshr_b32 s71, s67, 2
s_and_b32 s71, s71, 3
s_lshl_b32 s71, s71, 2
s_add_u32 s70, s70, s71
s_and_b32 s71, s67, 3
s_lshl_b32 s71, s71, 8
s_add_u32 s70, s70, s71
s_add_u32 s70, s70, 0x6a4000
v_lshlrev_b32 v14, 6, v13
v_lshl_add_u32 v14, v12, 1, v14
v_add_u32 v14, s70, v14
v_mul_f32 v15, v8, v8
v_mul_f32 v8, v9, v9
v_max_f32 v15, v15, v8
v_mul_f32 v8, v10, v10
v_max_f32 v15, v15, v8
v_mul_f32 v8, v11, v11
v_max_f32 v15, v15, v8
v_add_f32 v15, v15, v15
v_cmp_gt_u32 vcc, 2, v12
s_and_b64 s[72:73], vcc, s[72:73]
v_cndmask_b32 v15, 0, v15, s[72:73]
s_nop 1
v_max_f32_dpp v15, v15, v15 row_ror:8 row_mask:0xf bank_mask:0xf
s_nop 1
v_max_f32_dpp v15, v15, v15 row_ror:4 row_mask:0xf bank_mask:0xf
s_nop 1
v_max_f32_dpp v15, v15, v15 row_ror:2 row_mask:0xf bank_mask:0xf
s_nop 1
v_max_f32_dpp v15, v15, v15 row_ror:1 row_mask:0xf bank_mask:0xf
v_mov_b32 v8, v15
s_nop 1
v_permlane16_swap_b32 v15, v8
v_max_f32 v15, v15, v8
v_mov_b32 v8, v15
s_nop 1
v_permlane32_swap_b32 v15, v8
v_max_f32 v15, v15, v8
s_mov_b64 exec, s[72:73]
global_store_short v14, v16, s[30:31] sc1
global_store_short_d16_hi v14, v16, s[30:31] offset:16 sc1
global_store_short v14, v17, s[30:31] offset:32 sc1
global_store_short_d16_hi v14, v17, s[30:31] offset:48 sc1
s_mov_b64 exec, 1
s_lshl_b32 s70, s2, 2
s_add_u32 s70, s70, 0x6d8c00
v_mov_b32 v14, s70
global_store_dword v14, v15, s[30:31] sc1
s_mov_b64 exec, -1
KVS_L0_end:
T_kvdone:
s_waitcnt vmcnt(0) lgkmcnt(0)
v_mov_b32 v2, 158852
v_mov_b32 v3, 1
s_mov_b64 exec, 1
ds_add_rtn_u32 v4, v2, v3
s_waitcnt lgkmcnt(0)
v_readfirstlane_b32 s50, v4
s_cmp_eq_u32 s50, 2
s_cbranch_scc0 T_nobar
s_add_u32 s60, s14, 16
s_and_b32 s61, s15, 0xffff
s_lshl_b32 s61, s61, 8
s_lshl_b32 s47, s2, 3
s_add_u32 s47, s47, 0x6e0000
s_mov_b64 exec, 0xff
v_mul_u32_u24 v2, 2048, v1
v_add_u32 v2, s47, v2
v_mov_b32 v4, s60
v_mov_b32 v5, s61
global_store_dwordx2 v2, v[4:5], s[30:31] sc1
s_mov_b64 exec, -1
T_nobar:
s_mov_b64 exec, -1
s_branch T_wait
T_rest:
v_lshlrev_b32 v2, 4, v1
s_sub_u32 s50, s3, 3
s_lshl_b32 s50, s50, 10
v_add_u32 v3, s50, v2
ds_read_b128 v[8:11], v3 offset:20480
ds_read_b128 v[12:15], v3 offset:25600
ds_read_b128 v[16:19], v3 offset:30720
s_cmp_ge_u32 s3, 6
s_cbranch_scc1 T_nox3
ds_read_b128 v[20:23], v3 offset:35840
T_nox3:
s_lshr_b32 s51, s2, 1
s_mul_i32 s51, s51, 18432
s_add_u32 s51, s51, 0x440000
s_add_u32 s51, s51, s50
s_add_u32 s54, s30, s51
s_addc_u32 s55, s31, 0
s_and_b32 s56, s2, 1
s_cmp_eq_u32 s56, 0
s_mov_b32 s57, 0xff00ff00
s_cselect_b32 s57, 0x00ff00ff, s57
v_mov_b32 v4, 158860
ds_read_b32 v4, v4
s_waitcnt lgkmcnt(0)
v_readfirstlane_b32 s58, v4
s_mov_b32 exec_lo, s57
s_mov_b32 exec_hi, s57
s_cmp_eq_u32 s58, 1
s_cbranch_scc1 T_plain
global_store_dwordx4 v2, v[8:11], s[54:55] sc1
s_add_u32 s54, s54, 5120
s_addc_u32 s55, s55, 0
global_store_dwordx4 v2, v[12:15], s[54:55] sc1
s_add_u32 s54, s54, 5120
s_addc_u32 s55, s55, 0
global_store_dwordx4 v2, v[16:19], s[54:55] sc1
s_add_u32 s54, s54, 5120
s_addc_u32 s55, s55, 0
s_cmp_ge_u32 s3, 6
s_cbranch_scc1 T_nox4
global_store_dwordx4 v2, v[20:23], s[54:55] sc1
s_branch T_nox4
T_plain:
global_store_dwordx4 v2, v[8:11], s[54:55]
s_add_u32 s54, s54, 5120
s_addc_u32 s55, s55, 0
global_store_dwordx4 v2, v[12:15], s[54:55]
s_add_u32 s54, s54, 5120
s_addc_u32 s55, s55, 0
global_store_dwordx4 v2, v[16:19], s[54:55]
s_add_u32 s54, s54, 5120
s_addc_u32 s55, s55, 0
s_cmp_ge_u32 s3, 6
s_cbranch_scc1 T_nox4
global_store_dwordx4 v2, v[20:23], s[54:55]
T_nox4:
s_mov_b64 exec, -1
s_waitcnt vmcnt(0)
v_mov_b32 v2, 158848
v_mov_b32 v3, 1
s_mov_b64 exec, 1
ds_add_u32 v2, v3
s_mov_b64 exec, -1
s_cmp_lg_u32 s3, 3
s_cbranch_scc1 T_wait
s_waitcnt lgkmcnt(0)
s_add_u32 s60, s14, 16
s_and_b32 s61, s15, 0xffff
s_lshl_b32 s61, s61, 8
s_lshr_b32 s50, s2, 1
s_and_b32 s50, s50, 7
s_mul_i32 s50, s50, 2048
s_add_u32 s50, s50, 0x6e0000
v_lshlrev_b32 v2, 4, v1
v_add_u32 v2, s50, v2
s_mov_b32 s52, 0
T_poll:
global_load_dwordx4 v[8:11], v2, s[30:31] offset:0 sc1
global_load_dwordx4 v[12:15], v2, s[30:31] offset:1024 sc1
v_mov_b32 v4, 0
s_waitcnt vmcnt(0)
v_bitop3_b32 v4, v8, s60, v4 bitop3:0xbe
v_bitop3_b32 v4, v9, s61, v4 bitop3:0xbe
v_bitop3_b32 v4, v10, s60, v4 bitop3:0xbe
v_bitop3_b32 v4, v11, s61, v4 bitop3:0xbe
v_bitop3_b32 v4, v12, s60, v4 bitop3:0xbe
v_bitop3_b32 v4, v13, s61, v4 bitop3:0xbe
v_bitop3_b32 v4, v14, s60, v4 bitop3:0xbe
v_bitop3_b32 v4, v15, s61, v4 bitop3:0xbe
v_cmp_ne_u32 vcc, 0, v4
s_cbranch_vccz T_ok
s_add_u32 s52, s52, 1
s_cmp_gt_u32 s52, 20000
s_cbranch_scc1 T_ok
s_branch T_poll
T_ok:
T_pollok:
v_mov_b32 v2, 158856
v_mov_b32 v3, 1
ds_write_b32 v2, v3
T_wait:
s_mov_b32 s33, 1
s_mul_i32 s34, s33, 0x240000
s_add_u32 s34, s34, 0x200000
s_mul_i32 s35, s33, 0x10000
s_add_u32 s35, s35, 0x680000
s_mul_i32 s36, s33, 0x4000
s_add_u32 s36, s36, 0x6a0000
s_mul_i32 s37, s33, 0x14000
s_add_u32 s37, s37, 0x6b0000
s_mul_i32 s38, s33, 0x800
s_add_u32 s38, s38, 0x6d8000
s_mul_i32 s39, s33, 0x900000
s_add_u32 s39, s39, 0xe00000
s_setprio 0
s_mov_b32 s52, 0
v_mov_b32 v157, 0
T_gb_re:
v_mov_b32 v2, 158856
ds_read_b32 v3, v2
s_waitcnt lgkmcnt(0)
v_cmp_ne_u32 vcc, 1, v3
s_cbranch_vccz T_gb_ok
s_add_u32 s52, s52, 1
s_cmp_gt_u32 s52, 200000
s_cbranch_scc1 T_gb_ok
s_sleep 4
s_branch T_gb_re
T_gb_ok:
s_branch A_kv
L_fin:
s_endpgm
L_h0:
s_setprio 3
s_mov_b32 s68, 0x80808080
s_mov_b32 s69, 0x80808080
s_mov_b32 s70, 0x45800000
v_mbcnt_lo_u32_b32 v156, -1, 0
v_mbcnt_hi_u32_b32 v156, -1, v156
v_lshlrev_b32 v157, 4, v156
v_mov_b32 v167, 0
s_and_b32 s40, s2, 1
s_lshr_b32 s41, s2, 1
s_mul_i32 s41, s41, 18432
s_add_u32 s41, s41, s34
s_add_u32 s46, s41, 0
s_add_u32 s42, s30, s46
s_addc_u32 s43, s31, 0
s_mov_b32 m0, 20480
s_nop 0
global_load_lds_dwordx4 v157, s[42:43]
s_add_u32 s46, s41, 4096
s_add_u32 s42, s30, s46
s_addc_u32 s43, s31, 0
s_mov_b32 m0, 24576
s_nop 0
global_load_lds_dwordx4 v157, s[42:43]
s_add_u32 s46, s41, 8192
s_add_u32 s42, s30, s46
s_addc_u32 s43, s31, 0
s_mov_b32 m0, 28672
s_nop 0
global_load_lds_dwordx4 v157, s[42:43]
s_add_u32 s46, s41, 12288
s_add_u32 s42, s30, s46
s_addc_u32 s43, s31, 0
s_mov_b32 m0, 32768
s_nop 0
global_load_lds_dwordx4 v157, s[42:43]
s_add_u32 s46, s41, 16384
s_add_u32 s42, s30, s46
s_addc_u32 s43, s31, 0
s_mov_b32 m0, 36864
s_nop 0
global_load_lds_dwordx4 v157, s[42:43]
s_mul_i32 s46, s40, 294912
s_add_u32 s46, s46, 0x0
s_add_u32 s44, s30, s46
s_addc_u32 s45, s31, 0
global_load_dwordx4 v[0:3], v157, s[44:45] offset:0
global_load_dwordx4 v[4:7], v157, s[44:45] offset:1024
global_load_dwordx4 v[8:11], v157, s[44:45] offset:2048
global_load_dwordx4 v[12:15], v157, s[44:45] offset:3072
s_add_u32 s44, s44, 4096
s_addc_u32 s45, s45, 0
global_load_dwordx4 v[16:19], v157, s[44:45] offset:0
global_load_dwordx4 v[20:23], v157, s[44:45] offset:1024
global_load_dwordx4 v[24:27], v157, s[44:45] offset:2048
global_load_dwordx4 v[28:31], v157, s[44:45] offset:3072
s_add_u32 s44, s44, 4096
s_addc_u32 s45, s45, 0
global_load_dwordx4 v[32:35], v157, s[44:45] offset:0
global_load_dwordx4 v[36:39], v157, s[44:45] offset:1024
global_load_dwordx4 v[40:43], v157, s[44:45] offset:2048
global_load_dwordx4 v[44:47], v157, s[44:45] offset:3072
s_add_u32 s44, s44, 4096
s_addc_u32 s45, s45, 0
global_load_dwordx4 v[48:51], v157, s[44:45] offset:0
global_load_dwordx4 v[52:55], v157, s[44:45] offset:1024
global_load_dwordx4 v[56:59], v157, s[44:45] offset:2048
global_load_dwordx4 v[60:63], v157, s[44:45] offset:3072
s_add_u32 s44, s44, 4096
s_addc_u32 s45, s45, 0
global_load_dwordx4 v[64:67], v157, s[44:45] offset:0
global_load_dwordx4 v[68:71], v157, s[44:45] offset:1024
s_add_u32 s46, 0, 0x6dc000
s_add_u32 s48, s30, s46
s_addc_u32 s49, s31, 0
s_load_dwordx2 s[60:61], s[48:49], 0
v_mov_b32 v159, 1
v_mov_b32 v158, 0
ds_write_b8 v158, v159 offset:528
v_and_b32 v162, 15, v156
v_lshrrev_b32 v163, 4, v156
v_lshrrev_b32 v165, 1, v163
v_lshlrev_b32 v165, 8, v165
v_lshl_add_u32 v165, v162, 4, v165
v_and_b32 v164, 1, v163
v_lshlrev_b32 v164, 10, v164
v_add_u32 v164, v164, v165
v_add_u32 v165, 2048, v165
v_lshrrev_b32 v166, 1, v163
v_lshlrev_b32 v166, 9, v166
v_lshl_add_u32 v166, v162, 4, v166
v_and_b32 v160, 1, v163
v_lshl_add_u32 v166, v160, 3, v166
s_waitcnt vmcnt(18) lgkmcnt(0)
H0_tags:
s_add_u32 s60, s60, s33
s_add_u32 s60, s60, 1
s_and_b32 s62, s60, 0xfff
s_lshr_b32 s63, s60, 12
s_and_b32 s63, s63, 0xfff
s_lshr_b64 s[64:65], s[60:61], 24
s_lshr_b32 s65, s64, 12
s_and_b32 s64, s64, 0xfff
s_and_b32 s65, s65, 0xfff
v_mov_b32 v159, 1
s_mov_b64 exec, 1
ds_add_u32 v167, v159 offset:592
s_mov_b64 exec, -1
s_getreg_b32 s71, hwreg(HW_REG_XCC_ID, 0, 4)
s_and_b32 s61, s61, 0xffff
s_lshl_b32 s61, s61, 8
s_or_b32 s61, s61, s71
s_lshl_b32 s46, s33, 11
s_lshl_b32 s47, s2, 3
s_add_u32 s46, s46, s47
s_add_u32 s46, s46, 0x6dd000
v_mov_b32 v158, s46
v_mov_b32 v148, s60
v_mov_b32 v149, s61
s_mov_b64 exec, 1
global_store_dwordx2 v158, v[148:149], s[30:31] sc1
s_mov_b64 exec, -1
s_mov_b32 s52, 0
H0_sp1_re:
ds_read_b32 v159, v167 offset:592
s_waitcnt lgkmcnt(0)
v_cmp_ne_u32 vcc, 4, v159
s_cbranch_vccz H0_sp1_ok
s_add_u32 s52, s52, 1
s_cmp_gt_u32 s52, 200000
s_cbranch_scc1 H0_sp1_ok
s_sleep 0
s_branch H0_sp1_re
H0_sp1_ok:
ds_read_b128 v[72:75], v157 offset:20480
ds_read_b128 v[76:79], v157 offset:21504
ds_read_b128 v[80:83], v157 offset:22528
ds_read_b128 v[84:87], v157 offset:23552
ds_read_b128 v[88:91], v157 offset:24576
ds_read_b128 v[92:95], v157 offset:25600
ds_read_b128 v[96:99], v157 offset:26624
ds_read_b128 v[100:103], v157 offset:27648
ds_read_b128 v[104:107], v157 offset:28672
s_waitcnt lgkmcnt(0)
ds_read_b128 v[108:111], v157 offset:29696
ds_read_b128 v[112:115], v157 offset:30720
ds_read_b128 v[116:119], v157 offset:31744
ds_read_b128 v[120:123], v157 offset:32768
ds_read_b128 v[124:127], v157 offset:33792
ds_read_b128 v[128:131], v157 offset:34816
ds_read_b128 v[132:135], v157 offset:35840
ds_read_b128 v[136:139], v157 offset:36864
ds_read_b128 v[140:143], v157 offset:37888
s_waitcnt lgkmcnt(0)
s_waitcnt vmcnt(17)
v_mfma_f32_16x16x32_bf16 v[144:147], v[0:3], v[72:75], 0
s_waitcnt vmcnt(16)
v_mfma_f32_16x16x32_bf16 v[144:147], v[4:7], v[76:79], v[144:147]
s_waitcnt vmcnt(15)
v_mfma_f32_16x16x32_bf16 v[144:147], v[8:11], v[80:83], v[144:147]
s_waitcnt vmcnt(14)
v_mfma_f32_16x16x32_bf16 v[144:147], v[12:15], v[84:87], v[144:147]
s_waitcnt vmcnt(13)
v_mfma_f32_16x16x32_bf16 v[144:147], v[16:19], v[88:91], v[144:147]
s_waitcnt vmcnt(12)
v_mfma_f32_16x16x32_bf16 v[144:147], v[20:23], v[92:95], v[144:147]
s_waitcnt vmcnt(11)
v_mfma_f32_16x16x32_bf16 v[144:147], v[24:27], v[96:99], v[144:147]
s_waitcnt vmcnt(10)
v_mfma_f32_16x16x32_bf16 v[144:147], v[28:31], v[100:103], v[144:147]
s_waitcnt vmcnt(9)
v_mfma_f32_16x16x32_bf16 v[144:147], v[32:35], v[104:107], v[144:147]
s_waitcnt vmcnt(8)
v_mfma_f32_16x16x32_bf16 v[144:147], v[36:39], v[108:111], v[144:147]
s_waitcnt vmcnt(7)
v_mfma_f32_16x16x32_bf16 v[144:147], v[40:43], v[112:115], v[144:147]
s_waitcnt vmcnt(6)
v_mfma_f32_16x16x32_bf16 v[144:147], v[44:47], v[116:119], v[144:147]
s_waitcnt vmcnt(5)
v_mfma_f32_16x16x32_bf16 v[144:147], v[48:51], v[120:123], v[144:147]
s_waitcnt vmcnt(4)
v_mfma_f32_16x16x32_bf16 v[144:147], v[52:55], v[124:127], v[144:147]
s_waitcnt vmcnt(3)
v_mfma_f32_16x16x32_bf16 v[144:147], v[56:59], v[128:131], v[144:147]
s_waitcnt vmcnt(2)
v_mfma_f32_16x16x32_bf16 v[144:147], v[60:63], v[132:135], v[144:147]
s_waitcnt vmcnt(1)
v_mfma_f32_16x16x32_bf16 v[144:147], v[64:67], v[136:139], v[144:147]
s_waitcnt vmcnt(0)
v_mfma_f32_16x16x32_bf16 v[144:147], v[68:71], v[140:143], v[144:147]
s_nop 7
v_mul_f32 v144, 0x3eae1a93, v144
v_mul_f32 v145, 0x3eae1a93, v145
v_mul_f32 v146, 0x3eae1a93, v146
v_mul_f32 v147, 0x3eae1a93, v147
v_mul_f32 v158, v144, v144
v_fmac_f32 v158, v145, v145
v_fmac_f32 v158, v146, v146
v_fmac_f32 v158, v147, v147
v_cvt_pk_bf16_f32 v144, v144, v145
v_cvt_pk_bf16_f32 v145, v146, v147
ds_write_b64 v166, v[144:145] offset:2048
v_mov_b32 v160, v158
s_nop 1
v_permlane16_swap_b32 v158, v160
v_add_f32 v158, v158, v160
v_mov_b32 v160, v158
s_nop 1
v_permlane32_swap_b32 v158, v160
v_add_f32 v158, v158, v160
v_mov_b32 v160, 1
s_mov_b64 exec, 0xffff
ds_max_u32 v167, v158 offset:132
s_mov_b64 exec, 1
ds_add_rtn_u32 v159, v167, v160 offset:128
s_mov_b64 exec, -1
s_waitcnt lgkmcnt(0)
v_readfirstlane_b32 s50, v159
s_cmp_eq_u32 s50, 1
s_cbranch_scc0 H0_nf2
H0_fz3_re:
ds_read_b128 v[148:151], v167 offset:576
ds_read_b128 v[152:155], v167 offset:128
s_waitcnt lgkmcnt(0)
v_and_b32 v159, v148, v151
v_cmp_ne_u32 vcc, 1, v159
s_cbranch_vccz H0_fz3_ok
s_add_u32 s52, s52, 1
s_cmp_gt_u32 s52, 200000
s_cbranch_scc1 H0_fz3_ok
s_sleep 0
s_branch H0_fz3_re
H0_fz3_ok:
v_add_f32 v153, v153, v154
v_mul_f32 v153, v153, v150
v_cmp_nge_f32 vcc, s70, v153
s_nop 1
v_cndmask_b32 v153, 1, 2, vcc
s_mov_b64 exec, 1
ds_write_b32 v167, v153 offset:0
s_mov_b64 exec, -1
H0_nf2:
H0_sp4_re:
ds_read_b64 v[148:149], v167 offset:512
s_waitcnt lgkmcnt(0)
v_cmp_ne_u64 vcc, s[68:69], v[148:149]
s_cbranch_vccz H0_sp4_ok
s_add_u32 s52, s52, 1
s_cmp_gt_u32 s52, 200000
s_cbranch_scc1 H0_sp4_ok
s_sleep 1
s_branch H0_sp4_re
H0_sp4_ok:
s_mul_i32 s46, s40, 294912
s_add_u32 s46, s46, 0xd800
s_add_u32 s44, s30, s46
s_addc_u32 s45, s31, 0
global_load_dwordx4 v[0:3], v157, s[44:45] offset:0
global_load_dwordx4 v[4:7], v157, s[44:45] offset:1024
global_load_dwordx4 v[8:11], v157, s[44:45] offset:2048
global_load_dwordx4 v[12:15], v157, s[44:45] offset:3072
s_add_u32 s44, s44, 4096
s_addc_u32 s45, s45, 0
global_load_dwordx4 v[16:19], v157, s[44:45] offset:0
global_load_dwordx4 v[20:23], v157, s[44:45] offset:1024
global_load_dwordx4 v[24:27], v157, s[44:45] offset:2048
global_load_dwordx4 v[28:31], v157, s[44:45] offset:3072
s_add_u32 s44, s44, 4096
s_addc_u32 s45, s45, 0
global_load_dwordx4 v[32:35], v157, s[44:45] offset:0
global_load_dwordx4 v[36:39], v157, s[44:45] offset:1024
global_load_dwordx4 v[40:43], v157, s[44:45] offset:2048
global_load_dwordx4 v[44:47], v157, s[44:45] offset:3072
s_add_u32 s44, s44, 4096
s_addc_u32 s45, s45, 0
global_load_dwordx4 v[48:51], v157, s[44:45] offset:0
global_load_dwordx4 v[52:55], v157, s[44:45] offset:1024
global_load_dwordx4 v[56:59], v157, s[44:45] offset:2048
global_load_dwordx4 v[60:63], v157, s[44:45] offset:3072
s_add_u32 s44, s44, 4096
s_addc_u32 s45, s45, 0
global_load_dwordx4 v[64:67], v157, s[44:45] offset:0
global_load_dwordx4 v[68:71], v157, s[44:45] offset:1024
s_waitcnt vmcnt(17)
v_mfma_f32_16x16x32_bf16 v[144:147], v[0:3], v[72:75], 0
s_waitcnt vmcnt(16)
v_mfma_f32_16x16x32_bf16 v[144:147], v[4:7], v[76:79], v[144:147]
s_waitcnt vmcnt(15)
v_mfma_f32_16x16x32_bf16 v[144:147], v[8:11], v[80:83], v[144:147]
s_waitcnt vmcnt(14)
v_mfma_f32_16x16x32_bf16 v[144:147], v[12:15], v[84:87], v[144:147]
s_waitcnt vmcnt(13)
v_mfma_f32_16x16x32_bf16 v[144:147], v[16:19], v[88:91], v[144:147]
s_waitcnt vmcnt(12)
v_mfma_f32_16x16x32_bf16 v[144:147], v[20:23], v[92:95], v[144:147]
s_waitcnt vmcnt(11)
v_mfma_f32_16x16x32_bf16 v[144:147], v[24:27], v[96:99], v[144:147]
s_waitcnt vmcnt(10)
v_mfma_f32_16x16x32_bf16 v[144:147], v[28:31], v[100:103], v[144:147]
s_waitcnt vmcnt(9)
v_mfma_f32_16x16x32_bf16 v[144:147], v[32:35], v[104:107], v[144:147]
s_waitcnt vmcnt(8)
v_mfma_f32_16x16x32_bf16 v[144:147], v[36:39], v[108:111], v[144:147]
s_waitcnt vmcnt(7)
v_mfma_f32_16x16x32_bf16 v[144:147], v[40:43], v[112:115], v[144:147]
s_waitcnt vmcnt(6)
v_mfma_f32_16x16x32_bf16 v[144:147], v[44:47], v[116:119], v[144:147]
s_waitcnt vmcnt(5)
v_mfma_f32_16x16x32_bf16 v[144:147], v[48:51], v[120:123], v[144:147]
s_waitcnt vmcnt(4)
v_mfma_f32_16x16x32_bf16 v[144:147], v[52:55], v[124:127], v[144:147]
s_waitcnt vmcnt(3)
v_mfma_f32_16x16x32_bf16 v[144:147], v[56:59], v[128:131], v[144:147]
s_waitcnt vmcnt(2)
v_mfma_f32_16x16x32_bf16 v[144:147], v[60:63], v[132:135], v[144:147]
s_waitcnt vmcnt(1)
v_mfma_f32_16x16x32_bf16 v[144:147], v[64:67], v[136:139], v[144:147]
s_waitcnt vmcnt(0)
v_mfma_f32_16x16x32_bf16 v[144:147], v[68:71], v[140:143], v[144:147]
s_nop 7
v_mul_f32 v144, 0x3eae1a93, v144
v_mul_f32 v145, 0x3eae1a93, v145
v_mul_f32 v146, 0x3eae1a93, v146
v_mul_f32 v147, 0x3eae1a93, v147
v_mul_f32 v158, v144, v144
v_fmac_f32 v158, v145, v145
v_fmac_f32 v158, v146, v146
v_fmac_f32 v158, v147, v147
v_cvt_pk_bf16_f32 v144, v144, v145
v_cvt_pk_bf16_f32 v145, v146, v147
ds_write_b64 v166, v[144:145] offset:3328
v_mov_b32 v160, v158
s_nop 1
v_permlane16_swap_b32 v158, v160
v_add_f32 v158, v158, v160
v_mov_b32 v160, v158
s_nop 1
v_permlane32_swap_b32 v158, v160
v_add_f32 v158, v158, v160
v_mov_b32 v160, 1
s_mov_b64 exec, 0xffff
ds_max_u32 v167, v158 offset:148
s_mov_b64 exec, 1
ds_add_rtn_u32 v159, v167, v160 offset:144
s_mov_b64 exec, -1
s_waitcnt lgkmcnt(0)
v_readfirstlane_b32 s50, v159
s_cmp_eq_u32 s50, 1
s_cbranch_scc0 H0_nf5
H0_fz6_re:
ds_read_b128 v[148:151], v167 offset:576
ds_read_b128 v[152:155], v167 offset:144
s_waitcnt lgkmcnt(0)
v_and_b32 v159, v148, v151
v_cmp_ne_u32 vcc, 1, v159
s_cbranch_vccz H0_fz6_ok
s_add_u32 s52, s52, 1
s_cmp_gt_u32 s52, 200000
s_cbranch_scc1 H0_fz6_ok
s_sleep 0
s_branch H0_fz6_re
H0_fz6_ok:
v_add_f32 v153, v153, v154
v_mul_f32 v153, v153, v150
v_cmp_nge_f32 vcc, s70, v153
s_nop 1
v_cndmask_b32 v153, 1, 2, vcc
s_mov_b64 exec, 1
ds_write_b32 v167, v153 offset:8
s_mov_b64 exec, -1
H0_nf5:
H0_sp7_re:
ds_read_b64 v[148:149], v167 offset:520
s_waitcnt lgkmcnt(0)
v_cmp_ne_u64 vcc, s[68:69], v[148:149]
s_cbranch_vccz H0_sp7_ok
s_add_u32 s52, s52, 1
s_cmp_gt_u32 s52, 200000
s_cbranch_scc1 H0_sp7_ok
s_sleep 3
s_branch H0_sp7_re
H0_sp7_ok:
s_mul_i32 s46, s40, 294912
s_add_u32 s46, s46, 0x1f800
s_add_u32 s44, s30, s46
s_addc_u32 s45, s31, 0
global_load_dwordx4 v[0:3], v157, s[44:45] offset:0
global_load_dwordx4 v[4:7], v157, s[44:45] offset:1024
global_load_dwordx4 v[8:11], v157, s[44:45] offset:2048
global_load_dwordx4 v[12:15], v157, s[44:45] offset:3072
s_add_u32 s44, s44, 4096
s_addc_u32 s45, s45, 0
global_load_dwordx4 v[16:19], v157, s[44:45] offset:0
global_load_dwordx4 v[20:23], v157, s[44:45] offset:1024
global_load_dwordx4 v[24:27], v157, s[44:45] offset:2048
global_load_dwordx4 v[28:31], v157, s[44:45] offset:3072
s_add_u32 s44, s44, 4096
s_addc_u32 s45, s45, 0
global_load_dwordx4 v[32:35], v157, s[44:45] offset:0
global_load_dwordx4 v[36:39], v157, s[44:45] offset:1024
global_load_dwordx4 v[40:43], v157, s[44:45] offset:2048
global_load_dwordx4 v[44:47], v157, s[44:45] offset:3072
s_add_u32 s44, s44, 4096
s_addc_u32 s45, s45, 0
global_load_dwordx4 v[48:51], v157, s[44:45] offset:0
global_load_dwordx4 v[52:55], v157, s[44:45] offset:1024
global_load_dwordx4 v[56:59], v157, s[44:45] offset:2048
global_load_dwordx4 v[60:63], v157, s[44:45] offset:3072
s_add_u32 s44, s44, 4096
s_addc_u32 s45, s45, 0
global_load_dwordx4 v[64:67], v157, s[44:45] offset:0
global_load_dwordx4 v[68:71], v157, s[44:45] offset:1024
s_mul_i32 s46, s40, 294912
s_add_u32 s46, s46, 0x31800
s_add_u32 s44, s30, s46
s_addc_u32 s45, s31, 0
s_waitcnt vmcnt(17)
v_mfma_f32_16x16x32_bf16 v[144:147], v[0:3], v[72:75], 0
global_load_dwordx4 v[0:3], v157, s[44:45] offset:0
s_waitcnt vmcnt(17)
v_mfma_f32_16x16x32_bf16 v[144:147], v[4:7], v[76:79], v[144:147]
global_load_dwordx4 v[4:7], v157, s[44:45] offset:1024
s_waitcnt vmcnt(17)
v_mfma_f32_16x16x32_bf16 v[144:147], v[8:11], v[80:83], v[144:147]
global_load_dwordx4 v[8:11], v157, s[44:45] offset:2048
s_waitcnt vmcnt(17)
v_mfma_f32_16x16x32_bf16 v[144:147], v[12:15], v[84:87], v[144:147]
global_load_dwordx4 v[12:15], v157, s[44:45] offset:3072
s_waitcnt vmcnt(17)
v_mfma_f32_16x16x32_bf16 v[144:147], v[16:19], v[88:91], v[144:147]
s_add_u32 s44, s44, 4096
s_addc_u32 s45, s45, 0
global_load_dwordx4 v[16:19], v157, s[44:45] offset:0
s_waitcnt vmcnt(17)
v_mfma_f32_16x16x32_bf16 v[144:147], v[20:23], v[92:95], v[144:147]
global_load_dwordx4 v[20:23], v157, s[44:45] offset:1024
s_waitcnt vmcnt(17)
v_mfma_f32_16x16x32_bf16 v[144:147], v[24:27], v[96:99], v[144:147]
global_load_dwordx4 v[24:27], v157, s[44:45] offset:2048
s_waitcnt vmcnt(17)
v_mfma_f32_16x16x32_bf16 v[144:147], v[28:31], v[100:103], v[144:147]
global_load_dwordx4 v[28:31], v157, s[44:45] offset:3072
s_waitcnt vmcnt(17)
v_mfma_f32_16x16x32_bf16 v[144:147], v[32:35], v[104:107], v[144:147]
s_add_u32 s44, s44, 4096
s_addc_u32 s45, s45, 0
global_load_dwordx4 v[32:35], v157, s[44:45] offset:0
s_waitcnt vmcnt(17)
v_mfma_f32_16x16x32_bf16 v[144:147], v[36:39], v[108:111], v[144:147]
global_load_dwordx4 v[36:39], v157, s[44:45] offset:1024
s_waitcnt vmcnt(17)
v_mfma_f32_16x16x32_bf16 v[144:147], v[40:43], v[112:115], v[144:147]
global_load_dwordx4 v[40:43], v157, s[44:45] offset:2048
s_waitcnt vmcnt(17)
v_mfma_f32_16x16x32_bf16 v[144:147], v[44:47], v[116:119], v[144:147]
global_load_dwordx4 v[44:47], v157, s[44:45] offset:3072
s_waitcnt vmcnt(17)
v_mfma_f32_16x16x32_bf16 v[144:147], v[48:51], v[120:123], v[144:147]
s_add_u32 s44, s44, 4096
s_addc_u32 s45, s45, 0
global_load_dwordx4 v[48:51], v157, s[44:45] offset:0
s_waitcnt vmcnt(17)
v_mfma_f32_16x16x32_bf16 v[144:147], v[52:55], v[124:127], v[144:147]
global_load_dwordx4 v[52:55], v157, s[44:45] offset:1024
s_waitcnt vmcnt(17)
v_mfma_f32_16x16x32_bf16 v[144:147], v[56:59], v[128:131], v[144:147]
global_load_dwordx4 v[56:59], v157, s[44:45] offset:2048
s_waitcnt vmcnt(17)
v_mfma_f32_16x16x32_bf16 v[144:147], v[60:63], v[132:135], v[144:147]
global_load_dwordx4 v[60:63], v157, s[44:45] offset:3072
s_waitcnt vmcnt(17)
v_mfma_f32_16x16x32_bf16 v[144:147], v[64:67], v[136:139], v[144:147]
s_add_u32 s44, s44, 4096
s_addc_u32 s45, s45, 0
global_load_dwordx4 v[64:67], v157, s[44:45] offset:0
s_waitcnt vmcnt(17)
v_mfma_f32_16x16x32_bf16 v[144:147], v[68:71], v[140:143], v[144:147]
global_load_dwordx4 v[68:71], v157, s[44:45] offset:1024
s_nop 6
v_mul_f32 v144, 0x3eae1a93, v144
v_mul_f32 v145, 0x3eae1a93, v145
v_mul_f32 v146, 0x3eae1a93, v146
v_mul_f32 v147, 0x3eae1a93, v147
v_mul_f32 v158, v144, v144
v_fmac_f32 v158, v145, v145
v_fmac_f32 v158, v146, v146
v_fmac_f32 v158, v147, v147
v_cvt_pk_bf16_f32 v144, v144, v145
v_cvt_pk_bf16_f32 v145, v146, v147
ds_write_b64 v166, v[144:145] offset:5376
v_mov_b32 v160, v158
s_nop 1
v_permlane16_swap_b32 v158, v160
v_add_f32 v158, v158, v160
v_mov_b32 v160, v158
s_nop 1
v_permlane32_swap_b32 v158, v160
v_add_f32 v158, v158, v160
v_mov_b32 v160, 1
s_mov_b64 exec, 0xffff
ds_max_u32 v167, v158 offset:180
s_mov_b64 exec, 1
ds_add_rtn_u32 v159, v167, v160 offset:176
s_mov_b64 exec, -1
s_waitcnt lgkmcnt(0)
v_readfirstlane_b32 s50, v159
s_cmp_eq_u32 s50, 1
s_cbranch_scc0 H0_nf8
H0_fz9_re:
ds_read_b128 v[148:151], v167 offset:576
ds_read_b128 v[152:155], v167 offset:176
s_waitcnt lgkmcnt(0)
v_and_b32 v159, v148, v151
v_cmp_ne_u32 vcc, 1, v159
s_cbranch_vccz H0_fz9_ok
s_add_u32 s52, s52, 1
s_cmp_gt_u32 s52, 200000
s_cbranch_scc1 H0_fz9_ok
s_sleep 0
s_branch H0_fz9_re
H0_fz9_ok:
v_add_f32 v153, v153, v154
v_mul_f32 v153, v153, v150
v_cmp_nge_f32 vcc, s70, v153
s_nop 1
v_cndmask_b32 v153, 1, 2, vcc
s_mov_b64 exec, 1
ds_write_b32 v167, v153 offset:24
s_mov_b64 exec, -1
H0_nf8:
s_mul_i32 s46, s40, 294912
s_add_u32 s46, s46, 0x43800
s_add_u32 s44, s30, s46
s_addc_u32 s45, s31, 0
s_waitcnt vmcnt(17)
v_mfma_f32_16x16x32_bf16 v[144:147], v[0:3], v[72:75], 0
global_load_dwordx4 v[0:3], v157, s[44:45] offset:0
s_waitcnt vmcnt(17)
v_mfma_f32_16x16x32_bf16 v[144:147], v[4:7], v[76:79], v[144:147]
global_load_dwordx4 v[4:7], v157, s[44:45] offset:1024
s_waitcnt vmcnt(17)
v_mfma_f32_16x16x32_bf16 v[144:147], v[8:11], v[80:83], v[144:147]
global_load_dwordx4 v[8:11], v157, s[44:45] offset:2048
s_waitcnt vmcnt(17)
v_mfma_f32_16x16x32_bf16 v[144:147], v[12:15], v[84:87], v[144:147]
global_load_dwordx4 v[12:15], v157, s[44:45] offset:3072
s_waitcnt vmcnt(17)
v_mfma_f32_16x16x32_bf16 v[144:147], v[16:19], v[88:91], v[144:147]
s_add_u32 s44, s44, 4096
s_addc_u32 s45, s45, 0
global_load_dwordx4 v[16:19], v157, s[44:45] offset:0
s_waitcnt vmcnt(17)
v_mfma_f32_16x16x32_bf16 v[144:147], v[20:23], v[92:95], v[144:147]
global_load_dwordx4 v[20:23], v157, s[44:45] offset:1024
s_waitcnt vmcnt(17)
v_mfma_f32_16x16x32_bf16 v[144:147], v[24:27], v[96:99], v[144:147]
global_load_dwordx4 v[24:27], v157, s[44:45] offset:2048
s_waitcnt vmcnt(17)
v_mfma_f32_16x16x32_bf16 v[144:147], v[28:31], v[100:103], v[144:147]
global_load_dwordx4 v[28:31], v157, s[44:45] offset:3072
s_waitcnt vmcnt(17)
v_mfma_f32_16x16x32_bf16 v[144:147], v[32:35], v[104:107], v[144:147]
s_add_u32 s44, s44, 4096
s_addc_u32 s45, s45, 0
global_load_dwordx4 v[32:35], v157, s[44:45] offset:0
s_waitcnt vmcnt(17)
v_mfma_f32_16x16x32_bf16 v[144:147], v[36:39], v[108:111], v[144:147]
global_load_dwordx4 v[36:39], v157, s[44:45] offset:1024
s_waitcnt vmcnt(17)
v_mfma_f32_16x16x32_bf16 v[144:147], v[40:43], v[112:115], v[144:147]
global_load_dwordx4 v[40:43], v157, s[44:45] offset:2048
s_waitcnt vmcnt(17)
v_mfma_f32_16x16x32_bf16 v[144:147], v[44:47], v[116:119], v[144:147]
global_load_dwordx4 v[44:47], v157, s[44:45] offset:3072
s_waitcnt vmcnt(17)
v_mfma_f32_16x16x32_bf16 v[144:147], v[48:51], v[120:123], v[144:147]
s_add_u32 s44, s44, 4096
s_addc_u32 s45, s45, 0
global_load_dwordx4 v[48:51], v157, s[44:45] offset:0
s_waitcnt vmcnt(17)
v_mfma_f32_16x16x32_bf16 v[144:147], v[52:55], v[124:127], v[144:147]
global_load_dwordx4 v[52:55], v157, s[44:45] offset:1024
s_waitcnt vmcnt(17)
v_mfma_f32_16x16x32_bf16 v[144:147], v[56:59], v[128:131], v[144:147]
global_load_dwordx4 v[56:59], v157, s[44:45] offset:2048
s_waitcnt vmcnt(17)
v_mfma_f32_16x16x32_bf16 v[144:147], v[60:63], v[132:135], v[144:147]
global_load_dwordx4 v[60:63], v157, s[44:45] offset:3072
s_waitcnt vmcnt(17)
v_mfma_f32_16x16x32_bf16 v[144:147], v[64:67], v[136:139], v[144:147]
s_add_u32 s44, s44, 4096
s_addc_u32 s45, s45, 0
global_load_dwordx4 v[64:67], v157, s[44:45] offset:0
s_waitcnt vmcnt(17)
v_mfma_f32_16x16x32_bf16 v[144:147], v[68:71], v[140:143], v[144:147]
global_load_dwordx4 v[68:71], v157, s[44:45] offset:1024
s_nop 6
v_mul_f32 v144, 0x3eae1a93, v144
v_mul_f32 v145, 0x3eae1a93, v145
v_mul_f32 v146, 0x3eae1a93, v146
v_mul_f32 v147, 0x3eae1a93, v147
v_mul_f32 v158, v144, v144
v_fmac_f32 v158, v145, v145
v_fmac_f32 v158, v146, v146
v_fmac_f32 v158, v147, v147
v_cvt_pk_bf16_f32 v144, v144, v145
v_cvt_pk_bf16_f32 v145, v146, v147
ds_write_b64 v166, v[144:145] offset:7424
v_mov_b32 v160, v158
s_nop 1
v_permlane16_swap_b32 v158, v160
v_add_f32 v158, v158, v160
v_mov_b32 v160, v158
s_nop 1
v_permlane32_swap_b32 v158, v160
v_add_f32 v158, v158, v160
v_mov_b32 v160, 1
s_mov_b64 exec, 0xffff
ds_max_u32 v167, v158 offset:212
s_mov_b64 exec, 1
ds_add_rtn_u32 v159, v167, v160 offset:208
s_mov_b64 exec, -1
s_waitcnt lgkmcnt(0)
v_readfirstlane_b32 s50, v159
s_cmp_eq_u32 s50, 1
s_cbranch_scc0 H0_nf10
H0_fz11_re:
ds_read_b128 v[148:151], v167 offset:576
ds_read_b128 v[152:155], v167 offset:208
s_waitcnt lgkmcnt(0)
v_and_b32 v159, v149, v151
v_cmp_ne_u32 vcc, 1, v159
s_cbranch_vccz H0_fz11_ok
s_add_u32 s52, s52, 1
s_cmp_gt_u32 s52, 200000
s_cbranch_scc1 H0_fz11_ok
s_sleep 0
s_branch H0_fz11_re
H0_fz11_ok:
v_add_f32 v153, v153, v154
v_mul_f32 v153, v153, v150
v_cmp_nge_f32 vcc, s70, v153
s_nop 1
v_cndmask_b32 v153, 1, 2, vcc
s_mov_b64 exec, 1
ds_write_b32 v167, v153 offset:40
s_mov_b64 exec, -1
H0_nf10:
s_waitcnt vmcnt(17)
v_mfma_f32_16x16x32_bf16 v[144:147], v[0:3], v[72:75], 0
s_waitcnt vmcnt(16)
v_mfma_f32_16x16x32_bf16 v[144:147], v[4:7], v[76:79], v[144:147]
s_waitcnt vmcnt(15)
v_mfma_f32_16x16x32_bf16 v[144:147], v[8:11], v[80:83], v[144:147]
s_waitcnt vmcnt(14)
v_mfma_f32_16x16x32_bf16 v[144:147], v[12:15], v[84:87], v[144:147]
s_waitcnt vmcnt(13)
v_mfma_f32_16x16x32_bf16 v[144:147], v[16:19], v[88:91], v[144:147]
s_waitcnt vmcnt(12)
v_mfma_f32_16x16x32_bf16 v[144:147], v[20:23], v[92:95], v[144:147]
s_waitcnt vmcnt(11)
v_mfma_f32_16x16x32_bf16 v[144:147], v[24:27], v[96:99], v[144:147]
s_waitcnt vmcnt(10)
v_mfma_f32_16x16x32_bf16 v[144:147], v[28:31], v[100:103], v[144:147]
s_waitcnt vmcnt(9)
v_mfma_f32_16x16x32_bf16 v[144:147], v[32:35], v[104:107], v[144:147]
s_waitcnt vmcnt(8)
v_mfma_f32_16x16x32_bf16 v[144:147], v[36:39], v[108:111], v[144:147]
s_waitcnt vmcnt(7)
v_mfma_f32_16x16x32_bf16 v[144:147], v[40:43], v[112:115], v[144:147]
s_waitcnt vmcnt(6)
v_mfma_f32_16x16x32_bf16 v[144:147], v[44:47], v[116:119], v[144:147]
s_waitcnt vmcnt(5)
v_mfma_f32_16x16x32_bf16 v[144:147], v[48:51], v[120:123], v[144:147]
s_waitcnt vmcnt(4)
v_mfma_f32_16x16x32_bf16 v[144:147], v[52:55], v[124:127], v[144:147]
s_waitcnt vmcnt(3)
v_mfma_f32_16x16x32_bf16 v[144:147], v[56:59], v[128:131], v[144:147]
s_waitcnt vmcnt(2)
v_mfma_f32_16x16x32_bf16 v[144:147], v[60:63], v[132:135], v[144:147]
s_waitcnt vmcnt(1)
v_mfma_f32_16x16x32_bf16 v[144:147], v[64:67], v[136:139], v[144:147]
s_waitcnt vmcnt(0)
v_mfma_f32_16x16x32_bf16 v[144:147], v[68:71], v[140:143], v[144:147]
s_nop 7
v_mul_f32 v144, 0x3eae1a93, v144
v_mul_f32 v145, 0x3eae1a93, v145
v_mul_f32 v146, 0x3eae1a93, v146
v_mul_f32 v147, 0x3eae1a93, v147
v_mul_f32 v158, v144, v144
v_fmac_f32 v158, v145, v145
v_fmac_f32 v158, v146, v146
v_fmac_f32 v158, v147, v147
v_cvt_pk_bf16_f32 v144, v144, v145
v_cvt_pk_bf16_f32 v145, v146, v147
ds_write_b64 v166, v[144:145] offset:9472
v_mov_b32 v160, v158
s_nop 1
v_permlane16_swap_b32 v158, v160
v_add_f32 v158, v158, v160
v_mov_b32 v160, v158
s_nop 1
v_permlane32_swap_b32 v158, v160
v_add_f32 v158, v158, v160
v_mov_b32 v160, 1
s_mov_b64 exec, 0xffff
ds_max_u32 v167, v158 offset:244
s_mov_b64 exec, 1
ds_add_rtn_u32 v159, v167, v160 offset:240
s_mov_b64 exec, -1
s_waitcnt lgkmcnt(0)
v_readfirstlane_b32 s50, v159
s_cmp_eq_u32 s50, 1
s_cbranch_scc0 H0_nf12
H0_fz13_re:
ds_read_b128 v[148:151], v167 offset:576
ds_read_b128 v[152:155], v167 offset:240
s_waitcnt lgkmcnt(0)
v_and_b32 v159, v149, v151
v_cmp_ne_u32 vcc, 1, v159
s_cbranch_vccz H0_fz13_ok
s_add_u32 s52, s52, 1
s_cmp_gt_u32 s52, 200000
s_cbranch_scc1 H0_fz13_ok
s_sleep 0
s_branch H0_fz13_re
H0_fz13_ok:
v_add_f32 v153, v153, v154
v_mul_f32 v153, v153, v150
v_cmp_nge_f32 vcc, s70, v153
s_nop 1
v_cndmask_b32 v153, 1, 2, vcc
s_mov_b64 exec, 1
ds_write_b32 v167, v153 offset:56
s_mov_b64 exec, -1
H0_nf12:
v_lshrrev_b32 v158, 3, v162
v_cmp_eq_u32 vcc, s40, v158
s_mov_b64 s[54:55], vcc
s_not_b64 s[56:57], s[54:55]
v_and_b32 v166, 7, v162
v_mul_u32_u24 v156, 2320, v166
v_lshl_add_u32 v156, v163, 4, v156
v_add_u32 v156, 100352, v156
v_lshl_add_u32 v166, v163, 3, v166
v_lshlrev_b32 v166, 4, v166
s_lshl_b32 s46, s2, 2
s_add_u32 s46, s46, 0
s_mul_i32 s46, s46, 4608
s_add_u32 s46, s46, s39
s_add_u32 s48, s30, s46
s_addc_u32 s49, s31, 0
s_xor_b32 s47, s2, 1
s_lshl_b32 s46, s47, 2
s_add_u32 s46, s46, 0
s_mul_i32 s46, s46, 4608
s_add_u32 s46, s46, s39
s_add_u32 s66, s30, s46
s_addc_u32 s67, s31, 0
s_lshl_b32 s46, s33, 11
s_lshl_b32 s47, s47, 3
s_add_u32 s46, s46, s47
s_add_u32 s46, s46, 0x6dd000
v_mov_b32 v158, s46
global_load_dwordx2 v[148:149], v158, s[30:31] sc1
s_waitcnt vmcnt(0)
v_cmp_eq_u64 vcc, s[60:61], v[148:149]
s_cmp_eq_u64 vcc, -1
s_cselect_b32 s71, 1, 0
v_mov_b32 v158, 158860
v_mov_b32 v159, s71
ds_write_b32 v158, v159
s_mul_i32 s46, s40, 294912
s_add_u32 s46, s46, 0xa2000
s_add_u32 s58, s30, s46
s_addc_u32 s59, s31, 0
global_load_dwordx4 v[36:39], v157, s[58:59] offset:0
global_load_dwordx4 v[40:43], v157, s[58:59] offset:1024
global_load_dwordx4 v[44:47], v157, s[58:59] offset:2048
global_load_dwordx4 v[48:51], v157, s[58:59] offset:3072
s_add_u32 s58, s58, 4096
s_addc_u32 s59, s59, 0
global_load_dwordx4 v[52:55], v157, s[58:59] offset:0
global_load_dwordx4 v[56:59], v157, s[58:59] offset:1024
global_load_dwordx4 v[60:63], v157, s[58:59] offset:2048
global_load_dwordx4 v[64:67], v157, s[58:59] offset:3072
s_add_u32 s58, s58, 4096
s_addc_u32 s59, s59, 0
global_load_dwordx4 v[68:71], v157, s[58:59] offset:0
s_mul_i32 s46, s40, 294912
s_add_u32 s46, s46, 0xab000
s_add_u32 s58, s30, s46
s_addc_u32 s59, s31, 0
global_load_dwordx4 v[72:75], v157, s[58:59] offset:0
global_load_dwordx4 v[76:79], v157, s[58:59] offset:1024
global_load_dwordx4 v[80:83], v157, s[58:59] offset:2048
global_load_dwordx4 v[84:87], v157, s[58:59] offset:3072
s_add_u32 s58, s58, 4096
s_addc_u32 s59, s59, 0
global_load_dwordx4 v[88:91], v157, s[58:59] offset:0
global_load_dwordx4 v[92:95], v157, s[58:59] offset:1024
global_load_dwordx4 v[96:99], v157, s[58:59] offset:2048
global_load_dwordx4 v[100:103], v157, s[58:59] offset:3072
s_add_u32 s58, s58, 4096
s_addc_u32 s59, s59, 0
global_load_dwordx4 v[104:107], v157, s[58:59] offset:0
H0_sp15_re:
ds_read_b64 v[148:149], v167 offset:256
s_waitcnt lgkmcnt(0)
v_cmp_ne_u64 vcc, s[68:69], v[148:149]
s_cbranch_vccz H0_sp15_ok
s_add_u32 s52, s52, 1
s_cmp_gt_u32 s52, 200000
s_cbranch_scc1 H0_sp15_ok
s_sleep 2
s_branch H0_sp15_re
H0_sp15_ok:
v_add_u32 v160, 38912, v164
v_add_u32 v161, 38912, v165
ds_read_b128 v[144:147], v160 offset:0
ds_read_b128 v[148:151], v160 offset:512
ds_read_b128 v[152:155], v161 offset:0
ds_read_b128 v[108:111], v160 offset:2560
ds_read_b128 v[112:115], v160 offset:3072
ds_read_b128 v[116:119], v161 offset:2560
ds_read_b128 v[120:123], v160 offset:5120
ds_read_b128 v[124:127], v160 offset:5632
ds_read_b128 v[128:131], v161 offset:5120
ds_read_b128 v[132:135], v160 offset:7680
ds_read_b128 v[136:139], v160 offset:8192
ds_read_b128 v[140:143], v161 offset:7680
s_waitcnt lgkmcnt(6)
v_pk_add_f32 v[144:145], v[144:145], v[108:109]
v_pk_add_f32 v[146:147], v[146:147], v[110:111]
v_pk_add_f32 v[148:149], v[148:149], v[112:113]
v_pk_add_f32 v[150:151], v[150:151], v[114:115]
v_pk_add_f32 v[152:153], v[152:153], v[116:117]
v_add_f32 v154, v154, v118
ds_read_b128 v[108:111], v160 offset:10240
ds_read_b128 v[112:115], v160 offset:10752
ds_read_b128 v[116:119], v161 offset:10240
s_waitcnt lgkmcnt(6)
v_pk_add_f32 v[144:145], v[144:145], v[120:121]
v_pk_add_f32 v[146:147], v[146:147], v[122:123]
v_pk_add_f32 v[148:149], v[148:149], v[124:125]
v_pk_add_f32 v[150:151], v[150:151], v[126:127]
v_pk_add_f32 v[152:153], v[152:153], v[128:129]
v_add_f32 v154, v154, v130
ds_read_b128 v[120:123], v160 offset:12800
ds_read_b128 v[124:127], v160 offset:13312
ds_read_b128 v[128:131], v161 offset:12800
s_waitcnt lgkmcnt(6)
v_pk_add_f32 v[144:145], v[144:145], v[132:133]
v_pk_add_f32 v[146:147], v[146:147], v[134:135]
v_pk_add_f32 v[148:149], v[148:149], v[136:137]
v_pk_add_f32 v[150:151], v[150:151], v[138:139]
v_pk_add_f32 v[152:153], v[152:153], v[140:141]
v_add_f32 v154, v154, v142
ds_read_b128 v[132:135], v160 offset:15360
ds_read_b128 v[136:139], v160 offset:15872
ds_read_b128 v[140:143], v161 offset:15360
s_waitcnt lgkmcnt(6)
v_pk_add_f32 v[144:145], v[144:145], v[108:109]
v_pk_add_f32 v[146:147], v[146:147], v[110:111]
v_pk_add_f32 v[148:149], v[148:149], v[112:113]
v_pk_add_f32 v[150:151], v[150:151], v[114:115]
v_pk_add_f32 v[152:153], v[152:153], v[116:117]
v_add_f32 v154, v154, v118
ds_read_b128 v[108:111], v160 offset:17920
ds_read_b128 v[112:115], v160 offset:18432
ds_read_b128 v[116:119], v161 offset:17920
s_waitcnt lgkmcnt(6)
v_pk_add_f32 v[144:145], v[144:145], v[120:121]
v_pk_add_f32 v[146:147], v[146:147], v[122:123]
v_pk_add_f32 v[148:149], v[148:149], v[124:125]
v_pk_add_f32 v[150:151], v[150:151], v[126:127]
v_pk_add_f32 v[152:153], v[152:153], v[128:129]
v_add_f32 v154, v154, v130
s_waitcnt lgkmcnt(3)
v_pk_add_f32 v[144:145], v[144:145], v[132:133]
v_pk_add_f32 v[146:147], v[146:147], v[134:135]
v_pk_add_f32 v[148:149], v[148:149], v[136:137]
v_pk_add_f32 v[150:151], v[150:151], v[138:139]
v_pk_add_f32 v[152:153], v[152:153], v[140:141]
v_add_f32 v154, v154, v142
s_waitcnt lgkmcnt(0)
v_pk_add_f32 v[144:145], v[144:145], v[108:109]
v_pk_add_f32 v[146:147], v[146:147], v[110:111]
v_pk_add_f32 v[148:149], v[148:149], v[112:113]
v_pk_add_f32 v[150:151], v[150:151], v[114:115]
v_pk_add_f32 v[152:153], v[152:153], v[116:117]
v_add_f32 v154, v154, v118
v_rcp_f32 v154, v154
s_nop 0
v_mul_f32 v144, v144, v154
v_mul_f32 v145, v145, v154
v_mul_f32 v146, v146, v154
v_mul_f32 v147, v147, v154
v_mul_f32 v148, v148, v154
v_mul_f32 v149, v149, v154
v_mul_f32 v150, v150, v154
v_mul_f32 v151, v151, v154
v_mul_f32 v152, v152, v154
v_mul_f32 v153, v153, v154
v_cvt_pk_bf16_f32 v144, v144, v145
v_cvt_pk_bf16_f32 v145, v146, v147
v_cvt_pk_bf16_f32 v146, v148, v149
v_cvt_pk_bf16_f32 v147, v150, v151
v_cvt_pk_bf16_f32 v155, v152, v153
ds_write_b128 v157, v[144:147] offset:11264
v_lshlrev_b32 v160, 4, v162
v_lshrrev_b32 v161, 1, v163
v_lshl_add_u32 v160, v161, 2, v160
s_mov_b32 exec_lo, 0xffff
s_mov_b32 exec_hi, 0xffff
ds_write_b32 v160, v155 offset:19456
s_mov_b64 exec, 1
v_mov_b32 v160, 36
v_mov_b32 v161, 1
ds_write_b32 v160, v161
s_mov_b64 exec, -1
H0_sk14:
H0_sp16_re:
ds_read_b32 v159, v167 offset:36
s_waitcnt lgkmcnt(0)
v_cmp_ne_u32 vcc, 1, v159
s_cbranch_vccz H0_sp16_ok
s_add_u32 s52, s52, 1
s_cmp_gt_u32 s52, 200000
s_cbranch_scc1 H0_sp16_ok
s_sleep 4
s_branch H0_sp16_re
H0_sp16_ok:
ds_read_b128 v[144:147], v157 offset:11264
s_waitcnt lgkmcnt(0)
s_mul_i32 s46, s40, 294912
s_add_u32 s46, s46, 0xb4000
s_add_u32 s58, s30, s46
s_addc_u32 s59, s31, 0
s_waitcnt vmcnt(17)
v_mfma_f32_16x16x32_bf16 v[0:3], v[36:39], v[144:147], 0
global_load_dwordx4 v[36:39], v157, s[58:59] offset:0
s_waitcnt vmcnt(17)
v_mfma_f32_16x16x32_bf16 v[4:7], v[40:43], v[144:147], 0
global_load_dwordx4 v[40:43], v157, s[58:59] offset:1024
s_waitcnt vmcnt(17)
v_mfma_f32_16x16x32_bf16 v[8:11], v[44:47], v[144:147], 0
global_load_dwordx4 v[44:47], v157, s[58:59] offset:2048
s_waitcnt vmcnt(17)
v_mfma_f32_16x16x32_bf16 v[12:15], v[48:51], v[144:147], 0
global_load_dwordx4 v[48:51], v157, s[58:59] offset:3072
s_waitcnt vmcnt(17)
v_mfma_f32_16x16x32_bf16 v[16:19], v[52:55], v[144:147], 0
s_add_u32 s58, s58, 4096
s_addc_u32 s59, s59, 0
global_load_dwordx4 v[52:55], v157, s[58:59] offset:0
s_waitcnt vmcnt(17)
v_mfma_f32_16x16x32_bf16 v[20:23], v[56:59], v[144:147], 0
global_load_dwordx4 v[56:59], v157, s[58:59] offset:1024
s_waitcnt vmcnt(17)
v_mfma_f32_16x16x32_bf16 v[24:27], v[60:63], v[144:147], 0
global_load_dwordx4 v[60:63], v157, s[58:59] offset:2048
s_waitcnt vmcnt(17)
v_mfma_f32_16x16x32_bf16 v[28:31], v[64:67], v[144:147], 0
global_load_dwordx4 v[64:67], v157, s[58:59] offset:3072
s_waitcnt vmcnt(17)
v_mfma_f32_16x16x32_bf16 v[32:35], v[68:71], v[144:147], 0
s_add_u32 s58, s58, 4096
s_addc_u32 s59, s59, 0
global_load_dwordx4 v[68:71], v157, s[58:59] offset:0
s_cmp_eq_u32 s33, 0
s_cbranch_scc0 H0_sk17
H0_sp18_re:
ds_read_b64 v[148:149], v167 offset:264
s_waitcnt lgkmcnt(0)
v_cmp_ne_u64 vcc, s[68:69], v[148:149]
s_cbranch_vccz H0_sp18_ok
s_add_u32 s52, s52, 1
s_cmp_gt_u32 s52, 200000
s_cbranch_scc1 H0_sp18_ok
s_sleep 2
s_branch H0_sp18_re
H0_sp18_ok:
v_add_u32 v160, 59392, v164
v_add_u32 v161, 59392, v165
ds_read_b128 v[144:147], v160 offset:0
ds_read_b128 v[148:151], v160 offset:512
ds_read_b128 v[152:155], v161 offset:0
ds_read_b128 v[108:111], v160 offset:2560
ds_read_b128 v[112:115], v160 offset:3072
ds_read_b128 v[116:119], v161 offset:2560
ds_read_b128 v[120:123], v160 offset:5120
ds_read_b128 v[124:127], v160 offset:5632
ds_read_b128 v[128:131], v161 offset:5120
ds_read_b128 v[132:135], v160 offset:7680
ds_read_b128 v[136:139], v160 offset:8192
ds_read_b128 v[140:143], v161 offset:7680
s_waitcnt lgkmcnt(6)
v_pk_add_f32 v[144:145], v[144:145], v[108:109]
v_pk_add_f32 v[146:147], v[146:147], v[110:111]
v_pk_add_f32 v[148:149], v[148:149], v[112:113]
v_pk_add_f32 v[150:151], v[150:151], v[114:115]
v_pk_add_f32 v[152:153], v[152:153], v[116:117]
v_add_f32 v154, v154, v118
ds_read_b128 v[108:111], v160 offset:10240
ds_read_b128 v[112:115], v160 offset:10752
ds_read_b128 v[116:119], v161 offset:10240
s_waitcnt lgkmcnt(6)
v_pk_add_f32 v[144:145], v[144:145], v[120:121]
v_pk_add_f32 v[146:147], v[146:147], v[122:123]
v_pk_add_f32 v[148:149], v[148:149], v[124:125]
v_pk_add_f32 v[150:151], v[150:151], v[126:127]
v_pk_add_f32 v[152:153], v[152:153], v[128:129]
v_add_f32 v154, v154, v130
ds_read_b128 v[120:123], v160 offset:12800
ds_read_b128 v[124:127], v160 offset:13312
ds_read_b128 v[128:131], v161 offset:12800
s_waitcnt lgkmcnt(6)
v_pk_add_f32 v[144:145], v[144:145], v[132:133]
v_pk_add_f32 v[146:147], v[146:147], v[134:135]
v_pk_add_f32 v[148:149], v[148:149], v[136:137]
v_pk_add_f32 v[150:151], v[150:151], v[138:139]
v_pk_add_f32 v[152:153], v[152:153], v[140:141]
v_add_f32 v154, v154, v142
ds_read_b128 v[132:135], v160 offset:15360
ds_read_b128 v[136:139], v160 offset:15872
ds_read_b128 v[140:143], v161 offset:15360
s_waitcnt lgkmcnt(6)
v_pk_add_f32 v[144:145], v[144:145], v[108:109]
v_pk_add_f32 v[146:147], v[146:147], v[110:111]
v_pk_add_f32 v[148:149], v[148:149], v[112:113]
v_pk_add_f32 v[150:151], v[150:151], v[114:115]
v_pk_add_f32 v[152:153], v[152:153], v[116:117]
v_add_f32 v154, v154, v118
ds_read_b128 v[108:111], v160 offset:17920
ds_read_b128 v[112:115], v160 offset:18432
ds_read_b128 v[116:119], v161 offset:17920
s_waitcnt lgkmcnt(6)
v_pk_add_f32 v[144:145], v[144:145], v[120:121]
v_pk_add_f32 v[146:147], v[146:147], v[122:123]
v_pk_add_f32 v[148:149], v[148:149], v[124:125]
v_pk_add_f32 v[150:151], v[150:151], v[126:127]
v_pk_add_f32 v[152:153], v[152:153], v[128:129]
v_add_f32 v154, v154, v130
s_waitcnt lgkmcnt(3)
v_pk_add_f32 v[144:145], v[144:145], v[132:133]
v_pk_add_f32 v[146:147], v[146:147], v[134:135]
v_pk_add_f32 v[148:149], v[148:149], v[136:137]
v_pk_add_f32 v[150:151], v[150:151], v[138:139]
v_pk_add_f32 v[152:153], v[152:153], v[140:141]
v_add_f32 v154, v154, v142
s_waitcnt lgkmcnt(0)
v_pk_add_f32 v[144:145], v[144:145], v[108:109]
v_pk_add_f32 v[146:147], v[146:147], v[110:111]
v_pk_add_f32 v[148:149], v[148:149], v[112:113]
v_pk_add_f32 v[150:151], v[150:151], v[114:115]
v_pk_add_f32 v[152:153], v[152:153], v[116:117]
v_add_f32 v154, v154, v118
v_rcp_f32 v154, v154
s_nop 0
v_mul_f32 v144, v144, v154
v_mul_f32 v145, v145, v154
v_mul_f32 v146, v146, v154
v_mul_f32 v147, v147, v154
v_mul_f32 v148, v148, v154
v_mul_f32 v149, v149, v154
v_mul_f32 v150, v150, v154
v_mul_f32 v151, v151, v154
v_mul_f32 v152, v152, v154
v_mul_f32 v153, v153, v154
v_cvt_pk_bf16_f32 v144, v144, v145
v_cvt_pk_bf16_f32 v145, v146, v147
v_cvt_pk_bf16_f32 v146, v148, v149
v_cvt_pk_bf16_f32 v147, v150, v151
v_cvt_pk_bf16_f32 v155, v152, v153
ds_write_b128 v157, v[144:147] offset:12288
v_lshlrev_b32 v160, 4, v162
v_lshrrev_b32 v161, 1, v163
v_lshl_add_u32 v160, v161, 2, v160
s_mov_b32 exec_lo, 0xffff
s_mov_b32 exec_hi, 0xffff
ds_write_b32 v160, v155 offset:19464
s_mov_b64 exec, 1
v_mov_b32 v160, 44
v_mov_b32 v161, 1
ds_write_b32 v160, v161
s_mov_b64 exec, -1
H0_sk17:
H0_sp19_re:
ds_read_b32 v159, v167 offset:44
s_waitcnt lgkmcnt(0)
v_cmp_ne_u32 vcc, 1, v159
s_cbranch_vccz H0_sp19_ok
s_add_u32 s52, s52, 1
s_cmp_gt_u32 s52, 200000
s_cbranch_scc1 H0_sp19_ok
s_sleep 4
s_branch H0_sp19_re
H0_sp19_ok:
ds_read_b128 v[144:147], v157 offset:12288
s_waitcnt lgkmcnt(0)
s_mul_i32 s46, s40, 294912
s_add_u32 s46, s46, 0xbd000
s_add_u32 s58, s30, s46
s_addc_u32 s59, s31, 0
s_waitcnt vmcnt(17)
v_mfma_f32_16x16x32_bf16 v[0:3], v[72:75], v[144:147], v[0:3]
global_load_dwordx4 v[72:75], v157, s[58:59] offset:0
s_waitcnt vmcnt(17)
v_mfma_f32_16x16x32_bf16 v[4:7], v[76:79], v[144:147], v[4:7]
global_load_dwordx4 v[76:79], v157, s[58:59] offset:1024
s_waitcnt vmcnt(17)
v_mfma_f32_16x16x32_bf16 v[8:11], v[80:83], v[144:147], v[8:11]
global_load_dwordx4 v[80:83], v157, s[58:59] offset:2048
s_waitcnt vmcnt(17)
v_mfma_f32_16x16x32_bf16 v[12:15], v[84:87], v[144:147], v[12:15]
global_load_dwordx4 v[84:87], v157, s[58:59] offset:3072
s_waitcnt vmcnt(17)
v_mfma_f32_16x16x32_bf16 v[16:19], v[88:91], v[144:147], v[16:19]
s_add_u32 s58, s58, 4096
s_addc_u32 s59, s59, 0
global_load_dwordx4 v[88:91], v157, s[58:59] offset:0
s_waitcnt vmcnt(17)
v_mfma_f32_16x16x32_bf16 v[20:23], v[92:95], v[144:147], v[20:23]
global_load_dwordx4 v[92:95], v157, s[58:59] offset:1024
s_waitcnt vmcnt(17)
v_mfma_f32_16x16x32_bf16 v[24:27], v[96:99], v[144:147], v[24:27]
global_load_dwordx4 v[96:99], v157, s[58:59] offset:2048
s_waitcnt vmcnt(17)
v_mfma_f32_16x16x32_bf16 v[28:31], v[100:103], v[144:147], v[28:31]
global_load_dwordx4 v[100:103], v157, s[58:59] offset:3072
s_waitcnt vmcnt(17)
v_mfma_f32_16x16x32_bf16 v[32:35], v[104:107], v[144:147], v[32:35]
s_add_u32 s58, s58, 4096
s_addc_u32 s59, s59, 0
global_load_dwordx4 v[104:107], v157, s[58:59] offset:0
s_cmp_eq_u32 s33, 0
s_cbranch_scc0 H0_sk20
H0_sp21_re:
ds_read_b64 v[148:149], v167 offset:272
s_waitcnt lgkmcnt(0)
v_cmp_ne_u64 vcc, s[68:69], v[148:149]
s_cbranch_vccz H0_sp21_ok
s_add_u32 s52, s52, 1
s_cmp_gt_u32 s52, 200000
s_cbranch_scc1 H0_sp21_ok
s_sleep 2
s_branch H0_sp21_re
H0_sp21_ok:
v_add_u32 v160, 79872, v164
v_add_u32 v161, 79872, v165
ds_read_b128 v[144:147], v160 offset:0
ds_read_b128 v[148:151], v160 offset:512
ds_read_b128 v[152:155], v161 offset:0
ds_read_b128 v[108:111], v160 offset:2560
ds_read_b128 v[112:115], v160 offset:3072
ds_read_b128 v[116:119], v161 offset:2560
ds_read_b128 v[120:123], v160 offset:5120
ds_read_b128 v[124:127], v160 offset:5632
ds_read_b128 v[128:131], v161 offset:5120
ds_read_b128 v[132:135], v160 offset:7680
ds_read_b128 v[136:139], v160 offset:8192
ds_read_b128 v[140:143], v161 offset:7680
s_waitcnt lgkmcnt(6)
v_pk_add_f32 v[144:145], v[144:145], v[108:109]
v_pk_add_f32 v[146:147], v[146:147], v[110:111]
v_pk_add_f32 v[148:149], v[148:149], v[112:113]
v_pk_add_f32 v[150:151], v[150:151], v[114:115]
v_pk_add_f32 v[152:153], v[152:153], v[116:117]
v_add_f32 v154, v154, v118
ds_read_b128 v[108:111], v160 offset:10240
ds_read_b128 v[112:115], v160 offset:10752
ds_read_b128 v[116:119], v161 offset:10240
s_waitcnt lgkmcnt(6)
v_pk_add_f32 v[144:145], v[144:145], v[120:121]
v_pk_add_f32 v[146:147], v[146:147], v[122:123]
v_pk_add_f32 v[148:149], v[148:149], v[124:125]
v_pk_add_f32 v[150:151], v[150:151], v[126:127]
v_pk_add_f32 v[152:153], v[152:153], v[128:129]
v_add_f32 v154, v154, v130
ds_read_b128 v[120:123], v160 offset:12800
ds_read_b128 v[124:127], v160 offset:13312
ds_read_b128 v[128:131], v161 offset:12800
s_waitcnt lgkmcnt(6)
v_pk_add_f32 v[144:145], v[144:145], v[132:133]
v_pk_add_f32 v[146:147], v[146:147], v[134:135]
v_pk_add_f32 v[148:149], v[148:149], v[136:137]
v_pk_add_f32 v[150:151], v[150:151], v[138:139]
v_pk_add_f32 v[152:153], v[152:153], v[140:141]
v_add_f32 v154, v154, v142
ds_read_b128 v[132:135], v160 offset:15360
ds_read_b128 v[136:139], v160 offset:15872
ds_read_b128 v[140:143], v161 offset:15360
s_waitcnt lgkmcnt(6)
v_pk_add_f32 v[144:145], v[144:145], v[108:109]
v_pk_add_f32 v[146:147], v[146:147], v[110:111]
v_pk_add_f32 v[148:149], v[148:149], v[112:113]
v_pk_add_f32 v[150:151], v[150:151], v[114:115]
v_pk_add_f32 v[152:153], v[152:153], v[116:117]
v_add_f32 v154, v154, v118
ds_read_b128 v[108:111], v160 offset:17920
ds_read_b128 v[112:115], v160 offset:18432
ds_read_b128 v[116:119], v161 offset:17920
s_waitcnt lgkmcnt(6)
v_pk_add_f32 v[144:145], v[144:145], v[120:121]
v_pk_add_f32 v[146:147], v[146:147], v[122:123]
v_pk_add_f32 v[148:149], v[148:149], v[124:125]
v_pk_add_f32 v[150:151], v[150:151], v[126:127]
v_pk_add_f32 v[152:153], v[152:153], v[128:129]
v_add_f32 v154, v154, v130
s_waitcnt lgkmcnt(3)
v_pk_add_f32 v[144:145], v[144:145], v[132:133]
v_pk_add_f32 v[146:147], v[146:147], v[134:135]
v_pk_add_f32 v[148:149], v[148:149], v[136:137]
v_pk_add_f32 v[150:151], v[150:151], v[138:139]
v_pk_add_f32 v[152:153], v[152:153], v[140:141]
v_add_f32 v154, v154, v142
s_waitcnt lgkmcnt(0)
v_pk_add_f32 v[144:145], v[144:145], v[108:109]
v_pk_add_f32 v[146:147], v[146:147], v[110:111]
v_pk_add_f32 v[148:149], v[148:149], v[112:113]
v_pk_add_f32 v[150:151], v[150:151], v[114:115]
v_pk_add_f32 v[152:153], v[152:153], v[116:117]
v_add_f32 v154, v154, v118
v_rcp_f32 v154, v154
s_nop 0
v_mul_f32 v144, v144, v154
v_mul_f32 v145, v145, v154
v_mul_f32 v146, v146, v154
v_mul_f32 v147, v147, v154
v_mul_f32 v148, v148, v154
v_mul_f32 v149, v149, v154
v_mul_f32 v150, v150, v154
v_mul_f32 v151, v151, v154
v_mul_f32 v152, v152, v154
v_mul_f32 v153, v153, v154
v_cvt_pk_bf16_f32 v144, v144, v145
v_cvt_pk_bf16_f32 v145, v146, v147
v_cvt_pk_bf16_f32 v146, v148, v149
v_cvt_pk_bf16_f32 v147, v150, v151
v_cvt_pk_bf16_f32 v155, v152, v153
ds_write_b128 v157, v[144:147] offset:13312
v_lshlrev_b32 v160, 4, v162
v_lshrrev_b32 v161, 1, v163
v_lshl_add_u32 v160, v161, 2, v160
s_mov_b32 exec_lo, 0xffff
s_mov_b32 exec_hi, 0xffff
ds_write_b32 v160, v155 offset:19712
s_mov_b64 exec, 1
v_mov_b32 v160, 52
v_mov_b32 v161, 1
ds_write_b32 v160, v161
s_mov_b64 exec, -1
H0_sk20:
H0_sp22_re:
ds_read_b32 v159, v167 offset:52
s_waitcnt lgkmcnt(0)
v_cmp_ne_u32 vcc, 1, v159
s_cbranch_vccz H0_sp22_ok
s_add_u32 s52, s52, 1
s_cmp_gt_u32 s52, 200000
s_cbranch_scc1 H0_sp22_ok
s_sleep 4
s_branch H0_sp22_re
H0_sp22_ok:
ds_read_b128 v[144:147], v157 offset:13312
s_waitcnt lgkmcnt(0)
s_mul_i32 s46, s40, 294912
s_add_u32 s46, s46, 0xc6000
s_add_u32 s58, s30, s46
s_addc_u32 s59, s31, 0
s_waitcnt vmcnt(17)
v_mfma_f32_16x16x32_bf16 v[0:3], v[36:39], v[144:147], v[0:3]
global_load_dwordx4 v[36:39], v157, s[58:59] offset:0
s_waitcnt vmcnt(17)
v_mfma_f32_16x16x32_bf16 v[4:7], v[40:43], v[144:147], v[4:7]
global_load_dwordx4 v[40:43], v157, s[58:59] offset:1024
s_waitcnt vmcnt(17)
v_mfma_f32_16x16x32_bf16 v[8:11], v[44:47], v[144:147], v[8:11]
global_load_dwordx4 v[44:47], v157, s[58:59] offset:2048
s_waitcnt vmcnt(17)
v_mfma_f32_16x16x32_bf16 v[12:15], v[48:51], v[144:147], v[12:15]
global_load_dwordx4 v[48:51], v157, s[58:59] offset:3072
s_waitcnt vmcnt(17)
v_mfma_f32_16x16x32_bf16 v[16:19], v[52:55], v[144:147], v[16:19]
s_add_u32 s58, s58, 4096
s_addc_u32 s59, s59, 0
global_load_dwordx4 v[52:55], v157, s[58:59] offset:0
s_waitcnt vmcnt(17)
v_mfma_f32_16x16x32_bf16 v[20:23], v[56:59], v[144:147], v[20:23]
global_load_dwordx4 v[56:59], v157, s[58:59] offset:1024
s_waitcnt vmcnt(17)
v_mfma_f32_16x16x32_bf16 v[24:27], v[60:63], v[144:147], v[24:27]
global_load_dwordx4 v[60:63], v157, s[58:59] offset:2048
s_waitcnt vmcnt(17)
v_mfma_f32_16x16x32_bf16 v[28:31], v[64:67], v[144:147], v[28:31]
global_load_dwordx4 v[64:67], v157, s[58:59] offset:3072
s_waitcnt vmcnt(17)
v_mfma_f32_16x16x32_bf16 v[32:35], v[68:71], v[144:147], v[32:35]
s_add_u32 s58, s58, 4096
s_addc_u32 s59, s59, 0
global_load_dwordx4 v[68:71], v157, s[58:59] offset:0
s_cmp_eq_u32 s33, 0
s_cbranch_scc0 H0_sk23
H0_sp24_re:
ds_read_b64 v[148:149], v167 offset:280
s_waitcnt lgkmcnt(0)
v_cmp_ne_u64 vcc, s[68:69], v[148:149]
s_cbranch_vccz H0_sp24_ok
s_add_u32 s52, s52, 1
s_cmp_gt_u32 s52, 200000
s_cbranch_scc1 H0_sp24_ok
s_sleep 2
s_branch H0_sp24_re
H0_sp24_ok:
v_add_u32 v160, 38912, v164
v_add_u32 v161, 38912, v165
ds_read_b128 v[144:147], v160 offset:0
ds_read_b128 v[148:151], v160 offset:512
ds_read_b128 v[152:155], v161 offset:0
ds_read_b128 v[108:111], v160 offset:2560
ds_read_b128 v[112:115], v160 offset:3072
ds_read_b128 v[116:119], v161 offset:2560
ds_read_b128 v[120:123], v160 offset:5120
ds_read_b128 v[124:127], v160 offset:5632
ds_read_b128 v[128:131], v161 offset:5120
ds_read_b128 v[132:135], v160 offset:7680
ds_read_b128 v[136:139], v160 offset:8192
ds_read_b128 v[140:143], v161 offset:7680
s_waitcnt lgkmcnt(6)
v_pk_add_f32 v[144:145], v[144:145], v[108:109]
v_pk_add_f32 v[146:147], v[146:147], v[110:111]
v_pk_add_f32 v[148:149], v[148:149], v[112:113]
v_pk_add_f32 v[150:151], v[150:151], v[114:115]
v_pk_add_f32 v[152:153], v[152:153], v[116:117]
v_add_f32 v154, v154, v118
ds_read_b128 v[108:111], v160 offset:10240
ds_read_b128 v[112:115], v160 offset:10752
ds_read_b128 v[116:119], v161 offset:10240
s_waitcnt lgkmcnt(6)
v_pk_add_f32 v[144:145], v[144:145], v[120:121]
v_pk_add_f32 v[146:147], v[146:147], v[122:123]
v_pk_add_f32 v[148:149], v[148:149], v[124:125]
v_pk_add_f32 v[150:151], v[150:151], v[126:127]
v_pk_add_f32 v[152:153], v[152:153], v[128:129]
v_add_f32 v154, v154, v130
ds_read_b128 v[120:123], v160 offset:12800
ds_read_b128 v[124:127], v160 offset:13312
ds_read_b128 v[128:131], v161 offset:12800
s_waitcnt lgkmcnt(6)
v_pk_add_f32 v[144:145], v[144:145], v[132:133]
v_pk_add_f32 v[146:147], v[146:147], v[134:135]
v_pk_add_f32 v[148:149], v[148:149], v[136:137]
v_pk_add_f32 v[150:151], v[150:151], v[138:139]
v_pk_add_f32 v[152:153], v[152:153], v[140:141]
v_add_f32 v154, v154, v142
ds_read_b128 v[132:135], v160 offset:15360
ds_read_b128 v[136:139], v160 offset:15872
ds_read_b128 v[140:143], v161 offset:15360
s_waitcnt lgkmcnt(6)
v_pk_add_f32 v[144:145], v[144:145], v[108:109]
v_pk_add_f32 v[146:147], v[146:147], v[110:111]
v_pk_add_f32 v[148:149], v[148:149], v[112:113]
v_pk_add_f32 v[150:151], v[150:151], v[114:115]
v_pk_add_f32 v[152:153], v[152:153], v[116:117]
v_add_f32 v154, v154, v118
ds_read_b128 v[108:111], v160 offset:17920
ds_read_b128 v[112:115], v160 offset:18432
ds_read_b128 v[116:119], v161 offset:17920
s_waitcnt lgkmcnt(6)
v_pk_add_f32 v[144:145], v[144:145], v[120:121]
v_pk_add_f32 v[146:147], v[146:147], v[122:123]
v_pk_add_f32 v[148:149], v[148:149], v[124:125]
v_pk_add_f32 v[150:151], v[150:151], v[126:127]
v_pk_add_f32 v[152:153], v[152:153], v[128:129]
v_add_f32 v154, v154, v130
s_waitcnt lgkmcnt(3)
v_pk_add_f32 v[144:145], v[144:145], v[132:133]
v_pk_add_f32 v[146:147], v[146:147], v[134:135]
v_pk_add_f32 v[148:149], v[148:149], v[136:137]
v_pk_add_f32 v[150:151], v[150:151], v[138:139]
v_pk_add_f32 v[152:153], v[152:153], v[140:141]
v_add_f32 v154, v154, v142
s_waitcnt lgkmcnt(0)
v_pk_add_f32 v[144:145], v[144:145], v[108:109]
v_pk_add_f32 v[146:147], v[146:147], v[110:111]
v_pk_add_f32 v[148:149], v[148:149], v[112:113]
v_pk_add_f32 v[150:151], v[150:151], v[114:115]
v_pk_add_f32 v[152:153], v[152:153], v[116:117]
v_add_f32 v154, v154, v118
v_rcp_f32 v154, v154
s_nop 0
v_mul_f32 v144, v144, v154
v_mul_f32 v145, v145, v154
v_mul_f32 v146, v146, v154
v_mul_f32 v147, v147, v154
v_mul_f32 v148, v148, v154
v_mul_f32 v149, v149, v154
v_mul_f32 v150, v150, v154
v_mul_f32 v151, v151, v154
v_mul_f32 v152, v152, v154
v_mul_f32 v153, v153, v154
v_cvt_pk_bf16_f32 v144, v144, v145
v_cvt_pk_bf16_f32 v145, v146, v147
v_cvt_pk_bf16_f32 v146, v148, v149
v_cvt_pk_bf16_f32 v147, v150, v151
v_cvt_pk_bf16_f32 v155, v152, v153
ds_write_b128 v157, v[144:147] offset:14336
v_lshlrev_b32 v160, 4, v162
v_lshrrev_b32 v161, 1, v163
v_lshl_add_u32 v160, v161, 2, v160
s_mov_b32 exec_lo, 0xffff
s_mov_b32 exec_hi, 0xffff
ds_write_b32 v160, v155 offset:19720
s_mov_b64 exec, 1
v_mov_b32 v160, 60
v_mov_b32 v161, 1
ds_write_b32 v160, v161
s_mov_b64 exec, -1
H0_sk23:
H0_sp25_re:
ds_read_b32 v159, v167 offset:60
s_waitcnt lgkmcnt(0)
v_cmp_ne_u32 vcc, 1, v159
s_cbranch_vccz H0_sp25_ok
s_add_u32 s52, s52, 1
s_cmp_gt_u32 s52, 200000
s_cbranch_scc1 H0_sp25_ok
s_sleep 4
s_branch H0_sp25_re
H0_sp25_ok:
ds_read_b128 v[144:147], v157 offset:14336
s_waitcnt lgkmcnt(0)
s_mul_i32 s46, s40, 294912
s_add_u32 s46, s46, 0xcf000
s_add_u32 s58, s30, s46
s_addc_u32 s59, s31, 0
s_waitcnt vmcnt(17)
v_mfma_f32_16x16x32_bf16 v[0:3], v[72:75], v[144:147], v[0:3]
global_load_dwordx4 v[72:75], v157, s[58:59] offset:0
s_waitcnt vmcnt(17)
v_mfma_f32_16x16x32_bf16 v[4:7], v[76:79], v[144:147], v[4:7]
global_load_dwordx4 v[76:79], v157, s[58:59] offset:1024
s_waitcnt vmcnt(17)
v_mfma_f32_16x16x32_bf16 v[8:11], v[80:83], v[144:147], v[8:11]
global_load_dwordx4 v[80:83], v157, s[58:59] offset:2048
s_waitcnt vmcnt(17)
v_mfma_f32_16x16x32_bf16 v[12:15], v[84:87], v[144:147], v[12:15]
global_load_dwordx4 v[84:87], v157, s[58:59] offset:3072
s_waitcnt vmcnt(17)
v_mfma_f32_16x16x32_bf16 v[16:19], v[88:91], v[144:147], v[16:19]
s_add_u32 s58, s58, 4096
s_addc_u32 s59, s59, 0
global_load_dwordx4 v[88:91], v157, s[58:59] offset:0
s_waitcnt vmcnt(17)
v_mfma_f32_16x16x32_bf16 v[20:23], v[92:95], v[144:147], v[20:23]
global_load_dwordx4 v[92:95], v157, s[58:59] offset:1024
s_waitcnt vmcnt(17)
v_mfma_f32_16x16x32_bf16 v[24:27], v[96:99], v[144:147], v[24:27]
global_load_dwordx4 v[96:99], v157, s[58:59] offset:2048
s_waitcnt vmcnt(17)
v_mfma_f32_16x16x32_bf16 v[28:31], v[100:103], v[144:147], v[28:31]
global_load_dwordx4 v[100:103], v157, s[58:59] offset:3072
s_waitcnt vmcnt(17)
v_mfma_f32_16x16x32_bf16 v[32:35], v[104:107], v[144:147], v[32:35]
s_add_u32 s58, s58, 4096
s_addc_u32 s59, s59, 0
global_load_dwordx4 v[104:107], v157, s[58:59] offset:0
H0_sp27_re:
ds_read_b64 v[148:149], v167 offset:288
s_waitcnt lgkmcnt(0)
v_cmp_ne_u64 vcc, s[68:69], v[148:149]
s_cbranch_vccz H0_sp27_ok
s_add_u32 s52, s52, 1
s_cmp_gt_u32 s52, 200000
s_cbranch_scc1 H0_sp27_ok
s_sleep 2
s_branch H0_sp27_re
H0_sp27_ok:
v_add_u32 v160, 59392, v164
v_add_u32 v161, 59392, v165
ds_read_b128 v[144:147], v160 offset:0
ds_read_b128 v[148:151], v160 offset:512
ds_read_b128 v[152:155], v161 offset:0
ds_read_b128 v[108:111], v160 offset:2560
ds_read_b128 v[112:115], v160 offset:3072
ds_read_b128 v[116:119], v161 offset:2560
ds_read_b128 v[120:123], v160 offset:5120
ds_read_b128 v[124:127], v160 offset:5632
ds_read_b128 v[128:131], v161 offset:5120
ds_read_b128 v[132:135], v160 offset:7680
ds_read_b128 v[136:139], v160 offset:8192
ds_read_b128 v[140:143], v161 offset:7680
s_waitcnt lgkmcnt(6)
v_pk_add_f32 v[144:145], v[144:145], v[108:109]
v_pk_add_f32 v[146:147], v[146:147], v[110:111]
v_pk_add_f32 v[148:149], v[148:149], v[112:113]
v_pk_add_f32 v[150:151], v[150:151], v[114:115]
v_pk_add_f32 v[152:153], v[152:153], v[116:117]
v_add_f32 v154, v154, v118
ds_read_b128 v[108:111], v160 offset:10240
ds_read_b128 v[112:115], v160 offset:10752
ds_read_b128 v[116:119], v161 offset:10240
s_waitcnt lgkmcnt(6)
v_pk_add_f32 v[144:145], v[144:145], v[120:121]
v_pk_add_f32 v[146:147], v[146:147], v[122:123]
v_pk_add_f32 v[148:149], v[148:149], v[124:125]
v_pk_add_f32 v[150:151], v[150:151], v[126:127]
v_pk_add_f32 v[152:153], v[152:153], v[128:129]
v_add_f32 v154, v154, v130
ds_read_b128 v[120:123], v160 offset:12800
ds_read_b128 v[124:127], v160 offset:13312
ds_read_b128 v[128:131], v161 offset:12800
s_waitcnt lgkmcnt(6)
v_pk_add_f32 v[144:145], v[144:145], v[132:133]
v_pk_add_f32 v[146:147], v[146:147], v[134:135]
v_pk_add_f32 v[148:149], v[148:149], v[136:137]
v_pk_add_f32 v[150:151], v[150:151], v[138:139]
v_pk_add_f32 v[152:153], v[152:153], v[140:141]
v_add_f32 v154, v154, v142
ds_read_b128 v[132:135], v160 offset:15360
ds_read_b128 v[136:139], v160 offset:15872
ds_read_b128 v[140:143], v161 offset:15360
s_waitcnt lgkmcnt(6)
v_pk_add_f32 v[144:145], v[144:145], v[108:109]
v_pk_add_f32 v[146:147], v[146:147], v[110:111]
v_pk_add_f32 v[148:149], v[148:149], v[112:113]
v_pk_add_f32 v[150:151], v[150:151], v[114:115]
v_pk_add_f32 v[152:153], v[152:153], v[116:117]
v_add_f32 v154, v154, v118
ds_read_b128 v[108:111], v160 offset:17920
ds_read_b128 v[112:115], v160 offset:18432
ds_read_b128 v[116:119], v161 offset:17920
s_waitcnt lgkmcnt(6)
v_pk_add_f32 v[144:145], v[144:145], v[120:121]
v_pk_add_f32 v[146:147], v[146:147], v[122:123]
v_pk_add_f32 v[148:149], v[148:149], v[124:125]
v_pk_add_f32 v[150:151], v[150:151], v[126:127]
v_pk_add_f32 v[152:153], v[152:153], v[128:129]
v_add_f32 v154, v154, v130
s_waitcnt lgkmcnt(3)
v_pk_add_f32 v[144:145], v[144:145], v[132:133]
v_pk_add_f32 v[146:147], v[146:147], v[134:135]
v_pk_add_f32 v[148:149], v[148:149], v[136:137]
v_pk_add_f32 v[150:151], v[150:151], v[138:139]
v_pk_add_f32 v[152:153], v[152:153], v[140:141]
v_add_f32 v154, v154, v142
s_waitcnt lgkmcnt(0)
v_pk_add_f32 v[144:145], v[144:145], v[108:109]
v_pk_add_f32 v[146:147], v[146:147], v[110:111]
v_pk_add_f32 v[148:149], v[148:149], v[112:113]
v_pk_add_f32 v[150:151], v[150:151], v[114:115]
v_pk_add_f32 v[152:153], v[152:153], v[116:117]
v_add_f32 v154, v154, v118
v_rcp_f32 v154, v154
s_nop 0
v_mul_f32 v144, v144, v154
v_mul_f32 v145, v145, v154
v_mul_f32 v146, v146, v154
v_mul_f32 v147, v147, v154
v_mul_f32 v148, v148, v154
v_mul_f32 v149, v149, v154
v_mul_f32 v150, v150, v154
v_mul_f32 v151, v151, v154
v_mul_f32 v152, v152, v154
v_mul_f32 v153, v153, v154
v_cvt_pk_bf16_f32 v144, v144, v145
v_cvt_pk_bf16_f32 v145, v146, v147
v_cvt_pk_bf16_f32 v146, v148, v149
v_cvt_pk_bf16_f32 v147, v150, v151
v_cvt_pk_bf16_f32 v155, v152, v153
ds_write_b128 v157, v[144:147] offset:15360
v_lshlrev_b32 v160, 4, v162
v_lshrrev_b32 v161, 1, v163
v_lshl_add_u32 v160, v161, 2, v160
s_mov_b32 exec_lo, 0xffff
s_mov_b32 exec_hi, 0xffff
ds_write_b32 v160, v155 offset:19968
s_mov_b64 exec, 1
v_mov_b32 v160, 68
v_mov_b32 v161, 1
ds_write_b32 v160, v161
s_mov_b64 exec, -1
H0_sk26:
H0_sp28_re:
ds_read_b32 v159, v167 offset:68
s_waitcnt lgkmcnt(0)
v_cmp_ne_u32 vcc, 1, v159
s_cbranch_vccz H0_sp28_ok
s_add_u32 s52, s52, 1
s_cmp_gt_u32 s52, 200000
s_cbranch_scc1 H0_sp28_ok
s_sleep 4
s_branch H0_sp28_re
H0_sp28_ok:
ds_read_b128 v[144:147], v157 offset:15360
s_waitcnt lgkmcnt(0)
s_mul_i32 s46, s40, 294912
s_add_u32 s46, s46, 0xd8000
s_add_u32 s58, s30, s46
s_addc_u32 s59, s31, 0
s_waitcnt vmcnt(17)
v_mfma_f32_16x16x32_bf16 v[0:3], v[36:39], v[144:147], v[0:3]
global_load_dwordx4 v[36:39], v157, s[58:59] offset:0
s_waitcnt vmcnt(17)
v_mfma_f32_16x16x32_bf16 v[4:7], v[40:43], v[144:147], v[4:7]
global_load_dwordx4 v[40:43], v157, s[58:59] offset:1024
s_waitcnt vmcnt(17)
v_mfma_f32_16x16x32_bf16 v[8:11], v[44:47], v[144:147], v[8:11]
global_load_dwordx4 v[44:47], v157, s[58:59] offset:2048
s_waitcnt vmcnt(17)
v_mfma_f32_16x16x32_bf16 v[12:15], v[48:51], v[144:147], v[12:15]
global_load_dwordx4 v[48:51], v157, s[58:59] offset:3072
s_waitcnt vmcnt(17)
v_mfma_f32_16x16x32_bf16 v[16:19], v[52:55], v[144:147], v[16:19]
s_add_u32 s58, s58, 4096
s_addc_u32 s59, s59, 0
global_load_dwordx4 v[52:55], v157, s[58:59] offset:0
s_waitcnt vmcnt(17)
v_mfma_f32_16x16x32_bf16 v[20:23], v[56:59], v[144:147], v[20:23]
global_load_dwordx4 v[56:59], v157, s[58:59] offset:1024
s_waitcnt vmcnt(17)
v_mfma_f32_16x16x32_bf16 v[24:27], v[60:63], v[144:147], v[24:27]
global_load_dwordx4 v[60:63], v157, s[58:59] offset:2048
s_waitcnt vmcnt(17)
v_mfma_f32_16x16x32_bf16 v[28:31], v[64:67], v[144:147], v[28:31]
global_load_dwordx4 v[64:67], v157, s[58:59] offset:3072
s_waitcnt vmcnt(17)
v_mfma_f32_16x16x32_bf16 v[32:35], v[68:71], v[144:147], v[32:35]
s_add_u32 s58, s58, 4096
s_addc_u32 s59, s59, 0
global_load_dwordx4 v[68:71], v157, s[58:59] offset:0
s_cmp_eq_u32 s33, 0
s_cbranch_scc0 H0_sk29
H0_sp30_re:
ds_read_b64 v[148:149], v167 offset:296
s_waitcnt lgkmcnt(0)
v_cmp_ne_u64 vcc, s[68:69], v[148:149]
s_cbranch_vccz H0_sp30_ok
s_add_u32 s52, s52, 1
s_cmp_gt_u32 s52, 200000
s_cbranch_scc1 H0_sp30_ok
s_sleep 2
s_branch H0_sp30_re
H0_sp30_ok:
v_add_u32 v160, 79872, v164
v_add_u32 v161, 79872, v165
ds_read_b128 v[144:147], v160 offset:0
ds_read_b128 v[148:151], v160 offset:512
ds_read_b128 v[152:155], v161 offset:0
ds_read_b128 v[108:111], v160 offset:2560
ds_read_b128 v[112:115], v160 offset:3072
ds_read_b128 v[116:119], v161 offset:2560
ds_read_b128 v[120:123], v160 offset:5120
ds_read_b128 v[124:127], v160 offset:5632
ds_read_b128 v[128:131], v161 offset:5120
ds_read_b128 v[132:135], v160 offset:7680
ds_read_b128 v[136:139], v160 offset:8192
ds_read_b128 v[140:143], v161 offset:7680
s_waitcnt lgkmcnt(6)
v_pk_add_f32 v[144:145], v[144:145], v[108:109]
v_pk_add_f32 v[146:147], v[146:147], v[110:111]
v_pk_add_f32 v[148:149], v[148:149], v[112:113]
v_pk_add_f32 v[150:151], v[150:151], v[114:115]
v_pk_add_f32 v[152:153], v[152:153], v[116:117]
v_add_f32 v154, v154, v118
ds_read_b128 v[108:111], v160 offset:10240
ds_read_b128 v[112:115], v160 offset:10752
ds_read_b128 v[116:119], v161 offset:10240
s_waitcnt lgkmcnt(6)
v_pk_add_f32 v[144:145], v[144:145], v[120:121]
v_pk_add_f32 v[146:147], v[146:147], v[122:123]
v_pk_add_f32 v[148:149], v[148:149], v[124:125]
v_pk_add_f32 v[150:151], v[150:151], v[126:127]
v_pk_add_f32 v[152:153], v[152:153], v[128:129]
v_add_f32 v154, v154, v130
ds_read_b128 v[120:123], v160 offset:12800
ds_read_b128 v[124:127], v160 offset:13312
ds_read_b128 v[128:131], v161 offset:12800
s_waitcnt lgkmcnt(6)
v_pk_add_f32 v[144:145], v[144:145], v[132:133]
v_pk_add_f32 v[146:147], v[146:147], v[134:135]
v_pk_add_f32 v[148:149], v[148:149], v[136:137]
v_pk_add_f32 v[150:151], v[150:151], v[138:139]
v_pk_add_f32 v[152:153], v[152:153], v[140:141]
v_add_f32 v154, v154, v142
ds_read_b128 v[132:135], v160 offset:15360
ds_read_b128 v[136:139], v160 offset:15872
ds_read_b128 v[140:143], v161 offset:15360
s_waitcnt lgkmcnt(6)
v_pk_add_f32 v[144:145], v[144:145], v[108:109]
v_pk_add_f32 v[146:147], v[146:147], v[110:111]
v_pk_add_f32 v[148:149], v[148:149], v[112:113]
v_pk_add_f32 v[150:151], v[150:151], v[114:115]
v_pk_add_f32 v[152:153], v[152:153], v[116:117]
v_add_f32 v154, v154, v118
ds_read_b128 v[108:111], v160 offset:17920
ds_read_b128 v[112:115], v160 offset:18432
ds_read_b128 v[116:119], v161 offset:17920
s_waitcnt lgkmcnt(6)
v_pk_add_f32 v[144:145], v[144:145], v[120:121]
v_pk_add_f32 v[146:147], v[146:147], v[122:123]
v_pk_add_f32 v[148:149], v[148:149], v[124:125]
v_pk_add_f32 v[150:151], v[150:151], v[126:127]
v_pk_add_f32 v[152:153], v[152:153], v[128:129]
v_add_f32 v154, v154, v130
s_waitcnt lgkmcnt(3)
v_pk_add_f32 v[144:145], v[144:145], v[132:133]
v_pk_add_f32 v[146:147], v[146:147], v[134:135]
v_pk_add_f32 v[148:149], v[148:149], v[136:137]
v_pk_add_f32 v[150:151], v[150:151], v[138:139]
v_pk_add_f32 v[152:153], v[152:153], v[140:141]
v_add_f32 v154, v154, v142
s_waitcnt lgkmcnt(0)
v_pk_add_f32 v[144:145], v[144:145], v[108:109]
v_pk_add_f32 v[146:147], v[146:147], v[110:111]
v_pk_add_f32 v[148:149], v[148:149], v[112:113]
v_pk_add_f32 v[150:151], v[150:151], v[114:115]
v_pk_add_f32 v[152:153], v[152:153], v[116:117]
v_add_f32 v154, v154, v118
v_rcp_f32 v154, v154
s_nop 0
v_mul_f32 v144, v144, v154
v_mul_f32 v145, v145, v154
v_mul_f32 v146, v146, v154
v_mul_f32 v147, v147, v154
v_mul_f32 v148, v148, v154
v_mul_f32 v149, v149, v154
v_mul_f32 v150, v150, v154
v_mul_f32 v151, v151, v154
v_mul_f32 v152, v152, v154
v_mul_f32 v153, v153, v154
v_cvt_pk_bf16_f32 v144, v144, v145
v_cvt_pk_bf16_f32 v145, v146, v147
v_cvt_pk_bf16_f32 v146, v148, v149
v_cvt_pk_bf16_f32 v147, v150, v151
v_cvt_pk_bf16_f32 v155, v152, v153
ds_write_b128 v157, v[144:147] offset:16384
v_lshlrev_b32 v160, 4, v162
v_lshrrev_b32 v161, 1, v163
v_lshl_add_u32 v160, v161, 2, v160
s_mov_b32 exec_lo, 0xffff
s_mov_b32 exec_hi, 0xffff
ds_write_b32 v160, v155 offset:19976
s_mov_b64 exec, 1
v_mov_b32 v160, 76
v_mov_b32 v161, 1
ds_write_b32 v160, v161
s_mov_b64 exec, -1
H0_sk29:
H0_sp31_re:
ds_read_b32 v159, v167 offset:76
s_waitcnt lgkmcnt(0)
v_cmp_ne_u32 vcc, 1, v159
s_cbranch_vccz H0_sp31_ok
s_add_u32 s52, s52, 1
s_cmp_gt_u32 s52, 200000
s_cbranch_scc1 H0_sp31_ok
s_sleep 4
s_branch H0_sp31_re
H0_sp31_ok:
ds_read_b128 v[144:147], v157 offset:16384
s_waitcnt lgkmcnt(0)
s_mul_i32 s46, s40, 294912
s_add_u32 s46, s46, 0xe1000
s_add_u32 s58, s30, s46
s_addc_u32 s59, s31, 0
s_waitcnt vmcnt(17)
v_mfma_f32_16x16x32_bf16 v[0:3], v[72:75], v[144:147], v[0:3]
global_load_dwordx4 v[72:75], v157, s[58:59] offset:0
s_waitcnt vmcnt(17)
v_mfma_f32_16x16x32_bf16 v[4:7], v[76:79], v[144:147], v[4:7]
global_load_dwordx4 v[76:79], v157, s[58:59] offset:1024
s_waitcnt vmcnt(17)
v_mfma_f32_16x16x32_bf16 v[8:11], v[80:83], v[144:147], v[8:11]
global_load_dwordx4 v[80:83], v157, s[58:59] offset:2048
s_waitcnt vmcnt(17)
v_mfma_f32_16x16x32_bf16 v[12:15], v[84:87], v[144:147], v[12:15]
global_load_dwordx4 v[84:87], v157, s[58:59] offset:3072
s_waitcnt vmcnt(17)
v_mfma_f32_16x16x32_bf16 v[16:19], v[88:91], v[144:147], v[16:19]
s_add_u32 s58, s58, 4096
s_addc_u32 s59, s59, 0
global_load_dwordx4 v[88:91], v157, s[58:59] offset:0
s_waitcnt vmcnt(17)
v_mfma_f32_16x16x32_bf16 v[20:23], v[92:95], v[144:147], v[20:23]
global_load_dwordx4 v[92:95], v157, s[58:59] offset:1024
s_waitcnt vmcnt(17)
v_mfma_f32_16x16x32_bf16 v[24:27], v[96:99], v[144:147], v[24:27]
global_load_dwordx4 v[96:99], v157, s[58:59] offset:2048
s_waitcnt vmcnt(17)
v_mfma_f32_16x16x32_bf16 v[28:31], v[100:103], v[144:147], v[28:31]
global_load_dwordx4 v[100:103], v157, s[58:59] offset:3072
s_waitcnt vmcnt(17)
v_mfma_f32_16x16x32_bf16 v[32:35], v[104:107], v[144:147], v[32:35]
s_add_u32 s58, s58, 4096
s_addc_u32 s59, s59, 0
global_load_dwordx4 v[104:107], v157, s[58:59] offset:0
s_cmp_eq_u32 s33, 0
s_cbranch_scc0 H0_sk32
H0_sp33_re:
ds_read_b64 v[148:149], v167 offset:304
s_waitcnt lgkmcnt(0)
v_cmp_ne_u64 vcc, s[68:69], v[148:149]
s_cbranch_vccz H0_sp33_ok
s_add_u32 s52, s52, 1
s_cmp_gt_u32 s52, 200000
s_cbranch_scc1 H0_sp33_ok
s_sleep 2
s_branch H0_sp33_re
H0_sp33_ok:
v_add_u32 v160, 38912, v164
v_add_u32 v161, 38912, v165
ds_read_b128 v[144:147], v160 offset:0
ds_read_b128 v[148:151], v160 offset:512
ds_read_b128 v[152:155], v161 offset:0
ds_read_b128 v[108:111], v160 offset:2560
ds_read_b128 v[112:115], v160 offset:3072
ds_read_b128 v[116:119], v161 offset:2560
ds_read_b128 v[120:123], v160 offset:5120
ds_read_b128 v[124:127], v160 offset:5632
ds_read_b128 v[128:131], v161 offset:5120
ds_read_b128 v[132:135], v160 offset:7680
ds_read_b128 v[136:139], v160 offset:8192
ds_read_b128 v[140:143], v161 offset:7680
s_waitcnt lgkmcnt(6)
v_pk_add_f32 v[144:145], v[144:145], v[108:109]
v_pk_add_f32 v[146:147], v[146:147], v[110:111]
v_pk_add_f32 v[148:149], v[148:149], v[112:113]
v_pk_add_f32 v[150:151], v[150:151], v[114:115]
v_pk_add_f32 v[152:153], v[152:153], v[116:117]
v_add_f32 v154, v154, v118
ds_read_b128 v[108:111], v160 offset:10240
ds_read_b128 v[112:115], v160 offset:10752
ds_read_b128 v[116:119], v161 offset:10240
s_waitcnt lgkmcnt(6)
v_pk_add_f32 v[144:145], v[144:145], v[120:121]
v_pk_add_f32 v[146:147], v[146:147], v[122:123]
v_pk_add_f32 v[148:149], v[148:149], v[124:125]
v_pk_add_f32 v[150:151], v[150:151], v[126:127]
v_pk_add_f32 v[152:153], v[152:153], v[128:129]
v_add_f32 v154, v154, v130
ds_read_b128 v[120:123], v160 offset:12800
ds_read_b128 v[124:127], v160 offset:13312
ds_read_b128 v[128:131], v161 offset:12800
s_waitcnt lgkmcnt(6)
v_pk_add_f32 v[144:145], v[144:145], v[132:133]
v_pk_add_f32 v[146:147], v[146:147], v[134:135]
v_pk_add_f32 v[148:149], v[148:149], v[136:137]
v_pk_add_f32 v[150:151], v[150:151], v[138:139]
v_pk_add_f32 v[152:153], v[152:153], v[140:141]
v_add_f32 v154, v154, v142
ds_read_b128 v[132:135], v160 offset:15360
ds_read_b128 v[136:139], v160 offset:15872
ds_read_b128 v[140:143], v161 offset:15360
s_waitcnt lgkmcnt(6)
v_pk_add_f32 v[144:145], v[144:145], v[108:109]
v_pk_add_f32 v[146:147], v[146:147], v[110:111]
v_pk_add_f32 v[148:149], v[148:149], v[112:113]
v_pk_add_f32 v[150:151], v[150:151], v[114:115]
v_pk_add_f32 v[152:153], v[152:153], v[116:117]
v_add_f32 v154, v154, v118
ds_read_b128 v[108:111], v160 offset:17920
ds_read_b128 v[112:115], v160 offset:18432
ds_read_b128 v[116:119], v161 offset:17920
s_waitcnt lgkmcnt(6)
v_pk_add_f32 v[144:145], v[144:145], v[120:121]
v_pk_add_f32 v[146:147], v[146:147], v[122:123]
v_pk_add_f32 v[148:149], v[148:149], v[124:125]
v_pk_add_f32 v[150:151], v[150:151], v[126:127]
v_pk_add_f32 v[152:153], v[152:153], v[128:129]
v_add_f32 v154, v154, v130
s_waitcnt lgkmcnt(3)
v_pk_add_f32 v[144:145], v[144:145], v[132:133]
v_pk_add_f32 v[146:147], v[146:147], v[134:135]
v_pk_add_f32 v[148:149], v[148:149], v[136:137]
v_pk_add_f32 v[150:151], v[150:151], v[138:139]
v_pk_add_f32 v[152:153], v[152:153], v[140:141]
v_add_f32 v154, v154, v142
s_waitcnt lgkmcnt(0)
v_pk_add_f32 v[144:145], v[144:145], v[108:109]
v_pk_add_f32 v[146:147], v[146:147], v[110:111]
v_pk_add_f32 v[148:149], v[148:149], v[112:113]
v_pk_add_f32 v[150:151], v[150:151], v[114:115]
v_pk_add_f32 v[152:153], v[152:153], v[116:117]
v_add_f32 v154, v154, v118
v_rcp_f32 v154, v154
s_nop 0
v_mul_f32 v144, v144, v154
v_mul_f32 v145, v145, v154
v_mul_f32 v146, v146, v154
v_mul_f32 v147, v147, v154
v_mul_f32 v148, v148, v154
v_mul_f32 v149, v149, v154
v_mul_f32 v150, v150, v154
v_mul_f32 v151, v151, v154
v_mul_f32 v152, v152, v154
v_mul_f32 v153, v153, v154
v_cvt_pk_bf16_f32 v144, v144, v145
v_cvt_pk_bf16_f32 v145, v146, v147
v_cvt_pk_bf16_f32 v146, v148, v149
v_cvt_pk_bf16_f32 v147, v150, v151
v_cvt_pk_bf16_f32 v155, v152, v153
ds_write_b128 v157, v[144:147] offset:17408
v_lshlrev_b32 v160, 4, v162
v_lshrrev_b32 v161, 1, v163
v_lshl_add_u32 v160, v161, 2, v160
s_mov_b32 exec_lo, 0xffff
s_mov_b32 exec_hi, 0xffff
ds_write_b32 v160, v155 offset:20224
s_mov_b64 exec, 1
v_mov_b32 v160, 84
v_mov_b32 v161, 1
ds_write_b32 v160, v161
s_mov_b64 exec, -1
H0_sk32:
s_mul_i32 s46, s40, 36864
s_add_u32 s46, s46, 0x132000
s_add_u32 s58, s30, s46
s_addc_u32 s59, s31, 0
global_load_dwordx4 v[108:111], v157, s[58:59] offset:0
global_load_dwordx4 v[112:115], v157, s[58:59] offset:1024
global_load_dwordx4 v[116:119], v157, s[58:59] offset:2048
global_load_dwordx4 v[120:123], v157, s[58:59] offset:3072
s_add_u32 s58, s58, 4096
s_addc_u32 s59, s59, 0
global_load_dwordx4 v[124:127], v157, s[58:59] offset:0
global_load_dwordx4 v[128:131], v157, s[58:59] offset:1024
global_load_dwordx4 v[132:135], v157, s[58:59] offset:2048
global_load_dwordx4 v[136:139], v157, s[58:59] offset:3072
s_add_u32 s58, s58, 4096
s_addc_u32 s59, s59, 0
global_load_dwordx4 v[140:143], v157, s[58:59] offset:0
H0_sp34_re:
ds_read_b32 v159, v167 offset:84
s_waitcnt lgkmcnt(0)
v_cmp_ne_u32 vcc, 1, v159
s_cbranch_vccz H0_sp34_ok
s_add_u32 s52, s52, 1
s_cmp_gt_u32 s52, 200000
s_cbranch_scc1 H0_sp34_ok
s_sleep 4
s_branch H0_sp34_re
H0_sp34_ok:
ds_read_b128 v[144:147], v157 offset:17408
s_waitcnt lgkmcnt(0) vmcnt(0)
s_waitcnt vmcnt(8)
v_mfma_f32_16x16x32_bf16 v[0:3], v[36:39], v[144:147], v[0:3]
s_waitcnt vmcnt(7)
v_mfma_f32_16x16x32_bf16 v[4:7], v[40:43], v[144:147], v[4:7]
s_waitcnt vmcnt(6)
v_mfma_f32_16x16x32_bf16 v[8:11], v[44:47], v[144:147], v[8:11]
s_waitcnt vmcnt(5)
v_mfma_f32_16x16x32_bf16 v[12:15], v[48:51], v[144:147], v[12:15]
s_waitcnt vmcnt(4)
v_mfma_f32_16x16x32_bf16 v[16:19], v[52:55], v[144:147], v[16:19]
s_waitcnt vmcnt(3)
v_mfma_f32_16x16x32_bf16 v[20:23], v[56:59], v[144:147], v[20:23]
s_waitcnt vmcnt(2)
v_mfma_f32_16x16x32_bf16 v[24:27], v[60:63], v[144:147], v[24:27]
s_waitcnt vmcnt(1)
v_mfma_f32_16x16x32_bf16 v[28:31], v[64:67], v[144:147], v[28:31]
s_waitcnt vmcnt(0)
v_mfma_f32_16x16x32_bf16 v[32:35], v[68:71], v[144:147], v[32:35]
H0_sp35_re:
ds_read_b32 v159, v167 offset:92
s_waitcnt lgkmcnt(0)
v_cmp_ne_u32 vcc, 1, v159
s_cbranch_vccz H0_sp35_ok
s_add_u32 s52, s52, 1
s_cmp_gt_u32 s52, 200000
s_cbranch_scc1 H0_sp35_ok
s_sleep 0
s_branch H0_sp35_re
H0_sp35_ok:
ds_read_b128 v[144:147], v157 offset:18432
ds_read_b128 v[148:151], v157 offset:19456
s_waitcnt lgkmcnt(0)
s_waitcnt vmcnt(0)
v_mov_b32 v161, 0xfffff000
v_add_u32 v160, 4096, v166
s_cmp_eq_u32 s71, 1
s_cbranch_scc1 H0_stl
v_mfma_f32_16x16x32_bf16 v[0:3], v[72:75], v[144:147], v[0:3]
v_mfma_f32_16x16x32_bf16 v[0:3], v[108:111], v[148:151], v[0:3]
v_mfma_f32_16x16x32_bf16 v[4:7], v[76:79], v[144:147], v[4:7]
v_mfma_f32_16x16x32_bf16 v[4:7], v[112:115], v[148:151], v[4:7]
v_mfma_f32_16x16x32_bf16 v[8:11], v[80:83], v[144:147], v[8:11]
v_mfma_f32_16x16x32_bf16 v[8:11], v[116:119], v[148:151], v[8:11]
s_nop 3
v_and_or_b32 v108, v0, v161, s62
v_and_or_b32 v109, v1, v161, s63
v_and_or_b32 v110, v2, v161, s64
v_and_or_b32 v111, v3, v161, s65
s_mov_b64 exec, s[56:57]
global_store_dwordx4 v166, v[108:111], s[48:49] offset:0 sc1
s_mov_b64 exec, -1
v_mfma_f32_16x16x32_bf16 v[12:15], v[84:87], v[144:147], v[12:15]
v_mfma_f32_16x16x32_bf16 v[12:15], v[120:123], v[148:151], v[12:15]
v_and_or_b32 v112, v4, v161, s62
v_and_or_b32 v113, v5, v161, s63
v_and_or_b32 v114, v6, v161, s64
v_and_or_b32 v115, v7, v161, s65
s_mov_b64 exec, s[56:57]
global_store_dwordx4 v166, v[112:115], s[48:49] offset:512 sc1
s_mov_b64 exec, -1
v_mfma_f32_16x16x32_bf16 v[16:19], v[88:91], v[144:147], v[16:19]
v_mfma_f32_16x16x32_bf16 v[16:19], v[124:127], v[148:151], v[16:19]
v_and_or_b32 v116, v8, v161, s62
v_and_or_b32 v117, v9, v161, s63
v_and_or_b32 v118, v10, v161, s64
v_and_or_b32 v119, v11, v161, s65
s_mov_b64 exec, s[56:57]
global_store_dwordx4 v166, v[116:119], s[48:49] offset:1024 sc1
s_mov_b64 exec, -1
v_mfma_f32_16x16x32_bf16 v[20:23], v[92:95], v[144:147], v[20:23]
v_mfma_f32_16x16x32_bf16 v[20:23], v[128:131], v[148:151], v[20:23]
v_and_or_b32 v120, v12, v161, s62
v_and_or_b32 v121, v13, v161, s63
v_and_or_b32 v122, v14, v161, s64
v_and_or_b32 v123, v15, v161, s65
s_mov_b64 exec, s[56:57]
global_store_dwordx4 v166, v[120:123], s[48:49] offset:1536 sc1
s_mov_b64 exec, -1
v_mfma_f32_16x16x32_bf16 v[24:27], v[96:99], v[144:147], v[24:27]
v_mfma_f32_16x16x32_bf16 v[24:27], v[132:135], v[148:151], v[24:27]
v_and_or_b32 v124, v16, v161, s62
v_and_or_b32 v125, v17, v161, s63
v_and_or_b32 v126, v18, v161, s64
v_and_or_b32 v127, v19, v161, s65
s_mov_b64 exec, s[56:57]
global_store_dwordx4 v166, v[124:127], s[48:49] offset:2048 sc1
s_mov_b64 exec, -1
v_mfma_f32_16x16x32_bf16 v[28:31], v[100:103], v[144:147], v[28:31]
v_mfma_f32_16x16x32_bf16 v[28:31], v[136:139], v[148:151], v[28:31]
v_and_or_b32 v128, v20, v161, s62
v_and_or_b32 v129, v21, v161, s63
v_and_or_b32 v130, v22, v161, s64
v_and_or_b32 v131, v23, v161, s65
s_mov_b64 exec, s[56:57]
global_store_dwordx4 v166, v[128:131], s[48:49] offset:2560 sc1
s_mov_b64 exec, -1
v_mfma_f32_16x16x32_bf16 v[32:35], v[104:107], v[144:147], v[32:35]
v_mfma_f32_16x16x32_bf16 v[32:35], v[140:143], v[148:151], v[32:35]
v_and_or_b32 v132, v24, v161, s62
v_and_or_b32 v133, v25, v161, s63
v_and_or_b32 v134, v26, v161, s64
v_and_or_b32 v135, v27, v161, s65
s_mov_b64 exec, s[56:57]
global_store_dwordx4 v166, v[132:135], s[48:49] offset:3072 sc1
s_mov_b64 exec, -1
v_and_or_b32 v136, v28, v161, s62
v_and_or_b32 v137, v29, v161, s63
v_and_or_b32 v138, v30, v161, s64
v_and_or_b32 v139, v31, v161, s65
s_mov_b64 exec, s[56:57]
global_store_dwordx4 v166, v[136:139], s[48:49] offset:3584 sc1
s_mov_b64 exec, -1
v_and_or_b32 v140, v32, v161, s62
v_and_or_b32 v141, v33, v161, s63
v_and_or_b32 v142, v34, v161, s64
v_and_or_b32 v143, v35, v161, s65
s_mov_b64 exec, s[56:57]
global_store_dwordx4 v160, v[140:143], s[48:49] sc1
s_mov_b64 exec, -1
s_branch H0_std
H0_stl:
v_mfma_f32_16x16x32_bf16 v[0:3], v[72:75], v[144:147], v[0:3]
v_mfma_f32_16x16x32_bf16 v[0:3], v[108:111], v[148:151], v[0:3]
v_mfma_f32_16x16x32_bf16 v[4:7], v[76:79], v[144:147], v[4:7]
v_mfma_f32_16x16x32_bf16 v[4:7], v[112:115], v[148:151], v[4:7]
v_mfma_f32_16x16x32_bf16 v[8:11], v[80:83], v[144:147], v[8:11]
v_mfma_f32_16x16x32_bf16 v[8:11], v[116:119], v[148:151], v[8:11]
s_nop 3
v_and_or_b32 v108, v0, v161, s62
v_and_or_b32 v109, v1, v161, s63
v_and_or_b32 v110, v2, v161, s64
v_and_or_b32 v111, v3, v161, s65
s_mov_b64 exec, s[56:57]
global_store_dwordx4 v166, v[108:111], s[48:49] offset:0
s_mov_b64 exec, -1
v_mfma_f32_16x16x32_bf16 v[12:15], v[84:87], v[144:147], v[12:15]
v_mfma_f32_16x16x32_bf16 v[12:15], v[120:123], v[148:151], v[12:15]
v_and_or_b32 v112, v4, v161, s62
v_and_or_b32 v113, v5, v161, s63
v_and_or_b32 v114, v6, v161, s64
v_and_or_b32 v115, v7, v161, s65
s_mov_b64 exec, s[56:57]
global_store_dwordx4 v166, v[112:115], s[48:49] offset:512
s_mov_b64 exec, -1
v_mfma_f32_16x16x32_bf16 v[16:19], v[88:91], v[144:147], v[16:19]
v_mfma_f32_16x16x32_bf16 v[16:19], v[124:127], v[148:151], v[16:19]
v_and_or_b32 v116, v8, v161, s62
v_and_or_b32 v117, v9, v161, s63
v_and_or_b32 v118, v10, v161, s64
v_and_or_b32 v119, v11, v161, s65
s_mov_b64 exec, s[56:57]
global_store_dwordx4 v166, v[116:119], s[48:49] offset:1024
s_mov_b64 exec, -1
v_mfma_f32_16x16x32_bf16 v[20:23], v[92:95], v[144:147], v[20:23]
v_mfma_f32_16x16x32_bf16 v[20:23], v[128:131], v[148:151], v[20:23]
v_and_or_b32 v120, v12, v161, s62
v_and_or_b32 v121, v13, v161, s63
v_and_or_b32 v122, v14, v161, s64
v_and_or_b32 v123, v15, v161, s65
s_mov_b64 exec, s[56:57]
global_store_dwordx4 v166, v[120:123], s[48:49] offset:1536
s_mov_b64 exec, -1
v_mfma_f32_16x16x32_bf16 v[24:27], v[96:99], v[144:147], v[24:27]
v_mfma_f32_16x16x32_bf16 v[24:27], v[132:135], v[148:151], v[24:27]
v_and_or_b32 v124, v16, v161, s62
v_and_or_b32 v125, v17, v161, s63
v_and_or_b32 v126, v18, v161, s64
v_and_or_b32 v127, v19, v161, s65
s_mov_b64 exec, s[56:57]
global_store_dwordx4 v166, v[124:127], s[48:49] offset:2048
s_mov_b64 exec, -1
v_mfma_f32_16x16x32_bf16 v[28:31], v[100:103], v[144:147], v[28:31]
v_mfma_f32_16x16x32_bf16 v[28:31], v[136:139], v[148:151], v[28:31]
v_and_or_b32 v128, v20, v161, s62
v_and_or_b32 v129, v21, v161, s63
v_and_or_b32 v130, v22, v161, s64
v_and_or_b32 v131, v23, v161, s65
s_mov_b64 exec, s[56:57]
global_store_dwordx4 v166, v[128:131], s[48:49] offset:2560
s_mov_b64 exec, -1
v_mfma_f32_16x16x32_bf16 v[32:35], v[104:107], v[144:147], v[32:35]
v_mfma_f32_16x16x32_bf16 v[32:35], v[140:143], v[148:151], v[32:35]
v_and_or_b32 v132, v24, v161, s62
v_and_or_b32 v133, v25, v161, s63
v_and_or_b32 v134, v26, v161, s64
v_and_or_b32 v135, v27, v161, s65
s_mov_b64 exec, s[56:57]
global_store_dwordx4 v166, v[132:135], s[48:49] offset:3072
s_mov_b64 exec, -1
v_and_or_b32 v136, v28, v161, s62
v_and_or_b32 v137, v29, v161, s63
v_and_or_b32 v138, v30, v161, s64
v_and_or_b32 v139, v31, v161, s65
s_mov_b64 exec, s[56:57]
global_store_dwordx4 v166, v[136:139], s[48:49] offset:3584
s_mov_b64 exec, -1
v_and_or_b32 v140, v32, v161, s62
v_and_or_b32 v141, v33, v161, s63
v_and_or_b32 v142, v34, v161, s64
v_and_or_b32 v143, v35, v161, s65
s_mov_b64 exec, s[56:57]
global_store_dwordx4 v160, v[140:143], s[48:49]
s_mov_b64 exec, -1
H0_std:
s_mov_b64 exec, s[54:55]
s_mov_b32 s52, 0
global_load_dwordx4 v[36:39], v166, s[66:67] offset:0 sc1
global_load_dwordx4 v[40:43], v166, s[66:67] offset:512 sc1
global_load_dwordx4 v[44:47], v166, s[66:67] offset:1024 sc1
global_load_dwordx4 v[48:51], v166, s[66:67] offset:1536 sc1
global_load_dwordx4 v[52:55], v166, s[66:67] offset:2048 sc1
global_load_dwordx4 v[56:59], v166, s[66:67] offset:2560 sc1
global_load_dwordx4 v[60:63], v166, s[66:67] offset:3072 sc1
global_load_dwordx4 v[64:67], v166, s[66:67] offset:3584 sc1
global_load_dwordx4 v[68:71], v160, s[66:67] sc1
ds_write_b128 v156, v[0:3] offset:0
ds_write_b128 v156, v[4:7] offset:64
ds_write_b128 v156, v[8:11] offset:128
ds_write_b128 v156, v[12:15] offset:192
ds_write_b128 v156, v[16:19] offset:256
ds_write_b128 v156, v[20:23] offset:320
ds_write_b128 v156, v[24:27] offset:384
ds_write_b128 v156, v[28:31] offset:448
ds_write_b128 v156, v[32:35] offset:512
H0_poll:
s_waitcnt vmcnt(0)
v_mov_b32 v158, 0
v_bitop3_b32 v158, v36, s62, v158 bitop3:0xbe
v_bitop3_b32 v158, v37, s63, v158 bitop3:0xbe
v_bitop3_b32 v158, v38, s64, v158 bitop3:0xbe
v_bitop3_b32 v158, v39, s65, v158 bitop3:0xbe
v_bitop3_b32 v158, v40, s62, v158 bitop3:0xbe
v_bitop3_b32 v158, v41, s63, v158 bitop3:0xbe
v_bitop3_b32 v158, v42, s64, v158 bitop3:0xbe
v_bitop3_b32 v158, v43, s65, v158 bitop3:0xbe
v_bitop3_b32 v158, v44, s62, v158 bitop3:0xbe
v_bitop3_b32 v158, v45, s63, v158 bitop3:0xbe
v_bitop3_b32 v158, v46, s64, v158 bitop3:0xbe
v_bitop3_b32 v158, v47, s65, v158 bitop3:0xbe
v_bitop3_b32 v158, v48, s62, v158 bitop3:0xbe
v_bitop3_b32 v158, v49, s63, v158 bitop3:0xbe
v_bitop3_b32 v158, v50, s64, v158 bitop3:0xbe
v_bitop3_b32 v158, v51, s65, v158 bitop3:0xbe
v_bitop3_b32 v158, v52, s62, v158 bitop3:0xbe
v_bitop3_b32 v158, v53, s63, v158 bitop3:0xbe
v_bitop3_b32 v158, v54, s64, v158 bitop3:0xbe
v_bitop3_b32 v158, v55, s65, v158 bitop3:0xbe
v_bitop3_b32 v158, v56, s62, v158 bitop3:0xbe
v_bitop3_b32 v158, v57, s63, v158 bitop3:0xbe
v_bitop3_b32 v158, v58, s64, v158 bitop3:0xbe
v_bitop3_b32 v158, v59, s65, v158 bitop3:0xbe
v_bitop3_b32 v158, v60, s62, v158 bitop3:0xbe
v_bitop3_b32 v158, v61, s63, v158 bitop3:0xbe
v_bitop3_b32 v158, v62, s64, v158 bitop3:0xbe
v_bitop3_b32 v158, v63, s65, v158 bitop3:0xbe
v_bitop3_b32 v158, v64, s62, v158 bitop3:0xbe
v_bitop3_b32 v158, v65, s63, v158 bitop3:0xbe
v_bitop3_b32 v158, v66, s64, v158 bitop3:0xbe
v_bitop3_b32 v158, v67, s65, v158 bitop3:0xbe
v_bitop3_b32 v158, v68, s62, v158 bitop3:0xbe
v_bitop3_b32 v158, v69, s63, v158 bitop3:0xbe
v_bitop3_b32 v158, v70, s64, v158 bitop3:0xbe
v_bitop3_b32 v158, v71, s65, v158 bitop3:0xbe
v_and_b32 v158, 0xfff, v158
v_cmp_ne_u32 vcc, 0, v158
s_cbranch_vccz H0_pollok
s_add_u32 s52, s52, 1
s_cmp_gt_u32 s52, 20000
s_cbranch_scc1 H0_pollok
global_load_dwordx4 v[36:39], v166, s[66:67] offset:0 sc1
global_load_dwordx4 v[40:43], v166, s[66:67] offset:512 sc1
global_load_dwordx4 v[44:47], v166, s[66:67] offset:1024 sc1
global_load_dwordx4 v[48:51], v166, s[66:67] offset:1536 sc1
global_load_dwordx4 v[52:55], v166, s[66:67] offset:2048 sc1
global_load_dwordx4 v[56:59], v166, s[66:67] offset:2560 sc1
global_load_dwordx4 v[60:63], v166, s[66:67] offset:3072 sc1
global_load_dwordx4 v[64:67], v166, s[66:67] offset:3584 sc1
global_load_dwordx4 v[68:71], v160, s[66:67] sc1
s_branch H0_poll
H0_pollok:
v_add_u32 v156, 18560, v156
ds_write_b128 v156, v[36:39] offset:0
ds_write_b128 v156, v[40:43] offset:64
ds_write_b128 v156, v[44:47] offset:128
ds_write_b128 v156, v[48:51] offset:192
ds_write_b128 v156, v[52:55] offset:256
ds_write_b128 v156, v[56:59] offset:320
ds_write_b128 v156, v[60:63] offset:384
ds_write_b128 v156, v[64:67] offset:448
ds_write_b128 v156, v[68:71] offset:512
s_mov_b64 exec, -1
s_waitcnt lgkmcnt(0)
s_barrier
s_cmp_eq_u32 s33, 1
s_cbranch_scc1 L_hfin0
s_mov_b32 s33, 1
s_mul_i32 s34, s33, 0x240000
s_add_u32 s34, s34, 0x200000
s_mul_i32 s35, s33, 0x10000
s_add_u32 s35, s35, 0x680000
s_mul_i32 s36, s33, 0x4000
s_add_u32 s36, s36, 0x6a0000
s_mul_i32 s37, s33, 0x14000
s_add_u32 s37, s37, 0x6b0000
s_mul_i32 s38, s33, 0x800
s_add_u32 s38, s38, 0x6d8000
s_mul_i32 s39, s33, 0x900000
s_add_u32 s39, s39, 0xe00000
v_mbcnt_lo_u32_b32 v156, -1, 0
v_mbcnt_hi_u32_b32 v156, -1, v156
v_lshlrev_b32 v157, 4, v156
v_mov_b32 v167, 0
s_mul_i32 s46, s40, 294912
s_add_u32 s46, s46, 0x0
s_add_u32 s44, s30, s46
s_addc_u32 s45, s31, 0
global_load_dwordx4 v[0:3], v157, s[44:45] offset:0
global_load_dwordx4 v[4:7], v157, s[44:45] offset:1024
global_load_dwordx4 v[8:11], v157, s[44:45] offset:2048
global_load_dwordx4 v[12:15], v157, s[44:45] offset:3072
s_add_u32 s44, s44, 4096
s_addc_u32 s45, s45, 0
global_load_dwordx4 v[16:19], v157, s[44:45] offset:0
global_load_dwordx4 v[20:23], v157, s[44:45] offset:1024
global_load_dwordx4 v[24:27], v157, s[44:45] offset:2048
global_load_dwordx4 v[28:31], v157, s[44:45] offset:3072
s_add_u32 s44, s44, 4096
s_addc_u32 s45, s45, 0
global_load_dwordx4 v[32:35], v157, s[44:45] offset:0
global_load_dwordx4 v[36:39], v157, s[44:45] offset:1024
global_load_dwordx4 v[40:43], v157, s[44:45] offset:2048
global_load_dwordx4 v[44:47], v157, s[44:45] offset:3072
s_add_u32 s44, s44, 4096
s_addc_u32 s45, s45, 0
global_load_dwordx4 v[48:51], v157, s[44:45] offset:0
global_load_dwordx4 v[52:55], v157, s[44:45] offset:1024
global_load_dwordx4 v[56:59], v157, s[44:45] offset:2048
global_load_dwordx4 v[60:63], v157, s[44:45] offset:3072
s_add_u32 s44, s44, 4096
s_addc_u32 s45, s45, 0
global_load_dwordx4 v[64:67], v157, s[44:45] offset:0
global_load_dwordx4 v[68:71], v157, s[44:45] offset:1024
s_add_u32 s46, 0, 0x6dc000
s_add_u32 s48, s30, s46
s_addc_u32 s49, s31, 0
s_load_dwordx2 s[60:61], s[48:49], 0
s_barrier
v_and_b32 v162, 15, v156
v_lshrrev_b32 v163, 4, v156
v_lshrrev_b32 v165, 1, v163
v_lshlrev_b32 v165, 8, v165
v_lshl_add_u32 v165, v162, 4, v165
v_and_b32 v164, 1, v163
v_lshlrev_b32 v164, 10, v164
v_add_u32 v164, v164, v165
v_add_u32 v165, 2048, v165
v_lshrrev_b32 v166, 1, v163
v_lshlrev_b32 v166, 9, v166
v_lshl_add_u32 v166, v162, 4, v166
v_and_b32 v160, 1, v163
v_lshl_add_u32 v166, v160, 3, v166
s_waitcnt lgkmcnt(0)
s_add_u32 s50, s60, 32
s_and_b32 s51, s61, 0xffff
s_lshl_b32 s51, s51, 8
s_mov_b32 s52, 0
H0_xc_re:
v_mov_b32 v158, 158848
ds_read_b32 v159, v158
s_waitcnt lgkmcnt(0)
v_cmp_ne_u32 vcc, 5, v159
s_cbranch_vccz H0_xc_ok
s_add_u32 s52, s52, 1
s_cmp_gt_u32 s52, 200000
s_cbranch_scc1 H0_xc_ok
s_sleep 1
s_branch H0_xc_re
H0_xc_ok:
s_lshl_b32 s46, s2, 3
s_add_u32 s46, s46, 0x6da000
v_mov_b32 v158, s46
v_mov_b32 v148, s50
v_mov_b32 v149, s51
s_mov_b64 exec, 1
s_cmp_eq_u32 s71, 1
s_cbranch_scc1 H0_pfp
global_store_dwordx2 v158, v[148:149], s[30:31] sc1
s_branch H0_pfd
H0_pfp:
global_store_dwordx2 v158, v[148:149], s[30:31]
H0_pfd:
s_mov_b64 exec, -1
s_xor_b32 s47, s2, 1
s_lshl_b32 s46, s47, 3
s_add_u32 s46, s46, 0x6da000
v_mov_b32 v158, s46
H0_pf_re:
global_load_dwordx2 v[148:149], v158, s[30:31] sc1
s_waitcnt vmcnt(0)
v_cmp_ne_u64 vcc, s[50:51], v[148:149]
s_cbranch_vccz H0_pf_ok
s_add_u32 s52, s52, 1
s_cmp_gt_u32 s52, 200000
s_cbranch_scc1 H0_pf_ok
s_sleep 1
s_branch H0_pf_re
H0_pf_ok:
v_mov_b32 v158, 158888
v_mov_b32 v159, 1
ds_write_b32 v158, v159
s_lshr_b32 s41, s2, 1
s_mul_i32 s41, s41, 18432
s_add_u32 s41, s41, s34
s_cmp_eq_u32 s40, 0
s_mov_b32 s46, 0x00ff00ff
s_cselect_b32 s46, 0xff00ff00, s46
s_mov_b32 exec_lo, s46
s_mov_b32 exec_hi, s46
s_add_u32 s46, s41, 0
s_add_u32 s42, s30, s46
s_addc_u32 s43, s31, 0
s_mov_b32 m0, 20480
s_nop 0
global_load_lds_dwordx4 v157, s[42:43] sc1
s_add_u32 s46, s41, 4096
s_add_u32 s42, s30, s46
s_addc_u32 s43, s31, 0
s_mov_b32 m0, 24576
s_nop 0
global_load_lds_dwordx4 v157, s[42:43] sc1
s_add_u32 s46, s41, 8192
s_add_u32 s42, s30, s46
s_addc_u32 s43, s31, 0
s_mov_b32 m0, 28672
s_nop 0
global_load_lds_dwordx4 v157, s[42:43] sc1
s_add_u32 s46, s41, 12288
s_add_u32 s42, s30, s46
s_addc_u32 s43, s31, 0
s_mov_b32 m0, 32768
s_nop 0
global_load_lds_dwordx4 v157, s[42:43] sc1
s_add_u32 s46, s41, 16384
s_add_u32 s42, s30, s46
s_addc_u32 s43, s31, 0
s_mov_b32 m0, 36864
s_nop 0
global_load_lds_dwordx4 v157, s[42:43] sc1
s_mov_b64 exec, -1
s_waitcnt vmcnt(0)
s_branch H0_tags
L_hfin0:
s_endpgm
L_h1:
s_setprio 3
s_mov_b32 s68, 0x80808080
s_mov_b32 s69, 0x80808080
s_mov_b32 s70, 0x45800000
v_mbcnt_lo_u32_b32 v156, -1, 0
v_mbcnt_hi_u32_b32 v156, -1, v156
v_lshlrev_b32 v157, 4, v156
v_mov_b32 v167, 0
s_and_b32 s40, s2, 1
s_lshr_b32 s41, s2, 1
s_mul_i32 s41, s41, 18432
s_add_u32 s41, s41, s34
s_add_u32 s46, s41, 1024
s_add_u32 s42, s30, s46
s_addc_u32 s43, s31, 0
s_mov_b32 m0, 21504
s_nop 0
global_load_lds_dwordx4 v157, s[42:43]
s_add_u32 s46, s41, 5120
s_add_u32 s42, s30, s46
s_addc_u32 s43, s31, 0
s_mov_b32 m0, 25600
s_nop 0
global_load_lds_dwordx4 v157, s[42:43]
s_add_u32 s46, s41, 9216
s_add_u32 s42, s30, s46
s_addc_u32 s43, s31, 0
s_mov_b32 m0, 29696
s_nop 0
global_load_lds_dwordx4 v157, s[42:43]
s_add_u32 s46, s41, 13312
s_add_u32 s42, s30, s46
s_addc_u32 s43, s31, 0
s_mov_b32 m0, 33792
s_nop 0
global_load_lds_dwordx4 v157, s[42:43]
s_add_u32 s46, s41, 17408
s_add_u32 s42, s30, s46
s_addc_u32 s43, s31, 0
s_mov_b32 m0, 37888
s_nop 0
global_load_lds_dwordx4 v157, s[42:43]
s_mul_i32 s46, s40, 294912
s_add_u32 s46, s46, 0x4800
s_add_u32 s44, s30, s46
s_addc_u32 s45, s31, 0
global_load_dwordx4 v[0:3], v157, s[44:45] offset:0
global_load_dwordx4 v[4:7], v157, s[44:45] offset:1024
global_load_dwordx4 v[8:11], v157, s[44:45] offset:2048
global_load_dwordx4 v[12:15], v157, s[44:45] offset:3072
s_add_u32 s44, s44, 4096
s_addc_u32 s45, s45, 0
global_load_dwordx4 v[16:19], v157, s[44:45] offset:0
global_load_dwordx4 v[20:23], v157, s[44:45] offset:1024
global_load_dwordx4 v[24:27], v157, s[44:45] offset:2048
global_load_dwordx4 v[28:31], v157, s[44:45] offset:3072
s_add_u32 s44, s44, 4096
s_addc_u32 s45, s45, 0
global_load_dwordx4 v[32:35], v157, s[44:45] offset:0
global_load_dwordx4 v[36:39], v157, s[44:45] offset:1024
global_load_dwordx4 v[40:43], v157, s[44:45] offset:2048
global_load_dwordx4 v[44:47], v157, s[44:45] offset:3072
s_add_u32 s44, s44, 4096
s_addc_u32 s45, s45, 0
global_load_dwordx4 v[48:51], v157, s[44:45] offset:0
global_load_dwordx4 v[52:55], v157, s[44:45] offset:1024
global_load_dwordx4 v[56:59], v157, s[44:45] offset:2048
global_load_dwordx4 v[60:63], v157, s[44:45] offset:3072
s_add_u32 s44, s44, 4096
s_addc_u32 s45, s45, 0
global_load_dwordx4 v[64:67], v157, s[44:45] offset:0
global_load_dwordx4 v[68:71], v157, s[44:45] offset:1024
s_add_u32 s46, 0, 0x6dc000
s_add_u32 s48, s30, s46
s_addc_u32 s49, s31, 0
s_load_dwordx2 s[60:61], s[48:49], 0
v_mov_b32 v159, 1
v_mov_b32 v158, 1
ds_write_b8 v158, v159 offset:528
v_and_b32 v162, 15, v156
v_lshrrev_b32 v163, 4, v156
v_lshrrev_b32 v165, 1, v163
v_lshlrev_b32 v165, 8, v165
v_lshl_add_u32 v165, v162, 4, v165
v_and_b32 v164, 1, v163
v_lshlrev_b32 v164, 10, v164
v_add_u32 v164, v164, v165
v_add_u32 v165, 2048, v165
v_lshrrev_b32 v166, 1, v163
v_lshlrev_b32 v166, 9, v166
v_lshl_add_u32 v166, v162, 4, v166
v_and_b32 v160, 1, v163
v_lshl_add_u32 v166, v160, 3, v166
s_waitcnt vmcnt(18) lgkmcnt(0)
H1_tags:
s_add_u32 s60, s60, s33
s_add_u32 s60, s60, 1
s_and_b32 s62, s60, 0xfff
s_lshr_b32 s63, s60, 12
s_and_b32 s63, s63, 0xfff
s_lshr_b64 s[64:65], s[60:61], 24
s_lshr_b32 s65, s64, 12
s_and_b32 s64, s64, 0xfff
s_and_b32 s65, s65, 0xfff
v_mov_b32 v159, 1
s_mov_b64 exec, 1
ds_add_u32 v167, v159 offset:592
s_mov_b64 exec, -1
s_getreg_b32 s71, hwreg(HW_REG_XCC_ID, 0, 4)
s_and_b32 s61, s61, 0xffff
s_lshl_b32 s61, s61, 8
s_or_b32 s61, s61, s71
s_mov_b32 s52, 0
H1_sp1_re:
ds_read_b32 v159, v167 offset:592
s_waitcnt lgkmcnt(0)
v_cmp_ne_u32 vcc, 4, v159
s_cbranch_vccz H1_sp1_ok
s_add_u32 s52, s52, 1
s_cmp_gt_u32 s52, 200000
s_cbranch_scc1 H1_sp1_ok
s_sleep 0
s_branch H1_sp1_re
H1_sp1_ok:
ds_read_b128 v[72:75], v157 offset:20480
ds_read_b128 v[76:79], v157 offset:21504
ds_read_b128 v[80:83], v157 offset:22528
ds_read_b128 v[84:87], v157 offset:23552
ds_read_b128 v[88:91], v157 offset:24576
ds_read_b128 v[92:95], v157 offset:25600
ds_read_b128 v[96:99], v157 offset:26624
ds_read_b128 v[100:103], v157 offset:27648
ds_read_b128 v[104:107], v157 offset:28672
s_waitcnt lgkmcnt(0)
ds_read_b128 v[108:111], v157 offset:29696
ds_read_b128 v[112:115], v157 offset:30720
ds_read_b128 v[116:119], v157 offset:31744
ds_read_b128 v[120:123], v157 offset:32768
ds_read_b128 v[124:127], v157 offset:33792
ds_read_b128 v[128:131], v157 offset:34816
ds_read_b128 v[132:135], v157 offset:35840
ds_read_b128 v[136:139], v157 offset:36864
ds_read_b128 v[140:143], v157 offset:37888
s_waitcnt lgkmcnt(0)
s_waitcnt vmcnt(17)
v_mfma_f32_16x16x32_bf16 v[144:147], v[0:3], v[72:75], 0
s_waitcnt vmcnt(16)
v_mfma_f32_16x16x32_bf16 v[144:147], v[4:7], v[76:79], v[144:147]
s_waitcnt vmcnt(15)
v_mfma_f32_16x16x32_bf16 v[144:147], v[8:11], v[80:83], v[144:147]
s_waitcnt vmcnt(14)
v_mfma_f32_16x16x32_bf16 v[144:147], v[12:15], v[84:87], v[144:147]
s_waitcnt vmcnt(13)
v_mfma_f32_16x16x32_bf16 v[144:147], v[16:19], v[88:91], v[144:147]
s_waitcnt vmcnt(12)
v_mfma_f32_16x16x32_bf16 v[144:147], v[20:23], v[92:95], v[144:147]
s_waitcnt vmcnt(11)
v_mfma_f32_16x16x32_bf16 v[144:147], v[24:27], v[96:99], v[144:147]
s_waitcnt vmcnt(10)
v_mfma_f32_16x16x32_bf16 v[144:147], v[28:31], v[100:103], v[144:147]
s_waitcnt vmcnt(9)
v_mfma_f32_16x16x32_bf16 v[144:147], v[32:35], v[104:107], v[144:147]
s_waitcnt vmcnt(8)
v_mfma_f32_16x16x32_bf16 v[144:147], v[36:39], v[108:111], v[144:147]
s_waitcnt vmcnt(7)
v_mfma_f32_16x16x32_bf16 v[144:147], v[40:43], v[112:115], v[144:147]
s_waitcnt vmcnt(6)
v_mfma_f32_16x16x32_bf16 v[144:147], v[44:47], v[116:119], v[144:147]
s_waitcnt vmcnt(5)
v_mfma_f32_16x16x32_bf16 v[144:147], v[48:51], v[120:123], v[144:147]
s_waitcnt vmcnt(4)
v_mfma_f32_16x16x32_bf16 v[144:147], v[52:55], v[124:127], v[144:147]
s_waitcnt vmcnt(3)
v_mfma_f32_16x16x32_bf16 v[144:147], v[56:59], v[128:131], v[144:147]
s_waitcnt vmcnt(2)
v_mfma_f32_16x16x32_bf16 v[144:147], v[60:63], v[132:135], v[144:147]
s_waitcnt vmcnt(1)
v_mfma_f32_16x16x32_bf16 v[144:147], v[64:67], v[136:139], v[144:147]
s_waitcnt vmcnt(0)
v_mfma_f32_16x16x32_bf16 v[144:147], v[68:71], v[140:143], v[144:147]
s_nop 7
v_mul_f32 v144, 0x3eae1a93, v144
v_mul_f32 v145, 0x3eae1a93, v145
v_mul_f32 v146, 0x3eae1a93, v146
v_mul_f32 v147, 0x3eae1a93, v147
v_mul_f32 v158, v144, v144
v_fmac_f32 v158, v145, v145
v_fmac_f32 v158, v146, v146
v_fmac_f32 v158, v147, v147
v_cvt_pk_bf16_f32 v144, v144, v145
v_cvt_pk_bf16_f32 v145, v146, v147
ds_write_b64 v166, v[144:145] offset:2304
v_mov_b32 v160, v158
s_nop 1
v_permlane16_swap_b32 v158, v160
v_add_f32 v158, v158, v160
v_mov_b32 v160, v158
s_nop 1
v_permlane32_swap_b32 v158, v160
v_add_f32 v158, v158, v160
v_mov_b32 v160, 1
s_mov_b64 exec, 0xffff
ds_max_u32 v167, v158 offset:132
s_mov_b64 exec, 1
ds_add_rtn_u32 v159, v167, v160 offset:128
s_mov_b64 exec, -1
s_waitcnt lgkmcnt(0)
v_readfirstlane_b32 s50, v159
s_cmp_eq_u32 s50, 1
s_cbranch_scc0 H1_nf2
H1_fz3_re:
ds_read_b128 v[148:151], v167 offset:576
ds_read_b128 v[152:155], v167 offset:128
s_waitcnt lgkmcnt(0)
v_and_b32 v159, v148, v151
v_cmp_ne_u32 vcc, 1, v159
s_cbranch_vccz H1_fz3_ok
s_add_u32 s52, s52, 1
s_cmp_gt_u32 s52, 200000
s_cbranch_scc1 H1_fz3_ok
s_sleep 0
s_branch H1_fz3_re
H1_fz3_ok:
v_add_f32 v153, v153, v154
v_mul_f32 v153, v153, v150
v_cmp_nge_f32 vcc, s70, v153
s_nop 1
v_cndmask_b32 v153, 1, 2, vcc
s_mov_b64 exec, 1
ds_write_b32 v167, v153 offset:0
s_mov_b64 exec, -1
H1_nf2:
H1_sp4_re:
ds_read_b32 v159, v167 offset:8
s_waitcnt lgkmcnt(0)
v_cmp_eq_u32 vcc, 0, v159
s_cbranch_vccz H1_sp4_ok
s_add_u32 s52, s52, 1
s_cmp_gt_u32 s52, 200000
s_cbranch_scc1 H1_sp4_ok
s_sleep 2
s_branch H1_sp4_re
H1_sp4_ok:
s_mul_i32 s46, s40, 294912
s_add_u32 s46, s46, 0x12000
s_add_u32 s44, s30, s46
s_addc_u32 s45, s31, 0
global_load_dwordx4 v[0:3], v157, s[44:45] offset:0
global_load_dwordx4 v[4:7], v157, s[44:45] offset:1024
global_load_dwordx4 v[8:11], v157, s[44:45] offset:2048
global_load_dwordx4 v[12:15], v157, s[44:45] offset:3072
s_add_u32 s44, s44, 4096
s_addc_u32 s45, s45, 0
global_load_dwordx4 v[16:19], v157, s[44:45] offset:0
global_load_dwordx4 v[20:23], v157, s[44:45] offset:1024
global_load_dwordx4 v[24:27], v157, s[44:45] offset:2048
global_load_dwordx4 v[28:31], v157, s[44:45] offset:3072
s_add_u32 s44, s44, 4096
s_addc_u32 s45, s45, 0
global_load_dwordx4 v[32:35], v157, s[44:45] offset:0
global_load_dwordx4 v[36:39], v157, s[44:45] offset:1024
global_load_dwordx4 v[40:43], v157, s[44:45] offset:2048
global_load_dwordx4 v[44:47], v157, s[44:45] offset:3072
s_add_u32 s44, s44, 4096
s_addc_u32 s45, s45, 0
global_load_dwordx4 v[48:51], v157, s[44:45] offset:0
global_load_dwordx4 v[52:55], v157, s[44:45] offset:1024
global_load_dwordx4 v[56:59], v157, s[44:45] offset:2048
global_load_dwordx4 v[60:63], v157, s[44:45] offset:3072
s_add_u32 s44, s44, 4096
s_addc_u32 s45, s45, 0
global_load_dwordx4 v[64:67], v157, s[44:45] offset:0
global_load_dwordx4 v[68:71], v157, s[44:45] offset:1024
s_waitcnt vmcnt(17)
v_mfma_f32_16x16x32_bf16 v[144:147], v[0:3], v[72:75], 0
s_waitcnt vmcnt(16)
v_mfma_f32_16x16x32_bf16 v[144:147], v[4:7], v[76:79], v[144:147]
s_waitcnt vmcnt(15)
v_mfma_f32_16x16x32_bf16 v[144:147], v[8:11], v[80:83], v[144:147]
s_waitcnt vmcnt(14)
v_mfma_f32_16x16x32_bf16 v[144:147], v[12:15], v[84:87], v[144:147]
s_waitcnt vmcnt(13)
v_mfma_f32_16x16x32_bf16 v[144:147], v[16:19], v[88:91], v[144:147]
s_waitcnt vmcnt(12)
v_mfma_f32_16x16x32_bf16 v[144:147], v[20:23], v[92:95], v[144:147]
s_waitcnt vmcnt(11)
v_mfma_f32_16x16x32_bf16 v[144:147], v[24:27], v[96:99], v[144:147]
s_waitcnt vmcnt(10)
v_mfma_f32_16x16x32_bf16 v[144:147], v[28:31], v[100:103], v[144:147]
s_waitcnt vmcnt(9)
v_mfma_f32_16x16x32_bf16 v[144:147], v[32:35], v[104:107], v[144:147]
s_waitcnt vmcnt(8)
v_mfma_f32_16x16x32_bf16 v[144:147], v[36:39], v[108:111], v[144:147]
s_waitcnt vmcnt(7)
v_mfma_f32_16x16x32_bf16 v[144:147], v[40:43], v[112:115], v[144:147]
s_waitcnt vmcnt(6)
v_mfma_f32_16x16x32_bf16 v[144:147], v[44:47], v[116:119], v[144:147]
s_waitcnt vmcnt(5)
v_mfma_f32_16x16x32_bf16 v[144:147], v[48:51], v[120:123], v[144:147]
s_waitcnt vmcnt(4)
v_mfma_f32_16x16x32_bf16 v[144:147], v[52:55], v[124:127], v[144:147]
s_waitcnt vmcnt(3)
v_mfma_f32_16x16x32_bf16 v[144:147], v[56:59], v[128:131], v[144:147]
s_waitcnt vmcnt(2)
v_mfma_f32_16x16x32_bf16 v[144:147], v[60:63], v[132:135], v[144:147]
s_waitcnt vmcnt(1)
v_mfma_f32_16x16x32_bf16 v[144:147], v[64:67], v[136:139], v[144:147]
s_waitcnt vmcnt(0)
v_mfma_f32_16x16x32_bf16 v[144:147], v[68:71], v[140:143], v[144:147]
s_nop 7
v_mul_f32 v144, 0x3eae1a93, v144
v_mul_f32 v145, 0x3eae1a93, v145
v_mul_f32 v146, 0x3eae1a93, v146
v_mul_f32 v147, 0x3eae1a93, v147
v_mul_f32 v158, v144, v144
v_fmac_f32 v158, v145, v145
v_fmac_f32 v158, v146, v146
v_fmac_f32 v158, v147, v147
v_cvt_pk_bf16_f32 v144, v144, v145
v_cvt_pk_bf16_f32 v145, v146, v147
ds_write_b64 v166, v[144:145] offset:4096
v_mov_b32 v160, v158
s_nop 1
v_permlane16_swap_b32 v158, v160
v_add_f32 v158, v158, v160
v_mov_b32 v160, v158
s_nop 1
v_permlane32_swap_b32 v158, v160
v_add_f32 v158, v158, v160
v_mov_b32 v160, 1
s_mov_b64 exec, 0xffff
ds_max_u32 v167, v158 offset:164
s_mov_b64 exec, 1
ds_add_rtn_u32 v159, v167, v160 offset:160
s_mov_b64 exec, -1
s_waitcnt lgkmcnt(0)
v_readfirstlane_b32 s50, v159
s_cmp_eq_u32 s50, 1
s_cbranch_scc0 H1_nf5
H1_sp6_re:
ds_read_b64 v[148:149], v167 offset:520
s_waitcnt lgkmcnt(0)
v_cmp_ne_u64 vcc, s[68:69], v[148:149]
s_cbranch_vccz H1_sp6_ok
s_add_u32 s52, s52, 1
s_cmp_gt_u32 s52, 200000
s_cbranch_scc1 H1_sp6_ok
s_sleep 1
s_branch H1_sp6_re
H1_sp6_ok:
H1_fz7_re:
ds_read_b128 v[148:151], v167 offset:576
ds_read_b128 v[152:155], v167 offset:160
s_waitcnt lgkmcnt(0)
v_and_b32 v159, v148, v151
v_cmp_ne_u32 vcc, 1, v159
s_cbranch_vccz H1_fz7_ok
s_add_u32 s52, s52, 1
s_cmp_gt_u32 s52, 200000
s_cbranch_scc1 H1_fz7_ok
s_sleep 0
s_branch H1_fz7_re
H1_fz7_ok:
v_add_f32 v153, v153, v154
v_mul_f32 v153, v153, v150
v_cmp_nge_f32 vcc, s70, v153
s_nop 1
v_cndmask_b32 v153, 1, 2, vcc
s_mov_b64 exec, 1
ds_write_b32 v167, v153 offset:16
s_mov_b64 exec, -1
H1_nf5:
H1_sp8_re:
ds_read_b64 v[148:149], v167 offset:520
s_waitcnt lgkmcnt(0)
v_cmp_ne_u64 vcc, s[68:69], v[148:149]
s_cbranch_vccz H1_sp8_ok
s_add_u32 s52, s52, 1
s_cmp_gt_u32 s52, 200000
s_cbranch_scc1 H1_sp8_ok
s_sleep 3
s_branch H1_sp8_re
H1_sp8_ok:
s_mul_i32 s46, s40, 294912
s_add_u32 s46, s46, 0x24000
s_add_u32 s44, s30, s46
s_addc_u32 s45, s31, 0
global_load_dwordx4 v[0:3], v157, s[44:45] offset:0
global_load_dwordx4 v[4:7], v157, s[44:45] offset:1024
global_load_dwordx4 v[8:11], v157, s[44:45] offset:2048
global_load_dwordx4 v[12:15], v157, s[44:45] offset:3072
s_add_u32 s44, s44, 4096
s_addc_u32 s45, s45, 0
global_load_dwordx4 v[16:19], v157, s[44:45] offset:0
global_load_dwordx4 v[20:23], v157, s[44:45] offset:1024
global_load_dwordx4 v[24:27], v157, s[44:45] offset:2048
global_load_dwordx4 v[28:31], v157, s[44:45] offset:3072
s_add_u32 s44, s44, 4096
s_addc_u32 s45, s45, 0
global_load_dwordx4 v[32:35], v157, s[44:45] offset:0
global_load_dwordx4 v[36:39], v157, s[44:45] offset:1024
global_load_dwordx4 v[40:43], v157, s[44:45] offset:2048
global_load_dwordx4 v[44:47], v157, s[44:45] offset:3072
s_add_u32 s44, s44, 4096
s_addc_u32 s45, s45, 0
global_load_dwordx4 v[48:51], v157, s[44:45] offset:0
global_load_dwordx4 v[52:55], v157, s[44:45] offset:1024
global_load_dwordx4 v[56:59], v157, s[44:45] offset:2048
global_load_dwordx4 v[60:63], v157, s[44:45] offset:3072
s_add_u32 s44, s44, 4096
s_addc_u32 s45, s45, 0
global_load_dwordx4 v[64:67], v157, s[44:45] offset:0
global_load_dwordx4 v[68:71], v157, s[44:45] offset:1024
s_mul_i32 s46, s40, 294912
s_add_u32 s46, s46, 0x36000
s_add_u32 s44, s30, s46
s_addc_u32 s45, s31, 0
s_waitcnt vmcnt(17)
v_mfma_f32_16x16x32_bf16 v[144:147], v[0:3], v[72:75], 0
global_load_dwordx4 v[0:3], v157, s[44:45] offset:0
s_waitcnt vmcnt(17)
v_mfma_f32_16x16x32_bf16 v[144:147], v[4:7], v[76:79], v[144:147]
global_load_dwordx4 v[4:7], v157, s[44:45] offset:1024
s_waitcnt vmcnt(17)
v_mfma_f32_16x16x32_bf16 v[144:147], v[8:11], v[80:83], v[144:147]
global_load_dwordx4 v[8:11], v157, s[44:45] offset:2048
s_waitcnt vmcnt(17)
v_mfma_f32_16x16x32_bf16 v[144:147], v[12:15], v[84:87], v[144:147]
global_load_dwordx4 v[12:15], v157, s[44:45] offset:3072
s_waitcnt vmcnt(17)
v_mfma_f32_16x16x32_bf16 v[144:147], v[16:19], v[88:91], v[144:147]
s_add_u32 s44, s44, 4096
s_addc_u32 s45, s45, 0
global_load_dwordx4 v[16:19], v157, s[44:45] offset:0
s_waitcnt vmcnt(17)
v_mfma_f32_16x16x32_bf16 v[144:147], v[20:23], v[92:95], v[144:147]
global_load_dwordx4 v[20:23], v157, s[44:45] offset:1024
s_waitcnt vmcnt(17)
v_mfma_f32_16x16x32_bf16 v[144:147], v[24:27], v[96:99], v[144:147]
global_load_dwordx4 v[24:27], v157, s[44:45] offset:2048
s_waitcnt vmcnt(17)
v_mfma_f32_16x16x32_bf16 v[144:147], v[28:31], v[100:103], v[144:147]
global_load_dwordx4 v[28:31], v157, s[44:45] offset:3072
s_waitcnt vmcnt(17)
v_mfma_f32_16x16x32_bf16 v[144:147], v[32:35], v[104:107], v[144:147]
s_add_u32 s44, s44, 4096
s_addc_u32 s45, s45, 0
global_load_dwordx4 v[32:35], v157, s[44:45] offset:0
s_waitcnt vmcnt(17)
v_mfma_f32_16x16x32_bf16 v[144:147], v[36:39], v[108:111], v[144:147]
global_load_dwordx4 v[36:39], v157, s[44:45] offset:1024
s_waitcnt vmcnt(17)
v_mfma_f32_16x16x32_bf16 v[144:147], v[40:43], v[112:115], v[144:147]
global_load_dwordx4 v[40:43], v157, s[44:45] offset:2048
s_waitcnt vmcnt(17)
v_mfma_f32_16x16x32_bf16 v[144:147], v[44:47], v[116:119], v[144:147]
global_load_dwordx4 v[44:47], v157, s[44:45] offset:3072
s_waitcnt vmcnt(17)
v_mfma_f32_16x16x32_bf16 v[144:147], v[48:51], v[120:123], v[144:147]
s_add_u32 s44, s44, 4096
s_addc_u32 s45, s45, 0
global_load_dwordx4 v[48:51], v157, s[44:45] offset:0
s_waitcnt vmcnt(17)
v_mfma_f32_16x16x32_bf16 v[144:147], v[52:55], v[124:127], v[144:147]
global_load_dwordx4 v[52:55], v157, s[44:45] offset:1024
s_waitcnt vmcnt(17)
v_mfma_f32_16x16x32_bf16 v[144:147], v[56:59], v[128:131], v[144:147]
global_load_dwordx4 v[56:59], v157, s[44:45] offset:2048
s_waitcnt vmcnt(17)
v_mfma_f32_16x16x32_bf16 v[144:147], v[60:63], v[132:135], v[144:147]
global_load_dwordx4 v[60:63], v157, s[44:45] offset:3072
s_waitcnt vmcnt(17)
v_mfma_f32_16x16x32_bf16 v[144:147], v[64:67], v[136:139], v[144:147]
s_add_u32 s44, s44, 4096
s_addc_u32 s45, s45, 0
global_load_dwordx4 v[64:67], v157, s[44:45] offset:0
s_waitcnt vmcnt(17)
v_mfma_f32_16x16x32_bf16 v[144:147], v[68:71], v[140:143], v[144:147]
global_load_dwordx4 v[68:71], v157, s[44:45] offset:1024
s_nop 6
v_mul_f32 v144, 0x3eae1a93, v144
v_mul_f32 v145, 0x3eae1a93, v145
v_mul_f32 v146, 0x3eae1a93, v146
v_mul_f32 v147, 0x3eae1a93, v147
v_mul_f32 v158, v144, v144
v_fmac_f32 v158, v145, v145
v_fmac_f32 v158, v146, v146
v_fmac_f32 v158, v147, v147
v_cvt_pk_bf16_f32 v144, v144, v145
v_cvt_pk_bf16_f32 v145, v146, v147
ds_write_b64 v166, v[144:145] offset:6144
v_mov_b32 v160, v158
s_nop 1
v_permlane16_swap_b32 v158, v160
v_add_f32 v158, v158, v160
v_mov_b32 v160, v158
s_nop 1
v_permlane32_swap_b32 v158, v160
v_add_f32 v158, v158, v160
v_mov_b32 v160, 1
s_mov_b64 exec, 0xffff
ds_max_u32 v167, v158 offset:196
s_mov_b64 exec, 1
ds_add_rtn_u32 v159, v167, v160 offset:192
s_mov_b64 exec, -1
s_waitcnt lgkmcnt(0)
v_readfirstlane_b32 s50, v159
s_cmp_eq_u32 s50, 1
s_cbranch_scc0 H1_nf9
H1_fz10_re:
ds_read_b128 v[148:151], v167 offset:576
ds_read_b128 v[152:155], v167 offset:192
s_waitcnt lgkmcnt(0)
v_and_b32 v159, v149, v151
v_cmp_ne_u32 vcc, 1, v159
s_cbranch_vccz H1_fz10_ok
s_add_u32 s52, s52, 1
s_cmp_gt_u32 s52, 200000
s_cbranch_scc1 H1_fz10_ok
s_sleep 0
s_branch H1_fz10_re
H1_fz10_ok:
v_add_f32 v153, v153, v154
v_mul_f32 v153, v153, v150
v_cmp_nge_f32 vcc, s70, v153
s_nop 1
v_cndmask_b32 v153, 1, 2, vcc
s_mov_b64 exec, 1
ds_write_b32 v167, v153 offset:32
s_mov_b64 exec, -1
H1_nf9:
s_waitcnt vmcnt(17)
v_mfma_f32_16x16x32_bf16 v[144:147], v[0:3], v[72:75], 0
s_waitcnt vmcnt(16)
v_mfma_f32_16x16x32_bf16 v[144:147], v[4:7], v[76:79], v[144:147]
s_waitcnt vmcnt(15)
v_mfma_f32_16x16x32_bf16 v[144:147], v[8:11], v[80:83], v[144:147]
s_waitcnt vmcnt(14)
v_mfma_f32_16x16x32_bf16 v[144:147], v[12:15], v[84:87], v[144:147]
s_waitcnt vmcnt(13)
v_mfma_f32_16x16x32_bf16 v[144:147], v[16:19], v[88:91], v[144:147]
s_waitcnt vmcnt(12)
v_mfma_f32_16x16x32_bf16 v[144:147], v[20:23], v[92:95], v[144:147]
s_waitcnt vmcnt(11)
v_mfma_f32_16x16x32_bf16 v[144:147], v[24:27], v[96:99], v[144:147]
s_waitcnt vmcnt(10)
v_mfma_f32_16x16x32_bf16 v[144:147], v[28:31], v[100:103], v[144:147]
s_waitcnt vmcnt(9)
v_mfma_f32_16x16x32_bf16 v[144:147], v[32:35], v[104:107], v[144:147]
s_waitcnt vmcnt(8)
v_mfma_f32_16x16x32_bf16 v[144:147], v[36:39], v[108:111], v[144:147]
s_waitcnt vmcnt(7)
v_mfma_f32_16x16x32_bf16 v[144:147], v[40:43], v[112:115], v[144:147]
s_waitcnt vmcnt(6)
v_mfma_f32_16x16x32_bf16 v[144:147], v[44:47], v[116:119], v[144:147]
s_waitcnt vmcnt(5)
v_mfma_f32_16x16x32_bf16 v[144:147], v[48:51], v[120:123], v[144:147]
s_waitcnt vmcnt(4)
v_mfma_f32_16x16x32_bf16 v[144:147], v[52:55], v[124:127], v[144:147]
s_waitcnt vmcnt(3)
v_mfma_f32_16x16x32_bf16 v[144:147], v[56:59], v[128:131], v[144:147]
s_waitcnt vmcnt(2)
v_mfma_f32_16x16x32_bf16 v[144:147], v[60:63], v[132:135], v[144:147]
s_waitcnt vmcnt(1)
v_mfma_f32_16x16x32_bf16 v[144:147], v[64:67], v[136:139], v[144:147]
s_waitcnt vmcnt(0)
v_mfma_f32_16x16x32_bf16 v[144:147], v[68:71], v[140:143], v[144:147]
s_nop 7
v_mul_f32 v144, 0x3eae1a93, v144
v_mul_f32 v145, 0x3eae1a93, v145
v_mul_f32 v146, 0x3eae1a93, v146
v_mul_f32 v147, 0x3eae1a93, v147
v_mul_f32 v158, v144, v144
v_fmac_f32 v158, v145, v145
v_fmac_f32 v158, v146, v146
v_fmac_f32 v158, v147, v147
v_cvt_pk_bf16_f32 v144, v144, v145
v_cvt_pk_bf16_f32 v145, v146, v147
ds_write_b64 v166, v[144:145] offset:8192
v_mov_b32 v160, v158
s_nop 1
v_permlane16_swap_b32 v158, v160
v_add_f32 v158, v158, v160
v_mov_b32 v160, v158
s_nop 1
v_permlane32_swap_b32 v158, v160
v_add_f32 v158, v158, v160
v_mov_b32 v160, 1
s_mov_b64 exec, 0xffff
ds_max_u32 v167, v158 offset:228
s_mov_b64 exec, 1
ds_add_rtn_u32 v159, v167, v160 offset:224
s_mov_b64 exec, -1
s_waitcnt lgkmcnt(0)
v_readfirstlane_b32 s50, v159
s_cmp_eq_u32 s50, 1
s_cbranch_scc0 H1_nf11
H1_fz12_re:
ds_read_b128 v[148:151], v167 offset:576
ds_read_b128 v[152:155], v167 offset:224
s_waitcnt lgkmcnt(0)
v_and_b32 v159, v149, v151
v_cmp_ne_u32 vcc, 1, v159
s_cbranch_vccz H1_fz12_ok
s_add_u32 s52, s52, 1
s_cmp_gt_u32 s52, 200000
s_cbranch_scc1 H1_fz12_ok
s_sleep 0
s_branch H1_fz12_re
H1_fz12_ok:
v_add_f32 v153, v153, v154
v_mul_f32 v153, v153, v150
v_cmp_nge_f32 vcc, s70, v153
s_nop 1
v_cndmask_b32 v153, 1, 2, vcc
s_mov_b64 exec, 1
ds_write_b32 v167, v153 offset:48
s_mov_b64 exec, -1
H1_nf11:
s_cmp_eq_u32 s33, 1
s_cbranch_scc1 H1_noconv
s_lshl_b32 s50, s2, 1
s_sub_u32 s46, s60, 1
s_add_u32 s46, s46, 80
s_andn2_b32 s47, s61, 0xff
v_add_u32 v158, 0x6db000, v157
s_mov_b32 s53, 0
H1_xrp:
global_load_dwordx4 v[0:3], v158, s[30:31] sc1
global_load_dwordx4 v[4:7], v158, s[30:31] offset:1024 sc1
v_mov_b32 v159, 0
s_waitcnt vmcnt(0)
v_bitop3_b32 v159, v0, s46, v159 bitop3:0xbe
v_bitop3_b32 v159, v1, s47, v159 bitop3:0xbe
v_bitop3_b32 v159, v2, s46, v159 bitop3:0xbe
v_bitop3_b32 v159, v3, s47, v159 bitop3:0xbe
v_bitop3_b32 v159, v4, s46, v159 bitop3:0xbe
v_bitop3_b32 v159, v5, s47, v159 bitop3:0xbe
v_bitop3_b32 v159, v6, s46, v159 bitop3:0xbe
v_bitop3_b32 v159, v7, s47, v159 bitop3:0xbe
v_cmp_ne_u32 vcc, 0, v159
s_cbranch_vccz H1_xrok
s_add_u32 s53, s53, 1
s_cmp_gt_u32 s53, 20000
s_cbranch_scc1 H1_xrok
s_sleep 4
s_branch H1_xrp
H1_xrok:
s_mov_b32 s51, 100352
v_lshrrev_b32 v158, 4, v157
s_setprio 3
s_mov_b32 s44, s22
s_mov_b32 s45, s23
s_mov_b32 s46, 2359296
s_mov_b32 s47, 0x00020000
s_lshl_b32 s48, s50, 12
v_lshl_add_u32 v40, v158, 4, s48
buffer_load_dwordx4 v[56:59], v40, s[44:47], 0 offen offset:0
buffer_load_dword v88, v40, s[44:47], 0 offen offset:16
buffer_load_dwordx4 v[60:63], v40, s[44:47], 0 offen offset:1024
buffer_load_dword v89, v40, s[44:47], 0 offen offset:1040
buffer_load_dwordx4 v[64:67], v40, s[44:47], 0 offen offset:2048
buffer_load_dword v90, v40, s[44:47], 0 offen offset:2064
buffer_load_dwordx4 v[68:71], v40, s[44:47], 0 offen offset:3072
buffer_load_dword v91, v40, s[44:47], 0 offen offset:3088
v_mul_u32_u24 v41, 9216, v158
s_lshl_b32 s48, s50, 4
s_add_u32 s48, s48, 0x700000
v_add_u32 v41, s48, v41
global_load_dwordx4 v[72:75], v41, s[30:31]
v_add_u32 v41, 589824, v41
global_load_dwordx4 v[76:79], v41, s[30:31]
v_add_u32 v41, 589824, v41
global_load_dwordx4 v[80:83], v41, s[30:31]
v_add_u32 v41, 589824, v41
global_load_dwordx4 v[84:87], v41, s[30:31]
s_lshl_b32 s48, s50, 1
v_mov_b32 v42, s48
global_load_ushort v52, v42, s[24:25]
v_mov_b32 v44, 0
v_mov_b32 v45, 0
v_mov_b32 v46, 0
v_mov_b32 v47, 0
v_lshl_add_u32 v42, v158, 4, s51
ds_write_b128 v42, v[44:47] offset:13600
ds_write_b128 v42, v[44:47] offset:14624
s_mov_b64 exec, 0x7ffffff
ds_write_b128 v42, v[44:47] offset:15648
s_mov_b64 exec, -1
v_lshl_add_u32 v43, v158, 2, s51
s_mov_b64 exec, 0xffff
ds_write_b32 v43, v44 offset:0
s_mov_b64 exec, 0x7fff
ds_write_b32 v43, v44 offset:4292
s_mov_b64 exec, -1
v_lshrrev_b32 v40, 2, v158
v_mul_u32_u24 v40, 80, v40
v_and_b32 v41, 3, v158
v_lshl_add_u32 v40, v41, 4, v40
v_add_u32 v40, s51, v40
s_waitcnt vmcnt(5)
ds_write_b128 v42, v[56:59] offset:64
ds_write_b128 v42, v[60:63] offset:1088
ds_write_b128 v42, v[64:67] offset:2112
ds_write_b128 v42, v[68:71] offset:3136
v_alignbit_b32 v48, v57, v56, 16
v_alignbit_b32 v49, v58, v57, 16
v_alignbit_b32 v50, v59, v58, 16
v_alignbit_b32 v51, v88, v59, 16
v_add_u32 v41, 4356, v42
ds_write2_b32 v41, v48, v49 offset0:0 offset1:1
ds_write2_b32 v41, v50, v51 offset0:2 offset1:3
s_waitcnt lgkmcnt(0)
v_alignbit_b32 v48, v61, v60, 16
v_alignbit_b32 v49, v62, v61, 16
v_alignbit_b32 v50, v63, v62, 16
v_alignbit_b32 v51, v89, v63, 16
v_add_u32 v41, 5380, v42
ds_write2_b32 v41, v48, v49 offset0:0 offset1:1
ds_write2_b32 v41, v50, v51 offset0:2 offset1:3
s_waitcnt lgkmcnt(0)
v_alignbit_b32 v48, v65, v64, 16
v_alignbit_b32 v49, v66, v65, 16
v_alignbit_b32 v50, v67, v66, 16
v_alignbit_b32 v51, v90, v67, 16
v_add_u32 v41, 6404, v42
ds_write2_b32 v41, v48, v49 offset0:0 offset1:1
ds_write2_b32 v41, v50, v51 offset0:2 offset1:3
s_waitcnt lgkmcnt(0)
v_alignbit_b32 v48, v69, v68, 16
v_alignbit_b32 v49, v70, v69, 16
v_alignbit_b32 v50, v71, v70, 16
v_alignbit_b32 v51, v91, v71, 16
v_add_u32 v41, 7428, v42
ds_write2_b32 v41, v48, v49 offset0:0 offset1:1
ds_write2_b32 v41, v50, v51 offset0:2 offset1:3
s_waitcnt lgkmcnt(0)
v_lshlrev_b32 v48, 16, v56
s_mov_b64 exec, 1
ds_write_b32 v43, v48 offset:4352
s_mov_b64 exec, -1
s_waitcnt vmcnt(1)
ds_write_b128 v40, v[72:75] offset:8480
ds_write_b128 v40, v[76:79] offset:9760
ds_write_b128 v40, v[80:83] offset:11040
ds_write_b128 v40, v[84:87] offset:12320
v_and_b32 v43, 31, v158
v_lshrrev_b32 v44, 5, v158
v_add_u32 v45, 1, v43
v_and_b32 v45, 1, v45
s_waitcnt lgkmcnt(0)
v_mul_u32_u24 v40, 4290, v45
v_lshl_add_u32 v40, v43, 1, v40
v_lshl_add_u32 v40, v44, 4, v40
v_add3_u32 v40, v40, s51, 2
v_add_u32 v41, 2048, v40
v_sub_u32 v42, 31, v43
v_mul_u32_u24 v42, 80, v42
v_lshl_add_u32 v42, v44, 4, v42
v_add_u32 v42, s51, v42
v_add_u32 v42, 8480, v42
s_waitcnt vmcnt(0)
v_lshlrev_b32 v53, 16, v52
v_lshlrev_b32 v45, 3, v44
v_add_u32 v45, v45, v43
v_sub_u32 v46, 15, v45
v_cmp_eq_u32 vcc, 0, v46
s_nop 1
v_cndmask_b32 v32, 0, v52, vcc
v_cmp_eq_u32 vcc, 1, v46
s_nop 1
v_cndmask_b32 v32, v32, v53, vcc
v_cmp_eq_u32 vcc, 2, v46
s_nop 1
v_cndmask_b32 v33, 0, v52, vcc
v_cmp_eq_u32 vcc, 3, v46
s_nop 1
v_cndmask_b32 v33, v33, v53, vcc
v_cmp_eq_u32 vcc, 4, v46
s_nop 1
v_cndmask_b32 v34, 0, v52, vcc
v_cmp_eq_u32 vcc, 5, v46
s_nop 1
v_cndmask_b32 v34, v34, v53, vcc
v_cmp_eq_u32 vcc, 6, v46
s_nop 1
v_cndmask_b32 v35, 0, v52, vcc
v_cmp_eq_u32 vcc, 7, v46
s_nop 1
v_cndmask_b32 v35, v35, v53, vcc
v_sub_u32 v46, 31, v45
v_cmp_eq_u32 vcc, 0, v46
s_nop 1
v_cndmask_b32 v36, 0, v52, vcc
v_cmp_eq_u32 vcc, 1, v46
s_nop 1
v_cndmask_b32 v36, v36, v53, vcc
v_cmp_eq_u32 vcc, 2, v46
s_nop 1
v_cndmask_b32 v37, 0, v52, vcc
v_cmp_eq_u32 vcc, 3, v46
s_nop 1
v_cndmask_b32 v37, v37, v53, vcc
v_cmp_eq_u32 vcc, 4, v46
s_nop 1
v_cndmask_b32 v38, 0, v52, vcc
v_cmp_eq_u32 vcc, 5, v46
s_nop 1
v_cndmask_b32 v38, v38, v53, vcc
v_cmp_eq_u32 vcc, 6, v46
s_nop 1
v_cndmask_b32 v39, 0, v52, vcc
v_cmp_eq_u32 vcc, 7, v46
s_nop 1
v_cndmask_b32 v39, v39, v53, vcc
ds_read2_b32 v[56:57], v40 offset0:8 offset1:9
ds_read2_b32 v[58:59], v40 offset0:10 offset1:11
ds_read_b128 v[64:67], v42 offset:32
ds_read_b128 v[68:71], v42 offset:2592
ds_read2_b32 v[60:61], v41 offset0:8 offset1:9
ds_read2_b32 v[62:63], v41 offset0:10 offset1:11
ds_read2_b32 v[72:73], v40 offset0:0 offset1:1
ds_read2_b32 v[74:75], v40 offset0:2 offset1:3
ds_read_b128 v[80:83], v42 offset:0
ds_read_b128 v[84:87], v42 offset:2560
ds_read2_b32 v[76:77], v41 offset0:0 offset1:1
ds_read2_b32 v[78:79], v41 offset0:2 offset1:3
ds_read2_b32 v[88:89], v40 offset0:24 offset1:25
ds_read2_b32 v[90:91], v40 offset0:26 offset1:27
ds_read_b128 v[96:99], v42 offset:112
ds_read_b128 v[100:103], v42 offset:2672
ds_read2_b32 v[92:93], v41 offset0:24 offset1:25
ds_read2_b32 v[94:95], v41 offset0:26 offset1:27
s_waitcnt lgkmcnt(12)
v_mfma_f32_32x32x16_bf16 v[16:31], v[56:59], v[64:67], 0
v_mfma_f32_32x32x16_bf16 v[0:15], v[56:59], v[68:71], 0
v_mfma_f32_32x32x16_bf16 v[16:31], v[60:63], v[68:71], v[16:31]
v_mfma_f32_32x32x16_bf16 v[0:15], v[32:35], v[68:71], v[0:15]
v_mfma_f32_32x32x16_bf16 v[16:31], v[32:35], v[64:67], v[16:31]
ds_read2_b32 v[56:57], v40 offset0:16 offset1:17
ds_read2_b32 v[58:59], v40 offset0:18 offset1:19
ds_read_b128 v[64:67], v42 offset:80
ds_read_b128 v[68:71], v42 offset:2640
ds_read2_b32 v[60:61], v41 offset0:16 offset1:17
ds_read2_b32 v[62:63], v41 offset0:18 offset1:19
s_waitcnt lgkmcnt(12)
v_mfma_f32_32x32x16_bf16 v[16:31], v[72:75], v[80:83], v[16:31]
v_mfma_f32_32x32x16_bf16 v[0:15], v[72:75], v[84:87], v[0:15]
v_mfma_f32_32x32x16_bf16 v[16:31], v[76:79], v[84:87], v[16:31]
v_mfma_f32_32x32x16_bf16 v[0:15], v[36:39], v[84:87], v[0:15]
v_mfma_f32_32x32x16_bf16 v[16:31], v[36:39], v[80:83], v[16:31]
ds_read2_b32 v[72:73], v40 offset0:40 offset1:41
ds_read2_b32 v[74:75], v40 offset0:42 offset1:43
ds_read_b128 v[80:83], v42 offset:192
ds_read_b128 v[84:87], v42 offset:2752
ds_read2_b32 v[76:77], v41 offset0:40 offset1:41
ds_read2_b32 v[78:79], v41 offset0:42 offset1:43
s_waitcnt lgkmcnt(12)
v_mfma_f32_32x32x16_bf16 v[16:31], v[88:91], v[96:99], v[16:31]
v_mfma_f32_32x32x16_bf16 v[0:15], v[88:91], v[100:103], v[0:15]
v_mfma_f32_32x32x16_bf16 v[16:31], v[92:95], v[100:103], v[16:31]
ds_read2_b32 v[88:89], v40 offset0:32 offset1:33
ds_read2_b32 v[90:91], v40 offset0:34 offset1:35
ds_read_b128 v[96:99], v42 offset:160
ds_read_b128 v[100:103], v42 offset:2720
ds_read2_b32 v[92:93], v41 offset0:32 offset1:33
ds_read2_b32 v[94:95], v41 offset0:34 offset1:35
s_waitcnt lgkmcnt(12)
v_mfma_f32_32x32x16_bf16 v[16:31], v[56:59], v[64:67], v[16:31]
v_mfma_f32_32x32x16_bf16 v[0:15], v[56:59], v[68:71], v[0:15]
v_mfma_f32_32x32x16_bf16 v[16:31], v[60:63], v[68:71], v[16:31]
ds_read2_b32 v[56:57], v40 offset0:56 offset1:57
ds_read2_b32 v[58:59], v40 offset0:58 offset1:59
ds_read_b128 v[64:67], v42 offset:272
ds_read_b128 v[68:71], v42 offset:2832
ds_read2_b32 v[60:61], v41 offset0:56 offset1:57
ds_read2_b32 v[62:63], v41 offset0:58 offset1:59
s_waitcnt lgkmcnt(12)
v_mfma_f32_32x32x16_bf16 v[16:31], v[72:75], v[80:83], v[16:31]
v_mfma_f32_32x32x16_bf16 v[0:15], v[72:75], v[84:87], v[0:15]
v_mfma_f32_32x32x16_bf16 v[16:31], v[76:79], v[84:87], v[16:31]
ds_read2_b32 v[72:73], v40 offset0:48 offset1:49
ds_read2_b32 v[74:75], v40 offset0:50 offset1:51
ds_read_b128 v[80:83], v42 offset:240
ds_read_b128 v[84:87], v42 offset:2800
ds_read2_b32 v[76:77], v41 offset0:48 offset1:49
ds_read2_b32 v[78:79], v41 offset0:50 offset1:51
s_waitcnt lgkmcnt(12)
v_mfma_f32_32x32x16_bf16 v[16:31], v[88:91], v[96:99], v[16:31]
v_mfma_f32_32x32x16_bf16 v[0:15], v[88:91], v[100:103], v[0:15]
v_mfma_f32_32x32x16_bf16 v[16:31], v[92:95], v[100:103], v[16:31]
ds_read2_b32 v[88:89], v40 offset0:72 offset1:73
ds_read2_b32 v[90:91], v40 offset0:74 offset1:75
ds_read_b128 v[96:99], v42 offset:352
ds_read_b128 v[100:103], v42 offset:2912
ds_read2_b32 v[92:93], v41 offset0:72 offset1:73
ds_read2_b32 v[94:95], v41 offset0:74 offset1:75
s_waitcnt lgkmcnt(12)
v_mfma_f32_32x32x16_bf16 v[16:31], v[56:59], v[64:67], v[16:31]
v_mfma_f32_32x32x16_bf16 v[0:15], v[56:59], v[68:71], v[0:15]
v_mfma_f32_32x32x16_bf16 v[16:31], v[60:63], v[68:71], v[16:31]
ds_read2_b32 v[56:57], v40 offset0:64 offset1:65
ds_read2_b32 v[58:59], v40 offset0:66 offset1:67
ds_read_b128 v[64:67], v42 offset:320
ds_read_b128 v[68:71], v42 offset:2880
ds_read2_b32 v[60:61], v41 offset0:64 offset1:65
ds_read2_b32 v[62:63], v41 offset0:66 offset1:67
s_waitcnt lgkmcnt(12)
v_mfma_f32_32x32x16_bf16 v[16:31], v[72:75], v[80:83], v[16:31]
v_mfma_f32_32x32x16_bf16 v[0:15], v[72:75], v[84:87], v[0:15]
v_mfma_f32_32x32x16_bf16 v[16:31], v[76:79], v[84:87], v[16:31]
ds_read2_b32 v[72:73], v40 offset0:88 offset1:89
ds_read2_b32 v[74:75], v40 offset0:90 offset1:91
ds_read_b128 v[80:83], v42 offset:432
ds_read_b128 v[84:87], v42 offset:2992
ds_read2_b32 v[76:77], v41 offset0:88 offset1:89
ds_read2_b32 v[78:79], v41 offset0:90 offset1:91
s_waitcnt lgkmcnt(12)
v_mfma_f32_32x32x16_bf16 v[16:31], v[88:91], v[96:99], v[16:31]
v_mfma_f32_32x32x16_bf16 v[0:15], v[88:91], v[100:103], v[0:15]
v_mfma_f32_32x32x16_bf16 v[16:31], v[92:95], v[100:103], v[16:31]
ds_read2_b32 v[88:89], v40 offset0:80 offset1:81
ds_read2_b32 v[90:91], v40 offset0:82 offset1:83
ds_read_b128 v[96:99], v42 offset:400
ds_read_b128 v[100:103], v42 offset:2960
ds_read2_b32 v[92:93], v41 offset0:80 offset1:81
ds_read2_b32 v[94:95], v41 offset0:82 offset1:83
s_waitcnt lgkmcnt(12)
v_mfma_f32_32x32x16_bf16 v[16:31], v[56:59], v[64:67], v[16:31]
v_mfma_f32_32x32x16_bf16 v[0:15], v[56:59], v[68:71], v[0:15]
v_mfma_f32_32x32x16_bf16 v[16:31], v[60:63], v[68:71], v[16:31]
ds_read2_b32 v[56:57], v40 offset0:104 offset1:105
ds_read2_b32 v[58:59], v40 offset0:106 offset1:107
ds_read_b128 v[64:67], v42 offset:512
ds_read_b128 v[68:71], v42 offset:3072
ds_read2_b32 v[60:61], v41 offset0:104 offset1:105
ds_read2_b32 v[62:63], v41 offset0:106 offset1:107
s_waitcnt lgkmcnt(12)
v_mfma_f32_32x32x16_bf16 v[16:31], v[72:75], v[80:83], v[16:31]
v_mfma_f32_32x32x16_bf16 v[0:15], v[72:75], v[84:87], v[0:15]
v_mfma_f32_32x32x16_bf16 v[16:31], v[76:79], v[84:87], v[16:31]
ds_read2_b32 v[72:73], v40 offset0:96 offset1:97
ds_read2_b32 v[74:75], v40 offset0:98 offset1:99
ds_read_b128 v[80:83], v42 offset:480
ds_read_b128 v[84:87], v42 offset:3040
ds_read2_b32 v[76:77], v41 offset0:96 offset1:97
ds_read2_b32 v[78:79], v41 offset0:98 offset1:99
s_waitcnt lgkmcnt(12)
v_mfma_f32_32x32x16_bf16 v[16:31], v[88:91], v[96:99], v[16:31]
v_mfma_f32_32x32x16_bf16 v[0:15], v[88:91], v[100:103], v[0:15]
v_mfma_f32_32x32x16_bf16 v[16:31], v[92:95], v[100:103], v[16:31]
ds_read2_b32 v[88:89], v40 offset0:120 offset1:121
ds_read2_b32 v[90:91], v40 offset0:122 offset1:123
ds_read_b128 v[96:99], v42 offset:592
ds_read_b128 v[100:103], v42 offset:3152
ds_read2_b32 v[92:93], v41 offset0:120 offset1:121
ds_read2_b32 v[94:95], v41 offset0:122 offset1:123
s_waitcnt lgkmcnt(12)
v_mfma_f32_32x32x16_bf16 v[16:31], v[56:59], v[64:67], v[16:31]
v_mfma_f32_32x32x16_bf16 v[0:15], v[56:59], v[68:71], v[0:15]
v_mfma_f32_32x32x16_bf16 v[16:31], v[60:63], v[68:71], v[16:31]
ds_read2_b32 v[56:57], v40 offset0:112 offset1:113
ds_read2_b32 v[58:59], v40 offset0:114 offset1:115
ds_read_b128 v[64:67], v42 offset:560
ds_read_b128 v[68:71], v42 offset:3120
ds_read2_b32 v[60:61], v41 offset0:112 offset1:113
ds_read2_b32 v[62:63], v41 offset0:114 offset1:115
s_waitcnt lgkmcnt(12)
v_mfma_f32_32x32x16_bf16 v[16:31], v[72:75], v[80:83], v[16:31]
v_mfma_f32_32x32x16_bf16 v[0:15], v[72:75], v[84:87], v[0:15]
v_mfma_f32_32x32x16_bf16 v[16:31], v[76:79], v[84:87], v[16:31]
ds_read2_b32 v[72:73], v40 offset0:136 offset1:137
ds_read2_b32 v[74:75], v40 offset0:138 offset1:139
ds_read_b128 v[80:83], v42 offset:672
ds_read_b128 v[84:87], v42 offset:3232
ds_read2_b32 v[76:77], v41 offset0:136 offset1:137
ds_read2_b32 v[78:79], v41 offset0:138 offset1:139
s_waitcnt lgkmcnt(12)
v_mfma_f32_32x32x16_bf16 v[16:31], v[88:91], v[96:99], v[16:31]
v_mfma_f32_32x32x16_bf16 v[0:15], v[88:91], v[100:103], v[0:15]
v_mfma_f32_32x32x16_bf16 v[16:31], v[92:95], v[100:103], v[16:31]
ds_read2_b32 v[88:89], v40 offset0:128 offset1:129
ds_read2_b32 v[90:91], v40 offset0:130 offset1:131
ds_read_b128 v[96:99], v42 offset:640
ds_read_b128 v[100:103], v42 offset:3200
ds_read2_b32 v[92:93], v41 offset0:128 offset1:129
ds_read2_b32 v[94:95], v41 offset0:130 offset1:131
s_waitcnt lgkmcnt(12)
v_mfma_f32_32x32x16_bf16 v[16:31], v[56:59], v[64:67], v[16:31]
v_mfma_f32_32x32x16_bf16 v[0:15], v[56:59], v[68:71], v[0:15]
v_mfma_f32_32x32x16_bf16 v[16:31], v[60:63], v[68:71], v[16:31]
ds_read2_b32 v[56:57], v40 offset0:152 offset1:153
ds_read2_b32 v[58:59], v40 offset0:154 offset1:155
ds_read_b128 v[64:67], v42 offset:752
ds_read_b128 v[68:71], v42 offset:3312
ds_read2_b32 v[60:61], v41 offset0:152 offset1:153
ds_read2_b32 v[62:63], v41 offset0:154 offset1:155
s_waitcnt lgkmcnt(12)
v_mfma_f32_32x32x16_bf16 v[16:31], v[72:75], v[80:83], v[16:31]
v_mfma_f32_32x32x16_bf16 v[0:15], v[72:75], v[84:87], v[0:15]
v_mfma_f32_32x32x16_bf16 v[16:31], v[76:79], v[84:87], v[16:31]
ds_read2_b32 v[72:73], v40 offset0:144 offset1:145
ds_read2_b32 v[74:75], v40 offset0:146 offset1:147
ds_read_b128 v[80:83], v42 offset:720
ds_read_b128 v[84:87], v42 offset:3280
ds_read2_b32 v[76:77], v41 offset0:144 offset1:145
ds_read2_b32 v[78:79], v41 offset0:146 offset1:147
s_waitcnt lgkmcnt(12)
v_mfma_f32_32x32x16_bf16 v[16:31], v[88:91], v[96:99], v[16:31]
v_mfma_f32_32x32x16_bf16 v[0:15], v[88:91], v[100:103], v[0:15]
v_mfma_f32_32x32x16_bf16 v[16:31], v[92:95], v[100:103], v[16:31]
ds_read2_b32 v[88:89], v40 offset0:168 offset1:169
ds_read2_b32 v[90:91], v40 offset0:170 offset1:171
ds_read_b128 v[96:99], v42 offset:832
ds_read_b128 v[100:103], v42 offset:3392
ds_read2_b32 v[92:93], v41 offset0:168 offset1:169
ds_read2_b32 v[94:95], v41 offset0:170 offset1:171
s_waitcnt lgkmcnt(12)
v_mfma_f32_32x32x16_bf16 v[16:31], v[56:59], v[64:67], v[16:31]
v_mfma_f32_32x32x16_bf16 v[0:15], v[56:59], v[68:71], v[0:15]
v_mfma_f32_32x32x16_bf16 v[16:31], v[60:63], v[68:71], v[16:31]
ds_read2_b32 v[56:57], v40 offset0:160 offset1:161
ds_read2_b32 v[58:59], v40 offset0:162 offset1:163
ds_read_b128 v[64:67], v42 offset:800
ds_read_b128 v[68:71], v42 offset:3360
ds_read2_b32 v[60:61], v41 offset0:160 offset1:161
ds_read2_b32 v[62:63], v41 offset0:162 offset1:163
s_waitcnt lgkmcnt(12)
v_mfma_f32_32x32x16_bf16 v[16:31], v[72:75], v[80:83], v[16:31]
v_mfma_f32_32x32x16_bf16 v[0:15], v[72:75], v[84:87], v[0:15]
v_mfma_f32_32x32x16_bf16 v[16:31], v[76:79], v[84:87], v[16:31]
ds_read2_b32 v[72:73], v40 offset0:184 offset1:185
ds_read2_b32 v[74:75], v40 offset0:186 offset1:187
ds_read_b128 v[80:83], v42 offset:912
ds_read_b128 v[84:87], v42 offset:3472
ds_read2_b32 v[76:77], v41 offset0:184 offset1:185
ds_read2_b32 v[78:79], v41 offset0:186 offset1:187
s_waitcnt lgkmcnt(12)
v_mfma_f32_32x32x16_bf16 v[16:31], v[88:91], v[96:99], v[16:31]
v_mfma_f32_32x32x16_bf16 v[0:15], v[88:91], v[100:103], v[0:15]
v_mfma_f32_32x32x16_bf16 v[16:31], v[92:95], v[100:103], v[16:31]
ds_read2_b32 v[88:89], v40 offset0:176 offset1:177
ds_read2_b32 v[90:91], v40 offset0:178 offset1:179
ds_read_b128 v[96:99], v42 offset:880
ds_read_b128 v[100:103], v42 offset:3440
ds_read2_b32 v[92:93], v41 offset0:176 offset1:177
ds_read2_b32 v[94:95], v41 offset0:178 offset1:179
s_waitcnt lgkmcnt(12)
v_mfma_f32_32x32x16_bf16 v[16:31], v[56:59], v[64:67], v[16:31]
v_mfma_f32_32x32x16_bf16 v[0:15], v[56:59], v[68:71], v[0:15]
v_mfma_f32_32x32x16_bf16 v[16:31], v[60:63], v[68:71], v[16:31]
ds_read2_b32 v[56:57], v40 offset0:200 offset1:201
ds_read2_b32 v[58:59], v40 offset0:202 offset1:203
ds_read_b128 v[64:67], v42 offset:992
ds_read_b128 v[68:71], v42 offset:3552
ds_read2_b32 v[60:61], v41 offset0:200 offset1:201
ds_read2_b32 v[62:63], v41 offset0:202 offset1:203
s_waitcnt lgkmcnt(12)
v_mfma_f32_32x32x16_bf16 v[16:31], v[72:75], v[80:83], v[16:31]
v_mfma_f32_32x32x16_bf16 v[0:15], v[72:75], v[84:87], v[0:15]
v_mfma_f32_32x32x16_bf16 v[16:31], v[76:79], v[84:87], v[16:31]
ds_read2_b32 v[72:73], v40 offset0:192 offset1:193
ds_read2_b32 v[74:75], v40 offset0:194 offset1:195
ds_read_b128 v[80:83], v42 offset:960
ds_read_b128 v[84:87], v42 offset:3520
ds_read2_b32 v[76:77], v41 offset0:192 offset1:193
ds_read2_b32 v[78:79], v41 offset0:194 offset1:195
s_waitcnt lgkmcnt(12)
v_mfma_f32_32x32x16_bf16 v[16:31], v[88:91], v[96:99], v[16:31]
v_mfma_f32_32x32x16_bf16 v[0:15], v[88:91], v[100:103], v[0:15]
v_mfma_f32_32x32x16_bf16 v[16:31], v[92:95], v[100:103], v[16:31]
ds_read2_b32 v[88:89], v40 offset0:216 offset1:217
ds_read2_b32 v[90:91], v40 offset0:218 offset1:219
ds_read_b128 v[96:99], v42 offset:1072
ds_read_b128 v[100:103], v42 offset:3632
ds_read2_b32 v[92:93], v41 offset0:216 offset1:217
ds_read2_b32 v[94:95], v41 offset0:218 offset1:219
s_waitcnt lgkmcnt(12)
v_mfma_f32_32x32x16_bf16 v[16:31], v[56:59], v[64:67], v[16:31]
v_mfma_f32_32x32x16_bf16 v[0:15], v[56:59], v[68:71], v[0:15]
v_mfma_f32_32x32x16_bf16 v[16:31], v[60:63], v[68:71], v[16:31]
ds_read2_b32 v[56:57], v40 offset0:208 offset1:209
ds_read2_b32 v[58:59], v40 offset0:210 offset1:211
ds_read_b128 v[64:67], v42 offset:1040
ds_read_b128 v[68:71], v42 offset:3600
ds_read2_b32 v[60:61], v41 offset0:208 offset1:209
ds_read2_b32 v[62:63], v41 offset0:210 offset1:211
s_waitcnt lgkmcnt(12)
v_mfma_f32_32x32x16_bf16 v[16:31], v[72:75], v[80:83], v[16:31]
v_mfma_f32_32x32x16_bf16 v[0:15], v[72:75], v[84:87], v[0:15]
v_mfma_f32_32x32x16_bf16 v[16:31], v[76:79], v[84:87], v[16:31]
ds_read2_b32 v[72:73], v40 offset0:232 offset1:233
ds_read2_b32 v[74:75], v40 offset0:234 offset1:235
ds_read_b128 v[80:83], v42 offset:1152
ds_read_b128 v[84:87], v42 offset:3712
ds_read2_b32 v[76:77], v41 offset0:232 offset1:233
ds_read2_b32 v[78:79], v41 offset0:234 offset1:235
s_waitcnt lgkmcnt(12)
v_mfma_f32_32x32x16_bf16 v[16:31], v[88:91], v[96:99], v[16:31]
v_mfma_f32_32x32x16_bf16 v[0:15], v[88:91], v[100:103], v[0:15]
v_mfma_f32_32x32x16_bf16 v[16:31], v[92:95], v[100:103], v[16:31]
ds_read2_b32 v[88:89], v40 offset0:224 offset1:225
ds_read2_b32 v[90:91], v40 offset0:226 offset1:227
ds_read_b128 v[96:99], v42 offset:1120
ds_read_b128 v[100:103], v42 offset:3680
ds_read2_b32 v[92:93], v41 offset0:224 offset1:225
ds_read2_b32 v[94:95], v41 offset0:226 offset1:227
s_waitcnt lgkmcnt(12)
v_mfma_f32_32x32x16_bf16 v[16:31], v[56:59], v[64:67], v[16:31]
v_mfma_f32_32x32x16_bf16 v[0:15], v[56:59], v[68:71], v[0:15]
v_mfma_f32_32x32x16_bf16 v[16:31], v[60:63], v[68:71], v[16:31]
ds_read2_b32 v[56:57], v40 offset0:248 offset1:249
ds_read2_b32 v[58:59], v40 offset0:250 offset1:251
ds_read_b128 v[64:67], v42 offset:1232
ds_read_b128 v[68:71], v42 offset:3792
ds_read2_b32 v[60:61], v41 offset0:248 offset1:249
ds_read2_b32 v[62:63], v41 offset0:250 offset1:251
s_waitcnt lgkmcnt(12)
v_mfma_f32_32x32x16_bf16 v[16:31], v[72:75], v[80:83], v[16:31]
v_mfma_f32_32x32x16_bf16 v[0:15], v[72:75], v[84:87], v[0:15]
v_mfma_f32_32x32x16_bf16 v[16:31], v[76:79], v[84:87], v[16:31]
ds_read2_b32 v[72:73], v40 offset0:240 offset1:241
ds_read2_b32 v[74:75], v40 offset0:242 offset1:243
ds_read_b128 v[80:83], v42 offset:1200
ds_read_b128 v[84:87], v42 offset:3760
ds_read2_b32 v[76:77], v41 offset0:240 offset1:241
ds_read2_b32 v[78:79], v41 offset0:242 offset1:243
s_waitcnt lgkmcnt(12)
v_mfma_f32_32x32x16_bf16 v[16:31], v[88:91], v[96:99], v[16:31]
v_mfma_f32_32x32x16_bf16 v[0:15], v[88:91], v[100:103], v[0:15]
v_mfma_f32_32x32x16_bf16 v[16:31], v[92:95], v[100:103], v[16:31]
v_add_u32 v40, 1024, v40
v_add_u32 v41, 1024, v41
ds_read2_b32 v[88:89], v40 offset0:8 offset1:9
ds_read2_b32 v[90:91], v40 offset0:10 offset1:11
ds_read_b128 v[96:99], v42 offset:1312
ds_read_b128 v[100:103], v42 offset:3872
ds_read2_b32 v[92:93], v41 offset0:8 offset1:9
ds_read2_b32 v[94:95], v41 offset0:10 offset1:11
s_waitcnt lgkmcnt(12)
v_mfma_f32_32x32x16_bf16 v[16:31], v[56:59], v[64:67], v[16:31]
v_mfma_f32_32x32x16_bf16 v[0:15], v[56:59], v[68:71], v[0:15]
v_mfma_f32_32x32x16_bf16 v[16:31], v[60:63], v[68:71], v[16:31]
ds_read2_b32 v[56:57], v40 offset0:0 offset1:1
ds_read2_b32 v[58:59], v40 offset0:2 offset1:3
ds_read_b128 v[64:67], v42 offset:1280
ds_read_b128 v[68:71], v42 offset:3840
ds_read2_b32 v[60:61], v41 offset0:0 offset1:1
ds_read2_b32 v[62:63], v41 offset0:2 offset1:3
s_waitcnt lgkmcnt(12)
v_mfma_f32_32x32x16_bf16 v[16:31], v[72:75], v[80:83], v[16:31]
v_mfma_f32_32x32x16_bf16 v[0:15], v[72:75], v[84:87], v[0:15]
v_mfma_f32_32x32x16_bf16 v[16:31], v[76:79], v[84:87], v[16:31]
s_setprio 3
ds_read2_b32 v[72:73], v40 offset0:24 offset1:25
ds_read2_b32 v[74:75], v40 offset0:26 offset1:27
ds_read_b128 v[80:83], v42 offset:1392
ds_read_b128 v[84:87], v42 offset:3952
ds_read2_b32 v[76:77], v41 offset0:24 offset1:25
ds_read2_b32 v[78:79], v41 offset0:26 offset1:27
s_waitcnt lgkmcnt(12)
v_mfma_f32_32x32x16_bf16 v[16:31], v[88:91], v[96:99], v[16:31]
v_mfma_f32_32x32x16_bf16 v[0:15], v[88:91], v[100:103], v[0:15]
v_mfma_f32_32x32x16_bf16 v[16:31], v[92:95], v[100:103], v[16:31]
ds_read2_b32 v[88:89], v40 offset0:16 offset1:17
ds_read2_b32 v[90:91], v40 offset0:18 offset1:19
ds_read_b128 v[96:99], v42 offset:1360
ds_read_b128 v[100:103], v42 offset:3920
ds_read2_b32 v[92:93], v41 offset0:16 offset1:17
ds_read2_b32 v[94:95], v41 offset0:18 offset1:19
s_waitcnt lgkmcnt(12)
v_mfma_f32_32x32x16_bf16 v[16:31], v[56:59], v[64:67], v[16:31]
v_mfma_f32_32x32x16_bf16 v[0:15], v[56:59], v[68:71], v[0:15]
v_mfma_f32_32x32x16_bf16 v[16:31], v[60:63], v[68:71], v[16:31]
ds_read2_b32 v[56:57], v40 offset0:40 offset1:41
ds_read2_b32 v[58:59], v40 offset0:42 offset1:43
ds_read_b128 v[64:67], v42 offset:1472
ds_read_b128 v[68:71], v42 offset:4032
ds_read2_b32 v[60:61], v41 offset0:40 offset1:41
ds_read2_b32 v[62:63], v41 offset0:42 offset1:43
s_waitcnt lgkmcnt(12)
v_mfma_f32_32x32x16_bf16 v[16:31], v[72:75], v[80:83], v[16:31]
v_mfma_f32_32x32x16_bf16 v[0:15], v[72:75], v[84:87], v[0:15]
v_mfma_f32_32x32x16_bf16 v[16:31], v[76:79], v[84:87], v[16:31]
ds_read2_b32 v[72:73], v40 offset0:32 offset1:33
ds_read2_b32 v[74:75], v40 offset0:34 offset1:35
ds_read_b128 v[80:83], v42 offset:1440
ds_read_b128 v[84:87], v42 offset:4000
ds_read2_b32 v[76:77], v41 offset0:32 offset1:33
ds_read2_b32 v[78:79], v41 offset0:34 offset1:35
s_waitcnt lgkmcnt(12)
v_mfma_f32_32x32x16_bf16 v[16:31], v[88:91], v[96:99], v[16:31]
v_mfma_f32_32x32x16_bf16 v[0:15], v[88:91], v[100:103], v[0:15]
v_mfma_f32_32x32x16_bf16 v[16:31], v[92:95], v[100:103], v[16:31]
ds_read2_b32 v[88:89], v40 offset0:56 offset1:57
ds_read2_b32 v[90:91], v40 offset0:58 offset1:59
ds_read_b128 v[96:99], v42 offset:1552
ds_read_b128 v[100:103], v42 offset:4112
ds_read2_b32 v[92:93], v41 offset0:56 offset1:57
ds_read2_b32 v[94:95], v41 offset0:58 offset1:59
s_waitcnt lgkmcnt(12)
v_mfma_f32_32x32x16_bf16 v[16:31], v[56:59], v[64:67], v[16:31]
v_mfma_f32_32x32x16_bf16 v[0:15], v[56:59], v[68:71], v[0:15]
v_mfma_f32_32x32x16_bf16 v[16:31], v[60:63], v[68:71], v[16:31]
ds_read2_b32 v[56:57], v40 offset0:48 offset1:49
ds_read2_b32 v[58:59], v40 offset0:50 offset1:51
ds_read_b128 v[64:67], v42 offset:1520
ds_read_b128 v[68:71], v42 offset:4080
ds_read2_b32 v[60:61], v41 offset0:48 offset1:49
ds_read2_b32 v[62:63], v41 offset0:50 offset1:51
s_waitcnt lgkmcnt(12)
v_mfma_f32_32x32x16_bf16 v[16:31], v[72:75], v[80:83], v[16:31]
v_mfma_f32_32x32x16_bf16 v[0:15], v[72:75], v[84:87], v[0:15]
v_mfma_f32_32x32x16_bf16 v[16:31], v[76:79], v[84:87], v[16:31]
ds_read2_b32 v[72:73], v40 offset0:72 offset1:73
ds_read2_b32 v[74:75], v40 offset0:74 offset1:75
ds_read_b128 v[80:83], v42 offset:1632
ds_read_b128 v[84:87], v42 offset:4192
ds_read2_b32 v[76:77], v41 offset0:72 offset1:73
ds_read2_b32 v[78:79], v41 offset0:74 offset1:75
s_waitcnt lgkmcnt(12)
v_mfma_f32_32x32x16_bf16 v[16:31], v[88:91], v[96:99], v[16:31]
v_mfma_f32_32x32x16_bf16 v[0:15], v[88:91], v[100:103], v[0:15]
v_mfma_f32_32x32x16_bf16 v[16:31], v[92:95], v[100:103], v[16:31]
ds_read2_b32 v[88:89], v40 offset0:64 offset1:65
ds_read2_b32 v[90:91], v40 offset0:66 offset1:67
ds_read_b128 v[96:99], v42 offset:1600
ds_read_b128 v[100:103], v42 offset:4160
ds_read2_b32 v[92:93], v41 offset0:64 offset1:65
ds_read2_b32 v[94:95], v41 offset0:66 offset1:67
s_waitcnt lgkmcnt(12)
v_mfma_f32_32x32x16_bf16 v[16:31], v[56:59], v[64:67], v[16:31]
v_mfma_f32_32x32x16_bf16 v[0:15], v[56:59], v[68:71], v[0:15]
v_mfma_f32_32x32x16_bf16 v[16:31], v[60:63], v[68:71], v[16:31]
ds_read2_b32 v[56:57], v40 offset0:88 offset1:89
ds_read2_b32 v[58:59], v40 offset0:90 offset1:91
ds_read_b128 v[64:67], v42 offset:1712
ds_read_b128 v[68:71], v42 offset:4272
ds_read2_b32 v[60:61], v41 offset0:88 offset1:89
ds_read2_b32 v[62:63], v41 offset0:90 offset1:91
s_waitcnt lgkmcnt(12)
v_mfma_f32_32x32x16_bf16 v[16:31], v[72:75], v[80:83], v[16:31]
v_mfma_f32_32x32x16_bf16 v[0:15], v[72:75], v[84:87], v[0:15]
v_mfma_f32_32x32x16_bf16 v[16:31], v[76:79], v[84:87], v[16:31]
ds_read2_b32 v[72:73], v40 offset0:80 offset1:81
ds_read2_b32 v[74:75], v40 offset0:82 offset1:83
ds_read_b128 v[80:83], v42 offset:1680
ds_read_b128 v[84:87], v42 offset:4240
ds_read2_b32 v[76:77], v41 offset0:80 offset1:81
ds_read2_b32 v[78:79], v41 offset0:82 offset1:83
s_waitcnt lgkmcnt(12)
v_mfma_f32_32x32x16_bf16 v[16:31], v[88:91], v[96:99], v[16:31]
v_mfma_f32_32x32x16_bf16 v[0:15], v[88:91], v[100:103], v[0:15]
v_mfma_f32_32x32x16_bf16 v[16:31], v[92:95], v[100:103], v[16:31]
ds_read2_b32 v[88:89], v40 offset0:104 offset1:105
ds_read2_b32 v[90:91], v40 offset0:106 offset1:107
ds_read_b128 v[96:99], v42 offset:1792
ds_read_b128 v[100:103], v42 offset:4352
ds_read2_b32 v[92:93], v41 offset0:104 offset1:105
ds_read2_b32 v[94:95], v41 offset0:106 offset1:107
s_waitcnt lgkmcnt(12)
v_mfma_f32_32x32x16_bf16 v[16:31], v[56:59], v[64:67], v[16:31]
v_mfma_f32_32x32x16_bf16 v[0:15], v[56:59], v[68:71], v[0:15]
v_mfma_f32_32x32x16_bf16 v[16:31], v[60:63], v[68:71], v[16:31]
ds_read2_b32 v[56:57], v40 offset0:96 offset1:97
ds_read2_b32 v[58:59], v40 offset0:98 offset1:99
ds_read_b128 v[64:67], v42 offset:1760
ds_read_b128 v[68:71], v42 offset:4320
ds_read2_b32 v[60:61], v41 offset0:96 offset1:97
ds_read2_b32 v[62:63], v41 offset0:98 offset1:99
s_waitcnt lgkmcnt(12)
v_mfma_f32_32x32x16_bf16 v[16:31], v[72:75], v[80:83], v[16:31]
v_mfma_f32_32x32x16_bf16 v[0:15], v[72:75], v[84:87], v[0:15]
v_mfma_f32_32x32x16_bf16 v[16:31], v[76:79], v[84:87], v[16:31]
ds_read2_b32 v[72:73], v40 offset0:120 offset1:121
ds_read2_b32 v[74:75], v40 offset0:122 offset1:123
ds_read_b128 v[80:83], v42 offset:1872
ds_read_b128 v[84:87], v42 offset:4432
ds_read2_b32 v[76:77], v41 offset0:120 offset1:121
ds_read2_b32 v[78:79], v41 offset0:122 offset1:123
s_waitcnt lgkmcnt(12)
v_mfma_f32_32x32x16_bf16 v[16:31], v[88:91], v[96:99], v[16:31]
v_mfma_f32_32x32x16_bf16 v[0:15], v[88:91], v[100:103], v[0:15]
v_mfma_f32_32x32x16_bf16 v[16:31], v[92:95], v[100:103], v[16:31]
ds_read2_b32 v[88:89], v40 offset0:112 offset1:113
ds_read2_b32 v[90:91], v40 offset0:114 offset1:115
ds_read_b128 v[96:99], v42 offset:1840
ds_read_b128 v[100:103], v42 offset:4400
ds_read2_b32 v[92:93], v41 offset0:112 offset1:113
ds_read2_b32 v[94:95], v41 offset0:114 offset1:115
s_waitcnt lgkmcnt(12)
v_mfma_f32_32x32x16_bf16 v[16:31], v[56:59], v[64:67], v[16:31]
v_mfma_f32_32x32x16_bf16 v[0:15], v[56:59], v[68:71], v[0:15]
v_mfma_f32_32x32x16_bf16 v[16:31], v[60:63], v[68:71], v[16:31]
ds_read2_b32 v[56:57], v40 offset0:136 offset1:137
ds_read2_b32 v[58:59], v40 offset0:138 offset1:139
ds_read_b128 v[64:67], v42 offset:1952
ds_read_b128 v[68:71], v42 offset:4512
ds_read2_b32 v[60:61], v41 offset0:136 offset1:137
ds_read2_b32 v[62:63], v41 offset0:138 offset1:139
s_waitcnt lgkmcnt(12)
v_mfma_f32_32x32x16_bf16 v[16:31], v[72:75], v[80:83], v[16:31]
v_mfma_f32_32x32x16_bf16 v[0:15], v[72:75], v[84:87], v[0:15]
v_mfma_f32_32x32x16_bf16 v[16:31], v[76:79], v[84:87], v[16:31]
ds_read2_b32 v[72:73], v40 offset0:128 offset1:129
ds_read2_b32 v[74:75], v40 offset0:130 offset1:131
ds_read_b128 v[80:83], v42 offset:1920
ds_read_b128 v[84:87], v42 offset:4480
ds_read2_b32 v[76:77], v41 offset0:128 offset1:129
ds_read2_b32 v[78:79], v41 offset0:130 offset1:131
s_waitcnt lgkmcnt(12)
v_mfma_f32_32x32x16_bf16 v[16:31], v[88:91], v[96:99], v[16:31]
v_mfma_f32_32x32x16_bf16 v[0:15], v[88:91], v[100:103], v[0:15]
v_mfma_f32_32x32x16_bf16 v[16:31], v[92:95], v[100:103], v[16:31]
ds_read2_b32 v[88:89], v40 offset0:152 offset1:153
ds_read2_b32 v[90:91], v40 offset0:154 offset1:155
ds_read_b128 v[96:99], v42 offset:2032
ds_read_b128 v[100:103], v42 offset:4592
ds_read2_b32 v[92:93], v41 offset0:152 offset1:153
ds_read2_b32 v[94:95], v41 offset0:154 offset1:155
s_waitcnt lgkmcnt(12)
v_mfma_f32_32x32x16_bf16 v[16:31], v[56:59], v[64:67], v[16:31]
v_mfma_f32_32x32x16_bf16 v[0:15], v[56:59], v[68:71], v[0:15]
v_mfma_f32_32x32x16_bf16 v[16:31], v[60:63], v[68:71], v[16:31]
ds_read2_b32 v[56:57], v40 offset0:144 offset1:145
ds_read2_b32 v[58:59], v40 offset0:146 offset1:147
ds_read_b128 v[64:67], v42 offset:2000
ds_read_b128 v[68:71], v42 offset:4560
ds_read2_b32 v[60:61], v41 offset0:144 offset1:145
ds_read2_b32 v[62:63], v41 offset0:146 offset1:147
s_waitcnt lgkmcnt(12)
v_mfma_f32_32x32x16_bf16 v[16:31], v[72:75], v[80:83], v[16:31]
v_mfma_f32_32x32x16_bf16 v[0:15], v[72:75], v[84:87], v[0:15]
v_mfma_f32_32x32x16_bf16 v[16:31], v[76:79], v[84:87], v[16:31]
ds_read2_b32 v[72:73], v40 offset0:168 offset1:169
ds_read2_b32 v[74:75], v40 offset0:170 offset1:171
ds_read_b128 v[80:83], v42 offset:2112
ds_read_b128 v[84:87], v42 offset:4672
ds_read2_b32 v[76:77], v41 offset0:168 offset1:169
ds_read2_b32 v[78:79], v41 offset0:170 offset1:171
s_waitcnt lgkmcnt(12)
v_mfma_f32_32x32x16_bf16 v[16:31], v[88:91], v[96:99], v[16:31]
v_mfma_f32_32x32x16_bf16 v[0:15], v[88:91], v[100:103], v[0:15]
v_mfma_f32_32x32x16_bf16 v[16:31], v[92:95], v[100:103], v[16:31]
ds_read2_b32 v[88:89], v40 offset0:160 offset1:161
ds_read2_b32 v[90:91], v40 offset0:162 offset1:163
ds_read_b128 v[96:99], v42 offset:2080
ds_read_b128 v[100:103], v42 offset:4640
ds_read2_b32 v[92:93], v41 offset0:160 offset1:161
ds_read2_b32 v[94:95], v41 offset0:162 offset1:163
s_waitcnt lgkmcnt(12)
v_mfma_f32_32x32x16_bf16 v[16:31], v[56:59], v[64:67], v[16:31]
v_mfma_f32_32x32x16_bf16 v[0:15], v[56:59], v[68:71], v[0:15]
v_mfma_f32_32x32x16_bf16 v[16:31], v[60:63], v[68:71], v[16:31]
ds_read2_b32 v[56:57], v40 offset0:184 offset1:185
ds_read2_b32 v[58:59], v40 offset0:186 offset1:187
ds_read_b128 v[64:67], v42 offset:2192
ds_read_b128 v[68:71], v42 offset:4752
ds_read2_b32 v[60:61], v41 offset0:184 offset1:185
ds_read2_b32 v[62:63], v41 offset0:186 offset1:187
s_waitcnt lgkmcnt(12)
v_mfma_f32_32x32x16_bf16 v[16:31], v[72:75], v[80:83], v[16:31]
v_mfma_f32_32x32x16_bf16 v[0:15], v[72:75], v[84:87], v[0:15]
v_mfma_f32_32x32x16_bf16 v[16:31], v[76:79], v[84:87], v[16:31]
ds_read2_b32 v[72:73], v40 offset0:176 offset1:177
ds_read2_b32 v[74:75], v40 offset0:178 offset1:179
ds_read_b128 v[80:83], v42 offset:2160
ds_read_b128 v[84:87], v42 offset:4720
ds_read2_b32 v[76:77], v41 offset0:176 offset1:177
ds_read2_b32 v[78:79], v41 offset0:178 offset1:179
s_waitcnt lgkmcnt(12)
v_mfma_f32_32x32x16_bf16 v[16:31], v[88:91], v[96:99], v[16:31]
v_mfma_f32_32x32x16_bf16 v[0:15], v[88:91], v[100:103], v[0:15]
v_mfma_f32_32x32x16_bf16 v[16:31], v[92:95], v[100:103], v[16:31]
ds_read2_b32 v[88:89], v40 offset0:200 offset1:201
ds_read2_b32 v[90:91], v40 offset0:202 offset1:203
ds_read_b128 v[96:99], v42 offset:2272
ds_read_b128 v[100:103], v42 offset:4832
ds_read2_b32 v[92:93], v41 offset0:200 offset1:201
ds_read2_b32 v[94:95], v41 offset0:202 offset1:203
s_waitcnt lgkmcnt(12)
v_mfma_f32_32x32x16_bf16 v[16:31], v[56:59], v[64:67], v[16:31]
v_mfma_f32_32x32x16_bf16 v[0:15], v[56:59], v[68:71], v[0:15]
v_mfma_f32_32x32x16_bf16 v[16:31], v[60:63], v[68:71], v[16:31]
ds_read2_b32 v[56:57], v40 offset0:192 offset1:193
ds_read2_b32 v[58:59], v40 offset0:194 offset1:195
ds_read_b128 v[64:67], v42 offset:2240
ds_read_b128 v[68:71], v42 offset:4800
ds_read2_b32 v[60:61], v41 offset0:192 offset1:193
ds_read2_b32 v[62:63], v41 offset0:194 offset1:195
s_waitcnt lgkmcnt(12)
v_mfma_f32_32x32x16_bf16 v[16:31], v[72:75], v[80:83], v[16:31]
v_mfma_f32_32x32x16_bf16 v[0:15], v[72:75], v[84:87], v[0:15]
v_mfma_f32_32x32x16_bf16 v[16:31], v[76:79], v[84:87], v[16:31]
ds_read2_b32 v[72:73], v40 offset0:216 offset1:217
ds_read2_b32 v[74:75], v40 offset0:218 offset1:219
ds_read_b128 v[80:83], v42 offset:2352
ds_read_b128 v[84:87], v42 offset:4912
ds_read2_b32 v[76:77], v41 offset0:216 offset1:217
ds_read2_b32 v[78:79], v41 offset0:218 offset1:219
s_waitcnt lgkmcnt(12)
v_mfma_f32_32x32x16_bf16 v[16:31], v[88:91], v[96:99], v[16:31]
v_mfma_f32_32x32x16_bf16 v[0:15], v[88:91], v[100:103], v[0:15]
v_mfma_f32_32x32x16_bf16 v[16:31], v[92:95], v[100:103], v[16:31]
ds_read2_b32 v[88:89], v40 offset0:208 offset1:209
ds_read2_b32 v[90:91], v40 offset0:210 offset1:211
ds_read_b128 v[96:99], v42 offset:2320
ds_read_b128 v[100:103], v42 offset:4880
ds_read2_b32 v[92:93], v41 offset0:208 offset1:209
ds_read2_b32 v[94:95], v41 offset0:210 offset1:211
s_waitcnt lgkmcnt(12)
v_mfma_f32_32x32x16_bf16 v[16:31], v[56:59], v[64:67], v[16:31]
v_mfma_f32_32x32x16_bf16 v[0:15], v[56:59], v[68:71], v[0:15]
v_mfma_f32_32x32x16_bf16 v[16:31], v[60:63], v[68:71], v[16:31]
ds_read2_b32 v[56:57], v40 offset0:232 offset1:233
ds_read2_b32 v[58:59], v40 offset0:234 offset1:235
ds_read_b128 v[64:67], v42 offset:2432
ds_read_b128 v[68:71], v42 offset:4992
ds_read2_b32 v[60:61], v41 offset0:232 offset1:233
ds_read2_b32 v[62:63], v41 offset0:234 offset1:235
s_waitcnt lgkmcnt(12)
v_mfma_f32_32x32x16_bf16 v[16:31], v[72:75], v[80:83], v[16:31]
v_mfma_f32_32x32x16_bf16 v[0:15], v[72:75], v[84:87], v[0:15]
v_mfma_f32_32x32x16_bf16 v[16:31], v[76:79], v[84:87], v[16:31]
ds_read2_b32 v[72:73], v40 offset0:224 offset1:225
ds_read2_b32 v[74:75], v40 offset0:226 offset1:227
ds_read_b128 v[80:83], v42 offset:2400
ds_read_b128 v[84:87], v42 offset:4960
ds_read2_b32 v[76:77], v41 offset0:224 offset1:225
ds_read2_b32 v[78:79], v41 offset0:226 offset1:227
s_waitcnt lgkmcnt(12)
v_mfma_f32_32x32x16_bf16 v[16:31], v[88:91], v[96:99], v[16:31]
v_mfma_f32_32x32x16_bf16 v[0:15], v[88:91], v[100:103], v[0:15]
v_mfma_f32_32x32x16_bf16 v[16:31], v[92:95], v[100:103], v[16:31]
ds_read2_b32 v[88:89], v40 offset0:248 offset1:249
ds_read2_b32 v[90:91], v40 offset0:250 offset1:251
ds_read_b128 v[96:99], v42 offset:2512
ds_read_b128 v[100:103], v42 offset:5072
ds_read2_b32 v[92:93], v41 offset0:248 offset1:249
ds_read2_b32 v[94:95], v41 offset0:250 offset1:251
s_waitcnt lgkmcnt(12)
v_mfma_f32_32x32x16_bf16 v[16:31], v[56:59], v[64:67], v[16:31]
v_mfma_f32_32x32x16_bf16 v[0:15], v[56:59], v[68:71], v[0:15]
v_mfma_f32_32x32x16_bf16 v[16:31], v[60:63], v[68:71], v[16:31]
ds_read2_b32 v[56:57], v40 offset0:240 offset1:241
ds_read2_b32 v[58:59], v40 offset0:242 offset1:243
ds_read_b128 v[64:67], v42 offset:2480
ds_read_b128 v[68:71], v42 offset:5040
ds_read2_b32 v[60:61], v41 offset0:240 offset1:241
ds_read2_b32 v[62:63], v41 offset0:242 offset1:243
s_waitcnt lgkmcnt(12)
v_mfma_f32_32x32x16_bf16 v[16:31], v[72:75], v[80:83], v[16:31]
v_mfma_f32_32x32x16_bf16 v[0:15], v[72:75], v[84:87], v[0:15]
v_mfma_f32_32x32x16_bf16 v[16:31], v[76:79], v[84:87], v[16:31]
s_waitcnt lgkmcnt(6)
v_mfma_f32_32x32x16_bf16 v[16:31], v[88:91], v[96:99], v[16:31]
v_mfma_f32_32x32x16_bf16 v[0:15], v[88:91], v[100:103], v[0:15]
v_mfma_f32_32x32x16_bf16 v[16:31], v[92:95], v[100:103], v[16:31]
s_waitcnt lgkmcnt(0)
v_mfma_f32_32x32x16_bf16 v[16:31], v[56:59], v[64:67], v[16:31]
v_mfma_f32_32x32x16_bf16 v[0:15], v[56:59], v[68:71], v[0:15]
v_mfma_f32_32x32x16_bf16 v[16:31], v[60:63], v[68:71], v[16:31]
v_mul_u32_u24 v45, 36864, v43
v_lshl_add_u32 v45, v44, 3, v45
s_lshl_b32 s48, s50, 4
s_add_u32 s48, s48, 0x940000
v_add_u32 v45, s48, v45
s_nop 5
v_cvt_pk_bf16_f32 v56, v0, v1
v_cvt_pk_bf16_f32 v57, v2, v3
global_store_dwordx2 v45, v[56:57], s[30:31] sc1
v_add_u32 v45, 9216, v45
v_cvt_pk_bf16_f32 v58, v4, v5
v_cvt_pk_bf16_f32 v59, v6, v7
global_store_dwordx2 v45, v[58:59], s[30:31] sc1
v_add_u32 v45, 9216, v45
v_cvt_pk_bf16_f32 v60, v8, v9
v_cvt_pk_bf16_f32 v61, v10, v11
global_store_dwordx2 v45, v[60:61], s[30:31] sc1
v_add_u32 v45, 9216, v45
v_cvt_pk_bf16_f32 v62, v12, v13
v_cvt_pk_bf16_f32 v63, v14, v15
global_store_dwordx2 v45, v[62:63], s[30:31] sc1
v_add_u32 v45, 1152000, v45
v_cvt_pk_bf16_f32 v64, v16, v17
v_cvt_pk_bf16_f32 v65, v18, v19
global_store_dwordx2 v45, v[64:65], s[30:31] sc1
v_add_u32 v45, 9216, v45
v_cvt_pk_bf16_f32 v66, v20, v21
v_cvt_pk_bf16_f32 v67, v22, v23
global_store_dwordx2 v45, v[66:67], s[30:31] sc1
v_add_u32 v45, 9216, v45
v_cvt_pk_bf16_f32 v68, v24, v25
v_cvt_pk_bf16_f32 v69, v26, v27
global_store_dwordx2 v45, v[68:69], s[30:31] sc1
v_add_u32 v45, 9216, v45
v_cvt_pk_bf16_f32 v70, v28, v29
v_cvt_pk_bf16_f32 v71, v30, v31
global_store_dwordx2 v45, v[70:71], s[30:31] sc1
s_setprio 3
s_waitcnt vmcnt(0)
s_lshl_b32 s50, s50, 3
s_add_u32 s50, s50, 0x6de000
s_andn2_b32 s51, s61, 0xff
v_mov_b32 v158, s50
v_mov_b32 v148, s60
v_mov_b32 v149, s51
s_mov_b64 exec, 1
global_store_dwordx2 v158, v[148:149], s[30:31] sc1
s_mov_b64 exec, -1
H1_noconv:
v_lshrrev_b32 v158, 3, v162
v_cmp_eq_u32 vcc, s40, v158
s_mov_b64 s[54:55], vcc
s_not_b64 s[56:57], s[54:55]
v_and_b32 v166, 7, v162
v_mul_u32_u24 v156, 2320, v166
v_lshl_add_u32 v156, v163, 4, v156
v_add_u32 v156, 100928, v156
v_lshl_add_u32 v166, v163, 3, v166
v_lshlrev_b32 v166, 4, v166
s_lshl_b32 s46, s2, 2
s_add_u32 s46, s46, 1
s_mul_i32 s46, s46, 4608
s_add_u32 s46, s46, s39
s_add_u32 s48, s30, s46
s_addc_u32 s49, s31, 0
s_xor_b32 s47, s2, 1
s_lshl_b32 s46, s47, 2
s_add_u32 s46, s46, 1
s_mul_i32 s46, s46, 4608
s_add_u32 s46, s46, s39
s_add_u32 s66, s30, s46
s_addc_u32 s67, s31, 0
s_lshl_b32 s46, s33, 11
s_lshl_b32 s47, s47, 3
s_add_u32 s46, s46, s47
s_add_u32 s46, s46, 0x6dd000
v_mov_b32 v158, s46
global_load_dwordx2 v[148:149], v158, s[30:31] sc1
s_waitcnt vmcnt(0)
v_cmp_eq_u64 vcc, s[60:61], v[148:149]
s_cmp_eq_u64 vcc, -1
s_cselect_b32 s71, 1, 0
s_mul_i32 s46, s40, 294912
s_add_u32 s46, s46, 0xa4400
s_add_u32 s58, s30, s46
s_addc_u32 s59, s31, 0
global_load_dwordx4 v[36:39], v157, s[58:59] offset:0
global_load_dwordx4 v[40:43], v157, s[58:59] offset:1024
global_load_dwordx4 v[44:47], v157, s[58:59] offset:2048
global_load_dwordx4 v[48:51], v157, s[58:59] offset:3072
s_add_u32 s58, s58, 4096
s_addc_u32 s59, s59, 0
global_load_dwordx4 v[52:55], v157, s[58:59] offset:0
global_load_dwordx4 v[56:59], v157, s[58:59] offset:1024
global_load_dwordx4 v[60:63], v157, s[58:59] offset:2048
global_load_dwordx4 v[64:67], v157, s[58:59] offset:3072
s_add_u32 s58, s58, 4096
s_addc_u32 s59, s59, 0
global_load_dwordx4 v[68:71], v157, s[58:59] offset:0
s_mul_i32 s46, s40, 294912
s_add_u32 s46, s46, 0xad400
s_add_u32 s58, s30, s46
s_addc_u32 s59, s31, 0
global_load_dwordx4 v[72:75], v157, s[58:59] offset:0
global_load_dwordx4 v[76:79], v157, s[58:59] offset:1024
global_load_dwordx4 v[80:83], v157, s[58:59] offset:2048
global_load_dwordx4 v[84:87], v157, s[58:59] offset:3072
s_add_u32 s58, s58, 4096
s_addc_u32 s59, s59, 0
global_load_dwordx4 v[88:91], v157, s[58:59] offset:0
global_load_dwordx4 v[92:95], v157, s[58:59] offset:1024
global_load_dwordx4 v[96:99], v157, s[58:59] offset:2048
global_load_dwordx4 v[100:103], v157, s[58:59] offset:3072
s_add_u32 s58, s58, 4096
s_addc_u32 s59, s59, 0
global_load_dwordx4 v[104:107], v157, s[58:59] offset:0
H1_sp13_re:
ds_read_b32 v159, v167 offset:36
s_waitcnt lgkmcnt(0)
v_cmp_ne_u32 vcc, 1, v159
s_cbranch_vccz H1_sp13_ok
s_add_u32 s52, s52, 1
s_cmp_gt_u32 s52, 200000
s_cbranch_scc1 H1_sp13_ok
s_sleep 4
s_branch H1_sp13_re
H1_sp13_ok:
ds_read_b128 v[144:147], v157 offset:11264
s_waitcnt lgkmcnt(0)
s_mul_i32 s46, s40, 294912
s_add_u32 s46, s46, 0xb6400
s_add_u32 s58, s30, s46
s_addc_u32 s59, s31, 0
s_waitcnt vmcnt(17)
v_mfma_f32_16x16x32_bf16 v[0:3], v[36:39], v[144:147], 0
global_load_dwordx4 v[36:39], v157, s[58:59] offset:0
s_waitcnt vmcnt(17)
v_mfma_f32_16x16x32_bf16 v[4:7], v[40:43], v[144:147], 0
global_load_dwordx4 v[40:43], v157, s[58:59] offset:1024
s_waitcnt vmcnt(17)
v_mfma_f32_16x16x32_bf16 v[8:11], v[44:47], v[144:147], 0
global_load_dwordx4 v[44:47], v157, s[58:59] offset:2048
s_waitcnt vmcnt(17)
v_mfma_f32_16x16x32_bf16 v[12:15], v[48:51], v[144:147], 0
global_load_dwordx4 v[48:51], v157, s[58:59] offset:3072
s_waitcnt vmcnt(17)
v_mfma_f32_16x16x32_bf16 v[16:19], v[52:55], v[144:147], 0
s_add_u32 s58, s58, 4096
s_addc_u32 s59, s59, 0
global_load_dwordx4 v[52:55], v157, s[58:59] offset:0
s_waitcnt vmcnt(17)
v_mfma_f32_16x16x32_bf16 v[20:23], v[56:59], v[144:147], 0
global_load_dwordx4 v[56:59], v157, s[58:59] offset:1024
s_waitcnt vmcnt(17)
v_mfma_f32_16x16x32_bf16 v[24:27], v[60:63], v[144:147], 0
global_load_dwordx4 v[60:63], v157, s[58:59] offset:2048
s_waitcnt vmcnt(17)
v_mfma_f32_16x16x32_bf16 v[28:31], v[64:67], v[144:147], 0
global_load_dwordx4 v[64:67], v157, s[58:59] offset:3072
s_waitcnt vmcnt(17)
v_mfma_f32_16x16x32_bf16 v[32:35], v[68:71], v[144:147], 0
s_add_u32 s58, s58, 4096
s_addc_u32 s59, s59, 0
global_load_dwordx4 v[68:71], v157, s[58:59] offset:0
s_cmp_eq_u32 s33, 1
s_cbranch_scc0 H1_sk14
H1_sp15_re:
ds_read_b64 v[148:149], v167 offset:264
s_waitcnt lgkmcnt(0)
v_cmp_ne_u64 vcc, s[68:69], v[148:149]
s_cbranch_vccz H1_sp15_ok
s_add_u32 s52, s52, 1
s_cmp_gt_u32 s52, 200000
s_cbranch_scc1 H1_sp15_ok
s_sleep 2
s_branch H1_sp15_re
H1_sp15_ok:
v_add_u32 v160, 59392, v164
v_add_u32 v161, 59392, v165
ds_read_b128 v[144:147], v160 offset:0
ds_read_b128 v[148:151], v160 offset:512
ds_read_b128 v[152:155], v161 offset:0
ds_read_b128 v[108:111], v160 offset:2560
ds_read_b128 v[112:115], v160 offset:3072
ds_read_b128 v[116:119], v161 offset:2560
ds_read_b128 v[120:123], v160 offset:5120
ds_read_b128 v[124:127], v160 offset:5632
ds_read_b128 v[128:131], v161 offset:5120
ds_read_b128 v[132:135], v160 offset:7680
ds_read_b128 v[136:139], v160 offset:8192
ds_read_b128 v[140:143], v161 offset:7680
s_waitcnt lgkmcnt(6)
v_pk_add_f32 v[144:145], v[144:145], v[108:109]
v_pk_add_f32 v[146:147], v[146:147], v[110:111]
v_pk_add_f32 v[148:149], v[148:149], v[112:113]
v_pk_add_f32 v[150:151], v[150:151], v[114:115]
v_pk_add_f32 v[152:153], v[152:153], v[116:117]
v_add_f32 v154, v154, v118
ds_read_b128 v[108:111], v160 offset:10240
ds_read_b128 v[112:115], v160 offset:10752
ds_read_b128 v[116:119], v161 offset:10240
s_waitcnt lgkmcnt(6)
v_pk_add_f32 v[144:145], v[144:145], v[120:121]
v_pk_add_f32 v[146:147], v[146:147], v[122:123]
v_pk_add_f32 v[148:149], v[148:149], v[124:125]
v_pk_add_f32 v[150:151], v[150:151], v[126:127]
v_pk_add_f32 v[152:153], v[152:153], v[128:129]
v_add_f32 v154, v154, v130
ds_read_b128 v[120:123], v160 offset:12800
ds_read_b128 v[124:127], v160 offset:13312
ds_read_b128 v[128:131], v161 offset:12800
s_waitcnt lgkmcnt(6)
v_pk_add_f32 v[144:145], v[144:145], v[132:133]
v_pk_add_f32 v[146:147], v[146:147], v[134:135]
v_pk_add_f32 v[148:149], v[148:149], v[136:137]
v_pk_add_f32 v[150:151], v[150:151], v[138:139]
v_pk_add_f32 v[152:153], v[152:153], v[140:141]
v_add_f32 v154, v154, v142
ds_read_b128 v[132:135], v160 offset:15360
ds_read_b128 v[136:139], v160 offset:15872
ds_read_b128 v[140:143], v161 offset:15360
s_waitcnt lgkmcnt(6)
v_pk_add_f32 v[144:145], v[144:145], v[108:109]
v_pk_add_f32 v[146:147], v[146:147], v[110:111]
v_pk_add_f32 v[148:149], v[148:149], v[112:113]
v_pk_add_f32 v[150:151], v[150:151], v[114:115]
v_pk_add_f32 v[152:153], v[152:153], v[116:117]
v_add_f32 v154, v154, v118
ds_read_b128 v[108:111], v160 offset:17920
ds_read_b128 v[112:115], v160 offset:18432
ds_read_b128 v[116:119], v161 offset:17920
s_waitcnt lgkmcnt(6)
v_pk_add_f32 v[144:145], v[144:145], v[120:121]
v_pk_add_f32 v[146:147], v[146:147], v[122:123]
v_pk_add_f32 v[148:149], v[148:149], v[124:125]
v_pk_add_f32 v[150:151], v[150:151], v[126:127]
v_pk_add_f32 v[152:153], v[152:153], v[128:129]
v_add_f32 v154, v154, v130
s_waitcnt lgkmcnt(3)
v_pk_add_f32 v[144:145], v[144:145], v[132:133]
v_pk_add_f32 v[146:147], v[146:147], v[134:135]
v_pk_add_f32 v[148:149], v[148:149], v[136:137]
v_pk_add_f32 v[150:151], v[150:151], v[138:139]
v_pk_add_f32 v[152:153], v[152:153], v[140:141]
v_add_f32 v154, v154, v142
s_waitcnt lgkmcnt(0)
v_pk_add_f32 v[144:145], v[144:145], v[108:109]
v_pk_add_f32 v[146:147], v[146:147], v[110:111]
v_pk_add_f32 v[148:149], v[148:149], v[112:113]
v_pk_add_f32 v[150:151], v[150:151], v[114:115]
v_pk_add_f32 v[152:153], v[152:153], v[116:117]
v_add_f32 v154, v154, v118
v_rcp_f32 v154, v154
s_nop 0
v_mul_f32 v144, v144, v154
v_mul_f32 v145, v145, v154
v_mul_f32 v146, v146, v154
v_mul_f32 v147, v147, v154
v_mul_f32 v148, v148, v154
v_mul_f32 v149, v149, v154
v_mul_f32 v150, v150, v154
v_mul_f32 v151, v151, v154
v_mul_f32 v152, v152, v154
v_mul_f32 v153, v153, v154
v_cvt_pk_bf16_f32 v144, v144, v145
v_cvt_pk_bf16_f32 v145, v146, v147
v_cvt_pk_bf16_f32 v146, v148, v149
v_cvt_pk_bf16_f32 v147, v150, v151
v_cvt_pk_bf16_f32 v155, v152, v153
ds_write_b128 v157, v[144:147] offset:12288
v_lshlrev_b32 v160, 4, v162
v_lshrrev_b32 v161, 1, v163
v_lshl_add_u32 v160, v161, 2, v160
s_mov_b32 exec_lo, 0xffff
s_mov_b32 exec_hi, 0xffff
ds_write_b32 v160, v155 offset:19464
s_mov_b64 exec, 1
v_mov_b32 v160, 44
v_mov_b32 v161, 1
ds_write_b32 v160, v161
s_mov_b64 exec, -1
H1_sk14:
H1_sp16_re:
ds_read_b32 v159, v167 offset:44
s_waitcnt lgkmcnt(0)
v_cmp_ne_u32 vcc, 1, v159
s_cbranch_vccz H1_sp16_ok
s_add_u32 s52, s52, 1
s_cmp_gt_u32 s52, 200000
s_cbranch_scc1 H1_sp16_ok
s_sleep 4
s_branch H1_sp16_re
H1_sp16_ok:
ds_read_b128 v[144:147], v157 offset:12288
s_waitcnt lgkmcnt(0)
s_mul_i32 s46, s40, 294912
s_add_u32 s46, s46, 0xbf400
s_add_u32 s58, s30, s46
s_addc_u32 s59, s31, 0
s_waitcnt vmcnt(17)
v_mfma_f32_16x16x32_bf16 v[0:3], v[72:75], v[144:147], v[0:3]
global_load_dwordx4 v[72:75], v157, s[58:59] offset:0
s_waitcnt vmcnt(17)
v_mfma_f32_16x16x32_bf16 v[4:7], v[76:79], v[144:147], v[4:7]
global_load_dwordx4 v[76:79], v157, s[58:59] offset:1024
s_waitcnt vmcnt(17)
v_mfma_f32_16x16x32_bf16 v[8:11], v[80:83], v[144:147], v[8:11]
global_load_dwordx4 v[80:83], v157, s[58:59] offset:2048
s_waitcnt vmcnt(17)
v_mfma_f32_16x16x32_bf16 v[12:15], v[84:87], v[144:147], v[12:15]
global_load_dwordx4 v[84:87], v157, s[58:59] offset:3072
s_waitcnt vmcnt(17)
v_mfma_f32_16x16x32_bf16 v[16:19], v[88:91], v[144:147], v[16:19]
s_add_u32 s58, s58, 4096
s_addc_u32 s59, s59, 0
global_load_dwordx4 v[88:91], v157, s[58:59] offset:0
s_waitcnt vmcnt(17)
v_mfma_f32_16x16x32_bf16 v[20:23], v[92:95], v[144:147], v[20:23]
global_load_dwordx4 v[92:95], v157, s[58:59] offset:1024
s_waitcnt vmcnt(17)
v_mfma_f32_16x16x32_bf16 v[24:27], v[96:99], v[144:147], v[24:27]
global_load_dwordx4 v[96:99], v157, s[58:59] offset:2048
s_waitcnt vmcnt(17)
v_mfma_f32_16x16x32_bf16 v[28:31], v[100:103], v[144:147], v[28:31]
global_load_dwordx4 v[100:103], v157, s[58:59] offset:3072
s_waitcnt vmcnt(17)
v_mfma_f32_16x16x32_bf16 v[32:35], v[104:107], v[144:147], v[32:35]
s_add_u32 s58, s58, 4096
s_addc_u32 s59, s59, 0
global_load_dwordx4 v[104:107], v157, s[58:59] offset:0
H1_sp17_re:
ds_read_b32 v159, v167 offset:52
s_waitcnt lgkmcnt(0)
v_cmp_ne_u32 vcc, 1, v159
s_cbranch_vccz H1_sp17_ok
s_add_u32 s52, s52, 1
s_cmp_gt_u32 s52, 200000
s_cbranch_scc1 H1_sp17_ok
s_sleep 4
s_branch H1_sp17_re
H1_sp17_ok:
ds_read_b128 v[144:147], v157 offset:13312
s_waitcnt lgkmcnt(0)
s_mul_i32 s46, s40, 294912
s_add_u32 s46, s46, 0xc8400
s_add_u32 s58, s30, s46
s_addc_u32 s59, s31, 0
s_waitcnt vmcnt(17)
v_mfma_f32_16x16x32_bf16 v[0:3], v[36:39], v[144:147], v[0:3]
global_load_dwordx4 v[36:39], v157, s[58:59] offset:0
s_waitcnt vmcnt(17)
v_mfma_f32_16x16x32_bf16 v[4:7], v[40:43], v[144:147], v[4:7]
global_load_dwordx4 v[40:43], v157, s[58:59] offset:1024
s_waitcnt vmcnt(17)
v_mfma_f32_16x16x32_bf16 v[8:11], v[44:47], v[144:147], v[8:11]
global_load_dwordx4 v[44:47], v157, s[58:59] offset:2048
s_waitcnt vmcnt(17)
v_mfma_f32_16x16x32_bf16 v[12:15], v[48:51], v[144:147], v[12:15]
global_load_dwordx4 v[48:51], v157, s[58:59] offset:3072
s_waitcnt vmcnt(17)
v_mfma_f32_16x16x32_bf16 v[16:19], v[52:55], v[144:147], v[16:19]
s_add_u32 s58, s58, 4096
s_addc_u32 s59, s59, 0
global_load_dwordx4 v[52:55], v157, s[58:59] offset:0
s_waitcnt vmcnt(17)
v_mfma_f32_16x16x32_bf16 v[20:23], v[56:59], v[144:147], v[20:23]
global_load_dwordx4 v[56:59], v157, s[58:59] offset:1024
s_waitcnt vmcnt(17)
v_mfma_f32_16x16x32_bf16 v[24:27], v[60:63], v[144:147], v[24:27]
global_load_dwordx4 v[60:63], v157, s[58:59] offset:2048
s_waitcnt vmcnt(17)
v_mfma_f32_16x16x32_bf16 v[28:31], v[64:67], v[144:147], v[28:31]
global_load_dwordx4 v[64:67], v157, s[58:59] offset:3072
s_waitcnt vmcnt(17)
v_mfma_f32_16x16x32_bf16 v[32:35], v[68:71], v[144:147], v[32:35]
s_add_u32 s58, s58, 4096
s_addc_u32 s59, s59, 0
global_load_dwordx4 v[68:71], v157, s[58:59] offset:0
H1_sp18_re:
ds_read_b32 v159, v167 offset:60
s_waitcnt lgkmcnt(0)
v_cmp_ne_u32 vcc, 1, v159
s_cbranch_vccz H1_sp18_ok
s_add_u32 s52, s52, 1
s_cmp_gt_u32 s52, 200000
s_cbranch_scc1 H1_sp18_ok
s_sleep 4
s_branch H1_sp18_re
H1_sp18_ok:
ds_read_b128 v[144:147], v157 offset:14336
s_waitcnt lgkmcnt(0)
s_mul_i32 s46, s40, 294912
s_add_u32 s46, s46, 0xd1400
s_add_u32 s58, s30, s46
s_addc_u32 s59, s31, 0
s_waitcnt vmcnt(17)
v_mfma_f32_16x16x32_bf16 v[0:3], v[72:75], v[144:147], v[0:3]
global_load_dwordx4 v[72:75], v157, s[58:59] offset:0
s_waitcnt vmcnt(17)
v_mfma_f32_16x16x32_bf16 v[4:7], v[76:79], v[144:147], v[4:7]
global_load_dwordx4 v[76:79], v157, s[58:59] offset:1024
s_waitcnt vmcnt(17)
v_mfma_f32_16x16x32_bf16 v[8:11], v[80:83], v[144:147], v[8:11]
global_load_dwordx4 v[80:83], v157, s[58:59] offset:2048
s_waitcnt vmcnt(17)
v_mfma_f32_16x16x32_bf16 v[12:15], v[84:87], v[144:147], v[12:15]
global_load_dwordx4 v[84:87], v157, s[58:59] offset:3072
s_waitcnt vmcnt(17)
v_mfma_f32_16x16x32_bf16 v[16:19], v[88:91], v[144:147], v[16:19]
s_add_u32 s58, s58, 4096
s_addc_u32 s59, s59, 0
global_load_dwordx4 v[88:91], v157, s[58:59] offset:0
s_waitcnt vmcnt(17)
v_mfma_f32_16x16x32_bf16 v[20:23], v[92:95], v[144:147], v[20:23]
global_load_dwordx4 v[92:95], v157, s[58:59] offset:1024
s_waitcnt vmcnt(17)
v_mfma_f32_16x16x32_bf16 v[24:27], v[96:99], v[144:147], v[24:27]
global_load_dwordx4 v[96:99], v157, s[58:59] offset:2048
s_waitcnt vmcnt(17)
v_mfma_f32_16x16x32_bf16 v[28:31], v[100:103], v[144:147], v[28:31]
global_load_dwordx4 v[100:103], v157, s[58:59] offset:3072
s_waitcnt vmcnt(17)
v_mfma_f32_16x16x32_bf16 v[32:35], v[104:107], v[144:147], v[32:35]
s_add_u32 s58, s58, 4096
s_addc_u32 s59, s59, 0
global_load_dwordx4 v[104:107], v157, s[58:59] offset:0
H1_sp19_re:
ds_read_b32 v159, v167 offset:68
s_waitcnt lgkmcnt(0)
v_cmp_ne_u32 vcc, 1, v159
s_cbranch_vccz H1_sp19_ok
s_add_u32 s52, s52, 1
s_cmp_gt_u32 s52, 200000
s_cbranch_scc1 H1_sp19_ok
s_sleep 4
s_branch H1_sp19_re
H1_sp19_ok:
ds_read_b128 v[144:147], v157 offset:15360
s_waitcnt lgkmcnt(0)
s_mul_i32 s46, s40, 294912
s_add_u32 s46, s46, 0xda400
s_add_u32 s58, s30, s46
s_addc_u32 s59, s31, 0
s_waitcnt vmcnt(17)
v_mfma_f32_16x16x32_bf16 v[0:3], v[36:39], v[144:147], v[0:3]
global_load_dwordx4 v[36:39], v157, s[58:59] offset:0
s_waitcnt vmcnt(17)
v_mfma_f32_16x16x32_bf16 v[4:7], v[40:43], v[144:147], v[4:7]
global_load_dwordx4 v[40:43], v157, s[58:59] offset:1024
s_waitcnt vmcnt(17)
v_mfma_f32_16x16x32_bf16 v[8:11], v[44:47], v[144:147], v[8:11]
global_load_dwordx4 v[44:47], v157, s[58:59] offset:2048
s_waitcnt vmcnt(17)
v_mfma_f32_16x16x32_bf16 v[12:15], v[48:51], v[144:147], v[12:15]
global_load_dwordx4 v[48:51], v157, s[58:59] offset:3072
s_waitcnt vmcnt(17)
v_mfma_f32_16x16x32_bf16 v[16:19], v[52:55], v[144:147], v[16:19]
s_add_u32 s58, s58, 4096
s_addc_u32 s59, s59, 0
global_load_dwordx4 v[52:55], v157, s[58:59] offset:0
s_waitcnt vmcnt(17)
v_mfma_f32_16x16x32_bf16 v[20:23], v[56:59], v[144:147], v[20:23]
global_load_dwordx4 v[56:59], v157, s[58:59] offset:1024
s_waitcnt vmcnt(17)
v_mfma_f32_16x16x32_bf16 v[24:27], v[60:63], v[144:147], v[24:27]
global_load_dwordx4 v[60:63], v157, s[58:59] offset:2048
s_waitcnt vmcnt(17)
v_mfma_f32_16x16x32_bf16 v[28:31], v[64:67], v[144:147], v[28:31]
global_load_dwordx4 v[64:67], v157, s[58:59] offset:3072
s_waitcnt vmcnt(17)
v_mfma_f32_16x16x32_bf16 v[32:35], v[68:71], v[144:147], v[32:35]
s_add_u32 s58, s58, 4096
s_addc_u32 s59, s59, 0
global_load_dwordx4 v[68:71], v157, s[58:59] offset:0
s_cmp_eq_u32 s33, 1
s_cbranch_scc0 H1_sk20
H1_sp21_re:
ds_read_b64 v[148:149], v167 offset:296
s_waitcnt lgkmcnt(0)
v_cmp_ne_u64 vcc, s[68:69], v[148:149]
s_cbranch_vccz H1_sp21_ok
s_add_u32 s52, s52, 1
s_cmp_gt_u32 s52, 200000
s_cbranch_scc1 H1_sp21_ok
s_sleep 2
s_branch H1_sp21_re
H1_sp21_ok:
v_add_u32 v160, 79872, v164
v_add_u32 v161, 79872, v165
ds_read_b128 v[144:147], v160 offset:0
ds_read_b128 v[148:151], v160 offset:512
ds_read_b128 v[152:155], v161 offset:0
ds_read_b128 v[108:111], v160 offset:2560
ds_read_b128 v[112:115], v160 offset:3072
ds_read_b128 v[116:119], v161 offset:2560
ds_read_b128 v[120:123], v160 offset:5120
ds_read_b128 v[124:127], v160 offset:5632
ds_read_b128 v[128:131], v161 offset:5120
ds_read_b128 v[132:135], v160 offset:7680
ds_read_b128 v[136:139], v160 offset:8192
ds_read_b128 v[140:143], v161 offset:7680
s_waitcnt lgkmcnt(6)
v_pk_add_f32 v[144:145], v[144:145], v[108:109]
v_pk_add_f32 v[146:147], v[146:147], v[110:111]
v_pk_add_f32 v[148:149], v[148:149], v[112:113]
v_pk_add_f32 v[150:151], v[150:151], v[114:115]
v_pk_add_f32 v[152:153], v[152:153], v[116:117]
v_add_f32 v154, v154, v118
ds_read_b128 v[108:111], v160 offset:10240
ds_read_b128 v[112:115], v160 offset:10752
ds_read_b128 v[116:119], v161 offset:10240
s_waitcnt lgkmcnt(6)
v_pk_add_f32 v[144:145], v[144:145], v[120:121]
v_pk_add_f32 v[146:147], v[146:147], v[122:123]
v_pk_add_f32 v[148:149], v[148:149], v[124:125]
v_pk_add_f32 v[150:151], v[150:151], v[126:127]
v_pk_add_f32 v[152:153], v[152:153], v[128:129]
v_add_f32 v154, v154, v130
ds_read_b128 v[120:123], v160 offset:12800
ds_read_b128 v[124:127], v160 offset:13312
ds_read_b128 v[128:131], v161 offset:12800
s_waitcnt lgkmcnt(6)
v_pk_add_f32 v[144:145], v[144:145], v[132:133]
v_pk_add_f32 v[146:147], v[146:147], v[134:135]
v_pk_add_f32 v[148:149], v[148:149], v[136:137]
v_pk_add_f32 v[150:151], v[150:151], v[138:139]
v_pk_add_f32 v[152:153], v[152:153], v[140:141]
v_add_f32 v154, v154, v142
ds_read_b128 v[132:135], v160 offset:15360
ds_read_b128 v[136:139], v160 offset:15872
ds_read_b128 v[140:143], v161 offset:15360
s_waitcnt lgkmcnt(6)
v_pk_add_f32 v[144:145], v[144:145], v[108:109]
v_pk_add_f32 v[146:147], v[146:147], v[110:111]
v_pk_add_f32 v[148:149], v[148:149], v[112:113]
v_pk_add_f32 v[150:151], v[150:151], v[114:115]
v_pk_add_f32 v[152:153], v[152:153], v[116:117]
v_add_f32 v154, v154, v118
ds_read_b128 v[108:111], v160 offset:17920
ds_read_b128 v[112:115], v160 offset:18432
ds_read_b128 v[116:119], v161 offset:17920
s_waitcnt lgkmcnt(6)
v_pk_add_f32 v[144:145], v[144:145], v[120:121]
v_pk_add_f32 v[146:147], v[146:147], v[122:123]
v_pk_add_f32 v[148:149], v[148:149], v[124:125]
v_pk_add_f32 v[150:151], v[150:151], v[126:127]
v_pk_add_f32 v[152:153], v[152:153], v[128:129]
v_add_f32 v154, v154, v130
s_waitcnt lgkmcnt(3)
v_pk_add_f32 v[144:145], v[144:145], v[132:133]
v_pk_add_f32 v[146:147], v[146:147], v[134:135]
v_pk_add_f32 v[148:149], v[148:149], v[136:137]
v_pk_add_f32 v[150:151], v[150:151], v[138:139]
v_pk_add_f32 v[152:153], v[152:153], v[140:141]
v_add_f32 v154, v154, v142
s_waitcnt lgkmcnt(0)
v_pk_add_f32 v[144:145], v[144:145], v[108:109]
v_pk_add_f32 v[146:147], v[146:147], v[110:111]
v_pk_add_f32 v[148:149], v[148:149], v[112:113]
v_pk_add_f32 v[150:151], v[150:151], v[114:115]
v_pk_add_f32 v[152:153], v[152:153], v[116:117]
v_add_f32 v154, v154, v118
v_rcp_f32 v154, v154
s_nop 0
v_mul_f32 v144, v144, v154
v_mul_f32 v145, v145, v154
v_mul_f32 v146, v146, v154
v_mul_f32 v147, v147, v154
v_mul_f32 v148, v148, v154
v_mul_f32 v149, v149, v154
v_mul_f32 v150, v150, v154
v_mul_f32 v151, v151, v154
v_mul_f32 v152, v152, v154
v_mul_f32 v153, v153, v154
v_cvt_pk_bf16_f32 v144, v144, v145
v_cvt_pk_bf16_f32 v145, v146, v147
v_cvt_pk_bf16_f32 v146, v148, v149
v_cvt_pk_bf16_f32 v147, v150, v151
v_cvt_pk_bf16_f32 v155, v152, v153
ds_write_b128 v157, v[144:147] offset:16384
v_lshlrev_b32 v160, 4, v162
v_lshrrev_b32 v161, 1, v163
v_lshl_add_u32 v160, v161, 2, v160
s_mov_b32 exec_lo, 0xffff
s_mov_b32 exec_hi, 0xffff
ds_write_b32 v160, v155 offset:19976
s_mov_b64 exec, 1
v_mov_b32 v160, 76
v_mov_b32 v161, 1
ds_write_b32 v160, v161
s_mov_b64 exec, -1
H1_sk20:
s_mul_i32 s46, s40, 36864
s_add_u32 s46, s46, 0x134400
s_add_u32 s58, s30, s46
s_addc_u32 s59, s31, 0
global_load_dwordx4 v[108:111], v157, s[58:59] offset:0
global_load_dwordx4 v[112:115], v157, s[58:59] offset:1024
global_load_dwordx4 v[116:119], v157, s[58:59] offset:2048
global_load_dwordx4 v[120:123], v157, s[58:59] offset:3072
s_add_u32 s58, s58, 4096
s_addc_u32 s59, s59, 0
global_load_dwordx4 v[124:127], v157, s[58:59] offset:0
global_load_dwordx4 v[128:131], v157, s[58:59] offset:1024
global_load_dwordx4 v[132:135], v157, s[58:59] offset:2048
global_load_dwordx4 v[136:139], v157, s[58:59] offset:3072
s_add_u32 s58, s58, 4096
s_addc_u32 s59, s59, 0
global_load_dwordx4 v[140:143], v157, s[58:59] offset:0
H1_sp22_re:
ds_read_b32 v159, v167 offset:76
s_waitcnt lgkmcnt(0)
v_cmp_ne_u32 vcc, 1, v159
s_cbranch_vccz H1_sp22_ok
s_add_u32 s52, s52, 1
s_cmp_gt_u32 s52, 200000
s_cbranch_scc1 H1_sp22_ok
s_sleep 4
s_branch H1_sp22_re
H1_sp22_ok:
ds_read_b128 v[144:147], v157 offset:16384
s_waitcnt lgkmcnt(0) vmcnt(0)
s_mul_i32 s46, s40, 294912
s_add_u32 s46, s46, 0xe3400
s_add_u32 s58, s30, s46
s_addc_u32 s59, s31, 0
s_waitcnt vmcnt(8)
v_mfma_f32_16x16x32_bf16 v[0:3], v[72:75], v[144:147], v[0:3]
global_load_dwordx4 v[72:75], v157, s[58:59] offset:0
s_waitcnt vmcnt(8)
v_mfma_f32_16x16x32_bf16 v[4:7], v[76:79], v[144:147], v[4:7]
global_load_dwordx4 v[76:79], v157, s[58:59] offset:1024
s_waitcnt vmcnt(8)
v_mfma_f32_16x16x32_bf16 v[8:11], v[80:83], v[144:147], v[8:11]
global_load_dwordx4 v[80:83], v157, s[58:59] offset:2048
s_waitcnt vmcnt(8)
v_mfma_f32_16x16x32_bf16 v[12:15], v[84:87], v[144:147], v[12:15]
global_load_dwordx4 v[84:87], v157, s[58:59] offset:3072
s_waitcnt vmcnt(8)
v_mfma_f32_16x16x32_bf16 v[16:19], v[88:91], v[144:147], v[16:19]
s_add_u32 s58, s58, 4096
s_addc_u32 s59, s59, 0
global_load_dwordx4 v[88:91], v157, s[58:59] offset:0
s_waitcnt vmcnt(8)
v_mfma_f32_16x16x32_bf16 v[20:23], v[92:95], v[144:147], v[20:23]
global_load_dwordx4 v[92:95], v157, s[58:59] offset:1024
s_waitcnt vmcnt(8)
v_mfma_f32_16x16x32_bf16 v[24:27], v[96:99], v[144:147], v[24:27]
global_load_dwordx4 v[96:99], v157, s[58:59] offset:2048
s_waitcnt vmcnt(8)
v_mfma_f32_16x16x32_bf16 v[28:31], v[100:103], v[144:147], v[28:31]
global_load_dwordx4 v[100:103], v157, s[58:59] offset:3072
s_waitcnt vmcnt(8)
v_mfma_f32_16x16x32_bf16 v[32:35], v[104:107], v[144:147], v[32:35]
s_add_u32 s58, s58, 4096
s_addc_u32 s59, s59, 0
global_load_dwordx4 v[104:107], v157, s[58:59] offset:0
H1_sp23_re:
ds_read_b32 v159, v167 offset:84
s_waitcnt lgkmcnt(0)
v_cmp_ne_u32 vcc, 1, v159
s_cbranch_vccz H1_sp23_ok
s_add_u32 s52, s52, 1
s_cmp_gt_u32 s52, 200000
s_cbranch_scc1 H1_sp23_ok
s_sleep 4
s_branch H1_sp23_re
H1_sp23_ok:
ds_read_b128 v[144:147], v157 offset:17408
s_waitcnt lgkmcnt(0)
s_waitcnt vmcnt(17)
v_mfma_f32_16x16x32_bf16 v[0:3], v[36:39], v[144:147], v[0:3]
s_waitcnt vmcnt(16)
v_mfma_f32_16x16x32_bf16 v[4:7], v[40:43], v[144:147], v[4:7]
s_waitcnt vmcnt(15)
v_mfma_f32_16x16x32_bf16 v[8:11], v[44:47], v[144:147], v[8:11]
s_waitcnt vmcnt(14)
v_mfma_f32_16x16x32_bf16 v[12:15], v[48:51], v[144:147], v[12:15]
s_waitcnt vmcnt(13)
v_mfma_f32_16x16x32_bf16 v[16:19], v[52:55], v[144:147], v[16:19]
s_waitcnt vmcnt(12)
v_mfma_f32_16x16x32_bf16 v[20:23], v[56:59], v[144:147], v[20:23]
s_waitcnt vmcnt(11)
v_mfma_f32_16x16x32_bf16 v[24:27], v[60:63], v[144:147], v[24:27]
s_waitcnt vmcnt(10)
v_mfma_f32_16x16x32_bf16 v[28:31], v[64:67], v[144:147], v[28:31]
s_waitcnt vmcnt(9)
v_mfma_f32_16x16x32_bf16 v[32:35], v[68:71], v[144:147], v[32:35]
H1_sp24_re:
ds_read_b32 v159, v167 offset:92
s_waitcnt lgkmcnt(0)
v_cmp_ne_u32 vcc, 1, v159
s_cbranch_vccz H1_sp24_ok
s_add_u32 s52, s52, 1
s_cmp_gt_u32 s52, 200000
s_cbranch_scc1 H1_sp24_ok
s_sleep 0
s_branch H1_sp24_re
H1_sp24_ok:
ds_read_b128 v[144:147], v157 offset:18432
ds_read_b128 v[148:151], v157 offset:19456
s_waitcnt lgkmcnt(0)
s_waitcnt vmcnt(0)
v_mov_b32 v161, 0xfffff000
v_add_u32 v160, 4096, v166
s_cmp_eq_u32 s71, 1
s_cbranch_scc1 H1_stl
v_mfma_f32_16x16x32_bf16 v[0:3], v[72:75], v[144:147], v[0:3]
v_mfma_f32_16x16x32_bf16 v[0:3], v[108:111], v[148:151], v[0:3]
v_mfma_f32_16x16x32_bf16 v[4:7], v[76:79], v[144:147], v[4:7]
v_mfma_f32_16x16x32_bf16 v[4:7], v[112:115], v[148:151], v[4:7]
v_mfma_f32_16x16x32_bf16 v[8:11], v[80:83], v[144:147], v[8:11]
v_mfma_f32_16x16x32_bf16 v[8:11], v[116:119], v[148:151], v[8:11]
s_nop 3
v_and_or_b32 v108, v0, v161, s62
v_and_or_b32 v109, v1, v161, s63
v_and_or_b32 v110, v2, v161, s64
v_and_or_b32 v111, v3, v161, s65
s_mov_b64 exec, s[56:57]
global_store_dwordx4 v166, v[108:111], s[48:49] offset:0 sc1
s_mov_b64 exec, -1
v_mfma_f32_16x16x32_bf16 v[12:15], v[84:87], v[144:147], v[12:15]
v_mfma_f32_16x16x32_bf16 v[12:15], v[120:123], v[148:151], v[12:15]
v_and_or_b32 v112, v4, v161, s62
v_and_or_b32 v113, v5, v161, s63
v_and_or_b32 v114, v6, v161, s64
v_and_or_b32 v115, v7, v161, s65
s_mov_b64 exec, s[56:57]
global_store_dwordx4 v166, v[112:115], s[48:49] offset:512 sc1
s_mov_b64 exec, -1
v_mfma_f32_16x16x32_bf16 v[16:19], v[88:91], v[144:147], v[16:19]
v_mfma_f32_16x16x32_bf16 v[16:19], v[124:127], v[148:151], v[16:19]
v_and_or_b32 v116, v8, v161, s62
v_and_or_b32 v117, v9, v161, s63
v_and_or_b32 v118, v10, v161, s64
v_and_or_b32 v119, v11, v161, s65
s_mov_b64 exec, s[56:57]
global_store_dwordx4 v166, v[116:119], s[48:49] offset:1024 sc1
s_mov_b64 exec, -1
v_mfma_f32_16x16x32_bf16 v[20:23], v[92:95], v[144:147], v[20:23]
v_mfma_f32_16x16x32_bf16 v[20:23], v[128:131], v[148:151], v[20:23]
v_and_or_b32 v120, v12, v161, s62
v_and_or_b32 v121, v13, v161, s63
v_and_or_b32 v122, v14, v161, s64
v_and_or_b32 v123, v15, v161, s65
s_mov_b64 exec, s[56:57]
global_store_dwordx4 v166, v[120:123], s[48:49] offset:1536 sc1
s_mov_b64 exec, -1
v_mfma_f32_16x16x32_bf16 v[24:27], v[96:99], v[144:147], v[24:27]
v_mfma_f32_16x16x32_bf16 v[24:27], v[132:135], v[148:151], v[24:27]
v_and_or_b32 v124, v16, v161, s62
v_and_or_b32 v125, v17, v161, s63
v_and_or_b32 v126, v18, v161, s64
v_and_or_b32 v127, v19, v161, s65
s_mov_b64 exec, s[56:57]
global_store_dwordx4 v166, v[124:127], s[48:49] offset:2048 sc1
s_mov_b64 exec, -1
v_mfma_f32_16x16x32_bf16 v[28:31], v[100:103], v[144:147], v[28:31]
v_mfma_f32_16x16x32_bf16 v[28:31], v[136:139], v[148:151], v[28:31]
v_and_or_b32 v128, v20, v161, s62
v_and_or_b32 v129, v21, v161, s63
v_and_or_b32 v130, v22, v161, s64
v_and_or_b32 v131, v23, v161, s65
s_mov_b64 exec, s[56:57]
global_store_dwordx4 v166, v[128:131], s[48:49] offset:2560 sc1
s_mov_b64 exec, -1
v_mfma_f32_16x16x32_bf16 v[32:35], v[104:107], v[144:147], v[32:35]
v_mfma_f32_16x16x32_bf16 v[32:35], v[140:143], v[148:151], v[32:35]
v_and_or_b32 v132, v24, v161, s62
v_and_or_b32 v133, v25, v161, s63
v_and_or_b32 v134, v26, v161, s64
v_and_or_b32 v135, v27, v161, s65
s_mov_b64 exec, s[56:57]
global_store_dwordx4 v166, v[132:135], s[48:49] offset:3072 sc1
s_mov_b64 exec, -1
v_and_or_b32 v136, v28, v161, s62
v_and_or_b32 v137, v29, v161, s63
v_and_or_b32 v138, v30, v161, s64
v_and_or_b32 v139, v31, v161, s65
s_mov_b64 exec, s[56:57]
global_store_dwordx4 v166, v[136:139], s[48:49] offset:3584 sc1
s_mov_b64 exec, -1
v_and_or_b32 v140, v32, v161, s62
v_and_or_b32 v141, v33, v161, s63
v_and_or_b32 v142, v34, v161, s64
v_and_or_b32 v143, v35, v161, s65
s_mov_b64 exec, s[56:57]
global_store_dwordx4 v160, v[140:143], s[48:49] sc1
s_mov_b64 exec, -1
s_branch H1_std
H1_stl:
v_mfma_f32_16x16x32_bf16 v[0:3], v[72:75], v[144:147], v[0:3]
v_mfma_f32_16x16x32_bf16 v[0:3], v[108:111], v[148:151], v[0:3]
v_mfma_f32_16x16x32_bf16 v[4:7], v[76:79], v[144:147], v[4:7]
v_mfma_f32_16x16x32_bf16 v[4:7], v[112:115], v[148:151], v[4:7]
v_mfma_f32_16x16x32_bf16 v[8:11], v[80:83], v[144:147], v[8:11]
v_mfma_f32_16x16x32_bf16 v[8:11], v[116:119], v[148:151], v[8:11]
s_nop 3
v_and_or_b32 v108, v0, v161, s62
v_and_or_b32 v109, v1, v161, s63
v_and_or_b32 v110, v2, v161, s64
v_and_or_b32 v111, v3, v161, s65
s_mov_b64 exec, s[56:57]
global_store_dwordx4 v166, v[108:111], s[48:49] offset:0
s_mov_b64 exec, -1
v_mfma_f32_16x16x32_bf16 v[12:15], v[84:87], v[144:147], v[12:15]
v_mfma_f32_16x16x32_bf16 v[12:15], v[120:123], v[148:151], v[12:15]
v_and_or_b32 v112, v4, v161, s62
v_and_or_b32 v113, v5, v161, s63
v_and_or_b32 v114, v6, v161, s64
v_and_or_b32 v115, v7, v161, s65
s_mov_b64 exec, s[56:57]
global_store_dwordx4 v166, v[112:115], s[48:49] offset:512
s_mov_b64 exec, -1
v_mfma_f32_16x16x32_bf16 v[16:19], v[88:91], v[144:147], v[16:19]
v_mfma_f32_16x16x32_bf16 v[16:19], v[124:127], v[148:151], v[16:19]
v_and_or_b32 v116, v8, v161, s62
v_and_or_b32 v117, v9, v161, s63
v_and_or_b32 v118, v10, v161, s64
v_and_or_b32 v119, v11, v161, s65
s_mov_b64 exec, s[56:57]
global_store_dwordx4 v166, v[116:119], s[48:49] offset:1024
s_mov_b64 exec, -1
v_mfma_f32_16x16x32_bf16 v[20:23], v[92:95], v[144:147], v[20:23]
v_mfma_f32_16x16x32_bf16 v[20:23], v[128:131], v[148:151], v[20:23]
v_and_or_b32 v120, v12, v161, s62
v_and_or_b32 v121, v13, v161, s63
v_and_or_b32 v122, v14, v161, s64
v_and_or_b32 v123, v15, v161, s65
s_mov_b64 exec, s[56:57]
global_store_dwordx4 v166, v[120:123], s[48:49] offset:1536
s_mov_b64 exec, -1
v_mfma_f32_16x16x32_bf16 v[24:27], v[96:99], v[144:147], v[24:27]
v_mfma_f32_16x16x32_bf16 v[24:27], v[132:135], v[148:151], v[24:27]
v_and_or_b32 v124, v16, v161, s62
v_and_or_b32 v125, v17, v161, s63
v_and_or_b32 v126, v18, v161, s64
v_and_or_b32 v127, v19, v161, s65
s_mov_b64 exec, s[56:57]
global_store_dwordx4 v166, v[124:127], s[48:49] offset:2048
s_mov_b64 exec, -1
v_mfma_f32_16x16x32_bf16 v[28:31], v[100:103], v[144:147], v[28:31]
v_mfma_f32_16x16x32_bf16 v[28:31], v[136:139], v[148:151], v[28:31]
v_and_or_b32 v128, v20, v161, s62
v_and_or_b32 v129, v21, v161, s63
v_and_or_b32 v130, v22, v161, s64
v_and_or_b32 v131, v23, v161, s65
s_mov_b64 exec, s[56:57]
global_store_dwordx4 v166, v[128:131], s[48:49] offset:2560
s_mov_b64 exec, -1
v_mfma_f32_16x16x32_bf16 v[32:35], v[104:107], v[144:147], v[32:35]
v_mfma_f32_16x16x32_bf16 v[32:35], v[140:143], v[148:151], v[32:35]
v_and_or_b32 v132, v24, v161, s62
v_and_or_b32 v133, v25, v161, s63
v_and_or_b32 v134, v26, v161, s64
v_and_or_b32 v135, v27, v161, s65
s_mov_b64 exec, s[56:57]
global_store_dwordx4 v166, v[132:135], s[48:49] offset:3072
s_mov_b64 exec, -1
v_and_or_b32 v136, v28, v161, s62
v_and_or_b32 v137, v29, v161, s63
v_and_or_b32 v138, v30, v161, s64
v_and_or_b32 v139, v31, v161, s65
s_mov_b64 exec, s[56:57]
global_store_dwordx4 v166, v[136:139], s[48:49] offset:3584
s_mov_b64 exec, -1
v_and_or_b32 v140, v32, v161, s62
v_and_or_b32 v141, v33, v161, s63
v_and_or_b32 v142, v34, v161, s64
v_and_or_b32 v143, v35, v161, s65
s_mov_b64 exec, s[56:57]
global_store_dwordx4 v160, v[140:143], s[48:49]
s_mov_b64 exec, -1
H1_std:
s_mov_b64 exec, s[54:55]
s_mov_b32 s52, 0
global_load_dwordx4 v[36:39], v166, s[66:67] offset:0 sc1
global_load_dwordx4 v[40:43], v166, s[66:67] offset:512 sc1
global_load_dwordx4 v[44:47], v166, s[66:67] offset:1024 sc1
global_load_dwordx4 v[48:51], v166, s[66:67] offset:1536 sc1
global_load_dwordx4 v[52:55], v166, s[66:67] offset:2048 sc1
global_load_dwordx4 v[56:59], v166, s[66:67] offset:2560 sc1
global_load_dwordx4 v[60:63], v166, s[66:67] offset:3072 sc1
global_load_dwordx4 v[64:67], v166, s[66:67] offset:3584 sc1
global_load_dwordx4 v[68:71], v160, s[66:67] sc1
ds_write_b128 v156, v[0:3] offset:0
ds_write_b128 v156, v[4:7] offset:64
ds_write_b128 v156, v[8:11] offset:128
ds_write_b128 v156, v[12:15] offset:192
ds_write_b128 v156, v[16:19] offset:256
ds_write_b128 v156, v[20:23] offset:320
ds_write_b128 v156, v[24:27] offset:384
ds_write_b128 v156, v[28:31] offset:448
ds_write_b128 v156, v[32:35] offset:512
H1_poll:
s_waitcnt vmcnt(0)
v_mov_b32 v158, 0
v_bitop3_b32 v158, v36, s62, v158 bitop3:0xbe
v_bitop3_b32 v158, v37, s63, v158 bitop3:0xbe
v_bitop3_b32 v158, v38, s64, v158 bitop3:0xbe
v_bitop3_b32 v158, v39, s65, v158 bitop3:0xbe
v_bitop3_b32 v158, v40, s62, v158 bitop3:0xbe
v_bitop3_b32 v158, v41, s63, v158 bitop3:0xbe
v_bitop3_b32 v158, v42, s64, v158 bitop3:0xbe
v_bitop3_b32 v158, v43, s65, v158 bitop3:0xbe
v_bitop3_b32 v158, v44, s62, v158 bitop3:0xbe
v_bitop3_b32 v158, v45, s63, v158 bitop3:0xbe
v_bitop3_b32 v158, v46, s64, v158 bitop3:0xbe
v_bitop3_b32 v158, v47, s65, v158 bitop3:0xbe
v_bitop3_b32 v158, v48, s62, v158 bitop3:0xbe
v_bitop3_b32 v158, v49, s63, v158 bitop3:0xbe
v_bitop3_b32 v158, v50, s64, v158 bitop3:0xbe
v_bitop3_b32 v158, v51, s65, v158 bitop3:0xbe
v_bitop3_b32 v158, v52, s62, v158 bitop3:0xbe
v_bitop3_b32 v158, v53, s63, v158 bitop3:0xbe
v_bitop3_b32 v158, v54, s64, v158 bitop3:0xbe
v_bitop3_b32 v158, v55, s65, v158 bitop3:0xbe
v_bitop3_b32 v158, v56, s62, v158 bitop3:0xbe
v_bitop3_b32 v158, v57, s63, v158 bitop3:0xbe
v_bitop3_b32 v158, v58, s64, v158 bitop3:0xbe
v_bitop3_b32 v158, v59, s65, v158 bitop3:0xbe
v_bitop3_b32 v158, v60, s62, v158 bitop3:0xbe
v_bitop3_b32 v158, v61, s63, v158 bitop3:0xbe
v_bitop3_b32 v158, v62, s64, v158 bitop3:0xbe
v_bitop3_b32 v158, v63, s65, v158 bitop3:0xbe
v_bitop3_b32 v158, v64, s62, v158 bitop3:0xbe
v_bitop3_b32 v158, v65, s63, v158 bitop3:0xbe
v_bitop3_b32 v158, v66, s64, v158 bitop3:0xbe
v_bitop3_b32 v158, v67, s65, v158 bitop3:0xbe
v_bitop3_b32 v158, v68, s62, v158 bitop3:0xbe
v_bitop3_b32 v158, v69, s63, v158 bitop3:0xbe
v_bitop3_b32 v158, v70, s64, v158 bitop3:0xbe
v_bitop3_b32 v158, v71, s65, v158 bitop3:0xbe
v_and_b32 v158, 0xfff, v158
v_cmp_ne_u32 vcc, 0, v158
s_cbranch_vccz H1_pollok
s_add_u32 s52, s52, 1
s_cmp_gt_u32 s52, 20000
s_cbranch_scc1 H1_pollok
global_load_dwordx4 v[36:39], v166, s[66:67] offset:0 sc1
global_load_dwordx4 v[40:43], v166, s[66:67] offset:512 sc1
global_load_dwordx4 v[44:47], v166, s[66:67] offset:1024 sc1
global_load_dwordx4 v[48:51], v166, s[66:67] offset:1536 sc1
global_load_dwordx4 v[52:55], v166, s[66:67] offset:2048 sc1
global_load_dwordx4 v[56:59], v166, s[66:67] offset:2560 sc1
global_load_dwordx4 v[60:63], v166, s[66:67] offset:3072 sc1
global_load_dwordx4 v[64:67], v166, s[66:67] offset:3584 sc1
global_load_dwordx4 v[68:71], v160, s[66:67] sc1
s_branch H1_poll
H1_pollok:
v_add_u32 v156, 18560, v156
ds_write_b128 v156, v[36:39] offset:0
ds_write_b128 v156, v[40:43] offset:64
ds_write_b128 v156, v[44:47] offset:128
ds_write_b128 v156, v[48:51] offset:192
ds_write_b128 v156, v[52:55] offset:256
ds_write_b128 v156, v[56:59] offset:320
ds_write_b128 v156, v[60:63] offset:384
ds_write_b128 v156, v[64:67] offset:448
ds_write_b128 v156, v[68:71] offset:512
s_mov_b64 exec, -1
s_waitcnt lgkmcnt(0)
s_barrier
s_cmp_eq_u32 s33, 1
s_cbranch_scc1 L_hfin1
v_mbcnt_lo_u32_b32 v165, -1, 0
v_mbcnt_hi_u32_b32 v165, -1, v165
v_mov_b32 v104, 0
v_mov_b32 v105, 0
v_mov_b32 v106, 0
v_mov_b32 v107, 0
v_lshlrev_b32 v161, 4, v165
ds_write_b128 v161, v[104:107]
v_lshlrev_b32 v160, 3, v165
v_mov_b32 v104, 1
s_mov_b64 exec, 0xf
ds_write_b32 v160, v104 offset:4
v_mov_b32 v104, 2
s_mov_b64 exec, 1
ds_write_b32 v160, v104 offset:64
s_mov_b64 exec, -1
v_mov_b32 v104, 0xff800000
v_mov_b32 v105, 0xff800000
v_mov_b32 v106, 0xff800000
v_mov_b32 v107, 0xff800000
ds_write_b128 v161, v[104:107] offset:1024
s_waitcnt lgkmcnt(0)
s_mov_b32 s33, 1
s_mul_i32 s34, s33, 0x240000
s_add_u32 s34, s34, 0x200000
s_mul_i32 s35, s33, 0x10000
s_add_u32 s35, s35, 0x680000
s_mul_i32 s36, s33, 0x4000
s_add_u32 s36, s36, 0x6a0000
s_mul_i32 s37, s33, 0x14000
s_add_u32 s37, s37, 0x6b0000
s_mul_i32 s38, s33, 0x800
s_add_u32 s38, s38, 0x6d8000
s_mul_i32 s39, s33, 0x900000
s_add_u32 s39, s39, 0xe00000
v_mbcnt_lo_u32_b32 v156, -1, 0
v_mbcnt_hi_u32_b32 v156, -1, v156
v_lshlrev_b32 v157, 4, v156
v_mov_b32 v167, 0
s_mul_i32 s46, s40, 294912
s_add_u32 s46, s46, 0x4800
s_add_u32 s44, s30, s46
s_addc_u32 s45, s31, 0
global_load_dwordx4 v[0:3], v157, s[44:45] offset:0
global_load_dwordx4 v[4:7], v157, s[44:45] offset:1024
global_load_dwordx4 v[8:11], v157, s[44:45] offset:2048
global_load_dwordx4 v[12:15], v157, s[44:45] offset:3072
s_add_u32 s44, s44, 4096
s_addc_u32 s45, s45, 0
global_load_dwordx4 v[16:19], v157, s[44:45] offset:0
global_load_dwordx4 v[20:23], v157, s[44:45] offset:1024
global_load_dwordx4 v[24:27], v157, s[44:45] offset:2048
global_load_dwordx4 v[28:31], v157, s[44:45] offset:3072
s_add_u32 s44, s44, 4096
s_addc_u32 s45, s45, 0
global_load_dwordx4 v[32:35], v157, s[44:45] offset:0
global_load_dwordx4 v[36:39], v157, s[44:45] offset:1024
global_load_dwordx4 v[40:43], v157, s[44:45] offset:2048
global_load_dwordx4 v[44:47], v157, s[44:45] offset:3072
s_add_u32 s44, s44, 4096
s_addc_u32 s45, s45, 0
global_load_dwordx4 v[48:51], v157, s[44:45] offset:0
global_load_dwordx4 v[52:55], v157, s[44:45] offset:1024
global_load_dwordx4 v[56:59], v157, s[44:45] offset:2048
global_load_dwordx4 v[60:63], v157, s[44:45] offset:3072
s_add_u32 s44, s44, 4096
s_addc_u32 s45, s45, 0
global_load_dwordx4 v[64:67], v157, s[44:45] offset:0
global_load_dwordx4 v[68:71], v157, s[44:45] offset:1024
s_add_u32 s46, 0, 0x6dc000
s_add_u32 s48, s30, s46
s_addc_u32 s49, s31, 0
s_load_dwordx2 s[60:61], s[48:49], 0
s_barrier
v_and_b32 v162, 15, v156
v_lshrrev_b32 v163, 4, v156
v_lshrrev_b32 v165, 1, v163
v_lshlrev_b32 v165, 8, v165
v_lshl_add_u32 v165, v162, 4, v165
v_and_b32 v164, 1, v163
v_lshlrev_b32 v164, 10, v164
v_add_u32 v164, v164, v165
v_add_u32 v165, 2048, v165
v_lshrrev_b32 v166, 1, v163
v_lshlrev_b32 v166, 9, v166
v_lshl_add_u32 v166, v162, 4, v166
v_and_b32 v160, 1, v163
v_lshl_add_u32 v166, v160, 3, v166
s_waitcnt lgkmcnt(0)
s_add_u32 s50, s60, 32
s_and_b32 s51, s61, 0xffff
s_lshl_b32 s51, s51, 8
s_mov_b32 s52, 0
H1_pl_re:
v_mov_b32 v158, 158888
ds_read_b32 v159, v158
s_waitcnt lgkmcnt(0)
v_cmp_ne_u32 vcc, 1, v159
s_cbranch_vccz H1_pl_ok
s_add_u32 s52, s52, 1
s_cmp_gt_u32 s52, 200000
s_cbranch_scc1 H1_pl_ok
s_sleep 4
s_branch H1_pl_re
H1_pl_ok:
s_lshr_b32 s41, s2, 1
s_mul_i32 s41, s41, 18432
s_add_u32 s41, s41, s34
s_cmp_eq_u32 s40, 0
s_mov_b32 s46, 0x00ff00ff
s_cselect_b32 s46, 0xff00ff00, s46
s_mov_b32 exec_lo, s46
s_mov_b32 exec_hi, s46
s_add_u32 s46, s41, 1024
s_add_u32 s42, s30, s46
s_addc_u32 s43, s31, 0
s_mov_b32 m0, 21504
s_nop 0
global_load_lds_dwordx4 v157, s[42:43] sc1
s_add_u32 s46, s41, 5120
s_add_u32 s42, s30, s46
s_addc_u32 s43, s31, 0
s_mov_b32 m0, 25600
s_nop 0
global_load_lds_dwordx4 v157, s[42:43] sc1
s_add_u32 s46, s41, 9216
s_add_u32 s42, s30, s46
s_addc_u32 s43, s31, 0
s_mov_b32 m0, 29696
s_nop 0
global_load_lds_dwordx4 v157, s[42:43] sc1
s_add_u32 s46, s41, 13312
s_add_u32 s42, s30, s46
s_addc_u32 s43, s31, 0
s_mov_b32 m0, 33792
s_nop 0
global_load_lds_dwordx4 v157, s[42:43] sc1
s_add_u32 s46, s41, 17408
s_add_u32 s42, s30, s46
s_addc_u32 s43, s31, 0
s_mov_b32 m0, 37888
s_nop 0
global_load_lds_dwordx4 v157, s[42:43] sc1
s_mov_b64 exec, -1
s_waitcnt vmcnt(0)
s_branch H1_tags
L_hfin1:
s_endpgm
L_h2:
s_setprio 3
s_mov_b32 s68, 0x80808080
s_mov_b32 s69, 0x80808080
s_mov_b32 s70, 0x45800000
v_mbcnt_lo_u32_b32 v156, -1, 0
v_mbcnt_hi_u32_b32 v156, -1, v156
v_lshlrev_b32 v157, 4, v156
v_mov_b32 v167, 0
s_and_b32 s40, s2, 1
s_lshr_b32 s41, s2, 1
s_mul_i32 s41, s41, 18432
s_add_u32 s41, s41, s34
s_add_u32 s46, s41, 2048
s_add_u32 s42, s30, s46
s_addc_u32 s43, s31, 0
s_mov_b32 m0, 22528
s_nop 0
global_load_lds_dwordx4 v157, s[42:43]
s_add_u32 s46, s41, 6144
s_add_u32 s42, s30, s46
s_addc_u32 s43, s31, 0
s_mov_b32 m0, 26624
s_nop 0
global_load_lds_dwordx4 v157, s[42:43]
s_add_u32 s46, s41, 10240
s_add_u32 s42, s30, s46
s_addc_u32 s43, s31, 0
s_mov_b32 m0, 30720
s_nop 0
global_load_lds_dwordx4 v157, s[42:43]
s_add_u32 s46, s41, 14336
s_add_u32 s42, s30, s46
s_addc_u32 s43, s31, 0
s_mov_b32 m0, 34816
s_nop 0
global_load_lds_dwordx4 v157, s[42:43]
s_mul_i32 s46, s40, 36864
s_add_u32 s46, s46, 0x90000
s_add_u32 s44, s30, s46
s_addc_u32 s45, s31, 0
global_load_dwordx4 v[0:3], v157, s[44:45] offset:0
global_load_dwordx4 v[4:7], v157, s[44:45] offset:1024
global_load_dwordx4 v[8:11], v157, s[44:45] offset:2048
global_load_dwordx4 v[12:15], v157, s[44:45] offset:3072
s_add_u32 s44, s44, 4096
s_addc_u32 s45, s45, 0
global_load_dwordx4 v[16:19], v157, s[44:45] offset:0
global_load_dwordx4 v[20:23], v157, s[44:45] offset:1024
global_load_dwordx4 v[24:27], v157, s[44:45] offset:2048
global_load_dwordx4 v[28:31], v157, s[44:45] offset:3072
s_add_u32 s44, s44, 4096
s_addc_u32 s45, s45, 0
global_load_dwordx4 v[32:35], v157, s[44:45] offset:0
global_load_dwordx4 v[36:39], v157, s[44:45] offset:1024
global_load_dwordx4 v[40:43], v157, s[44:45] offset:2048
global_load_dwordx4 v[44:47], v157, s[44:45] offset:3072
s_add_u32 s44, s44, 4096
s_addc_u32 s45, s45, 0
global_load_dwordx4 v[48:51], v157, s[44:45] offset:0
global_load_dwordx4 v[52:55], v157, s[44:45] offset:1024
global_load_dwordx4 v[56:59], v157, s[44:45] offset:2048
global_load_dwordx4 v[60:63], v157, s[44:45] offset:3072
s_add_u32 s44, s44, 4096
s_addc_u32 s45, s45, 0
global_load_dwordx4 v[64:67], v157, s[44:45] offset:0
global_load_dwordx4 v[68:71], v157, s[44:45] offset:1024
s_add_u32 s46, 0, 0x6dc000
s_add_u32 s48, s30, s46
s_addc_u32 s49, s31, 0
s_load_dwordx2 s[60:61], s[48:49], 0
v_mov_b32 v159, 1
v_mov_b32 v158, 2
ds_write_b8 v158, v159 offset:528
v_and_b32 v162, 15, v156
v_lshrrev_b32 v163, 4, v156
v_lshrrev_b32 v165, 1, v163
v_lshlrev_b32 v165, 8, v165
v_lshl_add_u32 v165, v162, 4, v165
v_and_b32 v164, 1, v163
v_lshlrev_b32 v164, 10, v164
v_add_u32 v164, v164, v165
v_add_u32 v165, 2048, v165
v_lshrrev_b32 v166, 1, v163
v_lshlrev_b32 v166, 9, v166
v_lshl_add_u32 v166, v162, 4, v166
v_and_b32 v160, 1, v163
v_lshl_add_u32 v166, v160, 3, v166
s_waitcnt vmcnt(18) lgkmcnt(0)
H2_tags:
s_add_u32 s60, s60, s33
s_add_u32 s60, s60, 1
s_and_b32 s62, s60, 0xfff
s_lshr_b32 s63, s60, 12
s_and_b32 s63, s63, 0xfff
s_lshr_b64 s[64:65], s[60:61], 24
s_lshr_b32 s65, s64, 12
s_and_b32 s64, s64, 0xfff
s_and_b32 s65, s65, 0xfff
v_mov_b32 v159, 1
s_mov_b64 exec, 1
ds_add_u32 v167, v159 offset:592
s_mov_b64 exec, -1
s_getreg_b32 s71, hwreg(HW_REG_XCC_ID, 0, 4)
s_and_b32 s61, s61, 0xffff
s_lshl_b32 s61, s61, 8
s_or_b32 s61, s61, s71
s_mov_b32 s52, 0
H2_sp1_re:
ds_read_b32 v159, v167 offset:592
s_waitcnt lgkmcnt(0)
v_cmp_ne_u32 vcc, 4, v159
s_cbranch_vccz H2_sp1_ok
s_add_u32 s52, s52, 1
s_cmp_gt_u32 s52, 200000
s_cbranch_scc1 H2_sp1_ok
s_sleep 0
s_branch H2_sp1_re
H2_sp1_ok:
ds_read_b128 v[72:75], v157 offset:20480
ds_read_b128 v[76:79], v157 offset:21504
ds_read_b128 v[80:83], v157 offset:22528
ds_read_b128 v[84:87], v157 offset:23552
ds_read_b128 v[88:91], v157 offset:24576
ds_read_b128 v[92:95], v157 offset:25600
ds_read_b128 v[96:99], v157 offset:26624
ds_read_b128 v[100:103], v157 offset:27648
ds_read_b128 v[104:107], v157 offset:28672
s_waitcnt lgkmcnt(0)
ds_read_b128 v[108:111], v157 offset:29696
ds_read_b128 v[112:115], v157 offset:30720
ds_read_b128 v[116:119], v157 offset:31744
ds_read_b128 v[120:123], v157 offset:32768
ds_read_b128 v[124:127], v157 offset:33792
ds_read_b128 v[128:131], v157 offset:34816
ds_read_b128 v[132:135], v157 offset:35840
ds_read_b128 v[136:139], v157 offset:36864
ds_read_b128 v[140:143], v157 offset:37888
s_waitcnt lgkmcnt(0)
s_waitcnt vmcnt(17)
v_mfma_f32_16x16x32_bf16 v[144:147], v[0:3], v[72:75], 0
s_waitcnt vmcnt(16)
v_mfma_f32_16x16x32_bf16 v[144:147], v[4:7], v[76:79], v[144:147]
s_waitcnt vmcnt(15)
v_mfma_f32_16x16x32_bf16 v[144:147], v[8:11], v[80:83], v[144:147]
s_waitcnt vmcnt(14)
v_mfma_f32_16x16x32_bf16 v[144:147], v[12:15], v[84:87], v[144:147]
s_waitcnt vmcnt(13)
v_mfma_f32_16x16x32_bf16 v[144:147], v[16:19], v[88:91], v[144:147]
s_waitcnt vmcnt(12)
v_mfma_f32_16x16x32_bf16 v[144:147], v[20:23], v[92:95], v[144:147]
s_waitcnt vmcnt(11)
v_mfma_f32_16x16x32_bf16 v[144:147], v[24:27], v[96:99], v[144:147]
s_waitcnt vmcnt(10)
v_mfma_f32_16x16x32_bf16 v[144:147], v[28:31], v[100:103], v[144:147]
s_waitcnt vmcnt(9)
v_mfma_f32_16x16x32_bf16 v[144:147], v[32:35], v[104:107], v[144:147]
s_waitcnt vmcnt(8)
v_mfma_f32_16x16x32_bf16 v[144:147], v[36:39], v[108:111], v[144:147]
s_waitcnt vmcnt(7)
v_mfma_f32_16x16x32_bf16 v[144:147], v[40:43], v[112:115], v[144:147]
s_waitcnt vmcnt(6)
v_mfma_f32_16x16x32_bf16 v[144:147], v[44:47], v[116:119], v[144:147]
s_waitcnt vmcnt(5)
v_mfma_f32_16x16x32_bf16 v[144:147], v[48:51], v[120:123], v[144:147]
s_waitcnt vmcnt(4)
v_mfma_f32_16x16x32_bf16 v[144:147], v[52:55], v[124:127], v[144:147]
s_waitcnt vmcnt(3)
v_mfma_f32_16x16x32_bf16 v[144:147], v[56:59], v[128:131], v[144:147]
s_waitcnt vmcnt(2)
v_mfma_f32_16x16x32_bf16 v[144:147], v[60:63], v[132:135], v[144:147]
s_waitcnt vmcnt(1)
v_mfma_f32_16x16x32_bf16 v[144:147], v[64:67], v[136:139], v[144:147]
s_waitcnt vmcnt(0)
v_mfma_f32_16x16x32_bf16 v[144:147], v[68:71], v[140:143], v[144:147]
s_nop 7
v_mul_f32 v144, 0x3eae1a93, v144
v_mul_f32 v145, 0x3eae1a93, v145
v_mul_f32 v146, 0x3eae1a93, v146
v_mul_f32 v147, 0x3eae1a93, v147
v_mul_f32 v158, v144, v144
v_fmac_f32 v158, v145, v145
v_mul_f32 v159, v146, v146
v_fmac_f32 v159, v147, v147
v_max_f32 v158, v158, v159
v_cvt_pk_bf16_f32 v144, v144, v145
v_cvt_pk_bf16_f32 v145, v146, v147
v_lshlrev_b32 v159, 7, v163
v_lshl_add_u32 v159, v162, 2, v159
v_add_u32 v159, 10240, v159
ds_write2_b32 v159, v144, v145 offset0:0 offset1:16
v_lshlrev_b32 v159, 4, v163
v_mov_b32 v160, 1
ds_max_u32 v159, v158 offset:136
s_mov_b64 exec, 1
ds_write_b32 v167, v160 offset:576
ds_write_b32 v167, v160 offset:596
s_mov_b64 exec, -1
H2_sp2_re:
ds_read_b32 v159, v167 offset:8
s_waitcnt lgkmcnt(0)
v_cmp_eq_u32 vcc, 0, v159
s_cbranch_vccz H2_sp2_ok
s_add_u32 s52, s52, 1
s_cmp_gt_u32 s52, 200000
s_cbranch_scc1 H2_sp2_ok
s_sleep 2
s_branch H2_sp2_re
H2_sp2_ok:
s_mul_i32 s46, s40, 294912
s_add_u32 s46, s46, 0x16800
s_add_u32 s44, s30, s46
s_addc_u32 s45, s31, 0
global_load_dwordx4 v[0:3], v157, s[44:45] offset:0
global_load_dwordx4 v[4:7], v157, s[44:45] offset:1024
global_load_dwordx4 v[8:11], v157, s[44:45] offset:2048
global_load_dwordx4 v[12:15], v157, s[44:45] offset:3072
s_add_u32 s44, s44, 4096
s_addc_u32 s45, s45, 0
global_load_dwordx4 v[16:19], v157, s[44:45] offset:0
global_load_dwordx4 v[20:23], v157, s[44:45] offset:1024
global_load_dwordx4 v[24:27], v157, s[44:45] offset:2048
global_load_dwordx4 v[28:31], v157, s[44:45] offset:3072
s_add_u32 s44, s44, 4096
s_addc_u32 s45, s45, 0
global_load_dwordx4 v[32:35], v157, s[44:45] offset:0
global_load_dwordx4 v[36:39], v157, s[44:45] offset:1024
global_load_dwordx4 v[40:43], v157, s[44:45] offset:2048
global_load_dwordx4 v[44:47], v157, s[44:45] offset:3072
s_add_u32 s44, s44, 4096
s_addc_u32 s45, s45, 0
global_load_dwordx4 v[48:51], v157, s[44:45] offset:0
global_load_dwordx4 v[52:55], v157, s[44:45] offset:1024
global_load_dwordx4 v[56:59], v157, s[44:45] offset:2048
global_load_dwordx4 v[60:63], v157, s[44:45] offset:3072
s_add_u32 s44, s44, 4096
s_addc_u32 s45, s45, 0
global_load_dwordx4 v[64:67], v157, s[44:45] offset:0
global_load_dwordx4 v[68:71], v157, s[44:45] offset:1024
s_waitcnt vmcnt(17)
v_mfma_f32_16x16x32_bf16 v[144:147], v[0:3], v[72:75], 0
s_waitcnt vmcnt(16)
v_mfma_f32_16x16x32_bf16 v[144:147], v[4:7], v[76:79], v[144:147]
s_waitcnt vmcnt(15)
v_mfma_f32_16x16x32_bf16 v[144:147], v[8:11], v[80:83], v[144:147]
s_waitcnt vmcnt(14)
v_mfma_f32_16x16x32_bf16 v[144:147], v[12:15], v[84:87], v[144:147]
s_waitcnt vmcnt(13)
v_mfma_f32_16x16x32_bf16 v[144:147], v[16:19], v[88:91], v[144:147]
s_waitcnt vmcnt(12)
v_mfma_f32_16x16x32_bf16 v[144:147], v[20:23], v[92:95], v[144:147]
s_waitcnt vmcnt(11)
v_mfma_f32_16x16x32_bf16 v[144:147], v[24:27], v[96:99], v[144:147]
s_waitcnt vmcnt(10)
v_mfma_f32_16x16x32_bf16 v[144:147], v[28:31], v[100:103], v[144:147]
s_waitcnt vmcnt(9)
v_mfma_f32_16x16x32_bf16 v[144:147], v[32:35], v[104:107], v[144:147]
s_waitcnt vmcnt(8)
v_mfma_f32_16x16x32_bf16 v[144:147], v[36:39], v[108:111], v[144:147]
s_waitcnt vmcnt(7)
v_mfma_f32_16x16x32_bf16 v[144:147], v[40:43], v[112:115], v[144:147]
s_waitcnt vmcnt(6)
v_mfma_f32_16x16x32_bf16 v[144:147], v[44:47], v[116:119], v[144:147]
s_waitcnt vmcnt(5)
v_mfma_f32_16x16x32_bf16 v[144:147], v[48:51], v[120:123], v[144:147]
s_waitcnt vmcnt(4)
v_mfma_f32_16x16x32_bf16 v[144:147], v[52:55], v[124:127], v[144:147]
s_waitcnt vmcnt(3)
v_mfma_f32_16x16x32_bf16 v[144:147], v[56:59], v[128:131], v[144:147]
s_waitcnt vmcnt(2)
v_mfma_f32_16x16x32_bf16 v[144:147], v[60:63], v[132:135], v[144:147]
s_waitcnt vmcnt(1)
v_mfma_f32_16x16x32_bf16 v[144:147], v[64:67], v[136:139], v[144:147]
s_waitcnt vmcnt(0)
v_mfma_f32_16x16x32_bf16 v[144:147], v[68:71], v[140:143], v[144:147]
s_nop 7
v_mul_f32 v144, 0x3eae1a93, v144
v_mul_f32 v145, 0x3eae1a93, v145
v_mul_f32 v146, 0x3eae1a93, v146
v_mul_f32 v147, 0x3eae1a93, v147
v_mul_f32 v158, v144, v144
v_fmac_f32 v158, v145, v145
v_fmac_f32 v158, v146, v146
v_fmac_f32 v158, v147, v147
v_cvt_pk_bf16_f32 v144, v144, v145
v_cvt_pk_bf16_f32 v145, v146, v147
ds_write_b64 v166, v[144:145] offset:4352
v_mov_b32 v160, v158
s_nop 1
v_permlane16_swap_b32 v158, v160
v_add_f32 v158, v158, v160
v_mov_b32 v160, v158
s_nop 1
v_permlane32_swap_b32 v158, v160
v_add_f32 v158, v158, v160
v_mov_b32 v160, 1
s_mov_b64 exec, 0xffff
ds_max_u32 v167, v158 offset:164
s_mov_b64 exec, 1
ds_add_rtn_u32 v159, v167, v160 offset:160
s_mov_b64 exec, -1
s_waitcnt lgkmcnt(0)
v_readfirstlane_b32 s50, v159
s_cmp_eq_u32 s50, 1
s_cbranch_scc0 H2_nf3
H2_sp4_re:
ds_read_b64 v[148:149], v167 offset:520
s_waitcnt lgkmcnt(0)
v_cmp_ne_u64 vcc, s[68:69], v[148:149]
s_cbranch_vccz H2_sp4_ok
s_add_u32 s52, s52, 1
s_cmp_gt_u32 s52, 200000
s_cbranch_scc1 H2_sp4_ok
s_sleep 1
s_branch H2_sp4_re
H2_sp4_ok:
H2_fz5_re:
ds_read_b128 v[148:151], v167 offset:576
ds_read_b128 v[152:155], v167 offset:160
s_waitcnt lgkmcnt(0)
v_and_b32 v159, v148, v151
v_cmp_ne_u32 vcc, 1, v159
s_cbranch_vccz H2_fz5_ok
s_add_u32 s52, s52, 1
s_cmp_gt_u32 s52, 200000
s_cbranch_scc1 H2_fz5_ok
s_sleep 0
s_branch H2_fz5_re
H2_fz5_ok:
v_add_f32 v153, v153, v154
v_mul_f32 v153, v153, v150
v_cmp_nge_f32 vcc, s70, v153
s_nop 1
v_cndmask_b32 v153, 1, 2, vcc
s_mov_b64 exec, 1
ds_write_b32 v167, v153 offset:16
s_mov_b64 exec, -1
H2_nf3:
H2_sp6_re:
ds_read_b64 v[148:149], v167 offset:520
s_waitcnt lgkmcnt(0)
v_cmp_ne_u64 vcc, s[68:69], v[148:149]
s_cbranch_vccz H2_sp6_ok
s_add_u32 s52, s52, 1
s_cmp_gt_u32 s52, 200000
s_cbranch_scc1 H2_sp6_ok
s_sleep 3
s_branch H2_sp6_re
H2_sp6_ok:
s_mul_i32 s46, s40, 36864
s_add_u32 s46, s46, 0x94800
s_add_u32 s44, s30, s46
s_addc_u32 s45, s31, 0
global_load_dwordx4 v[0:3], v157, s[44:45] offset:0
global_load_dwordx4 v[4:7], v157, s[44:45] offset:1024
global_load_dwordx4 v[8:11], v157, s[44:45] offset:2048
global_load_dwordx4 v[12:15], v157, s[44:45] offset:3072
s_add_u32 s44, s44, 4096
s_addc_u32 s45, s45, 0
global_load_dwordx4 v[16:19], v157, s[44:45] offset:0
global_load_dwordx4 v[20:23], v157, s[44:45] offset:1024
global_load_dwordx4 v[24:27], v157, s[44:45] offset:2048
global_load_dwordx4 v[28:31], v157, s[44:45] offset:3072
s_add_u32 s44, s44, 4096
s_addc_u32 s45, s45, 0
global_load_dwordx4 v[32:35], v157, s[44:45] offset:0
global_load_dwordx4 v[36:39], v157, s[44:45] offset:1024
global_load_dwordx4 v[40:43], v157, s[44:45] offset:2048
global_load_dwordx4 v[44:47], v157, s[44:45] offset:3072
s_add_u32 s44, s44, 4096
s_addc_u32 s45, s45, 0
global_load_dwordx4 v[48:51], v157, s[44:45] offset:0
global_load_dwordx4 v[52:55], v157, s[44:45] offset:1024
global_load_dwordx4 v[56:59], v157, s[44:45] offset:2048
global_load_dwordx4 v[60:63], v157, s[44:45] offset:3072
s_add_u32 s44, s44, 4096
s_addc_u32 s45, s45, 0
global_load_dwordx4 v[64:67], v157, s[44:45] offset:0
global_load_dwordx4 v[68:71], v157, s[44:45] offset:1024
s_mul_i32 s46, s40, 294912
s_add_u32 s46, s46, 0x28800
s_add_u32 s44, s30, s46
s_addc_u32 s45, s31, 0
s_waitcnt vmcnt(17)
v_mfma_f32_16x16x32_bf16 v[144:147], v[0:3], v[72:75], 0
global_load_dwordx4 v[0:3], v157, s[44:45] offset:0
s_waitcnt vmcnt(17)
v_mfma_f32_16x16x32_bf16 v[144:147], v[4:7], v[76:79], v[144:147]
global_load_dwordx4 v[4:7], v157, s[44:45] offset:1024
s_waitcnt vmcnt(17)
v_mfma_f32_16x16x32_bf16 v[144:147], v[8:11], v[80:83], v[144:147]
global_load_dwordx4 v[8:11], v157, s[44:45] offset:2048
s_waitcnt vmcnt(17)
v_mfma_f32_16x16x32_bf16 v[144:147], v[12:15], v[84:87], v[144:147]
global_load_dwordx4 v[12:15], v157, s[44:45] offset:3072
s_waitcnt vmcnt(17)
v_mfma_f32_16x16x32_bf16 v[144:147], v[16:19], v[88:91], v[144:147]
s_add_u32 s44, s44, 4096
s_addc_u32 s45, s45, 0
global_load_dwordx4 v[16:19], v157, s[44:45] offset:0
s_waitcnt vmcnt(17)
v_mfma_f32_16x16x32_bf16 v[144:147], v[20:23], v[92:95], v[144:147]
global_load_dwordx4 v[20:23], v157, s[44:45] offset:1024
s_waitcnt vmcnt(17)
v_mfma_f32_16x16x32_bf16 v[144:147], v[24:27], v[96:99], v[144:147]
global_load_dwordx4 v[24:27], v157, s[44:45] offset:2048
s_waitcnt vmcnt(17)
v_mfma_f32_16x16x32_bf16 v[144:147], v[28:31], v[100:103], v[144:147]
global_load_dwordx4 v[28:31], v157, s[44:45] offset:3072
s_waitcnt vmcnt(17)
v_mfma_f32_16x16x32_bf16 v[144:147], v[32:35], v[104:107], v[144:147]
s_add_u32 s44, s44, 4096
s_addc_u32 s45, s45, 0
global_load_dwordx4 v[32:35], v157, s[44:45] offset:0
s_waitcnt vmcnt(17)
v_mfma_f32_16x16x32_bf16 v[144:147], v[36:39], v[108:111], v[144:147]
global_load_dwordx4 v[36:39], v157, s[44:45] offset:1024
s_waitcnt vmcnt(17)
v_mfma_f32_16x16x32_bf16 v[144:147], v[40:43], v[112:115], v[144:147]
global_load_dwordx4 v[40:43], v157, s[44:45] offset:2048
s_waitcnt vmcnt(17)
v_mfma_f32_16x16x32_bf16 v[144:147], v[44:47], v[116:119], v[144:147]
global_load_dwordx4 v[44:47], v157, s[44:45] offset:3072
s_waitcnt vmcnt(17)
v_mfma_f32_16x16x32_bf16 v[144:147], v[48:51], v[120:123], v[144:147]
s_add_u32 s44, s44, 4096
s_addc_u32 s45, s45, 0
global_load_dwordx4 v[48:51], v157, s[44:45] offset:0
s_waitcnt vmcnt(17)
v_mfma_f32_16x16x32_bf16 v[144:147], v[52:55], v[124:127], v[144:147]
global_load_dwordx4 v[52:55], v157, s[44:45] offset:1024
s_waitcnt vmcnt(17)
v_mfma_f32_16x16x32_bf16 v[144:147], v[56:59], v[128:131], v[144:147]
global_load_dwordx4 v[56:59], v157, s[44:45] offset:2048
s_waitcnt vmcnt(17)
v_mfma_f32_16x16x32_bf16 v[144:147], v[60:63], v[132:135], v[144:147]
global_load_dwordx4 v[60:63], v157, s[44:45] offset:3072
s_waitcnt vmcnt(17)
v_mfma_f32_16x16x32_bf16 v[144:147], v[64:67], v[136:139], v[144:147]
s_add_u32 s44, s44, 4096
s_addc_u32 s45, s45, 0
global_load_dwordx4 v[64:67], v157, s[44:45] offset:0
s_waitcnt vmcnt(17)
v_mfma_f32_16x16x32_bf16 v[144:147], v[68:71], v[140:143], v[144:147]
global_load_dwordx4 v[68:71], v157, s[44:45] offset:1024
s_nop 6
v_mul_f32 v144, 0x3eae1a93, v144
v_mul_f32 v145, 0x3eae1a93, v145
v_mul_f32 v146, 0x3eae1a93, v146
v_mul_f32 v147, 0x3eae1a93, v147
v_mul_f32 v158, v144, v144
v_fmac_f32 v158, v145, v145
v_mul_f32 v159, v146, v146
v_fmac_f32 v159, v147, v147
v_max_f32 v158, v158, v159
v_cvt_pk_bf16_f32 v144, v144, v145
v_cvt_pk_bf16_f32 v145, v146, v147
v_lshlrev_b32 v159, 7, v163
v_lshl_add_u32 v159, v162, 2, v159
v_add_u32 v159, 10752, v159
ds_write2_b32 v159, v144, v145 offset0:0 offset1:16
v_lshlrev_b32 v159, 4, v163
v_mov_b32 v160, 1
ds_max_u32 v159, v158 offset:200
s_mov_b64 exec, 1
ds_write_b32 v167, v160 offset:580
s_mov_b64 exec, -1
s_mul_i32 s46, s40, 294912
s_add_u32 s46, s46, 0x3a800
s_add_u32 s44, s30, s46
s_addc_u32 s45, s31, 0
s_waitcnt vmcnt(17)
v_mfma_f32_16x16x32_bf16 v[144:147], v[0:3], v[72:75], 0
global_load_dwordx4 v[0:3], v157, s[44:45] offset:0
s_waitcnt vmcnt(17)
v_mfma_f32_16x16x32_bf16 v[144:147], v[4:7], v[76:79], v[144:147]
global_load_dwordx4 v[4:7], v157, s[44:45] offset:1024
s_waitcnt vmcnt(17)
v_mfma_f32_16x16x32_bf16 v[144:147], v[8:11], v[80:83], v[144:147]
global_load_dwordx4 v[8:11], v157, s[44:45] offset:2048
s_waitcnt vmcnt(17)
v_mfma_f32_16x16x32_bf16 v[144:147], v[12:15], v[84:87], v[144:147]
global_load_dwordx4 v[12:15], v157, s[44:45] offset:3072
s_waitcnt vmcnt(17)
v_mfma_f32_16x16x32_bf16 v[144:147], v[16:19], v[88:91], v[144:147]
s_add_u32 s44, s44, 4096
s_addc_u32 s45, s45, 0
global_load_dwordx4 v[16:19], v157, s[44:45] offset:0
s_waitcnt vmcnt(17)
v_mfma_f32_16x16x32_bf16 v[144:147], v[20:23], v[92:95], v[144:147]
global_load_dwordx4 v[20:23], v157, s[44:45] offset:1024
s_waitcnt vmcnt(17)
v_mfma_f32_16x16x32_bf16 v[144:147], v[24:27], v[96:99], v[144:147]
global_load_dwordx4 v[24:27], v157, s[44:45] offset:2048
s_waitcnt vmcnt(17)
v_mfma_f32_16x16x32_bf16 v[144:147], v[28:31], v[100:103], v[144:147]
global_load_dwordx4 v[28:31], v157, s[44:45] offset:3072
s_waitcnt vmcnt(17)
v_mfma_f32_16x16x32_bf16 v[144:147], v[32:35], v[104:107], v[144:147]
s_add_u32 s44, s44, 4096
s_addc_u32 s45, s45, 0
global_load_dwordx4 v[32:35], v157, s[44:45] offset:0
s_waitcnt vmcnt(17)
v_mfma_f32_16x16x32_bf16 v[144:147], v[36:39], v[108:111], v[144:147]
global_load_dwordx4 v[36:39], v157, s[44:45] offset:1024
s_waitcnt vmcnt(17)
v_mfma_f32_16x16x32_bf16 v[144:147], v[40:43], v[112:115], v[144:147]
global_load_dwordx4 v[40:43], v157, s[44:45] offset:2048
s_waitcnt vmcnt(17)
v_mfma_f32_16x16x32_bf16 v[144:147], v[44:47], v[116:119], v[144:147]
global_load_dwordx4 v[44:47], v157, s[44:45] offset:3072
s_waitcnt vmcnt(17)
v_mfma_f32_16x16x32_bf16 v[144:147], v[48:51], v[120:123], v[144:147]
s_add_u32 s44, s44, 4096
s_addc_u32 s45, s45, 0
global_load_dwordx4 v[48:51], v157, s[44:45] offset:0
s_waitcnt vmcnt(17)
v_mfma_f32_16x16x32_bf16 v[144:147], v[52:55], v[124:127], v[144:147]
global_load_dwordx4 v[52:55], v157, s[44:45] offset:1024
s_waitcnt vmcnt(17)
v_mfma_f32_16x16x32_bf16 v[144:147], v[56:59], v[128:131], v[144:147]
global_load_dwordx4 v[56:59], v157, s[44:45] offset:2048
s_waitcnt vmcnt(17)
v_mfma_f32_16x16x32_bf16 v[144:147], v[60:63], v[132:135], v[144:147]
global_load_dwordx4 v[60:63], v157, s[44:45] offset:3072
s_waitcnt vmcnt(17)
v_mfma_f32_16x16x32_bf16 v[144:147], v[64:67], v[136:139], v[144:147]
s_add_u32 s44, s44, 4096
s_addc_u32 s45, s45, 0
global_load_dwordx4 v[64:67], v157, s[44:45] offset:0
s_waitcnt vmcnt(17)
v_mfma_f32_16x16x32_bf16 v[144:147], v[68:71], v[140:143], v[144:147]
global_load_dwordx4 v[68:71], v157, s[44:45] offset:1024
s_nop 6
v_mul_f32 v144, 0x3eae1a93, v144
v_mul_f32 v145, 0x3eae1a93, v145
v_mul_f32 v146, 0x3eae1a93, v146
v_mul_f32 v147, 0x3eae1a93, v147
v_mul_f32 v158, v144, v144
v_fmac_f32 v158, v145, v145
v_fmac_f32 v158, v146, v146
v_fmac_f32 v158, v147, v147
v_cvt_pk_bf16_f32 v144, v144, v145
v_cvt_pk_bf16_f32 v145, v146, v147
ds_write_b64 v166, v[144:145] offset:6400
v_mov_b32 v160, v158
s_nop 1
v_permlane16_swap_b32 v158, v160
v_add_f32 v158, v158, v160
v_mov_b32 v160, v158
s_nop 1
v_permlane32_swap_b32 v158, v160
v_add_f32 v158, v158, v160
v_mov_b32 v160, 1
s_mov_b64 exec, 0xffff
ds_max_u32 v167, v158 offset:196
s_mov_b64 exec, 1
ds_add_rtn_u32 v159, v167, v160 offset:192
s_mov_b64 exec, -1
s_waitcnt lgkmcnt(0)
v_readfirstlane_b32 s50, v159
s_cmp_eq_u32 s50, 1
s_cbranch_scc0 H2_nf7
H2_fz8_re:
ds_read_b128 v[148:151], v167 offset:576
ds_read_b128 v[152:155], v167 offset:192
s_waitcnt lgkmcnt(0)
v_and_b32 v159, v149, v151
v_cmp_ne_u32 vcc, 1, v159
s_cbranch_vccz H2_fz8_ok
s_add_u32 s52, s52, 1
s_cmp_gt_u32 s52, 200000
s_cbranch_scc1 H2_fz8_ok
s_sleep 0
s_branch H2_fz8_re
H2_fz8_ok:
v_add_f32 v153, v153, v154
v_mul_f32 v153, v153, v150
v_cmp_nge_f32 vcc, s70, v153
s_nop 1
v_cndmask_b32 v153, 1, 2, vcc
s_mov_b64 exec, 1
ds_write_b32 v167, v153 offset:32
s_mov_b64 exec, -1
H2_nf7:
s_waitcnt vmcnt(17)
v_mfma_f32_16x16x32_bf16 v[144:147], v[0:3], v[72:75], 0
s_waitcnt vmcnt(16)
v_mfma_f32_16x16x32_bf16 v[144:147], v[4:7], v[76:79], v[144:147]
s_waitcnt vmcnt(15)
v_mfma_f32_16x16x32_bf16 v[144:147], v[8:11], v[80:83], v[144:147]
s_waitcnt vmcnt(14)
v_mfma_f32_16x16x32_bf16 v[144:147], v[12:15], v[84:87], v[144:147]
s_waitcnt vmcnt(13)
v_mfma_f32_16x16x32_bf16 v[144:147], v[16:19], v[88:91], v[144:147]
s_waitcnt vmcnt(12)
v_mfma_f32_16x16x32_bf16 v[144:147], v[20:23], v[92:95], v[144:147]
s_waitcnt vmcnt(11)
v_mfma_f32_16x16x32_bf16 v[144:147], v[24:27], v[96:99], v[144:147]
s_waitcnt vmcnt(10)
v_mfma_f32_16x16x32_bf16 v[144:147], v[28:31], v[100:103], v[144:147]
s_waitcnt vmcnt(9)
v_mfma_f32_16x16x32_bf16 v[144:147], v[32:35], v[104:107], v[144:147]
s_waitcnt vmcnt(8)
v_mfma_f32_16x16x32_bf16 v[144:147], v[36:39], v[108:111], v[144:147]
s_waitcnt vmcnt(7)
v_mfma_f32_16x16x32_bf16 v[144:147], v[40:43], v[112:115], v[144:147]
s_waitcnt vmcnt(6)
v_mfma_f32_16x16x32_bf16 v[144:147], v[44:47], v[116:119], v[144:147]
s_waitcnt vmcnt(5)
v_mfma_f32_16x16x32_bf16 v[144:147], v[48:51], v[120:123], v[144:147]
s_waitcnt vmcnt(4)
v_mfma_f32_16x16x32_bf16 v[144:147], v[52:55], v[124:127], v[144:147]
s_waitcnt vmcnt(3)
v_mfma_f32_16x16x32_bf16 v[144:147], v[56:59], v[128:131], v[144:147]
s_waitcnt vmcnt(2)
v_mfma_f32_16x16x32_bf16 v[144:147], v[60:63], v[132:135], v[144:147]
s_waitcnt vmcnt(1)
v_mfma_f32_16x16x32_bf16 v[144:147], v[64:67], v[136:139], v[144:147]
s_waitcnt vmcnt(0)
v_mfma_f32_16x16x32_bf16 v[144:147], v[68:71], v[140:143], v[144:147]
s_nop 7
v_mul_f32 v144, 0x3eae1a93, v144
v_mul_f32 v145, 0x3eae1a93, v145
v_mul_f32 v146, 0x3eae1a93, v146
v_mul_f32 v147, 0x3eae1a93, v147
v_mul_f32 v158, v144, v144
v_fmac_f32 v158, v145, v145
v_fmac_f32 v158, v146, v146
v_fmac_f32 v158, v147, v147
v_cvt_pk_bf16_f32 v144, v144, v145
v_cvt_pk_bf16_f32 v145, v146, v147
ds_write_b64 v166, v[144:145] offset:8448
v_mov_b32 v160, v158
s_nop 1
v_permlane16_swap_b32 v158, v160
v_add_f32 v158, v158, v160
v_mov_b32 v160, v158
s_nop 1
v_permlane32_swap_b32 v158, v160
v_add_f32 v158, v158, v160
v_mov_b32 v160, 1
s_mov_b64 exec, 0xffff
ds_max_u32 v167, v158 offset:228
s_mov_b64 exec, 1
ds_add_rtn_u32 v159, v167, v160 offset:224
s_mov_b64 exec, -1
s_waitcnt lgkmcnt(0)
v_readfirstlane_b32 s50, v159
s_cmp_eq_u32 s50, 1
s_cbranch_scc0 H2_nf9
H2_fz10_re:
ds_read_b128 v[148:151], v167 offset:576
ds_read_b128 v[152:155], v167 offset:224
s_waitcnt lgkmcnt(0)
v_and_b32 v159, v149, v151
v_cmp_ne_u32 vcc, 1, v159
s_cbranch_vccz H2_fz10_ok
s_add_u32 s52, s52, 1
s_cmp_gt_u32 s52, 200000
s_cbranch_scc1 H2_fz10_ok
s_sleep 0
s_branch H2_fz10_re
H2_fz10_ok:
v_add_f32 v153, v153, v154
v_mul_f32 v153, v153, v150
v_cmp_nge_f32 vcc, s70, v153
s_nop 1
v_cndmask_b32 v153, 1, 2, vcc
s_mov_b64 exec, 1
ds_write_b32 v167, v153 offset:48
s_mov_b64 exec, -1
H2_nf9:
s_cmp_eq_u32 s33, 1
s_cbranch_scc1 H2_noconv
s_cmp_ge_u32 s2, 64
s_cbranch_scc1 H2_noconv
s_add_u32 s50, s2, 512
s_sub_u32 s46, s60, 1
s_add_u32 s46, s46, 80
s_andn2_b32 s47, s61, 0xff
v_add_u32 v158, 0x6db000, v157
s_mov_b32 s53, 0
H2_xrp:
global_load_dwordx4 v[0:3], v158, s[30:31] sc1
global_load_dwordx4 v[4:7], v158, s[30:31] offset:1024 sc1
v_mov_b32 v159, 0
s_waitcnt vmcnt(0)
v_bitop3_b32 v159, v0, s46, v159 bitop3:0xbe
v_bitop3_b32 v159, v1, s47, v159 bitop3:0xbe
v_bitop3_b32 v159, v2, s46, v159 bitop3:0xbe
v_bitop3_b32 v159, v3, s47, v159 bitop3:0xbe
v_bitop3_b32 v159, v4, s46, v159 bitop3:0xbe
v_bitop3_b32 v159, v5, s47, v159 bitop3:0xbe
v_bitop3_b32 v159, v6, s46, v159 bitop3:0xbe
v_bitop3_b32 v159, v7, s47, v159 bitop3:0xbe
v_cmp_ne_u32 vcc, 0, v159
s_cbranch_vccz H2_xrok
s_add_u32 s53, s53, 1
s_cmp_gt_u32 s53, 20000
s_cbranch_scc1 H2_xrok
s_sleep 4
s_branch H2_xrp
H2_xrok:
s_mov_b32 s51, 116736
v_lshrrev_b32 v158, 4, v157
s_setprio 3
s_mov_b32 s44, s22
s_mov_b32 s45, s23
s_mov_b32 s46, 2359296
s_mov_b32 s47, 0x00020000
s_lshl_b32 s48, s50, 12
v_lshl_add_u32 v40, v158, 4, s48
buffer_load_dwordx4 v[56:59], v40, s[44:47], 0 offen offset:0
buffer_load_dword v88, v40, s[44:47], 0 offen offset:16
buffer_load_dwordx4 v[60:63], v40, s[44:47], 0 offen offset:1024
buffer_load_dword v89, v40, s[44:47], 0 offen offset:1040
buffer_load_dwordx4 v[64:67], v40, s[44:47], 0 offen offset:2048
buffer_load_dword v90, v40, s[44:47], 0 offen offset:2064
buffer_load_dwordx4 v[68:71], v40, s[44:47], 0 offen offset:3072
buffer_load_dword v91, v40, s[44:47], 0 offen offset:3088
v_mul_u32_u24 v41, 9216, v158
s_lshl_b32 s48, s50, 4
s_add_u32 s48, s48, 0x700000
v_add_u32 v41, s48, v41
global_load_dwordx4 v[72:75], v41, s[30:31]
v_add_u32 v41, 589824, v41
global_load_dwordx4 v[76:79], v41, s[30:31]
v_add_u32 v41, 589824, v41
global_load_dwordx4 v[80:83], v41, s[30:31]
v_add_u32 v41, 589824, v41
global_load_dwordx4 v[84:87], v41, s[30:31]
s_lshl_b32 s48, s50, 1
v_mov_b32 v42, s48
global_load_ushort v52, v42, s[24:25]
v_mov_b32 v44, 0
v_mov_b32 v45, 0
v_mov_b32 v46, 0
v_mov_b32 v47, 0
v_lshl_add_u32 v42, v158, 4, s51
ds_write_b128 v42, v[44:47] offset:13600
ds_write_b128 v42, v[44:47] offset:14624
s_mov_b64 exec, 0x7ffffff
ds_write_b128 v42, v[44:47] offset:15648
s_mov_b64 exec, -1
v_lshl_add_u32 v43, v158, 2, s51
s_mov_b64 exec, 0xffff
ds_write_b32 v43, v44 offset:0
s_mov_b64 exec, 0x7fff
ds_write_b32 v43, v44 offset:4292
s_mov_b64 exec, -1
v_lshrrev_b32 v40, 2, v158
v_mul_u32_u24 v40, 80, v40
v_and_b32 v41, 3, v158
v_lshl_add_u32 v40, v41, 4, v40
v_add_u32 v40, s51, v40
s_waitcnt vmcnt(5)
ds_write_b128 v42, v[56:59] offset:64
ds_write_b128 v42, v[60:63] offset:1088
ds_write_b128 v42, v[64:67] offset:2112
ds_write_b128 v42, v[68:71] offset:3136
v_alignbit_b32 v48, v57, v56, 16
v_alignbit_b32 v49, v58, v57, 16
v_alignbit_b32 v50, v59, v58, 16
v_alignbit_b32 v51, v88, v59, 16
v_add_u32 v41, 4356, v42
ds_write2_b32 v41, v48, v49 offset0:0 offset1:1
ds_write2_b32 v41, v50, v51 offset0:2 offset1:3
s_waitcnt lgkmcnt(0)
v_alignbit_b32 v48, v61, v60, 16
v_alignbit_b32 v49, v62, v61, 16
v_alignbit_b32 v50, v63, v62, 16
v_alignbit_b32 v51, v89, v63, 16
v_add_u32 v41, 5380, v42
ds_write2_b32 v41, v48, v49 offset0:0 offset1:1
ds_write2_b32 v41, v50, v51 offset0:2 offset1:3
s_waitcnt lgkmcnt(0)
v_alignbit_b32 v48, v65, v64, 16
v_alignbit_b32 v49, v66, v65, 16
v_alignbit_b32 v50, v67, v66, 16
v_alignbit_b32 v51, v90, v67, 16
v_add_u32 v41, 6404, v42
ds_write2_b32 v41, v48, v49 offset0:0 offset1:1
ds_write2_b32 v41, v50, v51 offset0:2 offset1:3
s_waitcnt lgkmcnt(0)
v_alignbit_b32 v48, v69, v68, 16
v_alignbit_b32 v49, v70, v69, 16
v_alignbit_b32 v50, v71, v70, 16
v_alignbit_b32 v51, v91, v71, 16
v_add_u32 v41, 7428, v42
ds_write2_b32 v41, v48, v49 offset0:0 offset1:1
ds_write2_b32 v41, v50, v51 offset0:2 offset1:3
s_waitcnt lgkmcnt(0)
v_lshlrev_b32 v48, 16, v56
s_mov_b64 exec, 1
ds_write_b32 v43, v48 offset:4352
s_mov_b64 exec, -1
s_waitcnt vmcnt(1)
ds_write_b128 v40, v[72:75] offset:8480
ds_write_b128 v40, v[76:79] offset:9760
ds_write_b128 v40, v[80:83] offset:11040
ds_write_b128 v40, v[84:87] offset:12320
v_and_b32 v43, 31, v158
v_lshrrev_b32 v44, 5, v158
v_add_u32 v45, 1, v43
v_and_b32 v45, 1, v45
s_waitcnt lgkmcnt(0)
v_mul_u32_u24 v40, 4290, v45
v_lshl_add_u32 v40, v43, 1, v40
v_lshl_add_u32 v40, v44, 4, v40
v_add3_u32 v40, v40, s51, 2
v_add_u32 v41, 2048, v40
v_sub_u32 v42, 31, v43
v_mul_u32_u24 v42, 80, v42
v_lshl_add_u32 v42, v44, 4, v42
v_add_u32 v42, s51, v42
v_add_u32 v42, 8480, v42
s_waitcnt vmcnt(0)
v_lshlrev_b32 v53, 16, v52
v_lshlrev_b32 v45, 3, v44
v_add_u32 v45, v45, v43
v_sub_u32 v46, 15, v45
v_cmp_eq_u32 vcc, 0, v46
s_nop 1
v_cndmask_b32 v32, 0, v52, vcc
v_cmp_eq_u32 vcc, 1, v46
s_nop 1
v_cndmask_b32 v32, v32, v53, vcc
v_cmp_eq_u32 vcc, 2, v46
s_nop 1
v_cndmask_b32 v33, 0, v52, vcc
v_cmp_eq_u32 vcc, 3, v46
s_nop 1
v_cndmask_b32 v33, v33, v53, vcc
v_cmp_eq_u32 vcc, 4, v46
s_nop 1
v_cndmask_b32 v34, 0, v52, vcc
v_cmp_eq_u32 vcc, 5, v46
s_nop 1
v_cndmask_b32 v34, v34, v53, vcc
v_cmp_eq_u32 vcc, 6, v46
s_nop 1
v_cndmask_b32 v35, 0, v52, vcc
v_cmp_eq_u32 vcc, 7, v46
s_nop 1
v_cndmask_b32 v35, v35, v53, vcc
v_sub_u32 v46, 31, v45
v_cmp_eq_u32 vcc, 0, v46
s_nop 1
v_cndmask_b32 v36, 0, v52, vcc
v_cmp_eq_u32 vcc, 1, v46
s_nop 1
v_cndmask_b32 v36, v36, v53, vcc
v_cmp_eq_u32 vcc, 2, v46
s_nop 1
v_cndmask_b32 v37, 0, v52, vcc
v_cmp_eq_u32 vcc, 3, v46
s_nop 1
v_cndmask_b32 v37, v37, v53, vcc
v_cmp_eq_u32 vcc, 4, v46
s_nop 1
v_cndmask_b32 v38, 0, v52, vcc
v_cmp_eq_u32 vcc, 5, v46
s_nop 1
v_cndmask_b32 v38, v38, v53, vcc
v_cmp_eq_u32 vcc, 6, v46
s_nop 1
v_cndmask_b32 v39, 0, v52, vcc
v_cmp_eq_u32 vcc, 7, v46
s_nop 1
v_cndmask_b32 v39, v39, v53, vcc
ds_read2_b32 v[56:57], v40 offset0:8 offset1:9
ds_read2_b32 v[58:59], v40 offset0:10 offset1:11
ds_read_b128 v[64:67], v42 offset:32
ds_read_b128 v[68:71], v42 offset:2592
ds_read2_b32 v[60:61], v41 offset0:8 offset1:9
ds_read2_b32 v[62:63], v41 offset0:10 offset1:11
ds_read2_b32 v[72:73], v40 offset0:0 offset1:1
ds_read2_b32 v[74:75], v40 offset0:2 offset1:3
ds_read_b128 v[80:83], v42 offset:0
ds_read_b128 v[84:87], v42 offset:2560
ds_read2_b32 v[76:77], v41 offset0:0 offset1:1
ds_read2_b32 v[78:79], v41 offset0:2 offset1:3
ds_read2_b32 v[88:89], v40 offset0:24 offset1:25
ds_read2_b32 v[90:91], v40 offset0:26 offset1:27
ds_read_b128 v[96:99], v42 offset:112
ds_read_b128 v[100:103], v42 offset:2672
ds_read2_b32 v[92:93], v41 offset0:24 offset1:25
ds_read2_b32 v[94:95], v41 offset0:26 offset1:27
s_waitcnt lgkmcnt(12)
v_mfma_f32_32x32x16_bf16 v[16:31], v[56:59], v[64:67], 0
v_mfma_f32_32x32x16_bf16 v[0:15], v[56:59], v[68:71], 0
v_mfma_f32_32x32x16_bf16 v[16:31], v[60:63], v[68:71], v[16:31]
v_mfma_f32_32x32x16_bf16 v[0:15], v[32:35], v[68:71], v[0:15]
v_mfma_f32_32x32x16_bf16 v[16:31], v[32:35], v[64:67], v[16:31]
ds_read2_b32 v[56:57], v40 offset0:16 offset1:17
ds_read2_b32 v[58:59], v40 offset0:18 offset1:19
ds_read_b128 v[64:67], v42 offset:80
ds_read_b128 v[68:71], v42 offset:2640
ds_read2_b32 v[60:61], v41 offset0:16 offset1:17
ds_read2_b32 v[62:63], v41 offset0:18 offset1:19
s_waitcnt lgkmcnt(12)
v_mfma_f32_32x32x16_bf16 v[16:31], v[72:75], v[80:83], v[16:31]
v_mfma_f32_32x32x16_bf16 v[0:15], v[72:75], v[84:87], v[0:15]
v_mfma_f32_32x32x16_bf16 v[16:31], v[76:79], v[84:87], v[16:31]
v_mfma_f32_32x32x16_bf16 v[0:15], v[36:39], v[84:87], v[0:15]
v_mfma_f32_32x32x16_bf16 v[16:31], v[36:39], v[80:83], v[16:31]
ds_read2_b32 v[72:73], v40 offset0:40 offset1:41
ds_read2_b32 v[74:75], v40 offset0:42 offset1:43
ds_read_b128 v[80:83], v42 offset:192
ds_read_b128 v[84:87], v42 offset:2752
ds_read2_b32 v[76:77], v41 offset0:40 offset1:41
ds_read2_b32 v[78:79], v41 offset0:42 offset1:43
s_waitcnt lgkmcnt(12)
v_mfma_f32_32x32x16_bf16 v[16:31], v[88:91], v[96:99], v[16:31]
v_mfma_f32_32x32x16_bf16 v[0:15], v[88:91], v[100:103], v[0:15]
v_mfma_f32_32x32x16_bf16 v[16:31], v[92:95], v[100:103], v[16:31]
ds_read2_b32 v[88:89], v40 offset0:32 offset1:33
ds_read2_b32 v[90:91], v40 offset0:34 offset1:35
ds_read_b128 v[96:99], v42 offset:160
ds_read_b128 v[100:103], v42 offset:2720
ds_read2_b32 v[92:93], v41 offset0:32 offset1:33
ds_read2_b32 v[94:95], v41 offset0:34 offset1:35
s_waitcnt lgkmcnt(12)
v_mfma_f32_32x32x16_bf16 v[16:31], v[56:59], v[64:67], v[16:31]
v_mfma_f32_32x32x16_bf16 v[0:15], v[56:59], v[68:71], v[0:15]
v_mfma_f32_32x32x16_bf16 v[16:31], v[60:63], v[68:71], v[16:31]
ds_read2_b32 v[56:57], v40 offset0:56 offset1:57
ds_read2_b32 v[58:59], v40 offset0:58 offset1:59
ds_read_b128 v[64:67], v42 offset:272
ds_read_b128 v[68:71], v42 offset:2832
ds_read2_b32 v[60:61], v41 offset0:56 offset1:57
ds_read2_b32 v[62:63], v41 offset0:58 offset1:59
s_waitcnt lgkmcnt(12)
v_mfma_f32_32x32x16_bf16 v[16:31], v[72:75], v[80:83], v[16:31]
v_mfma_f32_32x32x16_bf16 v[0:15], v[72:75], v[84:87], v[0:15]
v_mfma_f32_32x32x16_bf16 v[16:31], v[76:79], v[84:87], v[16:31]
ds_read2_b32 v[72:73], v40 offset0:48 offset1:49
ds_read2_b32 v[74:75], v40 offset0:50 offset1:51
ds_read_b128 v[80:83], v42 offset:240
ds_read_b128 v[84:87], v42 offset:2800
ds_read2_b32 v[76:77], v41 offset0:48 offset1:49
ds_read2_b32 v[78:79], v41 offset0:50 offset1:51
s_waitcnt lgkmcnt(12)
v_mfma_f32_32x32x16_bf16 v[16:31], v[88:91], v[96:99], v[16:31]
v_mfma_f32_32x32x16_bf16 v[0:15], v[88:91], v[100:103], v[0:15]
v_mfma_f32_32x32x16_bf16 v[16:31], v[92:95], v[100:103], v[16:31]
ds_read2_b32 v[88:89], v40 offset0:72 offset1:73
ds_read2_b32 v[90:91], v40 offset0:74 offset1:75
ds_read_b128 v[96:99], v42 offset:352
ds_read_b128 v[100:103], v42 offset:2912
ds_read2_b32 v[92:93], v41 offset0:72 offset1:73
ds_read2_b32 v[94:95], v41 offset0:74 offset1:75
s_waitcnt lgkmcnt(12)
v_mfma_f32_32x32x16_bf16 v[16:31], v[56:59], v[64:67], v[16:31]
v_mfma_f32_32x32x16_bf16 v[0:15], v[56:59], v[68:71], v[0:15]
v_mfma_f32_32x32x16_bf16 v[16:31], v[60:63], v[68:71], v[16:31]
ds_read2_b32 v[56:57], v40 offset0:64 offset1:65
ds_read2_b32 v[58:59], v40 offset0:66 offset1:67
ds_read_b128 v[64:67], v42 offset:320
ds_read_b128 v[68:71], v42 offset:2880
ds_read2_b32 v[60:61], v41 offset0:64 offset1:65
ds_read2_b32 v[62:63], v41 offset0:66 offset1:67
s_waitcnt lgkmcnt(12)
v_mfma_f32_32x32x16_bf16 v[16:31], v[72:75], v[80:83], v[16:31]
v_mfma_f32_32x32x16_bf16 v[0:15], v[72:75], v[84:87], v[0:15]
v_mfma_f32_32x32x16_bf16 v[16:31], v[76:79], v[84:87], v[16:31]
ds_read2_b32 v[72:73], v40 offset0:88 offset1:89
ds_read2_b32 v[74:75], v40 offset0:90 offset1:91
ds_read_b128 v[80:83], v42 offset:432
ds_read_b128 v[84:87], v42 offset:2992
ds_read2_b32 v[76:77], v41 offset0:88 offset1:89
ds_read2_b32 v[78:79], v41 offset0:90 offset1:91
s_waitcnt lgkmcnt(12)
v_mfma_f32_32x32x16_bf16 v[16:31], v[88:91], v[96:99], v[16:31]
v_mfma_f32_32x32x16_bf16 v[0:15], v[88:91], v[100:103], v[0:15]
v_mfma_f32_32x32x16_bf16 v[16:31], v[92:95], v[100:103], v[16:31]
ds_read2_b32 v[88:89], v40 offset0:80 offset1:81
ds_read2_b32 v[90:91], v40 offset0:82 offset1:83
ds_read_b128 v[96:99], v42 offset:400
ds_read_b128 v[100:103], v42 offset:2960
ds_read2_b32 v[92:93], v41 offset0:80 offset1:81
ds_read2_b32 v[94:95], v41 offset0:82 offset1:83
s_waitcnt lgkmcnt(12)
v_mfma_f32_32x32x16_bf16 v[16:31], v[56:59], v[64:67], v[16:31]
v_mfma_f32_32x32x16_bf16 v[0:15], v[56:59], v[68:71], v[0:15]
v_mfma_f32_32x32x16_bf16 v[16:31], v[60:63], v[68:71], v[16:31]
ds_read2_b32 v[56:57], v40 offset0:104 offset1:105
ds_read2_b32 v[58:59], v40 offset0:106 offset1:107
ds_read_b128 v[64:67], v42 offset:512
ds_read_b128 v[68:71], v42 offset:3072
ds_read2_b32 v[60:61], v41 offset0:104 offset1:105
ds_read2_b32 v[62:63], v41 offset0:106 offset1:107
s_waitcnt lgkmcnt(12)
v_mfma_f32_32x32x16_bf16 v[16:31], v[72:75], v[80:83], v[16:31]
v_mfma_f32_32x32x16_bf16 v[0:15], v[72:75], v[84:87], v[0:15]
v_mfma_f32_32x32x16_bf16 v[16:31], v[76:79], v[84:87], v[16:31]
ds_read2_b32 v[72:73], v40 offset0:96 offset1:97
ds_read2_b32 v[74:75], v40 offset0:98 offset1:99
ds_read_b128 v[80:83], v42 offset:480
ds_read_b128 v[84:87], v42 offset:3040
ds_read2_b32 v[76:77], v41 offset0:96 offset1:97
ds_read2_b32 v[78:79], v41 offset0:98 offset1:99
s_waitcnt lgkmcnt(12)
v_mfma_f32_32x32x16_bf16 v[16:31], v[88:91], v[96:99], v[16:31]
v_mfma_f32_32x32x16_bf16 v[0:15], v[88:91], v[100:103], v[0:15]
v_mfma_f32_32x32x16_bf16 v[16:31], v[92:95], v[100:103], v[16:31]
ds_read2_b32 v[88:89], v40 offset0:120 offset1:121
ds_read2_b32 v[90:91], v40 offset0:122 offset1:123
ds_read_b128 v[96:99], v42 offset:592
ds_read_b128 v[100:103], v42 offset:3152
ds_read2_b32 v[92:93], v41 offset0:120 offset1:121
ds_read2_b32 v[94:95], v41 offset0:122 offset1:123
s_waitcnt lgkmcnt(12)
v_mfma_f32_32x32x16_bf16 v[16:31], v[56:59], v[64:67], v[16:31]
v_mfma_f32_32x32x16_bf16 v[0:15], v[56:59], v[68:71], v[0:15]
v_mfma_f32_32x32x16_bf16 v[16:31], v[60:63], v[68:71], v[16:31]
ds_read2_b32 v[56:57], v40 offset0:112 offset1:113
ds_read2_b32 v[58:59], v40 offset0:114 offset1:115
ds_read_b128 v[64:67], v42 offset:560
ds_read_b128 v[68:71], v42 offset:3120
ds_read2_b32 v[60:61], v41 offset0:112 offset1:113
ds_read2_b32 v[62:63], v41 offset0:114 offset1:115
s_waitcnt lgkmcnt(12)
v_mfma_f32_32x32x16_bf16 v[16:31], v[72:75], v[80:83], v[16:31]
v_mfma_f32_32x32x16_bf16 v[0:15], v[72:75], v[84:87], v[0:15]
v_mfma_f32_32x32x16_bf16 v[16:31], v[76:79], v[84:87], v[16:31]
ds_read2_b32 v[72:73], v40 offset0:136 offset1:137
ds_read2_b32 v[74:75], v40 offset0:138 offset1:139
ds_read_b128 v[80:83], v42 offset:672
ds_read_b128 v[84:87], v42 offset:3232
ds_read2_b32 v[76:77], v41 offset0:136 offset1:137
ds_read2_b32 v[78:79], v41 offset0:138 offset1:139
s_waitcnt lgkmcnt(12)
v_mfma_f32_32x32x16_bf16 v[16:31], v[88:91], v[96:99], v[16:31]
v_mfma_f32_32x32x16_bf16 v[0:15], v[88:91], v[100:103], v[0:15]
v_mfma_f32_32x32x16_bf16 v[16:31], v[92:95], v[100:103], v[16:31]
ds_read2_b32 v[88:89], v40 offset0:128 offset1:129
ds_read2_b32 v[90:91], v40 offset0:130 offset1:131
ds_read_b128 v[96:99], v42 offset:640
ds_read_b128 v[100:103], v42 offset:3200
ds_read2_b32 v[92:93], v41 offset0:128 offset1:129
ds_read2_b32 v[94:95], v41 offset0:130 offset1:131
s_waitcnt lgkmcnt(12)
v_mfma_f32_32x32x16_bf16 v[16:31], v[56:59], v[64:67], v[16:31]
v_mfma_f32_32x32x16_bf16 v[0:15], v[56:59], v[68:71], v[0:15]
v_mfma_f32_32x32x16_bf16 v[16:31], v[60:63], v[68:71], v[16:31]
ds_read2_b32 v[56:57], v40 offset0:152 offset1:153
ds_read2_b32 v[58:59], v40 offset0:154 offset1:155
ds_read_b128 v[64:67], v42 offset:752
ds_read_b128 v[68:71], v42 offset:3312
ds_read2_b32 v[60:61], v41 offset0:152 offset1:153
ds_read2_b32 v[62:63], v41 offset0:154 offset1:155
s_waitcnt lgkmcnt(12)
v_mfma_f32_32x32x16_bf16 v[16:31], v[72:75], v[80:83], v[16:31]
v_mfma_f32_32x32x16_bf16 v[0:15], v[72:75], v[84:87], v[0:15]
v_mfma_f32_32x32x16_bf16 v[16:31], v[76:79], v[84:87], v[16:31]
ds_read2_b32 v[72:73], v40 offset0:144 offset1:145
ds_read2_b32 v[74:75], v40 offset0:146 offset1:147
ds_read_b128 v[80:83], v42 offset:720
ds_read_b128 v[84:87], v42 offset:3280
ds_read2_b32 v[76:77], v41 offset0:144 offset1:145
ds_read2_b32 v[78:79], v41 offset0:146 offset1:147
s_waitcnt lgkmcnt(12)
v_mfma_f32_32x32x16_bf16 v[16:31], v[88:91], v[96:99], v[16:31]
v_mfma_f32_32x32x16_bf16 v[0:15], v[88:91], v[100:103], v[0:15]
v_mfma_f32_32x32x16_bf16 v[16:31], v[92:95], v[100:103], v[16:31]
ds_read2_b32 v[88:89], v40 offset0:168 offset1:169
ds_read2_b32 v[90:91], v40 offset0:170 offset1:171
ds_read_b128 v[96:99], v42 offset:832
ds_read_b128 v[100:103], v42 offset:3392
ds_read2_b32 v[92:93], v41 offset0:168 offset1:169
ds_read2_b32 v[94:95], v41 offset0:170 offset1:171
s_waitcnt lgkmcnt(12)
v_mfma_f32_32x32x16_bf16 v[16:31], v[56:59], v[64:67], v[16:31]
v_mfma_f32_32x32x16_bf16 v[0:15], v[56:59], v[68:71], v[0:15]
v_mfma_f32_32x32x16_bf16 v[16:31], v[60:63], v[68:71], v[16:31]
ds_read2_b32 v[56:57], v40 offset0:160 offset1:161
ds_read2_b32 v[58:59], v40 offset0:162 offset1:163
ds_read_b128 v[64:67], v42 offset:800
ds_read_b128 v[68:71], v42 offset:3360
ds_read2_b32 v[60:61], v41 offset0:160 offset1:161
ds_read2_b32 v[62:63], v41 offset0:162 offset1:163
s_waitcnt lgkmcnt(12)
v_mfma_f32_32x32x16_bf16 v[16:31], v[72:75], v[80:83], v[16:31]
v_mfma_f32_32x32x16_bf16 v[0:15], v[72:75], v[84:87], v[0:15]
v_mfma_f32_32x32x16_bf16 v[16:31], v[76:79], v[84:87], v[16:31]
ds_read2_b32 v[72:73], v40 offset0:184 offset1:185
ds_read2_b32 v[74:75], v40 offset0:186 offset1:187
ds_read_b128 v[80:83], v42 offset:912
ds_read_b128 v[84:87], v42 offset:3472
ds_read2_b32 v[76:77], v41 offset0:184 offset1:185
ds_read2_b32 v[78:79], v41 offset0:186 offset1:187
s_waitcnt lgkmcnt(12)
v_mfma_f32_32x32x16_bf16 v[16:31], v[88:91], v[96:99], v[16:31]
v_mfma_f32_32x32x16_bf16 v[0:15], v[88:91], v[100:103], v[0:15]
v_mfma_f32_32x32x16_bf16 v[16:31], v[92:95], v[100:103], v[16:31]
ds_read2_b32 v[88:89], v40 offset0:176 offset1:177
ds_read2_b32 v[90:91], v40 offset0:178 offset1:179
ds_read_b128 v[96:99], v42 offset:880
ds_read_b128 v[100:103], v42 offset:3440
ds_read2_b32 v[92:93], v41 offset0:176 offset1:177
ds_read2_b32 v[94:95], v41 offset0:178 offset1:179
s_waitcnt lgkmcnt(12)
v_mfma_f32_32x32x16_bf16 v[16:31], v[56:59], v[64:67], v[16:31]
v_mfma_f32_32x32x16_bf16 v[0:15], v[56:59], v[68:71], v[0:15]
v_mfma_f32_32x32x16_bf16 v[16:31], v[60:63], v[68:71], v[16:31]
ds_read2_b32 v[56:57], v40 offset0:200 offset1:201
ds_read2_b32 v[58:59], v40 offset0:202 offset1:203
ds_read_b128 v[64:67], v42 offset:992
ds_read_b128 v[68:71], v42 offset:3552
ds_read2_b32 v[60:61], v41 offset0:200 offset1:201
ds_read2_b32 v[62:63], v41 offset0:202 offset1:203
s_waitcnt lgkmcnt(12)
v_mfma_f32_32x32x16_bf16 v[16:31], v[72:75], v[80:83], v[16:31]
v_mfma_f32_32x32x16_bf16 v[0:15], v[72:75], v[84:87], v[0:15]
v_mfma_f32_32x32x16_bf16 v[16:31], v[76:79], v[84:87], v[16:31]
ds_read2_b32 v[72:73], v40 offset0:192 offset1:193
ds_read2_b32 v[74:75], v40 offset0:194 offset1:195
ds_read_b128 v[80:83], v42 offset:960
ds_read_b128 v[84:87], v42 offset:3520
ds_read2_b32 v[76:77], v41 offset0:192 offset1:193
ds_read2_b32 v[78:79], v41 offset0:194 offset1:195
s_waitcnt lgkmcnt(12)
v_mfma_f32_32x32x16_bf16 v[16:31], v[88:91], v[96:99], v[16:31]
v_mfma_f32_32x32x16_bf16 v[0:15], v[88:91], v[100:103], v[0:15]
v_mfma_f32_32x32x16_bf16 v[16:31], v[92:95], v[100:103], v[16:31]
ds_read2_b32 v[88:89], v40 offset0:216 offset1:217
ds_read2_b32 v[90:91], v40 offset0:218 offset1:219
ds_read_b128 v[96:99], v42 offset:1072
ds_read_b128 v[100:103], v42 offset:3632
ds_read2_b32 v[92:93], v41 offset0:216 offset1:217
ds_read2_b32 v[94:95], v41 offset0:218 offset1:219
s_waitcnt lgkmcnt(12)
v_mfma_f32_32x32x16_bf16 v[16:31], v[56:59], v[64:67], v[16:31]
v_mfma_f32_32x32x16_bf16 v[0:15], v[56:59], v[68:71], v[0:15]
v_mfma_f32_32x32x16_bf16 v[16:31], v[60:63], v[68:71], v[16:31]
ds_read2_b32 v[56:57], v40 offset0:208 offset1:209
ds_read2_b32 v[58:59], v40 offset0:210 offset1:211
ds_read_b128 v[64:67], v42 offset:1040
ds_read_b128 v[68:71], v42 offset:3600
ds_read2_b32 v[60:61], v41 offset0:208 offset1:209
ds_read2_b32 v[62:63], v41 offset0:210 offset1:211
s_waitcnt lgkmcnt(12)
v_mfma_f32_32x32x16_bf16 v[16:31], v[72:75], v[80:83], v[16:31]
v_mfma_f32_32x32x16_bf16 v[0:15], v[72:75], v[84:87], v[0:15]
v_mfma_f32_32x32x16_bf16 v[16:31], v[76:79], v[84:87], v[16:31]
ds_read2_b32 v[72:73], v40 offset0:232 offset1:233
ds_read2_b32 v[74:75], v40 offset0:234 offset1:235
ds_read_b128 v[80:83], v42 offset:1152
ds_read_b128 v[84:87], v42 offset:3712
ds_read2_b32 v[76:77], v41 offset0:232 offset1:233
ds_read2_b32 v[78:79], v41 offset0:234 offset1:235
s_waitcnt lgkmcnt(12)
v_mfma_f32_32x32x16_bf16 v[16:31], v[88:91], v[96:99], v[16:31]
v_mfma_f32_32x32x16_bf16 v[0:15], v[88:91], v[100:103], v[0:15]
v_mfma_f32_32x32x16_bf16 v[16:31], v[92:95], v[100:103], v[16:31]
ds_read2_b32 v[88:89], v40 offset0:224 offset1:225
ds_read2_b32 v[90:91], v40 offset0:226 offset1:227
ds_read_b128 v[96:99], v42 offset:1120
ds_read_b128 v[100:103], v42 offset:3680
ds_read2_b32 v[92:93], v41 offset0:224 offset1:225
ds_read2_b32 v[94:95], v41 offset0:226 offset1:227
s_waitcnt lgkmcnt(12)
v_mfma_f32_32x32x16_bf16 v[16:31], v[56:59], v[64:67], v[16:31]
v_mfma_f32_32x32x16_bf16 v[0:15], v[56:59], v[68:71], v[0:15]
v_mfma_f32_32x32x16_bf16 v[16:31], v[60:63], v[68:71], v[16:31]
ds_read2_b32 v[56:57], v40 offset0:248 offset1:249
ds_read2_b32 v[58:59], v40 offset0:250 offset1:251
ds_read_b128 v[64:67], v42 offset:1232
ds_read_b128 v[68:71], v42 offset:3792
ds_read2_b32 v[60:61], v41 offset0:248 offset1:249
ds_read2_b32 v[62:63], v41 offset0:250 offset1:251
s_waitcnt lgkmcnt(12)
v_mfma_f32_32x32x16_bf16 v[16:31], v[72:75], v[80:83], v[16:31]
v_mfma_f32_32x32x16_bf16 v[0:15], v[72:75], v[84:87], v[0:15]
v_mfma_f32_32x32x16_bf16 v[16:31], v[76:79], v[84:87], v[16:31]
ds_read2_b32 v[72:73], v40 offset0:240 offset1:241
ds_read2_b32 v[74:75], v40 offset0:242 offset1:243
ds_read_b128 v[80:83], v42 offset:1200
ds_read_b128 v[84:87], v42 offset:3760
ds_read2_b32 v[76:77], v41 offset0:240 offset1:241
ds_read2_b32 v[78:79], v41 offset0:242 offset1:243
s_waitcnt lgkmcnt(12)
v_mfma_f32_32x32x16_bf16 v[16:31], v[88:91], v[96:99], v[16:31]
v_mfma_f32_32x32x16_bf16 v[0:15], v[88:91], v[100:103], v[0:15]
v_mfma_f32_32x32x16_bf16 v[16:31], v[92:95], v[100:103], v[16:31]
v_add_u32 v40, 1024, v40
v_add_u32 v41, 1024, v41
ds_read2_b32 v[88:89], v40 offset0:8 offset1:9
ds_read2_b32 v[90:91], v40 offset0:10 offset1:11
ds_read_b128 v[96:99], v42 offset:1312
ds_read_b128 v[100:103], v42 offset:3872
ds_read2_b32 v[92:93], v41 offset0:8 offset1:9
ds_read2_b32 v[94:95], v41 offset0:10 offset1:11
s_waitcnt lgkmcnt(12)
v_mfma_f32_32x32x16_bf16 v[16:31], v[56:59], v[64:67], v[16:31]
v_mfma_f32_32x32x16_bf16 v[0:15], v[56:59], v[68:71], v[0:15]
v_mfma_f32_32x32x16_bf16 v[16:31], v[60:63], v[68:71], v[16:31]
ds_read2_b32 v[56:57], v40 offset0:0 offset1:1
ds_read2_b32 v[58:59], v40 offset0:2 offset1:3
ds_read_b128 v[64:67], v42 offset:1280
ds_read_b128 v[68:71], v42 offset:3840
ds_read2_b32 v[60:61], v41 offset0:0 offset1:1
ds_read2_b32 v[62:63], v41 offset0:2 offset1:3
s_waitcnt lgkmcnt(12)
v_mfma_f32_32x32x16_bf16 v[16:31], v[72:75], v[80:83], v[16:31]
v_mfma_f32_32x32x16_bf16 v[0:15], v[72:75], v[84:87], v[0:15]
v_mfma_f32_32x32x16_bf16 v[16:31], v[76:79], v[84:87], v[16:31]
s_setprio 3
ds_read2_b32 v[72:73], v40 offset0:24 offset1:25
ds_read2_b32 v[74:75], v40 offset0:26 offset1:27
ds_read_b128 v[80:83], v42 offset:1392
ds_read_b128 v[84:87], v42 offset:3952
ds_read2_b32 v[76:77], v41 offset0:24 offset1:25
ds_read2_b32 v[78:79], v41 offset0:26 offset1:27
s_waitcnt lgkmcnt(12)
v_mfma_f32_32x32x16_bf16 v[16:31], v[88:91], v[96:99], v[16:31]
v_mfma_f32_32x32x16_bf16 v[0:15], v[88:91], v[100:103], v[0:15]
v_mfma_f32_32x32x16_bf16 v[16:31], v[92:95], v[100:103], v[16:31]
ds_read2_b32 v[88:89], v40 offset0:16 offset1:17
ds_read2_b32 v[90:91], v40 offset0:18 offset1:19
ds_read_b128 v[96:99], v42 offset:1360
ds_read_b128 v[100:103], v42 offset:3920
ds_read2_b32 v[92:93], v41 offset0:16 offset1:17
ds_read2_b32 v[94:95], v41 offset0:18 offset1:19
s_waitcnt lgkmcnt(12)
v_mfma_f32_32x32x16_bf16 v[16:31], v[56:59], v[64:67], v[16:31]
v_mfma_f32_32x32x16_bf16 v[0:15], v[56:59], v[68:71], v[0:15]
v_mfma_f32_32x32x16_bf16 v[16:31], v[60:63], v[68:71], v[16:31]
ds_read2_b32 v[56:57], v40 offset0:40 offset1:41
ds_read2_b32 v[58:59], v40 offset0:42 offset1:43
ds_read_b128 v[64:67], v42 offset:1472
ds_read_b128 v[68:71], v42 offset:4032
ds_read2_b32 v[60:61], v41 offset0:40 offset1:41
ds_read2_b32 v[62:63], v41 offset0:42 offset1:43
s_waitcnt lgkmcnt(12)
v_mfma_f32_32x32x16_bf16 v[16:31], v[72:75], v[80:83], v[16:31]
v_mfma_f32_32x32x16_bf16 v[0:15], v[72:75], v[84:87], v[0:15]
v_mfma_f32_32x32x16_bf16 v[16:31], v[76:79], v[84:87], v[16:31]
ds_read2_b32 v[72:73], v40 offset0:32 offset1:33
ds_read2_b32 v[74:75], v40 offset0:34 offset1:35
ds_read_b128 v[80:83], v42 offset:1440
ds_read_b128 v[84:87], v42 offset:4000
ds_read2_b32 v[76:77], v41 offset0:32 offset1:33
ds_read2_b32 v[78:79], v41 offset0:34 offset1:35
s_waitcnt lgkmcnt(12)
v_mfma_f32_32x32x16_bf16 v[16:31], v[88:91], v[96:99], v[16:31]
v_mfma_f32_32x32x16_bf16 v[0:15], v[88:91], v[100:103], v[0:15]
v_mfma_f32_32x32x16_bf16 v[16:31], v[92:95], v[100:103], v[16:31]
ds_read2_b32 v[88:89], v40 offset0:56 offset1:57
ds_read2_b32 v[90:91], v40 offset0:58 offset1:59
ds_read_b128 v[96:99], v42 offset:1552
ds_read_b128 v[100:103], v42 offset:4112
ds_read2_b32 v[92:93], v41 offset0:56 offset1:57
ds_read2_b32 v[94:95], v41 offset0:58 offset1:59
s_waitcnt lgkmcnt(12)
v_mfma_f32_32x32x16_bf16 v[16:31], v[56:59], v[64:67], v[16:31]
v_mfma_f32_32x32x16_bf16 v[0:15], v[56:59], v[68:71], v[0:15]
v_mfma_f32_32x32x16_bf16 v[16:31], v[60:63], v[68:71], v[16:31]
ds_read2_b32 v[56:57], v40 offset0:48 offset1:49
ds_read2_b32 v[58:59], v40 offset0:50 offset1:51
ds_read_b128 v[64:67], v42 offset:1520
ds_read_b128 v[68:71], v42 offset:4080
ds_read2_b32 v[60:61], v41 offset0:48 offset1:49
ds_read2_b32 v[62:63], v41 offset0:50 offset1:51
s_waitcnt lgkmcnt(12)
v_mfma_f32_32x32x16_bf16 v[16:31], v[72:75], v[80:83], v[16:31]
v_mfma_f32_32x32x16_bf16 v[0:15], v[72:75], v[84:87], v[0:15]
v_mfma_f32_32x32x16_bf16 v[16:31], v[76:79], v[84:87], v[16:31]
ds_read2_b32 v[72:73], v40 offset0:72 offset1:73
ds_read2_b32 v[74:75], v40 offset0:74 offset1:75
ds_read_b128 v[80:83], v42 offset:1632
ds_read_b128 v[84:87], v42 offset:4192
ds_read2_b32 v[76:77], v41 offset0:72 offset1:73
ds_read2_b32 v[78:79], v41 offset0:74 offset1:75
s_waitcnt lgkmcnt(12)
v_mfma_f32_32x32x16_bf16 v[16:31], v[88:91], v[96:99], v[16:31]
v_mfma_f32_32x32x16_bf16 v[0:15], v[88:91], v[100:103], v[0:15]
v_mfma_f32_32x32x16_bf16 v[16:31], v[92:95], v[100:103], v[16:31]
ds_read2_b32 v[88:89], v40 offset0:64 offset1:65
ds_read2_b32 v[90:91], v40 offset0:66 offset1:67
ds_read_b128 v[96:99], v42 offset:1600
ds_read_b128 v[100:103], v42 offset:4160
ds_read2_b32 v[92:93], v41 offset0:64 offset1:65
ds_read2_b32 v[94:95], v41 offset0:66 offset1:67
s_waitcnt lgkmcnt(12)
v_mfma_f32_32x32x16_bf16 v[16:31], v[56:59], v[64:67], v[16:31]
v_mfma_f32_32x32x16_bf16 v[0:15], v[56:59], v[68:71], v[0:15]
v_mfma_f32_32x32x16_bf16 v[16:31], v[60:63], v[68:71], v[16:31]
ds_read2_b32 v[56:57], v40 offset0:88 offset1:89
ds_read2_b32 v[58:59], v40 offset0:90 offset1:91
ds_read_b128 v[64:67], v42 offset:1712
ds_read_b128 v[68:71], v42 offset:4272
ds_read2_b32 v[60:61], v41 offset0:88 offset1:89
ds_read2_b32 v[62:63], v41 offset0:90 offset1:91
s_waitcnt lgkmcnt(12)
v_mfma_f32_32x32x16_bf16 v[16:31], v[72:75], v[80:83], v[16:31]
v_mfma_f32_32x32x16_bf16 v[0:15], v[72:75], v[84:87], v[0:15]
v_mfma_f32_32x32x16_bf16 v[16:31], v[76:79], v[84:87], v[16:31]
ds_read2_b32 v[72:73], v40 offset0:80 offset1:81
ds_read2_b32 v[74:75], v40 offset0:82 offset1:83
ds_read_b128 v[80:83], v42 offset:1680
ds_read_b128 v[84:87], v42 offset:4240
ds_read2_b32 v[76:77], v41 offset0:80 offset1:81
ds_read2_b32 v[78:79], v41 offset0:82 offset1:83
s_waitcnt lgkmcnt(12)
v_mfma_f32_32x32x16_bf16 v[16:31], v[88:91], v[96:99], v[16:31]
v_mfma_f32_32x32x16_bf16 v[0:15], v[88:91], v[100:103], v[0:15]
v_mfma_f32_32x32x16_bf16 v[16:31], v[92:95], v[100:103], v[16:31]
ds_read2_b32 v[88:89], v40 offset0:104 offset1:105
ds_read2_b32 v[90:91], v40 offset0:106 offset1:107
ds_read_b128 v[96:99], v42 offset:1792
ds_read_b128 v[100:103], v42 offset:4352
ds_read2_b32 v[92:93], v41 offset0:104 offset1:105
ds_read2_b32 v[94:95], v41 offset0:106 offset1:107
s_waitcnt lgkmcnt(12)
v_mfma_f32_32x32x16_bf16 v[16:31], v[56:59], v[64:67], v[16:31]
v_mfma_f32_32x32x16_bf16 v[0:15], v[56:59], v[68:71], v[0:15]
v_mfma_f32_32x32x16_bf16 v[16:31], v[60:63], v[68:71], v[16:31]
ds_read2_b32 v[56:57], v40 offset0:96 offset1:97
ds_read2_b32 v[58:59], v40 offset0:98 offset1:99
ds_read_b128 v[64:67], v42 offset:1760
ds_read_b128 v[68:71], v42 offset:4320
ds_read2_b32 v[60:61], v41 offset0:96 offset1:97
ds_read2_b32 v[62:63], v41 offset0:98 offset1:99
s_waitcnt lgkmcnt(12)
v_mfma_f32_32x32x16_bf16 v[16:31], v[72:75], v[80:83], v[16:31]
v_mfma_f32_32x32x16_bf16 v[0:15], v[72:75], v[84:87], v[0:15]
v_mfma_f32_32x32x16_bf16 v[16:31], v[76:79], v[84:87], v[16:31]
ds_read2_b32 v[72:73], v40 offset0:120 offset1:121
ds_read2_b32 v[74:75], v40 offset0:122 offset1:123
ds_read_b128 v[80:83], v42 offset:1872
ds_read_b128 v[84:87], v42 offset:4432
ds_read2_b32 v[76:77], v41 offset0:120 offset1:121
ds_read2_b32 v[78:79], v41 offset0:122 offset1:123
s_waitcnt lgkmcnt(12)
v_mfma_f32_32x32x16_bf16 v[16:31], v[88:91], v[96:99], v[16:31]
v_mfma_f32_32x32x16_bf16 v[0:15], v[88:91], v[100:103], v[0:15]
v_mfma_f32_32x32x16_bf16 v[16:31], v[92:95], v[100:103], v[16:31]
ds_read2_b32 v[88:89], v40 offset0:112 offset1:113
ds_read2_b32 v[90:91], v40 offset0:114 offset1:115
ds_read_b128 v[96:99], v42 offset:1840
ds_read_b128 v[100:103], v42 offset:4400
ds_read2_b32 v[92:93], v41 offset0:112 offset1:113
ds_read2_b32 v[94:95], v41 offset0:114 offset1:115
s_waitcnt lgkmcnt(12)
v_mfma_f32_32x32x16_bf16 v[16:31], v[56:59], v[64:67], v[16:31]
v_mfma_f32_32x32x16_bf16 v[0:15], v[56:59], v[68:71], v[0:15]
v_mfma_f32_32x32x16_bf16 v[16:31], v[60:63], v[68:71], v[16:31]
ds_read2_b32 v[56:57], v40 offset0:136 offset1:137
ds_read2_b32 v[58:59], v40 offset0:138 offset1:139
ds_read_b128 v[64:67], v42 offset:1952
ds_read_b128 v[68:71], v42 offset:4512
ds_read2_b32 v[60:61], v41 offset0:136 offset1:137
ds_read2_b32 v[62:63], v41 offset0:138 offset1:139
s_waitcnt lgkmcnt(12)
v_mfma_f32_32x32x16_bf16 v[16:31], v[72:75], v[80:83], v[16:31]
v_mfma_f32_32x32x16_bf16 v[0:15], v[72:75], v[84:87], v[0:15]
v_mfma_f32_32x32x16_bf16 v[16:31], v[76:79], v[84:87], v[16:31]
ds_read2_b32 v[72:73], v40 offset0:128 offset1:129
ds_read2_b32 v[74:75], v40 offset0:130 offset1:131
ds_read_b128 v[80:83], v42 offset:1920
ds_read_b128 v[84:87], v42 offset:4480
ds_read2_b32 v[76:77], v41 offset0:128 offset1:129
ds_read2_b32 v[78:79], v41 offset0:130 offset1:131
s_waitcnt lgkmcnt(12)
v_mfma_f32_32x32x16_bf16 v[16:31], v[88:91], v[96:99], v[16:31]
v_mfma_f32_32x32x16_bf16 v[0:15], v[88:91], v[100:103], v[0:15]
v_mfma_f32_32x32x16_bf16 v[16:31], v[92:95], v[100:103], v[16:31]
ds_read2_b32 v[88:89], v40 offset0:152 offset1:153
ds_read2_b32 v[90:91], v40 offset0:154 offset1:155
ds_read_b128 v[96:99], v42 offset:2032
ds_read_b128 v[100:103], v42 offset:4592
ds_read2_b32 v[92:93], v41 offset0:152 offset1:153
ds_read2_b32 v[94:95], v41 offset0:154 offset1:155
s_waitcnt lgkmcnt(12)
v_mfma_f32_32x32x16_bf16 v[16:31], v[56:59], v[64:67], v[16:31]
v_mfma_f32_32x32x16_bf16 v[0:15], v[56:59], v[68:71], v[0:15]
v_mfma_f32_32x32x16_bf16 v[16:31], v[60:63], v[68:71], v[16:31]
ds_read2_b32 v[56:57], v40 offset0:144 offset1:145
ds_read2_b32 v[58:59], v40 offset0:146 offset1:147
ds_read_b128 v[64:67], v42 offset:2000
ds_read_b128 v[68:71], v42 offset:4560
ds_read2_b32 v[60:61], v41 offset0:144 offset1:145
ds_read2_b32 v[62:63], v41 offset0:146 offset1:147
s_waitcnt lgkmcnt(12)
v_mfma_f32_32x32x16_bf16 v[16:31], v[72:75], v[80:83], v[16:31]
v_mfma_f32_32x32x16_bf16 v[0:15], v[72:75], v[84:87], v[0:15]
v_mfma_f32_32x32x16_bf16 v[16:31], v[76:79], v[84:87], v[16:31]
ds_read2_b32 v[72:73], v40 offset0:168 offset1:169
ds_read2_b32 v[74:75], v40 offset0:170 offset1:171
ds_read_b128 v[80:83], v42 offset:2112
ds_read_b128 v[84:87], v42 offset:4672
ds_read2_b32 v[76:77], v41 offset0:168 offset1:169
ds_read2_b32 v[78:79], v41 offset0:170 offset1:171
s_waitcnt lgkmcnt(12)
v_mfma_f32_32x32x16_bf16 v[16:31], v[88:91], v[96:99], v[16:31]
v_mfma_f32_32x32x16_bf16 v[0:15], v[88:91], v[100:103], v[0:15]
v_mfma_f32_32x32x16_bf16 v[16:31], v[92:95], v[100:103], v[16:31]
ds_read2_b32 v[88:89], v40 offset0:160 offset1:161
ds_read2_b32 v[90:91], v40 offset0:162 offset1:163
ds_read_b128 v[96:99], v42 offset:2080
ds_read_b128 v[100:103], v42 offset:4640
ds_read2_b32 v[92:93], v41 offset0:160 offset1:161
ds_read2_b32 v[94:95], v41 offset0:162 offset1:163
s_waitcnt lgkmcnt(12)
v_mfma_f32_32x32x16_bf16 v[16:31], v[56:59], v[64:67], v[16:31]
v_mfma_f32_32x32x16_bf16 v[0:15], v[56:59], v[68:71], v[0:15]
v_mfma_f32_32x32x16_bf16 v[16:31], v[60:63], v[68:71], v[16:31]
ds_read2_b32 v[56:57], v40 offset0:184 offset1:185
ds_read2_b32 v[58:59], v40 offset0:186 offset1:187
ds_read_b128 v[64:67], v42 offset:2192
ds_read_b128 v[68:71], v42 offset:4752
ds_read2_b32 v[60:61], v41 offset0:184 offset1:185
ds_read2_b32 v[62:63], v41 offset0:186 offset1:187
s_waitcnt lgkmcnt(12)
v_mfma_f32_32x32x16_bf16 v[16:31], v[72:75], v[80:83], v[16:31]
v_mfma_f32_32x32x16_bf16 v[0:15], v[72:75], v[84:87], v[0:15]
v_mfma_f32_32x32x16_bf16 v[16:31], v[76:79], v[84:87], v[16:31]
ds_read2_b32 v[72:73], v40 offset0:176 offset1:177
ds_read2_b32 v[74:75], v40 offset0:178 offset1:179
ds_read_b128 v[80:83], v42 offset:2160
ds_read_b128 v[84:87], v42 offset:4720
ds_read2_b32 v[76:77], v41 offset0:176 offset1:177
ds_read2_b32 v[78:79], v41 offset0:178 offset1:179
s_waitcnt lgkmcnt(12)
v_mfma_f32_32x32x16_bf16 v[16:31], v[88:91], v[96:99], v[16:31]
v_mfma_f32_32x32x16_bf16 v[0:15], v[88:91], v[100:103], v[0:15]
v_mfma_f32_32x32x16_bf16 v[16:31], v[92:95], v[100:103], v[16:31]
ds_read2_b32 v[88:89], v40 offset0:200 offset1:201
ds_read2_b32 v[90:91], v40 offset0:202 offset1:203
ds_read_b128 v[96:99], v42 offset:2272
ds_read_b128 v[100:103], v42 offset:4832
ds_read2_b32 v[92:93], v41 offset0:200 offset1:201
ds_read2_b32 v[94:95], v41 offset0:202 offset1:203
s_waitcnt lgkmcnt(12)
v_mfma_f32_32x32x16_bf16 v[16:31], v[56:59], v[64:67], v[16:31]
v_mfma_f32_32x32x16_bf16 v[0:15], v[56:59], v[68:71], v[0:15]
v_mfma_f32_32x32x16_bf16 v[16:31], v[60:63], v[68:71], v[16:31]
ds_read2_b32 v[56:57], v40 offset0:192 offset1:193
ds_read2_b32 v[58:59], v40 offset0:194 offset1:195
ds_read_b128 v[64:67], v42 offset:2240
ds_read_b128 v[68:71], v42 offset:4800
ds_read2_b32 v[60:61], v41 offset0:192 offset1:193
ds_read2_b32 v[62:63], v41 offset0:194 offset1:195
s_waitcnt lgkmcnt(12)
v_mfma_f32_32x32x16_bf16 v[16:31], v[72:75], v[80:83], v[16:31]
v_mfma_f32_32x32x16_bf16 v[0:15], v[72:75], v[84:87], v[0:15]
v_mfma_f32_32x32x16_bf16 v[16:31], v[76:79], v[84:87], v[16:31]
ds_read2_b32 v[72:73], v40 offset0:216 offset1:217
ds_read2_b32 v[74:75], v40 offset0:218 offset1:219
ds_read_b128 v[80:83], v42 offset:2352
ds_read_b128 v[84:87], v42 offset:4912
ds_read2_b32 v[76:77], v41 offset0:216 offset1:217
ds_read2_b32 v[78:79], v41 offset0:218 offset1:219
s_waitcnt lgkmcnt(12)
v_mfma_f32_32x32x16_bf16 v[16:31], v[88:91], v[96:99], v[16:31]
v_mfma_f32_32x32x16_bf16 v[0:15], v[88:91], v[100:103], v[0:15]
v_mfma_f32_32x32x16_bf16 v[16:31], v[92:95], v[100:103], v[16:31]
ds_read2_b32 v[88:89], v40 offset0:208 offset1:209
ds_read2_b32 v[90:91], v40 offset0:210 offset1:211
ds_read_b128 v[96:99], v42 offset:2320
ds_read_b128 v[100:103], v42 offset:4880
ds_read2_b32 v[92:93], v41 offset0:208 offset1:209
ds_read2_b32 v[94:95], v41 offset0:210 offset1:211
s_waitcnt lgkmcnt(12)
v_mfma_f32_32x32x16_bf16 v[16:31], v[56:59], v[64:67], v[16:31]
v_mfma_f32_32x32x16_bf16 v[0:15], v[56:59], v[68:71], v[0:15]
v_mfma_f32_32x32x16_bf16 v[16:31], v[60:63], v[68:71], v[16:31]
ds_read2_b32 v[56:57], v40 offset0:232 offset1:233
ds_read2_b32 v[58:59], v40 offset0:234 offset1:235
ds_read_b128 v[64:67], v42 offset:2432
ds_read_b128 v[68:71], v42 offset:4992
ds_read2_b32 v[60:61], v41 offset0:232 offset1:233
ds_read2_b32 v[62:63], v41 offset0:234 offset1:235
s_waitcnt lgkmcnt(12)
v_mfma_f32_32x32x16_bf16 v[16:31], v[72:75], v[80:83], v[16:31]
v_mfma_f32_32x32x16_bf16 v[0:15], v[72:75], v[84:87], v[0:15]
v_mfma_f32_32x32x16_bf16 v[16:31], v[76:79], v[84:87], v[16:31]
ds_read2_b32 v[72:73], v40 offset0:224 offset1:225
ds_read2_b32 v[74:75], v40 offset0:226 offset1:227
ds_read_b128 v[80:83], v42 offset:2400
ds_read_b128 v[84:87], v42 offset:4960
ds_read2_b32 v[76:77], v41 offset0:224 offset1:225
ds_read2_b32 v[78:79], v41 offset0:226 offset1:227
s_waitcnt lgkmcnt(12)
v_mfma_f32_32x32x16_bf16 v[16:31], v[88:91], v[96:99], v[16:31]
v_mfma_f32_32x32x16_bf16 v[0:15], v[88:91], v[100:103], v[0:15]
v_mfma_f32_32x32x16_bf16 v[16:31], v[92:95], v[100:103], v[16:31]
ds_read2_b32 v[88:89], v40 offset0:248 offset1:249
ds_read2_b32 v[90:91], v40 offset0:250 offset1:251
ds_read_b128 v[96:99], v42 offset:2512
ds_read_b128 v[100:103], v42 offset:5072
ds_read2_b32 v[92:93], v41 offset0:248 offset1:249
ds_read2_b32 v[94:95], v41 offset0:250 offset1:251
s_waitcnt lgkmcnt(12)
v_mfma_f32_32x32x16_bf16 v[16:31], v[56:59], v[64:67], v[16:31]
v_mfma_f32_32x32x16_bf16 v[0:15], v[56:59], v[68:71], v[0:15]
v_mfma_f32_32x32x16_bf16 v[16:31], v[60:63], v[68:71], v[16:31]
ds_read2_b32 v[56:57], v40 offset0:240 offset1:241
ds_read2_b32 v[58:59], v40 offset0:242 offset1:243
ds_read_b128 v[64:67], v42 offset:2480
ds_read_b128 v[68:71], v42 offset:5040
ds_read2_b32 v[60:61], v41 offset0:240 offset1:241
ds_read2_b32 v[62:63], v41 offset0:242 offset1:243
s_waitcnt lgkmcnt(12)
v_mfma_f32_32x32x16_bf16 v[16:31], v[72:75], v[80:83], v[16:31]
v_mfma_f32_32x32x16_bf16 v[0:15], v[72:75], v[84:87], v[0:15]
v_mfma_f32_32x32x16_bf16 v[16:31], v[76:79], v[84:87], v[16:31]
s_waitcnt lgkmcnt(6)
v_mfma_f32_32x32x16_bf16 v[16:31], v[88:91], v[96:99], v[16:31]
v_mfma_f32_32x32x16_bf16 v[0:15], v[88:91], v[100:103], v[0:15]
v_mfma_f32_32x32x16_bf16 v[16:31], v[92:95], v[100:103], v[16:31]
s_waitcnt lgkmcnt(0)
v_mfma_f32_32x32x16_bf16 v[16:31], v[56:59], v[64:67], v[16:31]
v_mfma_f32_32x32x16_bf16 v[0:15], v[56:59], v[68:71], v[0:15]
v_mfma_f32_32x32x16_bf16 v[16:31], v[60:63], v[68:71], v[16:31]
v_mul_u32_u24 v45, 36864, v43
v_lshl_add_u32 v45, v44, 3, v45
s_lshl_b32 s48, s50, 4
s_add_u32 s48, s48, 0x940000
v_add_u32 v45, s48, v45
s_nop 5
v_cvt_pk_bf16_f32 v56, v0, v1
v_cvt_pk_bf16_f32 v57, v2, v3
global_store_dwordx2 v45, v[56:57], s[30:31] sc1
v_add_u32 v45, 9216, v45
v_cvt_pk_bf16_f32 v58, v4, v5
v_cvt_pk_bf16_f32 v59, v6, v7
global_store_dwordx2 v45, v[58:59], s[30:31] sc1
v_add_u32 v45, 9216, v45
v_cvt_pk_bf16_f32 v60, v8, v9
v_cvt_pk_bf16_f32 v61, v10, v11
global_store_dwordx2 v45, v[60:61], s[30:31] sc1
v_add_u32 v45, 9216, v45
v_cvt_pk_bf16_f32 v62, v12, v13
v_cvt_pk_bf16_f32 v63, v14, v15
global_store_dwordx2 v45, v[62:63], s[30:31] sc1
v_add_u32 v45, 1152000, v45
v_cvt_pk_bf16_f32 v64, v16, v17
v_cvt_pk_bf16_f32 v65, v18, v19
global_store_dwordx2 v45, v[64:65], s[30:31] sc1
v_add_u32 v45, 9216, v45
v_cvt_pk_bf16_f32 v66, v20, v21
v_cvt_pk_bf16_f32 v67, v22, v23
global_store_dwordx2 v45, v[66:67], s[30:31] sc1
v_add_u32 v45, 9216, v45
v_cvt_pk_bf16_f32 v68, v24, v25
v_cvt_pk_bf16_f32 v69, v26, v27
global_store_dwordx2 v45, v[68:69], s[30:31] sc1
v_add_u32 v45, 9216, v45
v_cvt_pk_bf16_f32 v70, v28, v29
v_cvt_pk_bf16_f32 v71, v30, v31
global_store_dwordx2 v45, v[70:71], s[30:31] sc1
s_setprio 3
s_waitcnt vmcnt(0)
s_lshl_b32 s50, s50, 3
s_add_u32 s50, s50, 0x6de000
s_andn2_b32 s51, s61, 0xff
v_mov_b32 v158, s50
v_mov_b32 v148, s60
v_mov_b32 v149, s51
s_mov_b64 exec, 1
global_store_dwordx2 v158, v[148:149], s[30:31] sc1
s_mov_b64 exec, -1
H2_noconv:
v_lshrrev_b32 v158, 3, v162
v_cmp_eq_u32 vcc, s40, v158
s_mov_b64 s[54:55], vcc
s_not_b64 s[56:57], s[54:55]
v_and_b32 v166, 7, v162
v_mul_u32_u24 v156, 2320, v166
v_lshl_add_u32 v156, v163, 4, v156
v_add_u32 v156, 101504, v156
v_lshl_add_u32 v166, v163, 3, v166
v_lshlrev_b32 v166, 4, v166
s_lshl_b32 s46, s2, 2
s_add_u32 s46, s46, 2
s_mul_i32 s46, s46, 4608
s_add_u32 s46, s46, s39
s_add_u32 s48, s30, s46
s_addc_u32 s49, s31, 0
s_xor_b32 s47, s2, 1
s_lshl_b32 s46, s47, 2
s_add_u32 s46, s46, 2
s_mul_i32 s46, s46, 4608
s_add_u32 s46, s46, s39
s_add_u32 s66, s30, s46
s_addc_u32 s67, s31, 0
s_lshl_b32 s46, s33, 11
s_lshl_b32 s47, s47, 3
s_add_u32 s46, s46, s47
s_add_u32 s46, s46, 0x6dd000
v_mov_b32 v158, s46
global_load_dwordx2 v[148:149], v158, s[30:31] sc1
s_waitcnt vmcnt(0)
v_cmp_eq_u64 vcc, s[60:61], v[148:149]
s_cmp_eq_u64 vcc, -1
s_cselect_b32 s71, 1, 0
s_mul_i32 s46, s40, 294912
s_add_u32 s46, s46, 0xa6800
s_add_u32 s58, s30, s46
s_addc_u32 s59, s31, 0
global_load_dwordx4 v[36:39], v157, s[58:59] offset:0
global_load_dwordx4 v[40:43], v157, s[58:59] offset:1024
global_load_dwordx4 v[44:47], v157, s[58:59] offset:2048
global_load_dwordx4 v[48:51], v157, s[58:59] offset:3072
s_add_u32 s58, s58, 4096
s_addc_u32 s59, s59, 0
global_load_dwordx4 v[52:55], v157, s[58:59] offset:0
global_load_dwordx4 v[56:59], v157, s[58:59] offset:1024
global_load_dwordx4 v[60:63], v157, s[58:59] offset:2048
global_load_dwordx4 v[64:67], v157, s[58:59] offset:3072
s_add_u32 s58, s58, 4096
s_addc_u32 s59, s59, 0
global_load_dwordx4 v[68:71], v157, s[58:59] offset:0
s_mul_i32 s46, s40, 294912
s_add_u32 s46, s46, 0xaf800
s_add_u32 s58, s30, s46
s_addc_u32 s59, s31, 0
global_load_dwordx4 v[72:75], v157, s[58:59] offset:0
global_load_dwordx4 v[76:79], v157, s[58:59] offset:1024
global_load_dwordx4 v[80:83], v157, s[58:59] offset:2048
global_load_dwordx4 v[84:87], v157, s[58:59] offset:3072
s_add_u32 s58, s58, 4096
s_addc_u32 s59, s59, 0
global_load_dwordx4 v[88:91], v157, s[58:59] offset:0
global_load_dwordx4 v[92:95], v157, s[58:59] offset:1024
global_load_dwordx4 v[96:99], v157, s[58:59] offset:2048
global_load_dwordx4 v[100:103], v157, s[58:59] offset:3072
s_add_u32 s58, s58, 4096
s_addc_u32 s59, s59, 0
global_load_dwordx4 v[104:107], v157, s[58:59] offset:0
H2_sp11_re:
ds_read_b32 v159, v167 offset:36
s_waitcnt lgkmcnt(0)
v_cmp_ne_u32 vcc, 1, v159
s_cbranch_vccz H2_sp11_ok
s_add_u32 s52, s52, 1
s_cmp_gt_u32 s52, 200000
s_cbranch_scc1 H2_sp11_ok
s_sleep 4
s_branch H2_sp11_re
H2_sp11_ok:
ds_read_b128 v[144:147], v157 offset:11264
s_waitcnt lgkmcnt(0)
s_mul_i32 s46, s40, 294912
s_add_u32 s46, s46, 0xb8800
s_add_u32 s58, s30, s46
s_addc_u32 s59, s31, 0
s_waitcnt vmcnt(17)
v_mfma_f32_16x16x32_bf16 v[0:3], v[36:39], v[144:147], 0
global_load_dwordx4 v[36:39], v157, s[58:59] offset:0
s_waitcnt vmcnt(17)
v_mfma_f32_16x16x32_bf16 v[4:7], v[40:43], v[144:147], 0
global_load_dwordx4 v[40:43], v157, s[58:59] offset:1024
s_waitcnt vmcnt(17)
v_mfma_f32_16x16x32_bf16 v[8:11], v[44:47], v[144:147], 0
global_load_dwordx4 v[44:47], v157, s[58:59] offset:2048
s_waitcnt vmcnt(17)
v_mfma_f32_16x16x32_bf16 v[12:15], v[48:51], v[144:147], 0
global_load_dwordx4 v[48:51], v157, s[58:59] offset:3072
s_waitcnt vmcnt(17)
v_mfma_f32_16x16x32_bf16 v[16:19], v[52:55], v[144:147], 0
s_add_u32 s58, s58, 4096
s_addc_u32 s59, s59, 0
global_load_dwordx4 v[52:55], v157, s[58:59] offset:0
s_waitcnt vmcnt(17)
v_mfma_f32_16x16x32_bf16 v[20:23], v[56:59], v[144:147], 0
global_load_dwordx4 v[56:59], v157, s[58:59] offset:1024
s_waitcnt vmcnt(17)
v_mfma_f32_16x16x32_bf16 v[24:27], v[60:63], v[144:147], 0
global_load_dwordx4 v[60:63], v157, s[58:59] offset:2048
s_waitcnt vmcnt(17)
v_mfma_f32_16x16x32_bf16 v[28:31], v[64:67], v[144:147], 0
global_load_dwordx4 v[64:67], v157, s[58:59] offset:3072
s_waitcnt vmcnt(17)
v_mfma_f32_16x16x32_bf16 v[32:35], v[68:71], v[144:147], 0
s_add_u32 s58, s58, 4096
s_addc_u32 s59, s59, 0
global_load_dwordx4 v[68:71], v157, s[58:59] offset:0
H2_sp12_re:
ds_read_b32 v159, v167 offset:44
s_waitcnt lgkmcnt(0)
v_cmp_ne_u32 vcc, 1, v159
s_cbranch_vccz H2_sp12_ok
s_add_u32 s52, s52, 1
s_cmp_gt_u32 s52, 200000
s_cbranch_scc1 H2_sp12_ok
s_sleep 4
s_branch H2_sp12_re
H2_sp12_ok:
ds_read_b128 v[144:147], v157 offset:12288
s_waitcnt lgkmcnt(0)
s_mul_i32 s46, s40, 294912
s_add_u32 s46, s46, 0xc1800
s_add_u32 s58, s30, s46
s_addc_u32 s59, s31, 0
s_waitcnt vmcnt(17)
v_mfma_f32_16x16x32_bf16 v[0:3], v[72:75], v[144:147], v[0:3]
global_load_dwordx4 v[72:75], v157, s[58:59] offset:0
s_waitcnt vmcnt(17)
v_mfma_f32_16x16x32_bf16 v[4:7], v[76:79], v[144:147], v[4:7]
global_load_dwordx4 v[76:79], v157, s[58:59] offset:1024
s_waitcnt vmcnt(17)
v_mfma_f32_16x16x32_bf16 v[8:11], v[80:83], v[144:147], v[8:11]
global_load_dwordx4 v[80:83], v157, s[58:59] offset:2048
s_waitcnt vmcnt(17)
v_mfma_f32_16x16x32_bf16 v[12:15], v[84:87], v[144:147], v[12:15]
global_load_dwordx4 v[84:87], v157, s[58:59] offset:3072
s_waitcnt vmcnt(17)
v_mfma_f32_16x16x32_bf16 v[16:19], v[88:91], v[144:147], v[16:19]
s_add_u32 s58, s58, 4096
s_addc_u32 s59, s59, 0
global_load_dwordx4 v[88:91], v157, s[58:59] offset:0
s_waitcnt vmcnt(17)
v_mfma_f32_16x16x32_bf16 v[20:23], v[92:95], v[144:147], v[20:23]
global_load_dwordx4 v[92:95], v157, s[58:59] offset:1024
s_waitcnt vmcnt(17)
v_mfma_f32_16x16x32_bf16 v[24:27], v[96:99], v[144:147], v[24:27]
global_load_dwordx4 v[96:99], v157, s[58:59] offset:2048
s_waitcnt vmcnt(17)
v_mfma_f32_16x16x32_bf16 v[28:31], v[100:103], v[144:147], v[28:31]
global_load_dwordx4 v[100:103], v157, s[58:59] offset:3072
s_waitcnt vmcnt(17)
v_mfma_f32_16x16x32_bf16 v[32:35], v[104:107], v[144:147], v[32:35]
s_add_u32 s58, s58, 4096
s_addc_u32 s59, s59, 0
global_load_dwordx4 v[104:107], v157, s[58:59] offset:0
s_cmp_eq_u32 s33, 1
s_cbranch_scc0 H2_sk13
H2_sp14_re:
ds_read_b64 v[148:149], v167 offset:272
s_waitcnt lgkmcnt(0)
v_cmp_ne_u64 vcc, s[68:69], v[148:149]
s_cbranch_vccz H2_sp14_ok
s_add_u32 s52, s52, 1
s_cmp_gt_u32 s52, 200000
s_cbranch_scc1 H2_sp14_ok
s_sleep 2
s_branch H2_sp14_re
H2_sp14_ok:
v_add_u32 v160, 79872, v164
v_add_u32 v161, 79872, v165
ds_read_b128 v[144:147], v160 offset:0
ds_read_b128 v[148:151], v160 offset:512
ds_read_b128 v[152:155], v161 offset:0
ds_read_b128 v[108:111], v160 offset:2560
ds_read_b128 v[112:115], v160 offset:3072
ds_read_b128 v[116:119], v161 offset:2560
ds_read_b128 v[120:123], v160 offset:5120
ds_read_b128 v[124:127], v160 offset:5632
ds_read_b128 v[128:131], v161 offset:5120
ds_read_b128 v[132:135], v160 offset:7680
ds_read_b128 v[136:139], v160 offset:8192
ds_read_b128 v[140:143], v161 offset:7680
s_waitcnt lgkmcnt(6)
v_pk_add_f32 v[144:145], v[144:145], v[108:109]
v_pk_add_f32 v[146:147], v[146:147], v[110:111]
v_pk_add_f32 v[148:149], v[148:149], v[112:113]
v_pk_add_f32 v[150:151], v[150:151], v[114:115]
v_pk_add_f32 v[152:153], v[152:153], v[116:117]
v_add_f32 v154, v154, v118
ds_read_b128 v[108:111], v160 offset:10240
ds_read_b128 v[112:115], v160 offset:10752
ds_read_b128 v[116:119], v161 offset:10240
s_waitcnt lgkmcnt(6)
v_pk_add_f32 v[144:145], v[144:145], v[120:121]
v_pk_add_f32 v[146:147], v[146:147], v[122:123]
v_pk_add_f32 v[148:149], v[148:149], v[124:125]
v_pk_add_f32 v[150:151], v[150:151], v[126:127]
v_pk_add_f32 v[152:153], v[152:153], v[128:129]
v_add_f32 v154, v154, v130
ds_read_b128 v[120:123], v160 offset:12800
ds_read_b128 v[124:127], v160 offset:13312
ds_read_b128 v[128:131], v161 offset:12800
s_waitcnt lgkmcnt(6)
v_pk_add_f32 v[144:145], v[144:145], v[132:133]
v_pk_add_f32 v[146:147], v[146:147], v[134:135]
v_pk_add_f32 v[148:149], v[148:149], v[136:137]
v_pk_add_f32 v[150:151], v[150:151], v[138:139]
v_pk_add_f32 v[152:153], v[152:153], v[140:141]
v_add_f32 v154, v154, v142
ds_read_b128 v[132:135], v160 offset:15360
ds_read_b128 v[136:139], v160 offset:15872
ds_read_b128 v[140:143], v161 offset:15360
s_waitcnt lgkmcnt(6)
v_pk_add_f32 v[144:145], v[144:145], v[108:109]
v_pk_add_f32 v[146:147], v[146:147], v[110:111]
v_pk_add_f32 v[148:149], v[148:149], v[112:113]
v_pk_add_f32 v[150:151], v[150:151], v[114:115]
v_pk_add_f32 v[152:153], v[152:153], v[116:117]
v_add_f32 v154, v154, v118
ds_read_b128 v[108:111], v160 offset:17920
ds_read_b128 v[112:115], v160 offset:18432
ds_read_b128 v[116:119], v161 offset:17920
s_waitcnt lgkmcnt(6)
v_pk_add_f32 v[144:145], v[144:145], v[120:121]
v_pk_add_f32 v[146:147], v[146:147], v[122:123]
v_pk_add_f32 v[148:149], v[148:149], v[124:125]
v_pk_add_f32 v[150:151], v[150:151], v[126:127]
v_pk_add_f32 v[152:153], v[152:153], v[128:129]
v_add_f32 v154, v154, v130
s_waitcnt lgkmcnt(3)
v_pk_add_f32 v[144:145], v[144:145], v[132:133]
v_pk_add_f32 v[146:147], v[146:147], v[134:135]
v_pk_add_f32 v[148:149], v[148:149], v[136:137]
v_pk_add_f32 v[150:151], v[150:151], v[138:139]
v_pk_add_f32 v[152:153], v[152:153], v[140:141]
v_add_f32 v154, v154, v142
s_waitcnt lgkmcnt(0)
v_pk_add_f32 v[144:145], v[144:145], v[108:109]
v_pk_add_f32 v[146:147], v[146:147], v[110:111]
v_pk_add_f32 v[148:149], v[148:149], v[112:113]
v_pk_add_f32 v[150:151], v[150:151], v[114:115]
v_pk_add_f32 v[152:153], v[152:153], v[116:117]
v_add_f32 v154, v154, v118
v_rcp_f32 v154, v154
s_nop 0
v_mul_f32 v144, v144, v154
v_mul_f32 v145, v145, v154
v_mul_f32 v146, v146, v154
v_mul_f32 v147, v147, v154
v_mul_f32 v148, v148, v154
v_mul_f32 v149, v149, v154
v_mul_f32 v150, v150, v154
v_mul_f32 v151, v151, v154
v_mul_f32 v152, v152, v154
v_mul_f32 v153, v153, v154
v_cvt_pk_bf16_f32 v144, v144, v145
v_cvt_pk_bf16_f32 v145, v146, v147
v_cvt_pk_bf16_f32 v146, v148, v149
v_cvt_pk_bf16_f32 v147, v150, v151
v_cvt_pk_bf16_f32 v155, v152, v153
ds_write_b128 v157, v[144:147] offset:13312
v_lshlrev_b32 v160, 4, v162
v_lshrrev_b32 v161, 1, v163
v_lshl_add_u32 v160, v161, 2, v160
s_mov_b32 exec_lo, 0xffff
s_mov_b32 exec_hi, 0xffff
ds_write_b32 v160, v155 offset:19712
s_mov_b64 exec, 1
v_mov_b32 v160, 52
v_mov_b32 v161, 1
ds_write_b32 v160, v161
s_mov_b64 exec, -1
H2_sk13:
H2_sp15_re:
ds_read_b32 v159, v167 offset:52
s_waitcnt lgkmcnt(0)
v_cmp_ne_u32 vcc, 1, v159
s_cbranch_vccz H2_sp15_ok
s_add_u32 s52, s52, 1
s_cmp_gt_u32 s52, 200000
s_cbranch_scc1 H2_sp15_ok
s_sleep 4
s_branch H2_sp15_re
H2_sp15_ok:
ds_read_b128 v[144:147], v157 offset:13312
s_waitcnt lgkmcnt(0)
s_mul_i32 s46, s40, 294912
s_add_u32 s46, s46, 0xca800
s_add_u32 s58, s30, s46
s_addc_u32 s59, s31, 0
s_waitcnt vmcnt(17)
v_mfma_f32_16x16x32_bf16 v[0:3], v[36:39], v[144:147], v[0:3]
global_load_dwordx4 v[36:39], v157, s[58:59] offset:0
s_waitcnt vmcnt(17)
v_mfma_f32_16x16x32_bf16 v[4:7], v[40:43], v[144:147], v[4:7]
global_load_dwordx4 v[40:43], v157, s[58:59] offset:1024
s_waitcnt vmcnt(17)
v_mfma_f32_16x16x32_bf16 v[8:11], v[44:47], v[144:147], v[8:11]
global_load_dwordx4 v[44:47], v157, s[58:59] offset:2048
s_waitcnt vmcnt(17)
v_mfma_f32_16x16x32_bf16 v[12:15], v[48:51], v[144:147], v[12:15]
global_load_dwordx4 v[48:51], v157, s[58:59] offset:3072
s_waitcnt vmcnt(17)
v_mfma_f32_16x16x32_bf16 v[16:19], v[52:55], v[144:147], v[16:19]
s_add_u32 s58, s58, 4096
s_addc_u32 s59, s59, 0
global_load_dwordx4 v[52:55], v157, s[58:59] offset:0
s_waitcnt vmcnt(17)
v_mfma_f32_16x16x32_bf16 v[20:23], v[56:59], v[144:147], v[20:23]
global_load_dwordx4 v[56:59], v157, s[58:59] offset:1024
s_waitcnt vmcnt(17)
v_mfma_f32_16x16x32_bf16 v[24:27], v[60:63], v[144:147], v[24:27]
global_load_dwordx4 v[60:63], v157, s[58:59] offset:2048
s_waitcnt vmcnt(17)
v_mfma_f32_16x16x32_bf16 v[28:31], v[64:67], v[144:147], v[28:31]
global_load_dwordx4 v[64:67], v157, s[58:59] offset:3072
s_waitcnt vmcnt(17)
v_mfma_f32_16x16x32_bf16 v[32:35], v[68:71], v[144:147], v[32:35]
s_add_u32 s58, s58, 4096
s_addc_u32 s59, s59, 0
global_load_dwordx4 v[68:71], v157, s[58:59] offset:0
H2_sp16_re:
ds_read_b32 v159, v167 offset:60
s_waitcnt lgkmcnt(0)
v_cmp_ne_u32 vcc, 1, v159
s_cbranch_vccz H2_sp16_ok
s_add_u32 s52, s52, 1
s_cmp_gt_u32 s52, 200000
s_cbranch_scc1 H2_sp16_ok
s_sleep 4
s_branch H2_sp16_re
H2_sp16_ok:
ds_read_b128 v[144:147], v157 offset:14336
s_waitcnt lgkmcnt(0)
s_mul_i32 s46, s40, 294912
s_add_u32 s46, s46, 0xd3800
s_add_u32 s58, s30, s46
s_addc_u32 s59, s31, 0
s_waitcnt vmcnt(17)
v_mfma_f32_16x16x32_bf16 v[0:3], v[72:75], v[144:147], v[0:3]
global_load_dwordx4 v[72:75], v157, s[58:59] offset:0
s_waitcnt vmcnt(17)
v_mfma_f32_16x16x32_bf16 v[4:7], v[76:79], v[144:147], v[4:7]
global_load_dwordx4 v[76:79], v157, s[58:59] offset:1024
s_waitcnt vmcnt(17)
v_mfma_f32_16x16x32_bf16 v[8:11], v[80:83], v[144:147], v[8:11]
global_load_dwordx4 v[80:83], v157, s[58:59] offset:2048
s_waitcnt vmcnt(17)
v_mfma_f32_16x16x32_bf16 v[12:15], v[84:87], v[144:147], v[12:15]
global_load_dwordx4 v[84:87], v157, s[58:59] offset:3072
s_waitcnt vmcnt(17)
v_mfma_f32_16x16x32_bf16 v[16:19], v[88:91], v[144:147], v[16:19]
s_add_u32 s58, s58, 4096
s_addc_u32 s59, s59, 0
global_load_dwordx4 v[88:91], v157, s[58:59] offset:0
s_waitcnt vmcnt(17)
v_mfma_f32_16x16x32_bf16 v[20:23], v[92:95], v[144:147], v[20:23]
global_load_dwordx4 v[92:95], v157, s[58:59] offset:1024
s_waitcnt vmcnt(17)
v_mfma_f32_16x16x32_bf16 v[24:27], v[96:99], v[144:147], v[24:27]
global_load_dwordx4 v[96:99], v157, s[58:59] offset:2048
s_waitcnt vmcnt(17)
v_mfma_f32_16x16x32_bf16 v[28:31], v[100:103], v[144:147], v[28:31]
global_load_dwordx4 v[100:103], v157, s[58:59] offset:3072
s_waitcnt vmcnt(17)
v_mfma_f32_16x16x32_bf16 v[32:35], v[104:107], v[144:147], v[32:35]
s_add_u32 s58, s58, 4096
s_addc_u32 s59, s59, 0
global_load_dwordx4 v[104:107], v157, s[58:59] offset:0
H2_sp17_re:
ds_read_b32 v159, v167 offset:68
s_waitcnt lgkmcnt(0)
v_cmp_ne_u32 vcc, 1, v159
s_cbranch_vccz H2_sp17_ok
s_add_u32 s52, s52, 1
s_cmp_gt_u32 s52, 200000
s_cbranch_scc1 H2_sp17_ok
s_sleep 4
s_branch H2_sp17_re
H2_sp17_ok:
ds_read_b128 v[144:147], v157 offset:15360
s_waitcnt lgkmcnt(0)
s_mul_i32 s46, s40, 294912
s_add_u32 s46, s46, 0xdc800
s_add_u32 s58, s30, s46
s_addc_u32 s59, s31, 0
s_waitcnt vmcnt(17)
v_mfma_f32_16x16x32_bf16 v[0:3], v[36:39], v[144:147], v[0:3]
global_load_dwordx4 v[36:39], v157, s[58:59] offset:0
s_waitcnt vmcnt(17)
v_mfma_f32_16x16x32_bf16 v[4:7], v[40:43], v[144:147], v[4:7]
global_load_dwordx4 v[40:43], v157, s[58:59] offset:1024
s_waitcnt vmcnt(17)
v_mfma_f32_16x16x32_bf16 v[8:11], v[44:47], v[144:147], v[8:11]
global_load_dwordx4 v[44:47], v157, s[58:59] offset:2048
s_waitcnt vmcnt(17)
v_mfma_f32_16x16x32_bf16 v[12:15], v[48:51], v[144:147], v[12:15]
global_load_dwordx4 v[48:51], v157, s[58:59] offset:3072
s_waitcnt vmcnt(17)
v_mfma_f32_16x16x32_bf16 v[16:19], v[52:55], v[144:147], v[16:19]
s_add_u32 s58, s58, 4096
s_addc_u32 s59, s59, 0
global_load_dwordx4 v[52:55], v157, s[58:59] offset:0
s_waitcnt vmcnt(17)
v_mfma_f32_16x16x32_bf16 v[20:23], v[56:59], v[144:147], v[20:23]
global_load_dwordx4 v[56:59], v157, s[58:59] offset:1024
s_waitcnt vmcnt(17)
v_mfma_f32_16x16x32_bf16 v[24:27], v[60:63], v[144:147], v[24:27]
global_load_dwordx4 v[60:63], v157, s[58:59] offset:2048
s_waitcnt vmcnt(17)
v_mfma_f32_16x16x32_bf16 v[28:31], v[64:67], v[144:147], v[28:31]
global_load_dwordx4 v[64:67], v157, s[58:59] offset:3072
s_waitcnt vmcnt(17)
v_mfma_f32_16x16x32_bf16 v[32:35], v[68:71], v[144:147], v[32:35]
s_add_u32 s58, s58, 4096
s_addc_u32 s59, s59, 0
global_load_dwordx4 v[68:71], v157, s[58:59] offset:0
H2_sp18_re:
ds_read_b32 v159, v167 offset:76
s_waitcnt lgkmcnt(0)
v_cmp_ne_u32 vcc, 1, v159
s_cbranch_vccz H2_sp18_ok
s_add_u32 s52, s52, 1
s_cmp_gt_u32 s52, 200000
s_cbranch_scc1 H2_sp18_ok
s_sleep 4
s_branch H2_sp18_re
H2_sp18_ok:
ds_read_b128 v[144:147], v157 offset:16384
s_waitcnt lgkmcnt(0)
s_mul_i32 s46, s40, 294912
s_add_u32 s46, s46, 0xe5800
s_add_u32 s58, s30, s46
s_addc_u32 s59, s31, 0
s_waitcnt vmcnt(17)
v_mfma_f32_16x16x32_bf16 v[0:3], v[72:75], v[144:147], v[0:3]
global_load_dwordx4 v[72:75], v157, s[58:59] offset:0
s_waitcnt vmcnt(17)
v_mfma_f32_16x16x32_bf16 v[4:7], v[76:79], v[144:147], v[4:7]
global_load_dwordx4 v[76:79], v157, s[58:59] offset:1024
s_waitcnt vmcnt(17)
v_mfma_f32_16x16x32_bf16 v[8:11], v[80:83], v[144:147], v[8:11]
global_load_dwordx4 v[80:83], v157, s[58:59] offset:2048
s_waitcnt vmcnt(17)
v_mfma_f32_16x16x32_bf16 v[12:15], v[84:87], v[144:147], v[12:15]
global_load_dwordx4 v[84:87], v157, s[58:59] offset:3072
s_waitcnt vmcnt(17)
v_mfma_f32_16x16x32_bf16 v[16:19], v[88:91], v[144:147], v[16:19]
s_add_u32 s58, s58, 4096
s_addc_u32 s59, s59, 0
global_load_dwordx4 v[88:91], v157, s[58:59] offset:0
s_waitcnt vmcnt(17)
v_mfma_f32_16x16x32_bf16 v[20:23], v[92:95], v[144:147], v[20:23]
global_load_dwordx4 v[92:95], v157, s[58:59] offset:1024
s_waitcnt vmcnt(17)
v_mfma_f32_16x16x32_bf16 v[24:27], v[96:99], v[144:147], v[24:27]
global_load_dwordx4 v[96:99], v157, s[58:59] offset:2048
s_waitcnt vmcnt(17)
v_mfma_f32_16x16x32_bf16 v[28:31], v[100:103], v[144:147], v[28:31]
global_load_dwordx4 v[100:103], v157, s[58:59] offset:3072
s_waitcnt vmcnt(17)
v_mfma_f32_16x16x32_bf16 v[32:35], v[104:107], v[144:147], v[32:35]
s_add_u32 s58, s58, 4096
s_addc_u32 s59, s59, 0
global_load_dwordx4 v[104:107], v157, s[58:59] offset:0
s_cmp_eq_u32 s33, 1
s_cbranch_scc0 H2_sk19
H2_sp20_re:
ds_read_b64 v[148:149], v167 offset:304
s_waitcnt lgkmcnt(0)
v_cmp_ne_u64 vcc, s[68:69], v[148:149]
s_cbranch_vccz H2_sp20_ok
s_add_u32 s52, s52, 1
s_cmp_gt_u32 s52, 200000
s_cbranch_scc1 H2_sp20_ok
s_sleep 2
s_branch H2_sp20_re
H2_sp20_ok:
v_add_u32 v160, 38912, v164
v_add_u32 v161, 38912, v165
ds_read_b128 v[144:147], v160 offset:0
ds_read_b128 v[148:151], v160 offset:512
ds_read_b128 v[152:155], v161 offset:0
ds_read_b128 v[108:111], v160 offset:2560
ds_read_b128 v[112:115], v160 offset:3072
ds_read_b128 v[116:119], v161 offset:2560
ds_read_b128 v[120:123], v160 offset:5120
ds_read_b128 v[124:127], v160 offset:5632
ds_read_b128 v[128:131], v161 offset:5120
ds_read_b128 v[132:135], v160 offset:7680
ds_read_b128 v[136:139], v160 offset:8192
ds_read_b128 v[140:143], v161 offset:7680
s_waitcnt lgkmcnt(6)
v_pk_add_f32 v[144:145], v[144:145], v[108:109]
v_pk_add_f32 v[146:147], v[146:147], v[110:111]
v_pk_add_f32 v[148:149], v[148:149], v[112:113]
v_pk_add_f32 v[150:151], v[150:151], v[114:115]
v_pk_add_f32 v[152:153], v[152:153], v[116:117]
v_add_f32 v154, v154, v118
ds_read_b128 v[108:111], v160 offset:10240
ds_read_b128 v[112:115], v160 offset:10752
ds_read_b128 v[116:119], v161 offset:10240
s_waitcnt lgkmcnt(6)
v_pk_add_f32 v[144:145], v[144:145], v[120:121]
v_pk_add_f32 v[146:147], v[146:147], v[122:123]
v_pk_add_f32 v[148:149], v[148:149], v[124:125]
v_pk_add_f32 v[150:151], v[150:151], v[126:127]
v_pk_add_f32 v[152:153], v[152:153], v[128:129]
v_add_f32 v154, v154, v130
ds_read_b128 v[120:123], v160 offset:12800
ds_read_b128 v[124:127], v160 offset:13312
ds_read_b128 v[128:131], v161 offset:12800
s_waitcnt lgkmcnt(6)
v_pk_add_f32 v[144:145], v[144:145], v[132:133]
v_pk_add_f32 v[146:147], v[146:147], v[134:135]
v_pk_add_f32 v[148:149], v[148:149], v[136:137]
v_pk_add_f32 v[150:151], v[150:151], v[138:139]
v_pk_add_f32 v[152:153], v[152:153], v[140:141]
v_add_f32 v154, v154, v142
ds_read_b128 v[132:135], v160 offset:15360
ds_read_b128 v[136:139], v160 offset:15872
ds_read_b128 v[140:143], v161 offset:15360
s_waitcnt lgkmcnt(6)
v_pk_add_f32 v[144:145], v[144:145], v[108:109]
v_pk_add_f32 v[146:147], v[146:147], v[110:111]
v_pk_add_f32 v[148:149], v[148:149], v[112:113]
v_pk_add_f32 v[150:151], v[150:151], v[114:115]
v_pk_add_f32 v[152:153], v[152:153], v[116:117]
v_add_f32 v154, v154, v118
ds_read_b128 v[108:111], v160 offset:17920
ds_read_b128 v[112:115], v160 offset:18432
ds_read_b128 v[116:119], v161 offset:17920
s_waitcnt lgkmcnt(6)
v_pk_add_f32 v[144:145], v[144:145], v[120:121]
v_pk_add_f32 v[146:147], v[146:147], v[122:123]
v_pk_add_f32 v[148:149], v[148:149], v[124:125]
v_pk_add_f32 v[150:151], v[150:151], v[126:127]
v_pk_add_f32 v[152:153], v[152:153], v[128:129]
v_add_f32 v154, v154, v130
s_waitcnt lgkmcnt(3)
v_pk_add_f32 v[144:145], v[144:145], v[132:133]
v_pk_add_f32 v[146:147], v[146:147], v[134:135]
v_pk_add_f32 v[148:149], v[148:149], v[136:137]
v_pk_add_f32 v[150:151], v[150:151], v[138:139]
v_pk_add_f32 v[152:153], v[152:153], v[140:141]
v_add_f32 v154, v154, v142
s_waitcnt lgkmcnt(0)
v_pk_add_f32 v[144:145], v[144:145], v[108:109]
v_pk_add_f32 v[146:147], v[146:147], v[110:111]
v_pk_add_f32 v[148:149], v[148:149], v[112:113]
v_pk_add_f32 v[150:151], v[150:151], v[114:115]
v_pk_add_f32 v[152:153], v[152:153], v[116:117]
v_add_f32 v154, v154, v118
v_rcp_f32 v154, v154
s_nop 0
v_mul_f32 v144, v144, v154
v_mul_f32 v145, v145, v154
v_mul_f32 v146, v146, v154
v_mul_f32 v147, v147, v154
v_mul_f32 v148, v148, v154
v_mul_f32 v149, v149, v154
v_mul_f32 v150, v150, v154
v_mul_f32 v151, v151, v154
v_mul_f32 v152, v152, v154
v_mul_f32 v153, v153, v154
v_cvt_pk_bf16_f32 v144, v144, v145
v_cvt_pk_bf16_f32 v145, v146, v147
v_cvt_pk_bf16_f32 v146, v148, v149
v_cvt_pk_bf16_f32 v147, v150, v151
v_cvt_pk_bf16_f32 v155, v152, v153
ds_write_b128 v157, v[144:147] offset:17408
v_lshlrev_b32 v160, 4, v162
v_lshrrev_b32 v161, 1, v163
v_lshl_add_u32 v160, v161, 2, v160
s_mov_b32 exec_lo, 0xffff
s_mov_b32 exec_hi, 0xffff
ds_write_b32 v160, v155 offset:20224
s_mov_b64 exec, 1
v_mov_b32 v160, 84
v_mov_b32 v161, 1
ds_write_b32 v160, v161
s_mov_b64 exec, -1
H2_sk19:
s_mul_i32 s46, s40, 36864
s_add_u32 s46, s46, 0x136800
s_add_u32 s58, s30, s46
s_addc_u32 s59, s31, 0
global_load_dwordx4 v[108:111], v157, s[58:59] offset:0
global_load_dwordx4 v[112:115], v157, s[58:59] offset:1024
global_load_dwordx4 v[116:119], v157, s[58:59] offset:2048
global_load_dwordx4 v[120:123], v157, s[58:59] offset:3072
s_add_u32 s58, s58, 4096
s_addc_u32 s59, s59, 0
global_load_dwordx4 v[124:127], v157, s[58:59] offset:0
global_load_dwordx4 v[128:131], v157, s[58:59] offset:1024
global_load_dwordx4 v[132:135], v157, s[58:59] offset:2048
global_load_dwordx4 v[136:139], v157, s[58:59] offset:3072
s_add_u32 s58, s58, 4096
s_addc_u32 s59, s59, 0
global_load_dwordx4 v[140:143], v157, s[58:59] offset:0
H2_sp21_re:
ds_read_b32 v159, v167 offset:84
s_waitcnt lgkmcnt(0)
v_cmp_ne_u32 vcc, 1, v159
s_cbranch_vccz H2_sp21_ok
s_add_u32 s52, s52, 1
s_cmp_gt_u32 s52, 200000
s_cbranch_scc1 H2_sp21_ok
s_sleep 4
s_branch H2_sp21_re
H2_sp21_ok:
ds_read_b128 v[144:147], v157 offset:17408
s_waitcnt lgkmcnt(0) vmcnt(0)
s_waitcnt vmcnt(8)
v_mfma_f32_16x16x32_bf16 v[0:3], v[36:39], v[144:147], v[0:3]
s_waitcnt vmcnt(7)
v_mfma_f32_16x16x32_bf16 v[4:7], v[40:43], v[144:147], v[4:7]
s_waitcnt vmcnt(6)
v_mfma_f32_16x16x32_bf16 v[8:11], v[44:47], v[144:147], v[8:11]
s_waitcnt vmcnt(5)
v_mfma_f32_16x16x32_bf16 v[12:15], v[48:51], v[144:147], v[12:15]
s_waitcnt vmcnt(4)
v_mfma_f32_16x16x32_bf16 v[16:19], v[52:55], v[144:147], v[16:19]
s_waitcnt vmcnt(3)
v_mfma_f32_16x16x32_bf16 v[20:23], v[56:59], v[144:147], v[20:23]
s_waitcnt vmcnt(2)
v_mfma_f32_16x16x32_bf16 v[24:27], v[60:63], v[144:147], v[24:27]
s_waitcnt vmcnt(1)
v_mfma_f32_16x16x32_bf16 v[28:31], v[64:67], v[144:147], v[28:31]
s_waitcnt vmcnt(0)
v_mfma_f32_16x16x32_bf16 v[32:35], v[68:71], v[144:147], v[32:35]
H2_sp22_re:
ds_read_b32 v159, v167 offset:92
s_waitcnt lgkmcnt(0)
v_cmp_ne_u32 vcc, 1, v159
s_cbranch_vccz H2_sp22_ok
s_add_u32 s52, s52, 1
s_cmp_gt_u32 s52, 200000
s_cbranch_scc1 H2_sp22_ok
s_sleep 0
s_branch H2_sp22_re
H2_sp22_ok:
ds_read_b128 v[144:147], v157 offset:18432
ds_read_b128 v[148:151], v157 offset:19456
s_waitcnt lgkmcnt(0)
s_waitcnt vmcnt(0)
v_mov_b32 v161, 0xfffff000
v_add_u32 v160, 4096, v166
s_cmp_eq_u32 s71, 1
s_cbranch_scc1 H2_stl
v_mfma_f32_16x16x32_bf16 v[0:3], v[72:75], v[144:147], v[0:3]
v_mfma_f32_16x16x32_bf16 v[0:3], v[108:111], v[148:151], v[0:3]
v_mfma_f32_16x16x32_bf16 v[4:7], v[76:79], v[144:147], v[4:7]
v_mfma_f32_16x16x32_bf16 v[4:7], v[112:115], v[148:151], v[4:7]
v_mfma_f32_16x16x32_bf16 v[8:11], v[80:83], v[144:147], v[8:11]
v_mfma_f32_16x16x32_bf16 v[8:11], v[116:119], v[148:151], v[8:11]
s_nop 3
v_and_or_b32 v108, v0, v161, s62
v_and_or_b32 v109, v1, v161, s63
v_and_or_b32 v110, v2, v161, s64
v_and_or_b32 v111, v3, v161, s65
s_mov_b64 exec, s[56:57]
global_store_dwordx4 v166, v[108:111], s[48:49] offset:0 sc1
s_mov_b64 exec, -1
v_mfma_f32_16x16x32_bf16 v[12:15], v[84:87], v[144:147], v[12:15]
v_mfma_f32_16x16x32_bf16 v[12:15], v[120:123], v[148:151], v[12:15]
v_and_or_b32 v112, v4, v161, s62
v_and_or_b32 v113, v5, v161, s63
v_and_or_b32 v114, v6, v161, s64
v_and_or_b32 v115, v7, v161, s65
s_mov_b64 exec, s[56:57]
global_store_dwordx4 v166, v[112:115], s[48:49] offset:512 sc1
s_mov_b64 exec, -1
v_mfma_f32_16x16x32_bf16 v[16:19], v[88:91], v[144:147], v[16:19]
v_mfma_f32_16x16x32_bf16 v[16:19], v[124:127], v[148:151], v[16:19]
v_and_or_b32 v116, v8, v161, s62
v_and_or_b32 v117, v9, v161, s63
v_and_or_b32 v118, v10, v161, s64
v_and_or_b32 v119, v11, v161, s65
s_mov_b64 exec, s[56:57]
global_store_dwordx4 v166, v[116:119], s[48:49] offset:1024 sc1
s_mov_b64 exec, -1
v_mfma_f32_16x16x32_bf16 v[20:23], v[92:95], v[144:147], v[20:23]
v_mfma_f32_16x16x32_bf16 v[20:23], v[128:131], v[148:151], v[20:23]
v_and_or_b32 v120, v12, v161, s62
v_and_or_b32 v121, v13, v161, s63
v_and_or_b32 v122, v14, v161, s64
v_and_or_b32 v123, v15, v161, s65
s_mov_b64 exec, s[56:57]
global_store_dwordx4 v166, v[120:123], s[48:49] offset:1536 sc1
s_mov_b64 exec, -1
v_mfma_f32_16x16x32_bf16 v[24:27], v[96:99], v[144:147], v[24:27]
v_mfma_f32_16x16x32_bf16 v[24:27], v[132:135], v[148:151], v[24:27]
v_and_or_b32 v124, v16, v161, s62
v_and_or_b32 v125, v17, v161, s63
v_and_or_b32 v126, v18, v161, s64
v_and_or_b32 v127, v19, v161, s65
s_mov_b64 exec, s[56:57]
global_store_dwordx4 v166, v[124:127], s[48:49] offset:2048 sc1
s_mov_b64 exec, -1
v_mfma_f32_16x16x32_bf16 v[28:31], v[100:103], v[144:147], v[28:31]
v_mfma_f32_16x16x32_bf16 v[28:31], v[136:139], v[148:151], v[28:31]
v_and_or_b32 v128, v20, v161, s62
v_and_or_b32 v129, v21, v161, s63
v_and_or_b32 v130, v22, v161, s64
v_and_or_b32 v131, v23, v161, s65
s_mov_b64 exec, s[56:57]
global_store_dwordx4 v166, v[128:131], s[48:49] offset:2560 sc1
s_mov_b64 exec, -1
v_mfma_f32_16x16x32_bf16 v[32:35], v[104:107], v[144:147], v[32:35]
v_mfma_f32_16x16x32_bf16 v[32:35], v[140:143], v[148:151], v[32:35]
v_and_or_b32 v132, v24, v161, s62
v_and_or_b32 v133, v25, v161, s63
v_and_or_b32 v134, v26, v161, s64
v_and_or_b32 v135, v27, v161, s65
s_mov_b64 exec, s[56:57]
global_store_dwordx4 v166, v[132:135], s[48:49] offset:3072 sc1
s_mov_b64 exec, -1
v_and_or_b32 v136, v28, v161, s62
v_and_or_b32 v137, v29, v161, s63
v_and_or_b32 v138, v30, v161, s64
v_and_or_b32 v139, v31, v161, s65
s_mov_b64 exec, s[56:57]
global_store_dwordx4 v166, v[136:139], s[48:49] offset:3584 sc1
s_mov_b64 exec, -1
v_and_or_b32 v140, v32, v161, s62
v_and_or_b32 v141, v33, v161, s63
v_and_or_b32 v142, v34, v161, s64
v_and_or_b32 v143, v35, v161, s65
s_mov_b64 exec, s[56:57]
global_store_dwordx4 v160, v[140:143], s[48:49] sc1
s_mov_b64 exec, -1
s_branch H2_std
H2_stl:
v_mfma_f32_16x16x32_bf16 v[0:3], v[72:75], v[144:147], v[0:3]
v_mfma_f32_16x16x32_bf16 v[0:3], v[108:111], v[148:151], v[0:3]
v_mfma_f32_16x16x32_bf16 v[4:7], v[76:79], v[144:147], v[4:7]
v_mfma_f32_16x16x32_bf16 v[4:7], v[112:115], v[148:151], v[4:7]
v_mfma_f32_16x16x32_bf16 v[8:11], v[80:83], v[144:147], v[8:11]
v_mfma_f32_16x16x32_bf16 v[8:11], v[116:119], v[148:151], v[8:11]
s_nop 3
v_and_or_b32 v108, v0, v161, s62
v_and_or_b32 v109, v1, v161, s63
v_and_or_b32 v110, v2, v161, s64
v_and_or_b32 v111, v3, v161, s65
s_mov_b64 exec, s[56:57]
global_store_dwordx4 v166, v[108:111], s[48:49] offset:0
s_mov_b64 exec, -1
v_mfma_f32_16x16x32_bf16 v[12:15], v[84:87], v[144:147], v[12:15]
v_mfma_f32_16x16x32_bf16 v[12:15], v[120:123], v[148:151], v[12:15]
v_and_or_b32 v112, v4, v161, s62
v_and_or_b32 v113, v5, v161, s63
v_and_or_b32 v114, v6, v161, s64
v_and_or_b32 v115, v7, v161, s65
s_mov_b64 exec, s[56:57]
global_store_dwordx4 v166, v[112:115], s[48:49] offset:512
s_mov_b64 exec, -1
v_mfma_f32_16x16x32_bf16 v[16:19], v[88:91], v[144:147], v[16:19]
v_mfma_f32_16x16x32_bf16 v[16:19], v[124:127], v[148:151], v[16:19]
v_and_or_b32 v116, v8, v161, s62
v_and_or_b32 v117, v9, v161, s63
v_and_or_b32 v118, v10, v161, s64
v_and_or_b32 v119, v11, v161, s65
s_mov_b64 exec, s[56:57]
global_store_dwordx4 v166, v[116:119], s[48:49] offset:1024
s_mov_b64 exec, -1
v_mfma_f32_16x16x32_bf16 v[20:23], v[92:95], v[144:147], v[20:23]
v_mfma_f32_16x16x32_bf16 v[20:23], v[128:131], v[148:151], v[20:23]
v_and_or_b32 v120, v12, v161, s62
v_and_or_b32 v121, v13, v161, s63
v_and_or_b32 v122, v14, v161, s64
v_and_or_b32 v123, v15, v161, s65
s_mov_b64 exec, s[56:57]
global_store_dwordx4 v166, v[120:123], s[48:49] offset:1536
s_mov_b64 exec, -1
v_mfma_f32_16x16x32_bf16 v[24:27], v[96:99], v[144:147], v[24:27]
v_mfma_f32_16x16x32_bf16 v[24:27], v[132:135], v[148:151], v[24:27]
v_and_or_b32 v124, v16, v161, s62
v_and_or_b32 v125, v17, v161, s63
v_and_or_b32 v126, v18, v161, s64
v_and_or_b32 v127, v19, v161, s65
s_mov_b64 exec, s[56:57]
global_store_dwordx4 v166, v[124:127], s[48:49] offset:2048
s_mov_b64 exec, -1
v_mfma_f32_16x16x32_bf16 v[28:31], v[100:103], v[144:147], v[28:31]
v_mfma_f32_16x16x32_bf16 v[28:31], v[136:139], v[148:151], v[28:31]
v_and_or_b32 v128, v20, v161, s62
v_and_or_b32 v129, v21, v161, s63
v_and_or_b32 v130, v22, v161, s64
v_and_or_b32 v131, v23, v161, s65
s_mov_b64 exec, s[56:57]
global_store_dwordx4 v166, v[128:131], s[48:49] offset:2560
s_mov_b64 exec, -1
v_mfma_f32_16x16x32_bf16 v[32:35], v[104:107], v[144:147], v[32:35]
v_mfma_f32_16x16x32_bf16 v[32:35], v[140:143], v[148:151], v[32:35]
v_and_or_b32 v132, v24, v161, s62
v_and_or_b32 v133, v25, v161, s63
v_and_or_b32 v134, v26, v161, s64
v_and_or_b32 v135, v27, v161, s65
s_mov_b64 exec, s[56:57]
global_store_dwordx4 v166, v[132:135], s[48:49] offset:3072
s_mov_b64 exec, -1
v_and_or_b32 v136, v28, v161, s62
v_and_or_b32 v137, v29, v161, s63
v_and_or_b32 v138, v30, v161, s64
v_and_or_b32 v139, v31, v161, s65
s_mov_b64 exec, s[56:57]
global_store_dwordx4 v166, v[136:139], s[48:49] offset:3584
s_mov_b64 exec, -1
v_and_or_b32 v140, v32, v161, s62
v_and_or_b32 v141, v33, v161, s63
v_and_or_b32 v142, v34, v161, s64
v_and_or_b32 v143, v35, v161, s65
s_mov_b64 exec, s[56:57]
global_store_dwordx4 v160, v[140:143], s[48:49]
s_mov_b64 exec, -1
H2_std:
s_mov_b64 exec, s[54:55]
s_mov_b32 s52, 0
global_load_dwordx4 v[36:39], v166, s[66:67] offset:0 sc1
global_load_dwordx4 v[40:43], v166, s[66:67] offset:512 sc1
global_load_dwordx4 v[44:47], v166, s[66:67] offset:1024 sc1
global_load_dwordx4 v[48:51], v166, s[66:67] offset:1536 sc1
global_load_dwordx4 v[52:55], v166, s[66:67] offset:2048 sc1
global_load_dwordx4 v[56:59], v166, s[66:67] offset:2560 sc1
global_load_dwordx4 v[60:63], v166, s[66:67] offset:3072 sc1
global_load_dwordx4 v[64:67], v166, s[66:67] offset:3584 sc1
global_load_dwordx4 v[68:71], v160, s[66:67] sc1
ds_write_b128 v156, v[0:3] offset:0
ds_write_b128 v156, v[4:7] offset:64
ds_write_b128 v156, v[8:11] offset:128
ds_write_b128 v156, v[12:15] offset:192
ds_write_b128 v156, v[16:19] offset:256
ds_write_b128 v156, v[20:23] offset:320
ds_write_b128 v156, v[24:27] offset:384
ds_write_b128 v156, v[28:31] offset:448
ds_write_b128 v156, v[32:35] offset:512
H2_poll:
s_waitcnt vmcnt(0)
v_mov_b32 v158, 0
v_bitop3_b32 v158, v36, s62, v158 bitop3:0xbe
v_bitop3_b32 v158, v37, s63, v158 bitop3:0xbe
v_bitop3_b32 v158, v38, s64, v158 bitop3:0xbe
v_bitop3_b32 v158, v39, s65, v158 bitop3:0xbe
v_bitop3_b32 v158, v40, s62, v158 bitop3:0xbe
v_bitop3_b32 v158, v41, s63, v158 bitop3:0xbe
v_bitop3_b32 v158, v42, s64, v158 bitop3:0xbe
v_bitop3_b32 v158, v43, s65, v158 bitop3:0xbe
v_bitop3_b32 v158, v44, s62, v158 bitop3:0xbe
v_bitop3_b32 v158, v45, s63, v158 bitop3:0xbe
v_bitop3_b32 v158, v46, s64, v158 bitop3:0xbe
v_bitop3_b32 v158, v47, s65, v158 bitop3:0xbe
v_bitop3_b32 v158, v48, s62, v158 bitop3:0xbe
v_bitop3_b32 v158, v49, s63, v158 bitop3:0xbe
v_bitop3_b32 v158, v50, s64, v158 bitop3:0xbe
v_bitop3_b32 v158, v51, s65, v158 bitop3:0xbe
v_bitop3_b32 v158, v52, s62, v158 bitop3:0xbe
v_bitop3_b32 v158, v53, s63, v158 bitop3:0xbe
v_bitop3_b32 v158, v54, s64, v158 bitop3:0xbe
v_bitop3_b32 v158, v55, s65, v158 bitop3:0xbe
v_bitop3_b32 v158, v56, s62, v158 bitop3:0xbe
v_bitop3_b32 v158, v57, s63, v158 bitop3:0xbe
v_bitop3_b32 v158, v58, s64, v158 bitop3:0xbe
v_bitop3_b32 v158, v59, s65, v158 bitop3:0xbe
v_bitop3_b32 v158, v60, s62, v158 bitop3:0xbe
v_bitop3_b32 v158, v61, s63, v158 bitop3:0xbe
v_bitop3_b32 v158, v62, s64, v158 bitop3:0xbe
v_bitop3_b32 v158, v63, s65, v158 bitop3:0xbe
v_bitop3_b32 v158, v64, s62, v158 bitop3:0xbe
v_bitop3_b32 v158, v65, s63, v158 bitop3:0xbe
v_bitop3_b32 v158, v66, s64, v158 bitop3:0xbe
v_bitop3_b32 v158, v67, s65, v158 bitop3:0xbe
v_bitop3_b32 v158, v68, s62, v158 bitop3:0xbe
v_bitop3_b32 v158, v69, s63, v158 bitop3:0xbe
v_bitop3_b32 v158, v70, s64, v158 bitop3:0xbe
v_bitop3_b32 v158, v71, s65, v158 bitop3:0xbe
v_and_b32 v158, 0xfff, v158
v_cmp_ne_u32 vcc, 0, v158
s_cbranch_vccz H2_pollok
s_add_u32 s52, s52, 1
s_cmp_gt_u32 s52, 20000
s_cbranch_scc1 H2_pollok
global_load_dwordx4 v[36:39], v166, s[66:67] offset:0 sc1
global_load_dwordx4 v[40:43], v166, s[66:67] offset:512 sc1
global_load_dwordx4 v[44:47], v166, s[66:67] offset:1024 sc1
global_load_dwordx4 v[48:51], v166, s[66:67] offset:1536 sc1
global_load_dwordx4 v[52:55], v166, s[66:67] offset:2048 sc1
global_load_dwordx4 v[56:59], v166, s[66:67] offset:2560 sc1
global_load_dwordx4 v[60:63], v166, s[66:67] offset:3072 sc1
global_load_dwordx4 v[64:67], v166, s[66:67] offset:3584 sc1
global_load_dwordx4 v[68:71], v160, s[66:67] sc1
s_branch H2_poll
H2_pollok:
v_add_u32 v156, 18560, v156
ds_write_b128 v156, v[36:39] offset:0
ds_write_b128 v156, v[40:43] offset:64
ds_write_b128 v156, v[44:47] offset:128
ds_write_b128 v156, v[48:51] offset:192
ds_write_b128 v156, v[52:55] offset:256
ds_write_b128 v156, v[56:59] offset:320
ds_write_b128 v156, v[60:63] offset:384
ds_write_b128 v156, v[64:67] offset:448
ds_write_b128 v156, v[68:71] offset:512
s_mov_b64 exec, -1
s_waitcnt lgkmcnt(0)
s_barrier
s_cmp_eq_u32 s33, 1
s_cbranch_scc1 L_hfin2
s_mov_b32 s33, 1
s_mul_i32 s34, s33, 0x240000
s_add_u32 s34, s34, 0x200000
s_mul_i32 s35, s33, 0x10000
s_add_u32 s35, s35, 0x680000
s_mul_i32 s36, s33, 0x4000
s_add_u32 s36, s36, 0x6a0000
s_mul_i32 s37, s33, 0x14000
s_add_u32 s37, s37, 0x6b0000
s_mul_i32 s38, s33, 0x800
s_add_u32 s38, s38, 0x6d8000
s_mul_i32 s39, s33, 0x900000
s_add_u32 s39, s39, 0xe00000
v_mbcnt_lo_u32_b32 v156, -1, 0
v_mbcnt_hi_u32_b32 v156, -1, v156
v_lshlrev_b32 v157, 4, v156
v_mov_b32 v167, 0
s_mul_i32 s46, s40, 36864
s_add_u32 s46, s46, 0x90000
s_add_u32 s44, s30, s46
s_addc_u32 s45, s31, 0
global_load_dwordx4 v[0:3], v157, s[44:45] offset:0
global_load_dwordx4 v[4:7], v157, s[44:45] offset:1024
global_load_dwordx4 v[8:11], v157, s[44:45] offset:2048
global_load_dwordx4 v[12:15], v157, s[44:45] offset:3072
s_add_u32 s44, s44, 4096
s_addc_u32 s45, s45, 0
global_load_dwordx4 v[16:19], v157, s[44:45] offset:0
global_load_dwordx4 v[20:23], v157, s[44:45] offset:1024
global_load_dwordx4 v[24:27], v157, s[44:45] offset:2048
global_load_dwordx4 v[28:31], v157, s[44:45] offset:3072
s_add_u32 s44, s44, 4096
s_addc_u32 s45, s45, 0
global_load_dwordx4 v[32:35], v157, s[44:45] offset:0
global_load_dwordx4 v[36:39], v157, s[44:45] offset:1024
global_load_dwordx4 v[40:43], v157, s[44:45] offset:2048
global_load_dwordx4 v[44:47], v157, s[44:45] offset:3072
s_add_u32 s44, s44, 4096
s_addc_u32 s45, s45, 0
global_load_dwordx4 v[48:51], v157, s[44:45] offset:0
global_load_dwordx4 v[52:55], v157, s[44:45] offset:1024
global_load_dwordx4 v[56:59], v157, s[44:45] offset:2048
global_load_dwordx4 v[60:63], v157, s[44:45] offset:3072
s_add_u32 s44, s44, 4096
s_addc_u32 s45, s45, 0
global_load_dwordx4 v[64:67], v157, s[44:45] offset:0
global_load_dwordx4 v[68:71], v157, s[44:45] offset:1024
s_add_u32 s46, 0, 0x6dc000
s_add_u32 s48, s30, s46
s_addc_u32 s49, s31, 0
s_load_dwordx2 s[60:61], s[48:49], 0
s_barrier
v_and_b32 v162, 15, v156
v_lshrrev_b32 v163, 4, v156
v_lshrrev_b32 v165, 1, v163
v_lshlrev_b32 v165, 8, v165
v_lshl_add_u32 v165, v162, 4, v165
v_and_b32 v164, 1, v163
v_lshlrev_b32 v164, 10, v164
v_add_u32 v164, v164, v165
v_add_u32 v165, 2048, v165
v_lshrrev_b32 v166, 1, v163
v_lshlrev_b32 v166, 9, v166
v_lshl_add_u32 v166, v162, 4, v166
v_and_b32 v160, 1, v163
v_lshl_add_u32 v166, v160, 3, v166
s_waitcnt lgkmcnt(0)
s_add_u32 s50, s60, 32
s_and_b32 s51, s61, 0xffff
s_lshl_b32 s51, s51, 8
s_mov_b32 s52, 0
H2_pl_re:
v_mov_b32 v158, 158888
ds_read_b32 v159, v158
s_waitcnt lgkmcnt(0)
v_cmp_ne_u32 vcc, 1, v159
s_cbranch_vccz H2_pl_ok
s_add_u32 s52, s52, 1
s_cmp_gt_u32 s52, 200000
s_cbranch_scc1 H2_pl_ok
s_sleep 4
s_branch H2_pl_re
H2_pl_ok:
s_lshr_b32 s41, s2, 1
s_mul_i32 s41, s41, 18432
s_add_u32 s41, s41, s34
s_cmp_eq_u32 s40, 0
s_mov_b32 s46, 0x00ff00ff
s_cselect_b32 s46, 0xff00ff00, s46
s_mov_b32 exec_lo, s46
s_mov_b32 exec_hi, s46
s_add_u32 s46, s41, 2048
s_add_u32 s42, s30, s46
s_addc_u32 s43, s31, 0
s_mov_b32 m0, 22528
s_nop 0
global_load_lds_dwordx4 v157, s[42:43] sc1
s_add_u32 s46, s41, 6144
s_add_u32 s42, s30, s46
s_addc_u32 s43, s31, 0
s_mov_b32 m0, 26624
s_nop 0
global_load_lds_dwordx4 v157, s[42:43] sc1
s_add_u32 s46, s41, 10240
s_add_u32 s42, s30, s46
s_addc_u32 s43, s31, 0
s_mov_b32 m0, 30720
s_nop 0
global_load_lds_dwordx4 v157, s[42:43] sc1
s_add_u32 s46, s41, 14336
s_add_u32 s42, s30, s46
s_addc_u32 s43, s31, 0
s_mov_b32 m0, 34816
s_nop 0
global_load_lds_dwordx4 v157, s[42:43] sc1
s_mov_b64 exec, -1
s_waitcnt vmcnt(0)
s_branch H2_tags
L_hfin2:
s_endpgm
L_h3:
s_setprio 3
s_mov_b32 s68, 0x80808080
s_mov_b32 s69, 0x80808080
s_mov_b32 s70, 0x45800000
v_mbcnt_lo_u32_b32 v156, -1, 0
v_mbcnt_hi_u32_b32 v156, -1, v156
v_lshlrev_b32 v157, 4, v156
v_mov_b32 v167, 0
s_and_b32 s40, s2, 1
s_lshr_b32 s41, s2, 1
s_mul_i32 s41, s41, 18432
s_add_u32 s41, s41, s34
s_add_u32 s46, s41, 3072
s_add_u32 s42, s30, s46
s_addc_u32 s43, s31, 0
s_mov_b32 m0, 23552
s_nop 0
global_load_lds_dwordx4 v157, s[42:43]
s_add_u32 s46, s41, 7168
s_add_u32 s42, s30, s46
s_addc_u32 s43, s31, 0
s_mov_b32 m0, 27648
s_nop 0
global_load_lds_dwordx4 v157, s[42:43]
s_add_u32 s46, s41, 11264
s_add_u32 s42, s30, s46
s_addc_u32 s43, s31, 0
s_mov_b32 m0, 31744
s_nop 0
global_load_lds_dwordx4 v157, s[42:43]
s_add_u32 s46, s41, 15360
s_add_u32 s42, s30, s46
s_addc_u32 s43, s31, 0
s_mov_b32 m0, 35840
s_nop 0
global_load_lds_dwordx4 v157, s[42:43]
s_add_u32 s48, s30, s38
s_addc_u32 s49, s31, 0
global_load_dwordx4 v[0:3], v157, s[48:49]
global_load_dwordx4 v[4:7], v157, s[48:49] offset:1024
s_add_u32 s46, 0, 0x6dc000
s_add_u32 s48, s30, s46
s_addc_u32 s49, s31, 0
s_load_dwordx2 s[60:61], s[48:49], 0
v_mov_b32 v159, 1
v_mov_b32 v158, 3
ds_write_b8 v158, v159 offset:528
v_and_b32 v162, 15, v156
v_lshrrev_b32 v163, 4, v156
v_lshrrev_b32 v165, 1, v163
v_lshlrev_b32 v165, 8, v165
v_lshl_add_u32 v165, v162, 4, v165
v_and_b32 v164, 1, v163
v_lshlrev_b32 v164, 10, v164
v_add_u32 v164, v164, v165
v_add_u32 v165, 2048, v165
v_lshrrev_b32 v166, 1, v163
v_lshlrev_b32 v166, 9, v166
v_lshl_add_u32 v166, v162, 4, v166
v_and_b32 v160, 1, v163
v_lshl_add_u32 v166, v160, 3, v166
s_waitcnt vmcnt(2) lgkmcnt(0)
H3_tags:
s_add_u32 s60, s60, s33
s_add_u32 s60, s60, 1
s_and_b32 s62, s60, 0xfff
s_lshr_b32 s63, s60, 12
s_and_b32 s63, s63, 0xfff
s_lshr_b64 s[64:65], s[60:61], 24
s_lshr_b32 s65, s64, 12
s_and_b32 s64, s64, 0xfff
s_and_b32 s65, s65, 0xfff
v_mov_b32 v159, 1
s_mov_b64 exec, 1
ds_add_u32 v167, v159 offset:592
s_mov_b64 exec, -1
s_getreg_b32 s71, hwreg(HW_REG_XCC_ID, 0, 4)
s_and_b32 s61, s61, 0xffff
s_lshl_b32 s61, s61, 8
s_or_b32 s61, s61, s71
s_mov_b32 s52, 0
s_mov_b32 s50, 158856
s_cmp_eq_u32 s33, 0
s_cselect_b32 s50, 158868, s50
H3_gb_re:
v_mov_b32 v158, s50
ds_read_b32 v159, v158
s_waitcnt lgkmcnt(0)
v_cmp_ne_u32 vcc, 1, v159
s_cbranch_vccz H3_gb_ok
s_add_u32 s52, s52, 1
s_cmp_gt_u32 s52, 200000
s_cbranch_scc1 H3_gb_ok
s_sleep 1
s_branch H3_gb_re
H3_gb_ok:
s_add_u32 s48, s30, s38
s_addc_u32 s49, s31, 0
global_load_dwordx4 v[0:3], v157, s[48:49]
global_load_dwordx4 v[4:7], v157, s[48:49] offset:1024
H3_havek:
s_waitcnt vmcnt(0)
v_max3_f32 v0, v0, v1, v2
v_max_f32 v0, v0, v3
v_max3_f32 v4, v4, v5, v6
v_max_f32 v4, v4, v7
v_max_f32_dpp v0, v0, v0 row_ror:8 row_mask:0xf bank_mask:0xf
s_nop 1
v_max_f32_dpp v0, v0, v0 row_ror:4 row_mask:0xf bank_mask:0xf
s_nop 1
v_max_f32_dpp v0, v0, v0 row_ror:2 row_mask:0xf bank_mask:0xf
s_nop 1
v_max_f32_dpp v0, v0, v0 row_ror:1 row_mask:0xf bank_mask:0xf
v_mov_b32 v158, v0
s_nop 1
v_permlane16_swap_b32 v0, v158
v_max_f32 v0, v0, v158
v_mov_b32 v158, v0
s_nop 1
v_permlane32_swap_b32 v0, v158
v_max_f32 v0, v0, v158
v_max_f32_dpp v4, v4, v4 row_ror:8 row_mask:0xf bank_mask:0xf
s_nop 1
v_max_f32_dpp v4, v4, v4 row_ror:4 row_mask:0xf bank_mask:0xf
s_nop 1
v_max_f32_dpp v4, v4, v4 row_ror:2 row_mask:0xf bank_mask:0xf
s_nop 1
v_max_f32_dpp v4, v4, v4 row_ror:1 row_mask:0xf bank_mask:0xf
v_mov_b32 v158, v4
s_nop 1
v_permlane16_swap_b32 v4, v158
v_max_f32 v4, v4, v158
v_mov_b32 v158, v4
s_nop 1
v_permlane32_swap_b32 v4, v158
v_max_f32 v4, v4, v158
v_add_f32 v0, v0, v4
v_mov_b32 v4, 1
s_mov_b64 exec, 1
ds_write_b32 v167, v0 offset:584
ds_write_b32 v167, v4 offset:588
s_mov_b64 exec, -1
H3_sp1_re:
ds_read_b32 v159, v167 offset:592
s_waitcnt lgkmcnt(0)
v_cmp_ne_u32 vcc, 4, v159
s_cbranch_vccz H3_sp1_ok
s_add_u32 s52, s52, 1
s_cmp_gt_u32 s52, 200000
s_cbranch_scc1 H3_sp1_ok
s_sleep 0
s_branch H3_sp1_re
H3_sp1_ok:
ds_read_b128 v[72:75], v157 offset:20480
ds_read_b128 v[76:79], v157 offset:21504
ds_read_b128 v[80:83], v157 offset:22528
ds_read_b128 v[84:87], v157 offset:23552
ds_read_b128 v[88:91], v157 offset:24576
ds_read_b128 v[92:95], v157 offset:25600
ds_read_b128 v[96:99], v157 offset:26624
ds_read_b128 v[100:103], v157 offset:27648
ds_read_b128 v[104:107], v157 offset:28672
s_waitcnt lgkmcnt(0)
ds_read_b128 v[108:111], v157 offset:29696
ds_read_b128 v[112:115], v157 offset:30720
ds_read_b128 v[116:119], v157 offset:31744
ds_read_b128 v[120:123], v157 offset:32768
ds_read_b128 v[124:127], v157 offset:33792
ds_read_b128 v[128:131], v157 offset:34816
ds_read_b128 v[132:135], v157 offset:35840
ds_read_b128 v[136:139], v157 offset:36864
ds_read_b128 v[140:143], v157 offset:37888
s_waitcnt lgkmcnt(0)
H3_sp2_re:
ds_read_b64 v[148:149], v167 offset:512
s_waitcnt lgkmcnt(0)
v_cmp_ne_u64 vcc, s[68:69], v[148:149]
s_cbranch_vccz H3_sp2_ok
s_add_u32 s52, s52, 1
s_cmp_gt_u32 s52, 200000
s_cbranch_scc1 H3_sp2_ok
s_sleep 1
s_branch H3_sp2_re
H3_sp2_ok:
s_mul_i32 s46, s40, 294912
s_add_u32 s46, s46, 0x9000
s_add_u32 s44, s30, s46
s_addc_u32 s45, s31, 0
global_load_dwordx4 v[0:3], v157, s[44:45] offset:0
global_load_dwordx4 v[4:7], v157, s[44:45] offset:1024
global_load_dwordx4 v[8:11], v157, s[44:45] offset:2048
global_load_dwordx4 v[12:15], v157, s[44:45] offset:3072
s_add_u32 s44, s44, 4096
s_addc_u32 s45, s45, 0
global_load_dwordx4 v[16:19], v157, s[44:45] offset:0
global_load_dwordx4 v[20:23], v157, s[44:45] offset:1024
global_load_dwordx4 v[24:27], v157, s[44:45] offset:2048
global_load_dwordx4 v[28:31], v157, s[44:45] offset:3072
s_add_u32 s44, s44, 4096
s_addc_u32 s45, s45, 0
global_load_dwordx4 v[32:35], v157, s[44:45] offset:0
global_load_dwordx4 v[36:39], v157, s[44:45] offset:1024
global_load_dwordx4 v[40:43], v157, s[44:45] offset:2048
global_load_dwordx4 v[44:47], v157, s[44:45] offset:3072
s_add_u32 s44, s44, 4096
s_addc_u32 s45, s45, 0
global_load_dwordx4 v[48:51], v157, s[44:45] offset:0
global_load_dwordx4 v[52:55], v157, s[44:45] offset:1024
global_load_dwordx4 v[56:59], v157, s[44:45] offset:2048
global_load_dwordx4 v[60:63], v157, s[44:45] offset:3072
s_add_u32 s44, s44, 4096
s_addc_u32 s45, s45, 0
global_load_dwordx4 v[64:67], v157, s[44:45] offset:0
global_load_dwordx4 v[68:71], v157, s[44:45] offset:1024
s_waitcnt vmcnt(17)
v_mfma_f32_16x16x32_bf16 v[144:147], v[0:3], v[72:75], 0
s_waitcnt vmcnt(16)
v_mfma_f32_16x16x32_bf16 v[144:147], v[4:7], v[76:79], v[144:147]
s_waitcnt vmcnt(15)
v_mfma_f32_16x16x32_bf16 v[144:147], v[8:11], v[80:83], v[144:147]
s_waitcnt vmcnt(14)
v_mfma_f32_16x16x32_bf16 v[144:147], v[12:15], v[84:87], v[144:147]
s_waitcnt vmcnt(13)
v_mfma_f32_16x16x32_bf16 v[144:147], v[16:19], v[88:91], v[144:147]
s_waitcnt vmcnt(12)
v_mfma_f32_16x16x32_bf16 v[144:147], v[20:23], v[92:95], v[144:147]
s_waitcnt vmcnt(11)
v_mfma_f32_16x16x32_bf16 v[144:147], v[24:27], v[96:99], v[144:147]
s_waitcnt vmcnt(10)
v_mfma_f32_16x16x32_bf16 v[144:147], v[28:31], v[100:103], v[144:147]
s_waitcnt vmcnt(9)
v_mfma_f32_16x16x32_bf16 v[144:147], v[32:35], v[104:107], v[144:147]
s_waitcnt vmcnt(8)
v_mfma_f32_16x16x32_bf16 v[144:147], v[36:39], v[108:111], v[144:147]
s_waitcnt vmcnt(7)
v_mfma_f32_16x16x32_bf16 v[144:147], v[40:43], v[112:115], v[144:147]
s_waitcnt vmcnt(6)
v_mfma_f32_16x16x32_bf16 v[144:147], v[44:47], v[116:119], v[144:147]
s_waitcnt vmcnt(5)
v_mfma_f32_16x16x32_bf16 v[144:147], v[48:51], v[120:123], v[144:147]
s_waitcnt vmcnt(4)
v_mfma_f32_16x16x32_bf16 v[144:147], v[52:55], v[124:127], v[144:147]
s_waitcnt vmcnt(3)
v_mfma_f32_16x16x32_bf16 v[144:147], v[56:59], v[128:131], v[144:147]
s_waitcnt vmcnt(2)
v_mfma_f32_16x16x32_bf16 v[144:147], v[60:63], v[132:135], v[144:147]
s_waitcnt vmcnt(1)
v_mfma_f32_16x16x32_bf16 v[144:147], v[64:67], v[136:139], v[144:147]
s_waitcnt vmcnt(0)
v_mfma_f32_16x16x32_bf16 v[144:147], v[68:71], v[140:143], v[144:147]
s_nop 7
v_mul_f32 v144, 0x3eae1a93, v144
v_mul_f32 v145, 0x3eae1a93, v145
v_mul_f32 v146, 0x3eae1a93, v146
v_mul_f32 v147, 0x3eae1a93, v147
v_mul_f32 v158, v144, v144
v_fmac_f32 v158, v145, v145
v_fmac_f32 v158, v146, v146
v_fmac_f32 v158, v147, v147
v_cvt_pk_bf16_f32 v144, v144, v145
v_cvt_pk_bf16_f32 v145, v146, v147
ds_write_b64 v166, v[144:145] offset:3072
v_mov_b32 v160, v158
s_nop 1
v_permlane16_swap_b32 v158, v160
v_add_f32 v158, v158, v160
v_mov_b32 v160, v158
s_nop 1
v_permlane32_swap_b32 v158, v160
v_add_f32 v158, v158, v160
v_mov_b32 v160, 1
s_mov_b64 exec, 0xffff
ds_max_u32 v167, v158 offset:148
s_mov_b64 exec, 1
ds_add_rtn_u32 v159, v167, v160 offset:144
s_mov_b64 exec, -1
s_waitcnt lgkmcnt(0)
v_readfirstlane_b32 s50, v159
s_cmp_eq_u32 s50, 1
s_cbranch_scc0 H3_nf3
H3_fz4_re:
ds_read_b128 v[148:151], v167 offset:576
ds_read_b128 v[152:155], v167 offset:144
s_waitcnt lgkmcnt(0)
v_and_b32 v159, v148, v151
v_cmp_ne_u32 vcc, 1, v159
s_cbranch_vccz H3_fz4_ok
s_add_u32 s52, s52, 1
s_cmp_gt_u32 s52, 200000
s_cbranch_scc1 H3_fz4_ok
s_sleep 0
s_branch H3_fz4_re
H3_fz4_ok:
v_add_f32 v153, v153, v154
v_mul_f32 v153, v153, v150
v_cmp_nge_f32 vcc, s70, v153
s_nop 1
v_cndmask_b32 v153, 1, 2, vcc
s_mov_b64 exec, 1
ds_write_b32 v167, v153 offset:8
s_mov_b64 exec, -1
H3_nf3:
H3_sp5_re:
ds_read_b64 v[148:149], v167 offset:520
s_waitcnt lgkmcnt(0)
v_cmp_ne_u64 vcc, s[68:69], v[148:149]
s_cbranch_vccz H3_sp5_ok
s_add_u32 s52, s52, 1
s_cmp_gt_u32 s52, 200000
s_cbranch_scc1 H3_sp5_ok
s_sleep 3
s_branch H3_sp5_re
H3_sp5_ok:
s_mul_i32 s46, s40, 294912
s_add_u32 s46, s46, 0x1b000
s_add_u32 s44, s30, s46
s_addc_u32 s45, s31, 0
global_load_dwordx4 v[0:3], v157, s[44:45] offset:0
global_load_dwordx4 v[4:7], v157, s[44:45] offset:1024
global_load_dwordx4 v[8:11], v157, s[44:45] offset:2048
global_load_dwordx4 v[12:15], v157, s[44:45] offset:3072
s_add_u32 s44, s44, 4096
s_addc_u32 s45, s45, 0
global_load_dwordx4 v[16:19], v157, s[44:45] offset:0
global_load_dwordx4 v[20:23], v157, s[44:45] offset:1024
global_load_dwordx4 v[24:27], v157, s[44:45] offset:2048
global_load_dwordx4 v[28:31], v157, s[44:45] offset:3072
s_add_u32 s44, s44, 4096
s_addc_u32 s45, s45, 0
global_load_dwordx4 v[32:35], v157, s[44:45] offset:0
global_load_dwordx4 v[36:39], v157, s[44:45] offset:1024
global_load_dwordx4 v[40:43], v157, s[44:45] offset:2048
global_load_dwordx4 v[44:47], v157, s[44:45] offset:3072
s_add_u32 s44, s44, 4096
s_addc_u32 s45, s45, 0
global_load_dwordx4 v[48:51], v157, s[44:45] offset:0
global_load_dwordx4 v[52:55], v157, s[44:45] offset:1024
global_load_dwordx4 v[56:59], v157, s[44:45] offset:2048
global_load_dwordx4 v[60:63], v157, s[44:45] offset:3072
s_add_u32 s44, s44, 4096
s_addc_u32 s45, s45, 0
global_load_dwordx4 v[64:67], v157, s[44:45] offset:0
global_load_dwordx4 v[68:71], v157, s[44:45] offset:1024
s_mul_i32 s46, s40, 294912
s_add_u32 s46, s46, 0x2d000
s_add_u32 s44, s30, s46
s_addc_u32 s45, s31, 0
s_waitcnt vmcnt(17)
v_mfma_f32_16x16x32_bf16 v[144:147], v[0:3], v[72:75], 0
global_load_dwordx4 v[0:3], v157, s[44:45] offset:0
s_waitcnt vmcnt(17)
v_mfma_f32_16x16x32_bf16 v[144:147], v[4:7], v[76:79], v[144:147]
global_load_dwordx4 v[4:7], v157, s[44:45] offset:1024
s_waitcnt vmcnt(17)
v_mfma_f32_16x16x32_bf16 v[144:147], v[8:11], v[80:83], v[144:147]
global_load_dwordx4 v[8:11], v157, s[44:45] offset:2048
s_waitcnt vmcnt(17)
v_mfma_f32_16x16x32_bf16 v[144:147], v[12:15], v[84:87], v[144:147]
global_load_dwordx4 v[12:15], v157, s[44:45] offset:3072
s_waitcnt vmcnt(17)
v_mfma_f32_16x16x32_bf16 v[144:147], v[16:19], v[88:91], v[144:147]
s_add_u32 s44, s44, 4096
s_addc_u32 s45, s45, 0
global_load_dwordx4 v[16:19], v157, s[44:45] offset:0
s_waitcnt vmcnt(17)
v_mfma_f32_16x16x32_bf16 v[144:147], v[20:23], v[92:95], v[144:147]
global_load_dwordx4 v[20:23], v157, s[44:45] offset:1024
s_waitcnt vmcnt(17)
v_mfma_f32_16x16x32_bf16 v[144:147], v[24:27], v[96:99], v[144:147]
global_load_dwordx4 v[24:27], v157, s[44:45] offset:2048
s_waitcnt vmcnt(17)
v_mfma_f32_16x16x32_bf16 v[144:147], v[28:31], v[100:103], v[144:147]
global_load_dwordx4 v[28:31], v157, s[44:45] offset:3072
s_waitcnt vmcnt(17)
v_mfma_f32_16x16x32_bf16 v[144:147], v[32:35], v[104:107], v[144:147]
s_add_u32 s44, s44, 4096
s_addc_u32 s45, s45, 0
global_load_dwordx4 v[32:35], v157, s[44:45] offset:0
s_waitcnt vmcnt(17)
v_mfma_f32_16x16x32_bf16 v[144:147], v[36:39], v[108:111], v[144:147]
global_load_dwordx4 v[36:39], v157, s[44:45] offset:1024
s_waitcnt vmcnt(17)
v_mfma_f32_16x16x32_bf16 v[144:147], v[40:43], v[112:115], v[144:147]
global_load_dwordx4 v[40:43], v157, s[44:45] offset:2048
s_waitcnt vmcnt(17)
v_mfma_f32_16x16x32_bf16 v[144:147], v[44:47], v[116:119], v[144:147]
global_load_dwordx4 v[44:47], v157, s[44:45] offset:3072
s_waitcnt vmcnt(17)
v_mfma_f32_16x16x32_bf16 v[144:147], v[48:51], v[120:123], v[144:147]
s_add_u32 s44, s44, 4096
s_addc_u32 s45, s45, 0
global_load_dwordx4 v[48:51], v157, s[44:45] offset:0
s_waitcnt vmcnt(17)
v_mfma_f32_16x16x32_bf16 v[144:147], v[52:55], v[124:127], v[144:147]
global_load_dwordx4 v[52:55], v157, s[44:45] offset:1024
s_waitcnt vmcnt(17)
v_mfma_f32_16x16x32_bf16 v[144:147], v[56:59], v[128:131], v[144:147]
global_load_dwordx4 v[56:59], v157, s[44:45] offset:2048
s_waitcnt vmcnt(17)
v_mfma_f32_16x16x32_bf16 v[144:147], v[60:63], v[132:135], v[144:147]
global_load_dwordx4 v[60:63], v157, s[44:45] offset:3072
s_waitcnt vmcnt(17)
v_mfma_f32_16x16x32_bf16 v[144:147], v[64:67], v[136:139], v[144:147]
s_add_u32 s44, s44, 4096
s_addc_u32 s45, s45, 0
global_load_dwordx4 v[64:67], v157, s[44:45] offset:0
s_waitcnt vmcnt(17)
v_mfma_f32_16x16x32_bf16 v[144:147], v[68:71], v[140:143], v[144:147]
global_load_dwordx4 v[68:71], v157, s[44:45] offset:1024
s_nop 6
v_mul_f32 v144, 0x3eae1a93, v144
v_mul_f32 v145, 0x3eae1a93, v145
v_mul_f32 v146, 0x3eae1a93, v146
v_mul_f32 v147, 0x3eae1a93, v147
v_mul_f32 v158, v144, v144
v_fmac_f32 v158, v145, v145
v_fmac_f32 v158, v146, v146
v_fmac_f32 v158, v147, v147
v_cvt_pk_bf16_f32 v144, v144, v145
v_cvt_pk_bf16_f32 v145, v146, v147
ds_write_b64 v166, v[144:145] offset:5120
v_mov_b32 v160, v158
s_nop 1
v_permlane16_swap_b32 v158, v160
v_add_f32 v158, v158, v160
v_mov_b32 v160, v158
s_nop 1
v_permlane32_swap_b32 v158, v160
v_add_f32 v158, v158, v160
v_mov_b32 v160, 1
s_mov_b64 exec, 0xffff
ds_max_u32 v167, v158 offset:180
s_mov_b64 exec, 1
ds_add_rtn_u32 v159, v167, v160 offset:176
s_mov_b64 exec, -1
s_waitcnt lgkmcnt(0)
v_readfirstlane_b32 s50, v159
s_cmp_eq_u32 s50, 1
s_cbranch_scc0 H3_nf6
H3_fz7_re:
ds_read_b128 v[148:151], v167 offset:576
ds_read_b128 v[152:155], v167 offset:176
s_waitcnt lgkmcnt(0)
v_and_b32 v159, v148, v151
v_cmp_ne_u32 vcc, 1, v159
s_cbranch_vccz H3_fz7_ok
s_add_u32 s52, s52, 1
s_cmp_gt_u32 s52, 200000
s_cbranch_scc1 H3_fz7_ok
s_sleep 0
s_branch H3_fz7_re
H3_fz7_ok:
v_add_f32 v153, v153, v154
v_mul_f32 v153, v153, v150
v_cmp_nge_f32 vcc, s70, v153
s_nop 1
v_cndmask_b32 v153, 1, 2, vcc
s_mov_b64 exec, 1
ds_write_b32 v167, v153 offset:24
s_mov_b64 exec, -1
H3_nf6:
s_mul_i32 s46, s40, 294912
s_add_u32 s46, s46, 0x3f000
s_add_u32 s44, s30, s46
s_addc_u32 s45, s31, 0
s_waitcnt vmcnt(17)
v_mfma_f32_16x16x32_bf16 v[144:147], v[0:3], v[72:75], 0
global_load_dwordx4 v[0:3], v157, s[44:45] offset:0
s_waitcnt vmcnt(17)
v_mfma_f32_16x16x32_bf16 v[144:147], v[4:7], v[76:79], v[144:147]
global_load_dwordx4 v[4:7], v157, s[44:45] offset:1024
s_waitcnt vmcnt(17)
v_mfma_f32_16x16x32_bf16 v[144:147], v[8:11], v[80:83], v[144:147]
global_load_dwordx4 v[8:11], v157, s[44:45] offset:2048
s_waitcnt vmcnt(17)
v_mfma_f32_16x16x32_bf16 v[144:147], v[12:15], v[84:87], v[144:147]
global_load_dwordx4 v[12:15], v157, s[44:45] offset:3072
s_waitcnt vmcnt(17)
v_mfma_f32_16x16x32_bf16 v[144:147], v[16:19], v[88:91], v[144:147]
s_add_u32 s44, s44, 4096
s_addc_u32 s45, s45, 0
global_load_dwordx4 v[16:19], v157, s[44:45] offset:0
s_waitcnt vmcnt(17)
v_mfma_f32_16x16x32_bf16 v[144:147], v[20:23], v[92:95], v[144:147]
global_load_dwordx4 v[20:23], v157, s[44:45] offset:1024
s_waitcnt vmcnt(17)
v_mfma_f32_16x16x32_bf16 v[144:147], v[24:27], v[96:99], v[144:147]
global_load_dwordx4 v[24:27], v157, s[44:45] offset:2048
s_waitcnt vmcnt(17)
v_mfma_f32_16x16x32_bf16 v[144:147], v[28:31], v[100:103], v[144:147]
global_load_dwordx4 v[28:31], v157, s[44:45] offset:3072
s_waitcnt vmcnt(17)
v_mfma_f32_16x16x32_bf16 v[144:147], v[32:35], v[104:107], v[144:147]
s_add_u32 s44, s44, 4096
s_addc_u32 s45, s45, 0
global_load_dwordx4 v[32:35], v157, s[44:45] offset:0
s_waitcnt vmcnt(17)
v_mfma_f32_16x16x32_bf16 v[144:147], v[36:39], v[108:111], v[144:147]
global_load_dwordx4 v[36:39], v157, s[44:45] offset:1024
s_waitcnt vmcnt(17)
v_mfma_f32_16x16x32_bf16 v[144:147], v[40:43], v[112:115], v[144:147]
global_load_dwordx4 v[40:43], v157, s[44:45] offset:2048
s_waitcnt vmcnt(17)
v_mfma_f32_16x16x32_bf16 v[144:147], v[44:47], v[116:119], v[144:147]
global_load_dwordx4 v[44:47], v157, s[44:45] offset:3072
s_waitcnt vmcnt(17)
v_mfma_f32_16x16x32_bf16 v[144:147], v[48:51], v[120:123], v[144:147]
s_add_u32 s44, s44, 4096
s_addc_u32 s45, s45, 0
global_load_dwordx4 v[48:51], v157, s[44:45] offset:0
s_waitcnt vmcnt(17)
v_mfma_f32_16x16x32_bf16 v[144:147], v[52:55], v[124:127], v[144:147]
global_load_dwordx4 v[52:55], v157, s[44:45] offset:1024
s_waitcnt vmcnt(17)
v_mfma_f32_16x16x32_bf16 v[144:147], v[56:59], v[128:131], v[144:147]
global_load_dwordx4 v[56:59], v157, s[44:45] offset:2048
s_waitcnt vmcnt(17)
v_mfma_f32_16x16x32_bf16 v[144:147], v[60:63], v[132:135], v[144:147]
global_load_dwordx4 v[60:63], v157, s[44:45] offset:3072
s_waitcnt vmcnt(17)
v_mfma_f32_16x16x32_bf16 v[144:147], v[64:67], v[136:139], v[144:147]
s_add_u32 s44, s44, 4096
s_addc_u32 s45, s45, 0
global_load_dwordx4 v[64:67], v157, s[44:45] offset:0
s_waitcnt vmcnt(17)
v_mfma_f32_16x16x32_bf16 v[144:147], v[68:71], v[140:143], v[144:147]
global_load_dwordx4 v[68:71], v157, s[44:45] offset:1024
s_nop 6
v_mul_f32 v144, 0x3eae1a93, v144
v_mul_f32 v145, 0x3eae1a93, v145
v_mul_f32 v146, 0x3eae1a93, v146
v_mul_f32 v147, 0x3eae1a93, v147
v_mul_f32 v158, v144, v144
v_fmac_f32 v158, v145, v145
v_fmac_f32 v158, v146, v146
v_fmac_f32 v158, v147, v147
v_cvt_pk_bf16_f32 v144, v144, v145
v_cvt_pk_bf16_f32 v145, v146, v147
ds_write_b64 v166, v[144:145] offset:7168
v_mov_b32 v160, v158
s_nop 1
v_permlane16_swap_b32 v158, v160
v_add_f32 v158, v158, v160
v_mov_b32 v160, v158
s_nop 1
v_permlane32_swap_b32 v158, v160
v_add_f32 v158, v158, v160
v_mov_b32 v160, 1
s_mov_b64 exec, 0xffff
ds_max_u32 v167, v158 offset:212
s_mov_b64 exec, 1
ds_add_rtn_u32 v159, v167, v160 offset:208
s_mov_b64 exec, -1
s_waitcnt lgkmcnt(0)
v_readfirstlane_b32 s50, v159
s_cmp_eq_u32 s50, 1
s_cbranch_scc0 H3_nf8
H3_fz9_re:
ds_read_b128 v[148:151], v167 offset:576
ds_read_b128 v[152:155], v167 offset:208
s_waitcnt lgkmcnt(0)
v_and_b32 v159, v149, v151
v_cmp_ne_u32 vcc, 1, v159
s_cbranch_vccz H3_fz9_ok
s_add_u32 s52, s52, 1
s_cmp_gt_u32 s52, 200000
s_cbranch_scc1 H3_fz9_ok
s_sleep 0
s_branch H3_fz9_re
H3_fz9_ok:
v_add_f32 v153, v153, v154
v_mul_f32 v153, v153, v150
v_cmp_nge_f32 vcc, s70, v153
s_nop 1
v_cndmask_b32 v153, 1, 2, vcc
s_mov_b64 exec, 1
ds_write_b32 v167, v153 offset:40
s_mov_b64 exec, -1
H3_nf8:
s_waitcnt vmcnt(17)
v_mfma_f32_16x16x32_bf16 v[144:147], v[0:3], v[72:75], 0
s_waitcnt vmcnt(16)
v_mfma_f32_16x16x32_bf16 v[144:147], v[4:7], v[76:79], v[144:147]
s_waitcnt vmcnt(15)
v_mfma_f32_16x16x32_bf16 v[144:147], v[8:11], v[80:83], v[144:147]
s_waitcnt vmcnt(14)
v_mfma_f32_16x16x32_bf16 v[144:147], v[12:15], v[84:87], v[144:147]
s_waitcnt vmcnt(13)
v_mfma_f32_16x16x32_bf16 v[144:147], v[16:19], v[88:91], v[144:147]
s_waitcnt vmcnt(12)
v_mfma_f32_16x16x32_bf16 v[144:147], v[20:23], v[92:95], v[144:147]
s_waitcnt vmcnt(11)
v_mfma_f32_16x16x32_bf16 v[144:147], v[24:27], v[96:99], v[144:147]
s_waitcnt vmcnt(10)
v_mfma_f32_16x16x32_bf16 v[144:147], v[28:31], v[100:103], v[144:147]
s_waitcnt vmcnt(9)
v_mfma_f32_16x16x32_bf16 v[144:147], v[32:35], v[104:107], v[144:147]
s_waitcnt vmcnt(8)
v_mfma_f32_16x16x32_bf16 v[144:147], v[36:39], v[108:111], v[144:147]
s_waitcnt vmcnt(7)
v_mfma_f32_16x16x32_bf16 v[144:147], v[40:43], v[112:115], v[144:147]
s_waitcnt vmcnt(6)
v_mfma_f32_16x16x32_bf16 v[144:147], v[44:47], v[116:119], v[144:147]
s_waitcnt vmcnt(5)
v_mfma_f32_16x16x32_bf16 v[144:147], v[48:51], v[120:123], v[144:147]
s_waitcnt vmcnt(4)
v_mfma_f32_16x16x32_bf16 v[144:147], v[52:55], v[124:127], v[144:147]
s_waitcnt vmcnt(3)
v_mfma_f32_16x16x32_bf16 v[144:147], v[56:59], v[128:131], v[144:147]
s_waitcnt vmcnt(2)
v_mfma_f32_16x16x32_bf16 v[144:147], v[60:63], v[132:135], v[144:147]
s_waitcnt vmcnt(1)
v_mfma_f32_16x16x32_bf16 v[144:147], v[64:67], v[136:139], v[144:147]
s_waitcnt vmcnt(0)
v_mfma_f32_16x16x32_bf16 v[144:147], v[68:71], v[140:143], v[144:147]
s_nop 7
v_mul_f32 v144, 0x3eae1a93, v144
v_mul_f32 v145, 0x3eae1a93, v145
v_mul_f32 v146, 0x3eae1a93, v146
v_mul_f32 v147, 0x3eae1a93, v147
v_mul_f32 v158, v144, v144
v_fmac_f32 v158, v145, v145
v_fmac_f32 v158, v146, v146
v_fmac_f32 v158, v147, v147
v_cvt_pk_bf16_f32 v144, v144, v145
v_cvt_pk_bf16_f32 v145, v146, v147
ds_write_b64 v166, v[144:145] offset:9216
v_mov_b32 v160, v158
s_nop 1
v_permlane16_swap_b32 v158, v160
v_add_f32 v158, v158, v160
v_mov_b32 v160, v158
s_nop 1
v_permlane32_swap_b32 v158, v160
v_add_f32 v158, v158, v160
v_mov_b32 v160, 1
s_mov_b64 exec, 0xffff
ds_max_u32 v167, v158 offset:244
s_mov_b64 exec, 1
ds_add_rtn_u32 v159, v167, v160 offset:240
s_mov_b64 exec, -1
s_waitcnt lgkmcnt(0)
v_readfirstlane_b32 s50, v159
s_cmp_eq_u32 s50, 1
s_cbranch_scc0 H3_nf10
H3_fz11_re:
ds_read_b128 v[148:151], v167 offset:576
ds_read_b128 v[152:155], v167 offset:240
s_waitcnt lgkmcnt(0)
v_and_b32 v159, v149, v151
v_cmp_ne_u32 vcc, 1, v159
s_cbranch_vccz H3_fz11_ok
s_add_u32 s52, s52, 1
s_cmp_gt_u32 s52, 200000
s_cbranch_scc1 H3_fz11_ok
s_sleep 0
s_branch H3_fz11_re
H3_fz11_ok:
v_add_f32 v153, v153, v154
v_mul_f32 v153, v153, v150
v_cmp_nge_f32 vcc, s70, v153
s_nop 1
v_cndmask_b32 v153, 1, 2, vcc
s_mov_b64 exec, 1
ds_write_b32 v167, v153 offset:56
s_mov_b64 exec, -1
H3_nf10:
s_cmp_eq_u32 s33, 1
s_cbranch_scc1 H3_noconv
s_lshl_b32 s50, s2, 1
s_add_u32 s50, s50, 1
s_sub_u32 s46, s60, 1
s_add_u32 s46, s46, 80
s_andn2_b32 s47, s61, 0xff
v_add_u32 v158, 0x6db000, v157
s_mov_b32 s53, 0
H3_xrp:
global_load_dwordx4 v[0:3], v158, s[30:31] sc1
global_load_dwordx4 v[4:7], v158, s[30:31] offset:1024 sc1
v_mov_b32 v159, 0
s_waitcnt vmcnt(0)
v_bitop3_b32 v159, v0, s46, v159 bitop3:0xbe
v_bitop3_b32 v159, v1, s47, v159 bitop3:0xbe
v_bitop3_b32 v159, v2, s46, v159 bitop3:0xbe
v_bitop3_b32 v159, v3, s47, v159 bitop3:0xbe
v_bitop3_b32 v159, v4, s46, v159 bitop3:0xbe
v_bitop3_b32 v159, v5, s47, v159 bitop3:0xbe
v_bitop3_b32 v159, v6, s46, v159 bitop3:0xbe
v_bitop3_b32 v159, v7, s47, v159 bitop3:0xbe
v_cmp_ne_u32 vcc, 0, v159
s_cbranch_vccz H3_xrok
s_add_u32 s53, s53, 1
s_cmp_gt_u32 s53, 20000
s_cbranch_scc1 H3_xrok
s_sleep 4
s_branch H3_xrp
H3_xrok:
s_mov_b32 s51, 133120
v_lshrrev_b32 v158, 4, v157
s_setprio 3
s_mov_b32 s44, s22
s_mov_b32 s45, s23
s_mov_b32 s46, 2359296
s_mov_b32 s47, 0x00020000
s_lshl_b32 s48, s50, 12
v_lshl_add_u32 v40, v158, 4, s48
buffer_load_dwordx4 v[56:59], v40, s[44:47], 0 offen offset:0
buffer_load_dword v88, v40, s[44:47], 0 offen offset:16
buffer_load_dwordx4 v[60:63], v40, s[44:47], 0 offen offset:1024
buffer_load_dword v89, v40, s[44:47], 0 offen offset:1040
buffer_load_dwordx4 v[64:67], v40, s[44:47], 0 offen offset:2048
buffer_load_dword v90, v40, s[44:47], 0 offen offset:2064
buffer_load_dwordx4 v[68:71], v40, s[44:47], 0 offen offset:3072
buffer_load_dword v91, v40, s[44:47], 0 offen offset:3088
v_mul_u32_u24 v41, 9216, v158
s_lshl_b32 s48, s50, 4
s_add_u32 s48, s48, 0x700000
v_add_u32 v41, s48, v41
global_load_dwordx4 v[72:75], v41, s[30:31]
v_add_u32 v41, 589824, v41
global_load_dwordx4 v[76:79], v41, s[30:31]
v_add_u32 v41, 589824, v41
global_load_dwordx4 v[80:83], v41, s[30:31]
v_add_u32 v41, 589824, v41
global_load_dwordx4 v[84:87], v41, s[30:31]
s_lshl_b32 s48, s50, 1
v_mov_b32 v42, s48
global_load_ushort v52, v42, s[24:25]
v_mov_b32 v44, 0
v_mov_b32 v45, 0
v_mov_b32 v46, 0
v_mov_b32 v47, 0
v_lshl_add_u32 v42, v158, 4, s51
ds_write_b128 v42, v[44:47] offset:13600
ds_write_b128 v42, v[44:47] offset:14624
s_mov_b64 exec, 0x7ffffff
ds_write_b128 v42, v[44:47] offset:15648
s_mov_b64 exec, -1
v_lshl_add_u32 v43, v158, 2, s51
s_mov_b64 exec, 0xffff
ds_write_b32 v43, v44 offset:0
s_mov_b64 exec, 0x7fff
ds_write_b32 v43, v44 offset:4292
s_mov_b64 exec, -1
v_lshrrev_b32 v40, 2, v158
v_mul_u32_u24 v40, 80, v40
v_and_b32 v41, 3, v158
v_lshl_add_u32 v40, v41, 4, v40
v_add_u32 v40, s51, v40
s_waitcnt vmcnt(5)
ds_write_b128 v42, v[56:59] offset:64
ds_write_b128 v42, v[60:63] offset:1088
ds_write_b128 v42, v[64:67] offset:2112
ds_write_b128 v42, v[68:71] offset:3136
v_alignbit_b32 v48, v57, v56, 16
v_alignbit_b32 v49, v58, v57, 16
v_alignbit_b32 v50, v59, v58, 16
v_alignbit_b32 v51, v88, v59, 16
v_add_u32 v41, 4356, v42
ds_write2_b32 v41, v48, v49 offset0:0 offset1:1
ds_write2_b32 v41, v50, v51 offset0:2 offset1:3
s_waitcnt lgkmcnt(0)
v_alignbit_b32 v48, v61, v60, 16
v_alignbit_b32 v49, v62, v61, 16
v_alignbit_b32 v50, v63, v62, 16
v_alignbit_b32 v51, v89, v63, 16
v_add_u32 v41, 5380, v42
ds_write2_b32 v41, v48, v49 offset0:0 offset1:1
ds_write2_b32 v41, v50, v51 offset0:2 offset1:3
s_waitcnt lgkmcnt(0)
v_alignbit_b32 v48, v65, v64, 16
v_alignbit_b32 v49, v66, v65, 16
v_alignbit_b32 v50, v67, v66, 16
v_alignbit_b32 v51, v90, v67, 16
v_add_u32 v41, 6404, v42
ds_write2_b32 v41, v48, v49 offset0:0 offset1:1
ds_write2_b32 v41, v50, v51 offset0:2 offset1:3
s_waitcnt lgkmcnt(0)
v_alignbit_b32 v48, v69, v68, 16
v_alignbit_b32 v49, v70, v69, 16
v_alignbit_b32 v50, v71, v70, 16
v_alignbit_b32 v51, v91, v71, 16
v_add_u32 v41, 7428, v42
ds_write2_b32 v41, v48, v49 offset0:0 offset1:1
ds_write2_b32 v41, v50, v51 offset0:2 offset1:3
s_waitcnt lgkmcnt(0)
v_lshlrev_b32 v48, 16, v56
s_mov_b64 exec, 1
ds_write_b32 v43, v48 offset:4352
s_mov_b64 exec, -1
s_waitcnt vmcnt(1)
ds_write_b128 v40, v[72:75] offset:8480
ds_write_b128 v40, v[76:79] offset:9760
ds_write_b128 v40, v[80:83] offset:11040
ds_write_b128 v40, v[84:87] offset:12320
v_and_b32 v43, 31, v158
v_lshrrev_b32 v44, 5, v158
v_add_u32 v45, 1, v43
v_and_b32 v45, 1, v45
s_waitcnt lgkmcnt(0)
v_mul_u32_u24 v40, 4290, v45
v_lshl_add_u32 v40, v43, 1, v40
v_lshl_add_u32 v40, v44, 4, v40
v_add3_u32 v40, v40, s51, 2
v_add_u32 v41, 2048, v40
v_sub_u32 v42, 31, v43
v_mul_u32_u24 v42, 80, v42
v_lshl_add_u32 v42, v44, 4, v42
v_add_u32 v42, s51, v42
v_add_u32 v42, 8480, v42
s_waitcnt vmcnt(0)
v_lshlrev_b32 v53, 16, v52
v_lshlrev_b32 v45, 3, v44
v_add_u32 v45, v45, v43
v_sub_u32 v46, 15, v45
v_cmp_eq_u32 vcc, 0, v46
s_nop 1
v_cndmask_b32 v32, 0, v52, vcc
v_cmp_eq_u32 vcc, 1, v46
s_nop 1
v_cndmask_b32 v32, v32, v53, vcc
v_cmp_eq_u32 vcc, 2, v46
s_nop 1
v_cndmask_b32 v33, 0, v52, vcc
v_cmp_eq_u32 vcc, 3, v46
s_nop 1
v_cndmask_b32 v33, v33, v53, vcc
v_cmp_eq_u32 vcc, 4, v46
s_nop 1
v_cndmask_b32 v34, 0, v52, vcc
v_cmp_eq_u32 vcc, 5, v46
s_nop 1
v_cndmask_b32 v34, v34, v53, vcc
v_cmp_eq_u32 vcc, 6, v46
s_nop 1
v_cndmask_b32 v35, 0, v52, vcc
v_cmp_eq_u32 vcc, 7, v46
s_nop 1
v_cndmask_b32 v35, v35, v53, vcc
v_sub_u32 v46, 31, v45
v_cmp_eq_u32 vcc, 0, v46
s_nop 1
v_cndmask_b32 v36, 0, v52, vcc
v_cmp_eq_u32 vcc, 1, v46
s_nop 1
v_cndmask_b32 v36, v36, v53, vcc
v_cmp_eq_u32 vcc, 2, v46
s_nop 1
v_cndmask_b32 v37, 0, v52, vcc
v_cmp_eq_u32 vcc, 3, v46
s_nop 1
v_cndmask_b32 v37, v37, v53, vcc
v_cmp_eq_u32 vcc, 4, v46
s_nop 1
v_cndmask_b32 v38, 0, v52, vcc
v_cmp_eq_u32 vcc, 5, v46
s_nop 1
v_cndmask_b32 v38, v38, v53, vcc
v_cmp_eq_u32 vcc, 6, v46
s_nop 1
v_cndmask_b32 v39, 0, v52, vcc
v_cmp_eq_u32 vcc, 7, v46
s_nop 1
v_cndmask_b32 v39, v39, v53, vcc
ds_read2_b32 v[56:57], v40 offset0:8 offset1:9
ds_read2_b32 v[58:59], v40 offset0:10 offset1:11
ds_read_b128 v[64:67], v42 offset:32
ds_read_b128 v[68:71], v42 offset:2592
ds_read2_b32 v[60:61], v41 offset0:8 offset1:9
ds_read2_b32 v[62:63], v41 offset0:10 offset1:11
ds_read2_b32 v[72:73], v40 offset0:0 offset1:1
ds_read2_b32 v[74:75], v40 offset0:2 offset1:3
ds_read_b128 v[80:83], v42 offset:0
ds_read_b128 v[84:87], v42 offset:2560
ds_read2_b32 v[76:77], v41 offset0:0 offset1:1
ds_read2_b32 v[78:79], v41 offset0:2 offset1:3
ds_read2_b32 v[88:89], v40 offset0:24 offset1:25
ds_read2_b32 v[90:91], v40 offset0:26 offset1:27
ds_read_b128 v[96:99], v42 offset:112
ds_read_b128 v[100:103], v42 offset:2672
ds_read2_b32 v[92:93], v41 offset0:24 offset1:25
ds_read2_b32 v[94:95], v41 offset0:26 offset1:27
s_waitcnt lgkmcnt(12)
v_mfma_f32_32x32x16_bf16 v[16:31], v[56:59], v[64:67], 0
v_mfma_f32_32x32x16_bf16 v[0:15], v[56:59], v[68:71], 0
v_mfma_f32_32x32x16_bf16 v[16:31], v[60:63], v[68:71], v[16:31]
v_mfma_f32_32x32x16_bf16 v[0:15], v[32:35], v[68:71], v[0:15]
v_mfma_f32_32x32x16_bf16 v[16:31], v[32:35], v[64:67], v[16:31]
ds_read2_b32 v[56:57], v40 offset0:16 offset1:17
ds_read2_b32 v[58:59], v40 offset0:18 offset1:19
ds_read_b128 v[64:67], v42 offset:80
ds_read_b128 v[68:71], v42 offset:2640
ds_read2_b32 v[60:61], v41 offset0:16 offset1:17
ds_read2_b32 v[62:63], v41 offset0:18 offset1:19
s_waitcnt lgkmcnt(12)
v_mfma_f32_32x32x16_bf16 v[16:31], v[72:75], v[80:83], v[16:31]
v_mfma_f32_32x32x16_bf16 v[0:15], v[72:75], v[84:87], v[0:15]
v_mfma_f32_32x32x16_bf16 v[16:31], v[76:79], v[84:87], v[16:31]
v_mfma_f32_32x32x16_bf16 v[0:15], v[36:39], v[84:87], v[0:15]
v_mfma_f32_32x32x16_bf16 v[16:31], v[36:39], v[80:83], v[16:31]
ds_read2_b32 v[72:73], v40 offset0:40 offset1:41
ds_read2_b32 v[74:75], v40 offset0:42 offset1:43
ds_read_b128 v[80:83], v42 offset:192
ds_read_b128 v[84:87], v42 offset:2752
ds_read2_b32 v[76:77], v41 offset0:40 offset1:41
ds_read2_b32 v[78:79], v41 offset0:42 offset1:43
s_waitcnt lgkmcnt(12)
v_mfma_f32_32x32x16_bf16 v[16:31], v[88:91], v[96:99], v[16:31]
v_mfma_f32_32x32x16_bf16 v[0:15], v[88:91], v[100:103], v[0:15]
v_mfma_f32_32x32x16_bf16 v[16:31], v[92:95], v[100:103], v[16:31]
ds_read2_b32 v[88:89], v40 offset0:32 offset1:33
ds_read2_b32 v[90:91], v40 offset0:34 offset1:35
ds_read_b128 v[96:99], v42 offset:160
ds_read_b128 v[100:103], v42 offset:2720
ds_read2_b32 v[92:93], v41 offset0:32 offset1:33
ds_read2_b32 v[94:95], v41 offset0:34 offset1:35
s_waitcnt lgkmcnt(12)
v_mfma_f32_32x32x16_bf16 v[16:31], v[56:59], v[64:67], v[16:31]
v_mfma_f32_32x32x16_bf16 v[0:15], v[56:59], v[68:71], v[0:15]
v_mfma_f32_32x32x16_bf16 v[16:31], v[60:63], v[68:71], v[16:31]
ds_read2_b32 v[56:57], v40 offset0:56 offset1:57
ds_read2_b32 v[58:59], v40 offset0:58 offset1:59
ds_read_b128 v[64:67], v42 offset:272
ds_read_b128 v[68:71], v42 offset:2832
ds_read2_b32 v[60:61], v41 offset0:56 offset1:57
ds_read2_b32 v[62:63], v41 offset0:58 offset1:59
s_waitcnt lgkmcnt(12)
v_mfma_f32_32x32x16_bf16 v[16:31], v[72:75], v[80:83], v[16:31]
v_mfma_f32_32x32x16_bf16 v[0:15], v[72:75], v[84:87], v[0:15]
v_mfma_f32_32x32x16_bf16 v[16:31], v[76:79], v[84:87], v[16:31]
ds_read2_b32 v[72:73], v40 offset0:48 offset1:49
ds_read2_b32 v[74:75], v40 offset0:50 offset1:51
ds_read_b128 v[80:83], v42 offset:240
ds_read_b128 v[84:87], v42 offset:2800
ds_read2_b32 v[76:77], v41 offset0:48 offset1:49
ds_read2_b32 v[78:79], v41 offset0:50 offset1:51
s_waitcnt lgkmcnt(12)
v_mfma_f32_32x32x16_bf16 v[16:31], v[88:91], v[96:99], v[16:31]
v_mfma_f32_32x32x16_bf16 v[0:15], v[88:91], v[100:103], v[0:15]
v_mfma_f32_32x32x16_bf16 v[16:31], v[92:95], v[100:103], v[16:31]
ds_read2_b32 v[88:89], v40 offset0:72 offset1:73
ds_read2_b32 v[90:91], v40 offset0:74 offset1:75
ds_read_b128 v[96:99], v42 offset:352
ds_read_b128 v[100:103], v42 offset:2912
ds_read2_b32 v[92:93], v41 offset0:72 offset1:73
ds_read2_b32 v[94:95], v41 offset0:74 offset1:75
s_waitcnt lgkmcnt(12)
v_mfma_f32_32x32x16_bf16 v[16:31], v[56:59], v[64:67], v[16:31]
v_mfma_f32_32x32x16_bf16 v[0:15], v[56:59], v[68:71], v[0:15]
v_mfma_f32_32x32x16_bf16 v[16:31], v[60:63], v[68:71], v[16:31]
ds_read2_b32 v[56:57], v40 offset0:64 offset1:65
ds_read2_b32 v[58:59], v40 offset0:66 offset1:67
ds_read_b128 v[64:67], v42 offset:320
ds_read_b128 v[68:71], v42 offset:2880
ds_read2_b32 v[60:61], v41 offset0:64 offset1:65
ds_read2_b32 v[62:63], v41 offset0:66 offset1:67
s_waitcnt lgkmcnt(12)
v_mfma_f32_32x32x16_bf16 v[16:31], v[72:75], v[80:83], v[16:31]
v_mfma_f32_32x32x16_bf16 v[0:15], v[72:75], v[84:87], v[0:15]
v_mfma_f32_32x32x16_bf16 v[16:31], v[76:79], v[84:87], v[16:31]
ds_read2_b32 v[72:73], v40 offset0:88 offset1:89
ds_read2_b32 v[74:75], v40 offset0:90 offset1:91
ds_read_b128 v[80:83], v42 offset:432
ds_read_b128 v[84:87], v42 offset:2992
ds_read2_b32 v[76:77], v41 offset0:88 offset1:89
ds_read2_b32 v[78:79], v41 offset0:90 offset1:91
s_waitcnt lgkmcnt(12)
v_mfma_f32_32x32x16_bf16 v[16:31], v[88:91], v[96:99], v[16:31]
v_mfma_f32_32x32x16_bf16 v[0:15], v[88:91], v[100:103], v[0:15]
v_mfma_f32_32x32x16_bf16 v[16:31], v[92:95], v[100:103], v[16:31]
ds_read2_b32 v[88:89], v40 offset0:80 offset1:81
ds_read2_b32 v[90:91], v40 offset0:82 offset1:83
ds_read_b128 v[96:99], v42 offset:400
ds_read_b128 v[100:103], v42 offset:2960
ds_read2_b32 v[92:93], v41 offset0:80 offset1:81
ds_read2_b32 v[94:95], v41 offset0:82 offset1:83
s_waitcnt lgkmcnt(12)
v_mfma_f32_32x32x16_bf16 v[16:31], v[56:59], v[64:67], v[16:31]
v_mfma_f32_32x32x16_bf16 v[0:15], v[56:59], v[68:71], v[0:15]
v_mfma_f32_32x32x16_bf16 v[16:31], v[60:63], v[68:71], v[16:31]
ds_read2_b32 v[56:57], v40 offset0:104 offset1:105
ds_read2_b32 v[58:59], v40 offset0:106 offset1:107
ds_read_b128 v[64:67], v42 offset:512
ds_read_b128 v[68:71], v42 offset:3072
ds_read2_b32 v[60:61], v41 offset0:104 offset1:105
ds_read2_b32 v[62:63], v41 offset0:106 offset1:107
s_waitcnt lgkmcnt(12)
v_mfma_f32_32x32x16_bf16 v[16:31], v[72:75], v[80:83], v[16:31]
v_mfma_f32_32x32x16_bf16 v[0:15], v[72:75], v[84:87], v[0:15]
v_mfma_f32_32x32x16_bf16 v[16:31], v[76:79], v[84:87], v[16:31]
ds_read2_b32 v[72:73], v40 offset0:96 offset1:97
ds_read2_b32 v[74:75], v40 offset0:98 offset1:99
ds_read_b128 v[80:83], v42 offset:480
ds_read_b128 v[84:87], v42 offset:3040
ds_read2_b32 v[76:77], v41 offset0:96 offset1:97
ds_read2_b32 v[78:79], v41 offset0:98 offset1:99
s_waitcnt lgkmcnt(12)
v_mfma_f32_32x32x16_bf16 v[16:31], v[88:91], v[96:99], v[16:31]
v_mfma_f32_32x32x16_bf16 v[0:15], v[88:91], v[100:103], v[0:15]
v_mfma_f32_32x32x16_bf16 v[16:31], v[92:95], v[100:103], v[16:31]
ds_read2_b32 v[88:89], v40 offset0:120 offset1:121
ds_read2_b32 v[90:91], v40 offset0:122 offset1:123
ds_read_b128 v[96:99], v42 offset:592
ds_read_b128 v[100:103], v42 offset:3152
ds_read2_b32 v[92:93], v41 offset0:120 offset1:121
ds_read2_b32 v[94:95], v41 offset0:122 offset1:123
s_waitcnt lgkmcnt(12)
v_mfma_f32_32x32x16_bf16 v[16:31], v[56:59], v[64:67], v[16:31]
v_mfma_f32_32x32x16_bf16 v[0:15], v[56:59], v[68:71], v[0:15]
v_mfma_f32_32x32x16_bf16 v[16:31], v[60:63], v[68:71], v[16:31]
ds_read2_b32 v[56:57], v40 offset0:112 offset1:113
ds_read2_b32 v[58:59], v40 offset0:114 offset1:115
ds_read_b128 v[64:67], v42 offset:560
ds_read_b128 v[68:71], v42 offset:3120
ds_read2_b32 v[60:61], v41 offset0:112 offset1:113
ds_read2_b32 v[62:63], v41 offset0:114 offset1:115
s_waitcnt lgkmcnt(12)
v_mfma_f32_32x32x16_bf16 v[16:31], v[72:75], v[80:83], v[16:31]
v_mfma_f32_32x32x16_bf16 v[0:15], v[72:75], v[84:87], v[0:15]
v_mfma_f32_32x32x16_bf16 v[16:31], v[76:79], v[84:87], v[16:31]
ds_read2_b32 v[72:73], v40 offset0:136 offset1:137
ds_read2_b32 v[74:75], v40 offset0:138 offset1:139
ds_read_b128 v[80:83], v42 offset:672
ds_read_b128 v[84:87], v42 offset:3232
ds_read2_b32 v[76:77], v41 offset0:136 offset1:137
ds_read2_b32 v[78:79], v41 offset0:138 offset1:139
s_waitcnt lgkmcnt(12)
v_mfma_f32_32x32x16_bf16 v[16:31], v[88:91], v[96:99], v[16:31]
v_mfma_f32_32x32x16_bf16 v[0:15], v[88:91], v[100:103], v[0:15]
v_mfma_f32_32x32x16_bf16 v[16:31], v[92:95], v[100:103], v[16:31]
ds_read2_b32 v[88:89], v40 offset0:128 offset1:129
ds_read2_b32 v[90:91], v40 offset0:130 offset1:131
ds_read_b128 v[96:99], v42 offset:640
ds_read_b128 v[100:103], v42 offset:3200
ds_read2_b32 v[92:93], v41 offset0:128 offset1:129
ds_read2_b32 v[94:95], v41 offset0:130 offset1:131
s_waitcnt lgkmcnt(12)
v_mfma_f32_32x32x16_bf16 v[16:31], v[56:59], v[64:67], v[16:31]
v_mfma_f32_32x32x16_bf16 v[0:15], v[56:59], v[68:71], v[0:15]
v_mfma_f32_32x32x16_bf16 v[16:31], v[60:63], v[68:71], v[16:31]
ds_read2_b32 v[56:57], v40 offset0:152 offset1:153
ds_read2_b32 v[58:59], v40 offset0:154 offset1:155
ds_read_b128 v[64:67], v42 offset:752
ds_read_b128 v[68:71], v42 offset:3312
ds_read2_b32 v[60:61], v41 offset0:152 offset1:153
ds_read2_b32 v[62:63], v41 offset0:154 offset1:155
s_waitcnt lgkmcnt(12)
v_mfma_f32_32x32x16_bf16 v[16:31], v[72:75], v[80:83], v[16:31]
v_mfma_f32_32x32x16_bf16 v[0:15], v[72:75], v[84:87], v[0:15]
v_mfma_f32_32x32x16_bf16 v[16:31], v[76:79], v[84:87], v[16:31]
ds_read2_b32 v[72:73], v40 offset0:144 offset1:145
ds_read2_b32 v[74:75], v40 offset0:146 offset1:147
ds_read_b128 v[80:83], v42 offset:720
ds_read_b128 v[84:87], v42 offset:3280
ds_read2_b32 v[76:77], v41 offset0:144 offset1:145
ds_read2_b32 v[78:79], v41 offset0:146 offset1:147
s_waitcnt lgkmcnt(12)
v_mfma_f32_32x32x16_bf16 v[16:31], v[88:91], v[96:99], v[16:31]
v_mfma_f32_32x32x16_bf16 v[0:15], v[88:91], v[100:103], v[0:15]
v_mfma_f32_32x32x16_bf16 v[16:31], v[92:95], v[100:103], v[16:31]
ds_read2_b32 v[88:89], v40 offset0:168 offset1:169
ds_read2_b32 v[90:91], v40 offset0:170 offset1:171
ds_read_b128 v[96:99], v42 offset:832
ds_read_b128 v[100:103], v42 offset:3392
ds_read2_b32 v[92:93], v41 offset0:168 offset1:169
ds_read2_b32 v[94:95], v41 offset0:170 offset1:171
s_waitcnt lgkmcnt(12)
v_mfma_f32_32x32x16_bf16 v[16:31], v[56:59], v[64:67], v[16:31]
v_mfma_f32_32x32x16_bf16 v[0:15], v[56:59], v[68:71], v[0:15]
v_mfma_f32_32x32x16_bf16 v[16:31], v[60:63], v[68:71], v[16:31]
ds_read2_b32 v[56:57], v40 offset0:160 offset1:161
ds_read2_b32 v[58:59], v40 offset0:162 offset1:163
ds_read_b128 v[64:67], v42 offset:800
ds_read_b128 v[68:71], v42 offset:3360
ds_read2_b32 v[60:61], v41 offset0:160 offset1:161
ds_read2_b32 v[62:63], v41 offset0:162 offset1:163
s_waitcnt lgkmcnt(12)
v_mfma_f32_32x32x16_bf16 v[16:31], v[72:75], v[80:83], v[16:31]
v_mfma_f32_32x32x16_bf16 v[0:15], v[72:75], v[84:87], v[0:15]
v_mfma_f32_32x32x16_bf16 v[16:31], v[76:79], v[84:87], v[16:31]
ds_read2_b32 v[72:73], v40 offset0:184 offset1:185
ds_read2_b32 v[74:75], v40 offset0:186 offset1:187
ds_read_b128 v[80:83], v42 offset:912
ds_read_b128 v[84:87], v42 offset:3472
ds_read2_b32 v[76:77], v41 offset0:184 offset1:185
ds_read2_b32 v[78:79], v41 offset0:186 offset1:187
s_waitcnt lgkmcnt(12)
v_mfma_f32_32x32x16_bf16 v[16:31], v[88:91], v[96:99], v[16:31]
v_mfma_f32_32x32x16_bf16 v[0:15], v[88:91], v[100:103], v[0:15]
v_mfma_f32_32x32x16_bf16 v[16:31], v[92:95], v[100:103], v[16:31]
ds_read2_b32 v[88:89], v40 offset0:176 offset1:177
ds_read2_b32 v[90:91], v40 offset0:178 offset1:179
ds_read_b128 v[96:99], v42 offset:880
ds_read_b128 v[100:103], v42 offset:3440
ds_read2_b32 v[92:93], v41 offset0:176 offset1:177
ds_read2_b32 v[94:95], v41 offset0:178 offset1:179
s_waitcnt lgkmcnt(12)
v_mfma_f32_32x32x16_bf16 v[16:31], v[56:59], v[64:67], v[16:31]
v_mfma_f32_32x32x16_bf16 v[0:15], v[56:59], v[68:71], v[0:15]
v_mfma_f32_32x32x16_bf16 v[16:31], v[60:63], v[68:71], v[16:31]
ds_read2_b32 v[56:57], v40 offset0:200 offset1:201
ds_read2_b32 v[58:59], v40 offset0:202 offset1:203
ds_read_b128 v[64:67], v42 offset:992
ds_read_b128 v[68:71], v42 offset:3552
ds_read2_b32 v[60:61], v41 offset0:200 offset1:201
ds_read2_b32 v[62:63], v41 offset0:202 offset1:203
s_waitcnt lgkmcnt(12)
v_mfma_f32_32x32x16_bf16 v[16:31], v[72:75], v[80:83], v[16:31]
v_mfma_f32_32x32x16_bf16 v[0:15], v[72:75], v[84:87], v[0:15]
v_mfma_f32_32x32x16_bf16 v[16:31], v[76:79], v[84:87], v[16:31]
ds_read2_b32 v[72:73], v40 offset0:192 offset1:193
ds_read2_b32 v[74:75], v40 offset0:194 offset1:195
ds_read_b128 v[80:83], v42 offset:960
ds_read_b128 v[84:87], v42 offset:3520
ds_read2_b32 v[76:77], v41 offset0:192 offset1:193
ds_read2_b32 v[78:79], v41 offset0:194 offset1:195
s_waitcnt lgkmcnt(12)
v_mfma_f32_32x32x16_bf16 v[16:31], v[88:91], v[96:99], v[16:31]
v_mfma_f32_32x32x16_bf16 v[0:15], v[88:91], v[100:103], v[0:15]
v_mfma_f32_32x32x16_bf16 v[16:31], v[92:95], v[100:103], v[16:31]
ds_read2_b32 v[88:89], v40 offset0:216 offset1:217
ds_read2_b32 v[90:91], v40 offset0:218 offset1:219
ds_read_b128 v[96:99], v42 offset:1072
ds_read_b128 v[100:103], v42 offset:3632
ds_read2_b32 v[92:93], v41 offset0:216 offset1:217
ds_read2_b32 v[94:95], v41 offset0:218 offset1:219
s_waitcnt lgkmcnt(12)
v_mfma_f32_32x32x16_bf16 v[16:31], v[56:59], v[64:67], v[16:31]
v_mfma_f32_32x32x16_bf16 v[0:15], v[56:59], v[68:71], v[0:15]
v_mfma_f32_32x32x16_bf16 v[16:31], v[60:63], v[68:71], v[16:31]
ds_read2_b32 v[56:57], v40 offset0:208 offset1:209
ds_read2_b32 v[58:59], v40 offset0:210 offset1:211
ds_read_b128 v[64:67], v42 offset:1040
ds_read_b128 v[68:71], v42 offset:3600
ds_read2_b32 v[60:61], v41 offset0:208 offset1:209
ds_read2_b32 v[62:63], v41 offset0:210 offset1:211
s_waitcnt lgkmcnt(12)
v_mfma_f32_32x32x16_bf16 v[16:31], v[72:75], v[80:83], v[16:31]
v_mfma_f32_32x32x16_bf16 v[0:15], v[72:75], v[84:87], v[0:15]
v_mfma_f32_32x32x16_bf16 v[16:31], v[76:79], v[84:87], v[16:31]
ds_read2_b32 v[72:73], v40 offset0:232 offset1:233
ds_read2_b32 v[74:75], v40 offset0:234 offset1:235
ds_read_b128 v[80:83], v42 offset:1152
ds_read_b128 v[84:87], v42 offset:3712
ds_read2_b32 v[76:77], v41 offset0:232 offset1:233
ds_read2_b32 v[78:79], v41 offset0:234 offset1:235
s_waitcnt lgkmcnt(12)
v_mfma_f32_32x32x16_bf16 v[16:31], v[88:91], v[96:99], v[16:31]
v_mfma_f32_32x32x16_bf16 v[0:15], v[88:91], v[100:103], v[0:15]
v_mfma_f32_32x32x16_bf16 v[16:31], v[92:95], v[100:103], v[16:31]
ds_read2_b32 v[88:89], v40 offset0:224 offset1:225
ds_read2_b32 v[90:91], v40 offset0:226 offset1:227
ds_read_b128 v[96:99], v42 offset:1120
ds_read_b128 v[100:103], v42 offset:3680
ds_read2_b32 v[92:93], v41 offset0:224 offset1:225
ds_read2_b32 v[94:95], v41 offset0:226 offset1:227
s_waitcnt lgkmcnt(12)
v_mfma_f32_32x32x16_bf16 v[16:31], v[56:59], v[64:67], v[16:31]
v_mfma_f32_32x32x16_bf16 v[0:15], v[56:59], v[68:71], v[0:15]
v_mfma_f32_32x32x16_bf16 v[16:31], v[60:63], v[68:71], v[16:31]
ds_read2_b32 v[56:57], v40 offset0:248 offset1:249
ds_read2_b32 v[58:59], v40 offset0:250 offset1:251
ds_read_b128 v[64:67], v42 offset:1232
ds_read_b128 v[68:71], v42 offset:3792
ds_read2_b32 v[60:61], v41 offset0:248 offset1:249
ds_read2_b32 v[62:63], v41 offset0:250 offset1:251
s_waitcnt lgkmcnt(12)
v_mfma_f32_32x32x16_bf16 v[16:31], v[72:75], v[80:83], v[16:31]
v_mfma_f32_32x32x16_bf16 v[0:15], v[72:75], v[84:87], v[0:15]
v_mfma_f32_32x32x16_bf16 v[16:31], v[76:79], v[84:87], v[16:31]
ds_read2_b32 v[72:73], v40 offset0:240 offset1:241
ds_read2_b32 v[74:75], v40 offset0:242 offset1:243
ds_read_b128 v[80:83], v42 offset:1200
ds_read_b128 v[84:87], v42 offset:3760
ds_read2_b32 v[76:77], v41 offset0:240 offset1:241
ds_read2_b32 v[78:79], v41 offset0:242 offset1:243
s_waitcnt lgkmcnt(12)
v_mfma_f32_32x32x16_bf16 v[16:31], v[88:91], v[96:99], v[16:31]
v_mfma_f32_32x32x16_bf16 v[0:15], v[88:91], v[100:103], v[0:15]
v_mfma_f32_32x32x16_bf16 v[16:31], v[92:95], v[100:103], v[16:31]
v_add_u32 v40, 1024, v40
v_add_u32 v41, 1024, v41
ds_read2_b32 v[88:89], v40 offset0:8 offset1:9
ds_read2_b32 v[90:91], v40 offset0:10 offset1:11
ds_read_b128 v[96:99], v42 offset:1312
ds_read_b128 v[100:103], v42 offset:3872
ds_read2_b32 v[92:93], v41 offset0:8 offset1:9
ds_read2_b32 v[94:95], v41 offset0:10 offset1:11
s_waitcnt lgkmcnt(12)
v_mfma_f32_32x32x16_bf16 v[16:31], v[56:59], v[64:67], v[16:31]
v_mfma_f32_32x32x16_bf16 v[0:15], v[56:59], v[68:71], v[0:15]
v_mfma_f32_32x32x16_bf16 v[16:31], v[60:63], v[68:71], v[16:31]
ds_read2_b32 v[56:57], v40 offset0:0 offset1:1
ds_read2_b32 v[58:59], v40 offset0:2 offset1:3
ds_read_b128 v[64:67], v42 offset:1280
ds_read_b128 v[68:71], v42 offset:3840
ds_read2_b32 v[60:61], v41 offset0:0 offset1:1
ds_read2_b32 v[62:63], v41 offset0:2 offset1:3
s_waitcnt lgkmcnt(12)
v_mfma_f32_32x32x16_bf16 v[16:31], v[72:75], v[80:83], v[16:31]
v_mfma_f32_32x32x16_bf16 v[0:15], v[72:75], v[84:87], v[0:15]
v_mfma_f32_32x32x16_bf16 v[16:31], v[76:79], v[84:87], v[16:31]
s_setprio 3
ds_read2_b32 v[72:73], v40 offset0:24 offset1:25
ds_read2_b32 v[74:75], v40 offset0:26 offset1:27
ds_read_b128 v[80:83], v42 offset:1392
ds_read_b128 v[84:87], v42 offset:3952
ds_read2_b32 v[76:77], v41 offset0:24 offset1:25
ds_read2_b32 v[78:79], v41 offset0:26 offset1:27
s_waitcnt lgkmcnt(12)
v_mfma_f32_32x32x16_bf16 v[16:31], v[88:91], v[96:99], v[16:31]
v_mfma_f32_32x32x16_bf16 v[0:15], v[88:91], v[100:103], v[0:15]
v_mfma_f32_32x32x16_bf16 v[16:31], v[92:95], v[100:103], v[16:31]
ds_read2_b32 v[88:89], v40 offset0:16 offset1:17
ds_read2_b32 v[90:91], v40 offset0:18 offset1:19
ds_read_b128 v[96:99], v42 offset:1360
ds_read_b128 v[100:103], v42 offset:3920
ds_read2_b32 v[92:93], v41 offset0:16 offset1:17
ds_read2_b32 v[94:95], v41 offset0:18 offset1:19
s_waitcnt lgkmcnt(12)
v_mfma_f32_32x32x16_bf16 v[16:31], v[56:59], v[64:67], v[16:31]
v_mfma_f32_32x32x16_bf16 v[0:15], v[56:59], v[68:71], v[0:15]
v_mfma_f32_32x32x16_bf16 v[16:31], v[60:63], v[68:71], v[16:31]
ds_read2_b32 v[56:57], v40 offset0:40 offset1:41
ds_read2_b32 v[58:59], v40 offset0:42 offset1:43
ds_read_b128 v[64:67], v42 offset:1472
ds_read_b128 v[68:71], v42 offset:4032
ds_read2_b32 v[60:61], v41 offset0:40 offset1:41
ds_read2_b32 v[62:63], v41 offset0:42 offset1:43
s_waitcnt lgkmcnt(12)
v_mfma_f32_32x32x16_bf16 v[16:31], v[72:75], v[80:83], v[16:31]
v_mfma_f32_32x32x16_bf16 v[0:15], v[72:75], v[84:87], v[0:15]
v_mfma_f32_32x32x16_bf16 v[16:31], v[76:79], v[84:87], v[16:31]
ds_read2_b32 v[72:73], v40 offset0:32 offset1:33
ds_read2_b32 v[74:75], v40 offset0:34 offset1:35
ds_read_b128 v[80:83], v42 offset:1440
ds_read_b128 v[84:87], v42 offset:4000
ds_read2_b32 v[76:77], v41 offset0:32 offset1:33
ds_read2_b32 v[78:79], v41 offset0:34 offset1:35
s_waitcnt lgkmcnt(12)
v_mfma_f32_32x32x16_bf16 v[16:31], v[88:91], v[96:99], v[16:31]
v_mfma_f32_32x32x16_bf16 v[0:15], v[88:91], v[100:103], v[0:15]
v_mfma_f32_32x32x16_bf16 v[16:31], v[92:95], v[100:103], v[16:31]
ds_read2_b32 v[88:89], v40 offset0:56 offset1:57
ds_read2_b32 v[90:91], v40 offset0:58 offset1:59
ds_read_b128 v[96:99], v42 offset:1552
ds_read_b128 v[100:103], v42 offset:4112
ds_read2_b32 v[92:93], v41 offset0:56 offset1:57
ds_read2_b32 v[94:95], v41 offset0:58 offset1:59
s_waitcnt lgkmcnt(12)
v_mfma_f32_32x32x16_bf16 v[16:31], v[56:59], v[64:67], v[16:31]
v_mfma_f32_32x32x16_bf16 v[0:15], v[56:59], v[68:71], v[0:15]
v_mfma_f32_32x32x16_bf16 v[16:31], v[60:63], v[68:71], v[16:31]
ds_read2_b32 v[56:57], v40 offset0:48 offset1:49
ds_read2_b32 v[58:59], v40 offset0:50 offset1:51
ds_read_b128 v[64:67], v42 offset:1520
ds_read_b128 v[68:71], v42 offset:4080
ds_read2_b32 v[60:61], v41 offset0:48 offset1:49
ds_read2_b32 v[62:63], v41 offset0:50 offset1:51
s_waitcnt lgkmcnt(12)
v_mfma_f32_32x32x16_bf16 v[16:31], v[72:75], v[80:83], v[16:31]
v_mfma_f32_32x32x16_bf16 v[0:15], v[72:75], v[84:87], v[0:15]
v_mfma_f32_32x32x16_bf16 v[16:31], v[76:79], v[84:87], v[16:31]
ds_read2_b32 v[72:73], v40 offset0:72 offset1:73
ds_read2_b32 v[74:75], v40 offset0:74 offset1:75
ds_read_b128 v[80:83], v42 offset:1632
ds_read_b128 v[84:87], v42 offset:4192
ds_read2_b32 v[76:77], v41 offset0:72 offset1:73
ds_read2_b32 v[78:79], v41 offset0:74 offset1:75
s_waitcnt lgkmcnt(12)
v_mfma_f32_32x32x16_bf16 v[16:31], v[88:91], v[96:99], v[16:31]
v_mfma_f32_32x32x16_bf16 v[0:15], v[88:91], v[100:103], v[0:15]
v_mfma_f32_32x32x16_bf16 v[16:31], v[92:95], v[100:103], v[16:31]
ds_read2_b32 v[88:89], v40 offset0:64 offset1:65
ds_read2_b32 v[90:91], v40 offset0:66 offset1:67
ds_read_b128 v[96:99], v42 offset:1600
ds_read_b128 v[100:103], v42 offset:4160
ds_read2_b32 v[92:93], v41 offset0:64 offset1:65
ds_read2_b32 v[94:95], v41 offset0:66 offset1:67
s_waitcnt lgkmcnt(12)
v_mfma_f32_32x32x16_bf16 v[16:31], v[56:59], v[64:67], v[16:31]
v_mfma_f32_32x32x16_bf16 v[0:15], v[56:59], v[68:71], v[0:15]
v_mfma_f32_32x32x16_bf16 v[16:31], v[60:63], v[68:71], v[16:31]
ds_read2_b32 v[56:57], v40 offset0:88 offset1:89
ds_read2_b32 v[58:59], v40 offset0:90 offset1:91
ds_read_b128 v[64:67], v42 offset:1712
ds_read_b128 v[68:71], v42 offset:4272
ds_read2_b32 v[60:61], v41 offset0:88 offset1:89
ds_read2_b32 v[62:63], v41 offset0:90 offset1:91
s_waitcnt lgkmcnt(12)
v_mfma_f32_32x32x16_bf16 v[16:31], v[72:75], v[80:83], v[16:31]
v_mfma_f32_32x32x16_bf16 v[0:15], v[72:75], v[84:87], v[0:15]
v_mfma_f32_32x32x16_bf16 v[16:31], v[76:79], v[84:87], v[16:31]
ds_read2_b32 v[72:73], v40 offset0:80 offset1:81
ds_read2_b32 v[74:75], v40 offset0:82 offset1:83
ds_read_b128 v[80:83], v42 offset:1680
ds_read_b128 v[84:87], v42 offset:4240
ds_read2_b32 v[76:77], v41 offset0:80 offset1:81
ds_read2_b32 v[78:79], v41 offset0:82 offset1:83
s_waitcnt lgkmcnt(12)
v_mfma_f32_32x32x16_bf16 v[16:31], v[88:91], v[96:99], v[16:31]
v_mfma_f32_32x32x16_bf16 v[0:15], v[88:91], v[100:103], v[0:15]
v_mfma_f32_32x32x16_bf16 v[16:31], v[92:95], v[100:103], v[16:31]
ds_read2_b32 v[88:89], v40 offset0:104 offset1:105
ds_read2_b32 v[90:91], v40 offset0:106 offset1:107
ds_read_b128 v[96:99], v42 offset:1792
ds_read_b128 v[100:103], v42 offset:4352
ds_read2_b32 v[92:93], v41 offset0:104 offset1:105
ds_read2_b32 v[94:95], v41 offset0:106 offset1:107
s_waitcnt lgkmcnt(12)
v_mfma_f32_32x32x16_bf16 v[16:31], v[56:59], v[64:67], v[16:31]
v_mfma_f32_32x32x16_bf16 v[0:15], v[56:59], v[68:71], v[0:15]
v_mfma_f32_32x32x16_bf16 v[16:31], v[60:63], v[68:71], v[16:31]
ds_read2_b32 v[56:57], v40 offset0:96 offset1:97
ds_read2_b32 v[58:59], v40 offset0:98 offset1:99
ds_read_b128 v[64:67], v42 offset:1760
ds_read_b128 v[68:71], v42 offset:4320
ds_read2_b32 v[60:61], v41 offset0:96 offset1:97
ds_read2_b32 v[62:63], v41 offset0:98 offset1:99
s_waitcnt lgkmcnt(12)
v_mfma_f32_32x32x16_bf16 v[16:31], v[72:75], v[80:83], v[16:31]
v_mfma_f32_32x32x16_bf16 v[0:15], v[72:75], v[84:87], v[0:15]
v_mfma_f32_32x32x16_bf16 v[16:31], v[76:79], v[84:87], v[16:31]
ds_read2_b32 v[72:73], v40 offset0:120 offset1:121
ds_read2_b32 v[74:75], v40 offset0:122 offset1:123
ds_read_b128 v[80:83], v42 offset:1872
ds_read_b128 v[84:87], v42 offset:4432
ds_read2_b32 v[76:77], v41 offset0:120 offset1:121
ds_read2_b32 v[78:79], v41 offset0:122 offset1:123
s_waitcnt lgkmcnt(12)
v_mfma_f32_32x32x16_bf16 v[16:31], v[88:91], v[96:99], v[16:31]
v_mfma_f32_32x32x16_bf16 v[0:15], v[88:91], v[100:103], v[0:15]
v_mfma_f32_32x32x16_bf16 v[16:31], v[92:95], v[100:103], v[16:31]
ds_read2_b32 v[88:89], v40 offset0:112 offset1:113
ds_read2_b32 v[90:91], v40 offset0:114 offset1:115
ds_read_b128 v[96:99], v42 offset:1840
ds_read_b128 v[100:103], v42 offset:4400
ds_read2_b32 v[92:93], v41 offset0:112 offset1:113
ds_read2_b32 v[94:95], v41 offset0:114 offset1:115
s_waitcnt lgkmcnt(12)
v_mfma_f32_32x32x16_bf16 v[16:31], v[56:59], v[64:67], v[16:31]
v_mfma_f32_32x32x16_bf16 v[0:15], v[56:59], v[68:71], v[0:15]
v_mfma_f32_32x32x16_bf16 v[16:31], v[60:63], v[68:71], v[16:31]
ds_read2_b32 v[56:57], v40 offset0:136 offset1:137
ds_read2_b32 v[58:59], v40 offset0:138 offset1:139
ds_read_b128 v[64:67], v42 offset:1952
ds_read_b128 v[68:71], v42 offset:4512
ds_read2_b32 v[60:61], v41 offset0:136 offset1:137
ds_read2_b32 v[62:63], v41 offset0:138 offset1:139
s_waitcnt lgkmcnt(12)
v_mfma_f32_32x32x16_bf16 v[16:31], v[72:75], v[80:83], v[16:31]
v_mfma_f32_32x32x16_bf16 v[0:15], v[72:75], v[84:87], v[0:15]
v_mfma_f32_32x32x16_bf16 v[16:31], v[76:79], v[84:87], v[16:31]
ds_read2_b32 v[72:73], v40 offset0:128 offset1:129
ds_read2_b32 v[74:75], v40 offset0:130 offset1:131
ds_read_b128 v[80:83], v42 offset:1920
ds_read_b128 v[84:87], v42 offset:4480
ds_read2_b32 v[76:77], v41 offset0:128 offset1:129
ds_read2_b32 v[78:79], v41 offset0:130 offset1:131
s_waitcnt lgkmcnt(12)
v_mfma_f32_32x32x16_bf16 v[16:31], v[88:91], v[96:99], v[16:31]
v_mfma_f32_32x32x16_bf16 v[0:15], v[88:91], v[100:103], v[0:15]
v_mfma_f32_32x32x16_bf16 v[16:31], v[92:95], v[100:103], v[16:31]
ds_read2_b32 v[88:89], v40 offset0:152 offset1:153
ds_read2_b32 v[90:91], v40 offset0:154 offset1:155
ds_read_b128 v[96:99], v42 offset:2032
ds_read_b128 v[100:103], v42 offset:4592
ds_read2_b32 v[92:93], v41 offset0:152 offset1:153
ds_read2_b32 v[94:95], v41 offset0:154 offset1:155
s_waitcnt lgkmcnt(12)
v_mfma_f32_32x32x16_bf16 v[16:31], v[56:59], v[64:67], v[16:31]
v_mfma_f32_32x32x16_bf16 v[0:15], v[56:59], v[68:71], v[0:15]
v_mfma_f32_32x32x16_bf16 v[16:31], v[60:63], v[68:71], v[16:31]
ds_read2_b32 v[56:57], v40 offset0:144 offset1:145
ds_read2_b32 v[58:59], v40 offset0:146 offset1:147
ds_read_b128 v[64:67], v42 offset:2000
ds_read_b128 v[68:71], v42 offset:4560
ds_read2_b32 v[60:61], v41 offset0:144 offset1:145
ds_read2_b32 v[62:63], v41 offset0:146 offset1:147
s_waitcnt lgkmcnt(12)
v_mfma_f32_32x32x16_bf16 v[16:31], v[72:75], v[80:83], v[16:31]
v_mfma_f32_32x32x16_bf16 v[0:15], v[72:75], v[84:87], v[0:15]
v_mfma_f32_32x32x16_bf16 v[16:31], v[76:79], v[84:87], v[16:31]
ds_read2_b32 v[72:73], v40 offset0:168 offset1:169
ds_read2_b32 v[74:75], v40 offset0:170 offset1:171
ds_read_b128 v[80:83], v42 offset:2112
ds_read_b128 v[84:87], v42 offset:4672
ds_read2_b32 v[76:77], v41 offset0:168 offset1:169
ds_read2_b32 v[78:79], v41 offset0:170 offset1:171
s_waitcnt lgkmcnt(12)
v_mfma_f32_32x32x16_bf16 v[16:31], v[88:91], v[96:99], v[16:31]
v_mfma_f32_32x32x16_bf16 v[0:15], v[88:91], v[100:103], v[0:15]
v_mfma_f32_32x32x16_bf16 v[16:31], v[92:95], v[100:103], v[16:31]
ds_read2_b32 v[88:89], v40 offset0:160 offset1:161
ds_read2_b32 v[90:91], v40 offset0:162 offset1:163
ds_read_b128 v[96:99], v42 offset:2080
ds_read_b128 v[100:103], v42 offset:4640
ds_read2_b32 v[92:93], v41 offset0:160 offset1:161
ds_read2_b32 v[94:95], v41 offset0:162 offset1:163
s_waitcnt lgkmcnt(12)
v_mfma_f32_32x32x16_bf16 v[16:31], v[56:59], v[64:67], v[16:31]
v_mfma_f32_32x32x16_bf16 v[0:15], v[56:59], v[68:71], v[0:15]
v_mfma_f32_32x32x16_bf16 v[16:31], v[60:63], v[68:71], v[16:31]
ds_read2_b32 v[56:57], v40 offset0:184 offset1:185
ds_read2_b32 v[58:59], v40 offset0:186 offset1:187
ds_read_b128 v[64:67], v42 offset:2192
ds_read_b128 v[68:71], v42 offset:4752
ds_read2_b32 v[60:61], v41 offset0:184 offset1:185
ds_read2_b32 v[62:63], v41 offset0:186 offset1:187
s_waitcnt lgkmcnt(12)
v_mfma_f32_32x32x16_bf16 v[16:31], v[72:75], v[80:83], v[16:31]
v_mfma_f32_32x32x16_bf16 v[0:15], v[72:75], v[84:87], v[0:15]
v_mfma_f32_32x32x16_bf16 v[16:31], v[76:79], v[84:87], v[16:31]
ds_read2_b32 v[72:73], v40 offset0:176 offset1:177
ds_read2_b32 v[74:75], v40 offset0:178 offset1:179
ds_read_b128 v[80:83], v42 offset:2160
ds_read_b128 v[84:87], v42 offset:4720
ds_read2_b32 v[76:77], v41 offset0:176 offset1:177
ds_read2_b32 v[78:79], v41 offset0:178 offset1:179
s_waitcnt lgkmcnt(12)
v_mfma_f32_32x32x16_bf16 v[16:31], v[88:91], v[96:99], v[16:31]
v_mfma_f32_32x32x16_bf16 v[0:15], v[88:91], v[100:103], v[0:15]
v_mfma_f32_32x32x16_bf16 v[16:31], v[92:95], v[100:103], v[16:31]
ds_read2_b32 v[88:89], v40 offset0:200 offset1:201
ds_read2_b32 v[90:91], v40 offset0:202 offset1:203
ds_read_b128 v[96:99], v42 offset:2272
ds_read_b128 v[100:103], v42 offset:4832
ds_read2_b32 v[92:93], v41 offset0:200 offset1:201
ds_read2_b32 v[94:95], v41 offset0:202 offset1:203
s_waitcnt lgkmcnt(12)
v_mfma_f32_32x32x16_bf16 v[16:31], v[56:59], v[64:67], v[16:31]
v_mfma_f32_32x32x16_bf16 v[0:15], v[56:59], v[68:71], v[0:15]
v_mfma_f32_32x32x16_bf16 v[16:31], v[60:63], v[68:71], v[16:31]
ds_read2_b32 v[56:57], v40 offset0:192 offset1:193
ds_read2_b32 v[58:59], v40 offset0:194 offset1:195
ds_read_b128 v[64:67], v42 offset:2240
ds_read_b128 v[68:71], v42 offset:4800
ds_read2_b32 v[60:61], v41 offset0:192 offset1:193
ds_read2_b32 v[62:63], v41 offset0:194 offset1:195
s_waitcnt lgkmcnt(12)
v_mfma_f32_32x32x16_bf16 v[16:31], v[72:75], v[80:83], v[16:31]
v_mfma_f32_32x32x16_bf16 v[0:15], v[72:75], v[84:87], v[0:15]
v_mfma_f32_32x32x16_bf16 v[16:31], v[76:79], v[84:87], v[16:31]
ds_read2_b32 v[72:73], v40 offset0:216 offset1:217
ds_read2_b32 v[74:75], v40 offset0:218 offset1:219
ds_read_b128 v[80:83], v42 offset:2352
ds_read_b128 v[84:87], v42 offset:4912
ds_read2_b32 v[76:77], v41 offset0:216 offset1:217
ds_read2_b32 v[78:79], v41 offset0:218 offset1:219
s_waitcnt lgkmcnt(12)
v_mfma_f32_32x32x16_bf16 v[16:31], v[88:91], v[96:99], v[16:31]
v_mfma_f32_32x32x16_bf16 v[0:15], v[88:91], v[100:103], v[0:15]
v_mfma_f32_32x32x16_bf16 v[16:31], v[92:95], v[100:103], v[16:31]
ds_read2_b32 v[88:89], v40 offset0:208 offset1:209
ds_read2_b32 v[90:91], v40 offset0:210 offset1:211
ds_read_b128 v[96:99], v42 offset:2320
ds_read_b128 v[100:103], v42 offset:4880
ds_read2_b32 v[92:93], v41 offset0:208 offset1:209
ds_read2_b32 v[94:95], v41 offset0:210 offset1:211
s_waitcnt lgkmcnt(12)
v_mfma_f32_32x32x16_bf16 v[16:31], v[56:59], v[64:67], v[16:31]
v_mfma_f32_32x32x16_bf16 v[0:15], v[56:59], v[68:71], v[0:15]
v_mfma_f32_32x32x16_bf16 v[16:31], v[60:63], v[68:71], v[16:31]
ds_read2_b32 v[56:57], v40 offset0:232 offset1:233
ds_read2_b32 v[58:59], v40 offset0:234 offset1:235
ds_read_b128 v[64:67], v42 offset:2432
ds_read_b128 v[68:71], v42 offset:4992
ds_read2_b32 v[60:61], v41 offset0:232 offset1:233
ds_read2_b32 v[62:63], v41 offset0:234 offset1:235
s_waitcnt lgkmcnt(12)
v_mfma_f32_32x32x16_bf16 v[16:31], v[72:75], v[80:83], v[16:31]
v_mfma_f32_32x32x16_bf16 v[0:15], v[72:75], v[84:87], v[0:15]
v_mfma_f32_32x32x16_bf16 v[16:31], v[76:79], v[84:87], v[16:31]
ds_read2_b32 v[72:73], v40 offset0:224 offset1:225
ds_read2_b32 v[74:75], v40 offset0:226 offset1:227
ds_read_b128 v[80:83], v42 offset:2400
ds_read_b128 v[84:87], v42 offset:4960
ds_read2_b32 v[76:77], v41 offset0:224 offset1:225
ds_read2_b32 v[78:79], v41 offset0:226 offset1:227
s_waitcnt lgkmcnt(12)
v_mfma_f32_32x32x16_bf16 v[16:31], v[88:91], v[96:99], v[16:31]
v_mfma_f32_32x32x16_bf16 v[0:15], v[88:91], v[100:103], v[0:15]
v_mfma_f32_32x32x16_bf16 v[16:31], v[92:95], v[100:103], v[16:31]
ds_read2_b32 v[88:89], v40 offset0:248 offset1:249
ds_read2_b32 v[90:91], v40 offset0:250 offset1:251
ds_read_b128 v[96:99], v42 offset:2512
ds_read_b128 v[100:103], v42 offset:5072
ds_read2_b32 v[92:93], v41 offset0:248 offset1:249
ds_read2_b32 v[94:95], v41 offset0:250 offset1:251
s_waitcnt lgkmcnt(12)
v_mfma_f32_32x32x16_bf16 v[16:31], v[56:59], v[64:67], v[16:31]
v_mfma_f32_32x32x16_bf16 v[0:15], v[56:59], v[68:71], v[0:15]
v_mfma_f32_32x32x16_bf16 v[16:31], v[60:63], v[68:71], v[16:31]
ds_read2_b32 v[56:57], v40 offset0:240 offset1:241
ds_read2_b32 v[58:59], v40 offset0:242 offset1:243
ds_read_b128 v[64:67], v42 offset:2480
ds_read_b128 v[68:71], v42 offset:5040
ds_read2_b32 v[60:61], v41 offset0:240 offset1:241
ds_read2_b32 v[62:63], v41 offset0:242 offset1:243
s_waitcnt lgkmcnt(12)
v_mfma_f32_32x32x16_bf16 v[16:31], v[72:75], v[80:83], v[16:31]
v_mfma_f32_32x32x16_bf16 v[0:15], v[72:75], v[84:87], v[0:15]
v_mfma_f32_32x32x16_bf16 v[16:31], v[76:79], v[84:87], v[16:31]
s_waitcnt lgkmcnt(6)
v_mfma_f32_32x32x16_bf16 v[16:31], v[88:91], v[96:99], v[16:31]
v_mfma_f32_32x32x16_bf16 v[0:15], v[88:91], v[100:103], v[0:15]
v_mfma_f32_32x32x16_bf16 v[16:31], v[92:95], v[100:103], v[16:31]
s_waitcnt lgkmcnt(0)
v_mfma_f32_32x32x16_bf16 v[16:31], v[56:59], v[64:67], v[16:31]
v_mfma_f32_32x32x16_bf16 v[0:15], v[56:59], v[68:71], v[0:15]
v_mfma_f32_32x32x16_bf16 v[16:31], v[60:63], v[68:71], v[16:31]
v_mul_u32_u24 v45, 36864, v43
v_lshl_add_u32 v45, v44, 3, v45
s_lshl_b32 s48, s50, 4
s_add_u32 s48, s48, 0x940000
v_add_u32 v45, s48, v45
s_nop 5
v_cvt_pk_bf16_f32 v56, v0, v1
v_cvt_pk_bf16_f32 v57, v2, v3
global_store_dwordx2 v45, v[56:57], s[30:31] sc1
v_add_u32 v45, 9216, v45
v_cvt_pk_bf16_f32 v58, v4, v5
v_cvt_pk_bf16_f32 v59, v6, v7
global_store_dwordx2 v45, v[58:59], s[30:31] sc1
v_add_u32 v45, 9216, v45
v_cvt_pk_bf16_f32 v60, v8, v9
v_cvt_pk_bf16_f32 v61, v10, v11
global_store_dwordx2 v45, v[60:61], s[30:31] sc1
v_add_u32 v45, 9216, v45
v_cvt_pk_bf16_f32 v62, v12, v13
v_cvt_pk_bf16_f32 v63, v14, v15
global_store_dwordx2 v45, v[62:63], s[30:31] sc1
v_add_u32 v45, 1152000, v45
v_cvt_pk_bf16_f32 v64, v16, v17
v_cvt_pk_bf16_f32 v65, v18, v19
global_store_dwordx2 v45, v[64:65], s[30:31] sc1
v_add_u32 v45, 9216, v45
v_cvt_pk_bf16_f32 v66, v20, v21
v_cvt_pk_bf16_f32 v67, v22, v23
global_store_dwordx2 v45, v[66:67], s[30:31] sc1
v_add_u32 v45, 9216, v45
v_cvt_pk_bf16_f32 v68, v24, v25
v_cvt_pk_bf16_f32 v69, v26, v27
global_store_dwordx2 v45, v[68:69], s[30:31] sc1
v_add_u32 v45, 9216, v45
v_cvt_pk_bf16_f32 v70, v28, v29
v_cvt_pk_bf16_f32 v71, v30, v31
global_store_dwordx2 v45, v[70:71], s[30:31] sc1
s_setprio 3
s_waitcnt vmcnt(0)
s_lshl_b32 s50, s50, 3
s_add_u32 s50, s50, 0x6de000
s_andn2_b32 s51, s61, 0xff
v_mov_b32 v158, s50
v_mov_b32 v148, s60
v_mov_b32 v149, s51
s_mov_b64 exec, 1
global_store_dwordx2 v158, v[148:149], s[30:31] sc1
s_mov_b64 exec, -1
H3_noconv:
v_lshrrev_b32 v158, 3, v162
v_cmp_eq_u32 vcc, s40, v158
s_mov_b64 s[54:55], vcc
s_not_b64 s[56:57], s[54:55]
v_and_b32 v166, 7, v162
v_mul_u32_u24 v156, 2320, v166
v_lshl_add_u32 v156, v163, 4, v156
v_add_u32 v156, 102080, v156
v_lshl_add_u32 v166, v163, 3, v166
v_lshlrev_b32 v166, 4, v166
s_lshl_b32 s46, s2, 2
s_add_u32 s46, s46, 3
s_mul_i32 s46, s46, 4608
s_add_u32 s46, s46, s39
s_add_u32 s48, s30, s46
s_addc_u32 s49, s31, 0
s_xor_b32 s47, s2, 1
s_lshl_b32 s46, s47, 2
s_add_u32 s46, s46, 3
s_mul_i32 s46, s46, 4608
s_add_u32 s46, s46, s39
s_add_u32 s66, s30, s46
s_addc_u32 s67, s31, 0
s_lshl_b32 s46, s33, 11
s_lshl_b32 s47, s47, 3
s_add_u32 s46, s46, s47
s_add_u32 s46, s46, 0x6dd000
v_mov_b32 v158, s46
global_load_dwordx2 v[148:149], v158, s[30:31] sc1
s_waitcnt vmcnt(0)
v_cmp_eq_u64 vcc, s[60:61], v[148:149]
s_cmp_eq_u64 vcc, -1
s_cselect_b32 s71, 1, 0
s_mul_i32 s46, s40, 294912
s_add_u32 s46, s46, 0xa8c00
s_add_u32 s58, s30, s46
s_addc_u32 s59, s31, 0
global_load_dwordx4 v[36:39], v157, s[58:59] offset:0
global_load_dwordx4 v[40:43], v157, s[58:59] offset:1024
global_load_dwordx4 v[44:47], v157, s[58:59] offset:2048
global_load_dwordx4 v[48:51], v157, s[58:59] offset:3072
s_add_u32 s58, s58, 4096
s_addc_u32 s59, s59, 0
global_load_dwordx4 v[52:55], v157, s[58:59] offset:0
global_load_dwordx4 v[56:59], v157, s[58:59] offset:1024
global_load_dwordx4 v[60:63], v157, s[58:59] offset:2048
global_load_dwordx4 v[64:67], v157, s[58:59] offset:3072
s_add_u32 s58, s58, 4096
s_addc_u32 s59, s59, 0
global_load_dwordx4 v[68:71], v157, s[58:59] offset:0
s_mul_i32 s46, s40, 294912
s_add_u32 s46, s46, 0xb1c00
s_add_u32 s58, s30, s46
s_addc_u32 s59, s31, 0
global_load_dwordx4 v[72:75], v157, s[58:59] offset:0
global_load_dwordx4 v[76:79], v157, s[58:59] offset:1024
global_load_dwordx4 v[80:83], v157, s[58:59] offset:2048
global_load_dwordx4 v[84:87], v157, s[58:59] offset:3072
s_add_u32 s58, s58, 4096
s_addc_u32 s59, s59, 0
global_load_dwordx4 v[88:91], v157, s[58:59] offset:0
global_load_dwordx4 v[92:95], v157, s[58:59] offset:1024
global_load_dwordx4 v[96:99], v157, s[58:59] offset:2048
global_load_dwordx4 v[100:103], v157, s[58:59] offset:3072
s_add_u32 s58, s58, 4096
s_addc_u32 s59, s59, 0
global_load_dwordx4 v[104:107], v157, s[58:59] offset:0
H3_sp12_re:
ds_read_b32 v159, v167 offset:36
s_waitcnt lgkmcnt(0)
v_cmp_ne_u32 vcc, 1, v159
s_cbranch_vccz H3_sp12_ok
s_add_u32 s52, s52, 1
s_cmp_gt_u32 s52, 200000
s_cbranch_scc1 H3_sp12_ok
s_sleep 4
s_branch H3_sp12_re
H3_sp12_ok:
ds_read_b128 v[144:147], v157 offset:11264
s_waitcnt lgkmcnt(0)
s_mul_i32 s46, s40, 294912
s_add_u32 s46, s46, 0xbac00
s_add_u32 s58, s30, s46
s_addc_u32 s59, s31, 0
s_waitcnt vmcnt(17)
v_mfma_f32_16x16x32_bf16 v[0:3], v[36:39], v[144:147], 0
global_load_dwordx4 v[36:39], v157, s[58:59] offset:0
s_waitcnt vmcnt(17)
v_mfma_f32_16x16x32_bf16 v[4:7], v[40:43], v[144:147], 0
global_load_dwordx4 v[40:43], v157, s[58:59] offset:1024
s_waitcnt vmcnt(17)
v_mfma_f32_16x16x32_bf16 v[8:11], v[44:47], v[144:147], 0
global_load_dwordx4 v[44:47], v157, s[58:59] offset:2048
s_waitcnt vmcnt(17)
v_mfma_f32_16x16x32_bf16 v[12:15], v[48:51], v[144:147], 0
global_load_dwordx4 v[48:51], v157, s[58:59] offset:3072
s_waitcnt vmcnt(17)
v_mfma_f32_16x16x32_bf16 v[16:19], v[52:55], v[144:147], 0
s_add_u32 s58, s58, 4096
s_addc_u32 s59, s59, 0
global_load_dwordx4 v[52:55], v157, s[58:59] offset:0
s_waitcnt vmcnt(17)
v_mfma_f32_16x16x32_bf16 v[20:23], v[56:59], v[144:147], 0
global_load_dwordx4 v[56:59], v157, s[58:59] offset:1024
s_waitcnt vmcnt(17)
v_mfma_f32_16x16x32_bf16 v[24:27], v[60:63], v[144:147], 0
global_load_dwordx4 v[60:63], v157, s[58:59] offset:2048
s_waitcnt vmcnt(17)
v_mfma_f32_16x16x32_bf16 v[28:31], v[64:67], v[144:147], 0
global_load_dwordx4 v[64:67], v157, s[58:59] offset:3072
s_waitcnt vmcnt(17)
v_mfma_f32_16x16x32_bf16 v[32:35], v[68:71], v[144:147], 0
s_add_u32 s58, s58, 4096
s_addc_u32 s59, s59, 0
global_load_dwordx4 v[68:71], v157, s[58:59] offset:0
H3_sp13_re:
ds_read_b32 v159, v167 offset:44
s_waitcnt lgkmcnt(0)
v_cmp_ne_u32 vcc, 1, v159
s_cbranch_vccz H3_sp13_ok
s_add_u32 s52, s52, 1
s_cmp_gt_u32 s52, 200000
s_cbranch_scc1 H3_sp13_ok
s_sleep 4
s_branch H3_sp13_re
H3_sp13_ok:
ds_read_b128 v[144:147], v157 offset:12288
s_waitcnt lgkmcnt(0)
s_mul_i32 s46, s40, 294912
s_add_u32 s46, s46, 0xc3c00
s_add_u32 s58, s30, s46
s_addc_u32 s59, s31, 0
s_waitcnt vmcnt(17)
v_mfma_f32_16x16x32_bf16 v[0:3], v[72:75], v[144:147], v[0:3]
global_load_dwordx4 v[72:75], v157, s[58:59] offset:0
s_waitcnt vmcnt(17)
v_mfma_f32_16x16x32_bf16 v[4:7], v[76:79], v[144:147], v[4:7]
global_load_dwordx4 v[76:79], v157, s[58:59] offset:1024
s_waitcnt vmcnt(17)
v_mfma_f32_16x16x32_bf16 v[8:11], v[80:83], v[144:147], v[8:11]
global_load_dwordx4 v[80:83], v157, s[58:59] offset:2048
s_waitcnt vmcnt(17)
v_mfma_f32_16x16x32_bf16 v[12:15], v[84:87], v[144:147], v[12:15]
global_load_dwordx4 v[84:87], v157, s[58:59] offset:3072
s_waitcnt vmcnt(17)
v_mfma_f32_16x16x32_bf16 v[16:19], v[88:91], v[144:147], v[16:19]
s_add_u32 s58, s58, 4096
s_addc_u32 s59, s59, 0
global_load_dwordx4 v[88:91], v157, s[58:59] offset:0
s_waitcnt vmcnt(17)
v_mfma_f32_16x16x32_bf16 v[20:23], v[92:95], v[144:147], v[20:23]
global_load_dwordx4 v[92:95], v157, s[58:59] offset:1024
s_waitcnt vmcnt(17)
v_mfma_f32_16x16x32_bf16 v[24:27], v[96:99], v[144:147], v[24:27]
global_load_dwordx4 v[96:99], v157, s[58:59] offset:2048
s_waitcnt vmcnt(17)
v_mfma_f32_16x16x32_bf16 v[28:31], v[100:103], v[144:147], v[28:31]
global_load_dwordx4 v[100:103], v157, s[58:59] offset:3072
s_waitcnt vmcnt(17)
v_mfma_f32_16x16x32_bf16 v[32:35], v[104:107], v[144:147], v[32:35]
s_add_u32 s58, s58, 4096
s_addc_u32 s59, s59, 0
global_load_dwordx4 v[104:107], v157, s[58:59] offset:0
H3_sp14_re:
ds_read_b32 v159, v167 offset:52
s_waitcnt lgkmcnt(0)
v_cmp_ne_u32 vcc, 1, v159
s_cbranch_vccz H3_sp14_ok
s_add_u32 s52, s52, 1
s_cmp_gt_u32 s52, 200000
s_cbranch_scc1 H3_sp14_ok
s_sleep 4
s_branch H3_sp14_re
H3_sp14_ok:
ds_read_b128 v[144:147], v157 offset:13312
s_waitcnt lgkmcnt(0)
s_mul_i32 s46, s40, 294912
s_add_u32 s46, s46, 0xccc00
s_add_u32 s58, s30, s46
s_addc_u32 s59, s31, 0
s_waitcnt vmcnt(17)
v_mfma_f32_16x16x32_bf16 v[0:3], v[36:39], v[144:147], v[0:3]
global_load_dwordx4 v[36:39], v157, s[58:59] offset:0
s_waitcnt vmcnt(17)
v_mfma_f32_16x16x32_bf16 v[4:7], v[40:43], v[144:147], v[4:7]
global_load_dwordx4 v[40:43], v157, s[58:59] offset:1024
s_waitcnt vmcnt(17)
v_mfma_f32_16x16x32_bf16 v[8:11], v[44:47], v[144:147], v[8:11]
global_load_dwordx4 v[44:47], v157, s[58:59] offset:2048
s_waitcnt vmcnt(17)
v_mfma_f32_16x16x32_bf16 v[12:15], v[48:51], v[144:147], v[12:15]
global_load_dwordx4 v[48:51], v157, s[58:59] offset:3072
s_waitcnt vmcnt(17)
v_mfma_f32_16x16x32_bf16 v[16:19], v[52:55], v[144:147], v[16:19]
s_add_u32 s58, s58, 4096
s_addc_u32 s59, s59, 0
global_load_dwordx4 v[52:55], v157, s[58:59] offset:0
s_waitcnt vmcnt(17)
v_mfma_f32_16x16x32_bf16 v[20:23], v[56:59], v[144:147], v[20:23]
global_load_dwordx4 v[56:59], v157, s[58:59] offset:1024
s_waitcnt vmcnt(17)
v_mfma_f32_16x16x32_bf16 v[24:27], v[60:63], v[144:147], v[24:27]
global_load_dwordx4 v[60:63], v157, s[58:59] offset:2048
s_waitcnt vmcnt(17)
v_mfma_f32_16x16x32_bf16 v[28:31], v[64:67], v[144:147], v[28:31]
global_load_dwordx4 v[64:67], v157, s[58:59] offset:3072
s_waitcnt vmcnt(17)
v_mfma_f32_16x16x32_bf16 v[32:35], v[68:71], v[144:147], v[32:35]
s_add_u32 s58, s58, 4096
s_addc_u32 s59, s59, 0
global_load_dwordx4 v[68:71], v157, s[58:59] offset:0
s_cmp_eq_u32 s33, 1
s_cbranch_scc0 H3_sk15
H3_sp16_re:
ds_read_b64 v[148:149], v167 offset:280
s_waitcnt lgkmcnt(0)
v_cmp_ne_u64 vcc, s[68:69], v[148:149]
s_cbranch_vccz H3_sp16_ok
s_add_u32 s52, s52, 1
s_cmp_gt_u32 s52, 200000
s_cbranch_scc1 H3_sp16_ok
s_sleep 2
s_branch H3_sp16_re
H3_sp16_ok:
v_add_u32 v160, 38912, v164
v_add_u32 v161, 38912, v165
ds_read_b128 v[144:147], v160 offset:0
ds_read_b128 v[148:151], v160 offset:512
ds_read_b128 v[152:155], v161 offset:0
ds_read_b128 v[108:111], v160 offset:2560
ds_read_b128 v[112:115], v160 offset:3072
ds_read_b128 v[116:119], v161 offset:2560
ds_read_b128 v[120:123], v160 offset:5120
ds_read_b128 v[124:127], v160 offset:5632
ds_read_b128 v[128:131], v161 offset:5120
ds_read_b128 v[132:135], v160 offset:7680
ds_read_b128 v[136:139], v160 offset:8192
ds_read_b128 v[140:143], v161 offset:7680
s_waitcnt lgkmcnt(6)
v_pk_add_f32 v[144:145], v[144:145], v[108:109]
v_pk_add_f32 v[146:147], v[146:147], v[110:111]
v_pk_add_f32 v[148:149], v[148:149], v[112:113]
v_pk_add_f32 v[150:151], v[150:151], v[114:115]
v_pk_add_f32 v[152:153], v[152:153], v[116:117]
v_add_f32 v154, v154, v118
ds_read_b128 v[108:111], v160 offset:10240
ds_read_b128 v[112:115], v160 offset:10752
ds_read_b128 v[116:119], v161 offset:10240
s_waitcnt lgkmcnt(6)
v_pk_add_f32 v[144:145], v[144:145], v[120:121]
v_pk_add_f32 v[146:147], v[146:147], v[122:123]
v_pk_add_f32 v[148:149], v[148:149], v[124:125]
v_pk_add_f32 v[150:151], v[150:151], v[126:127]
v_pk_add_f32 v[152:153], v[152:153], v[128:129]
v_add_f32 v154, v154, v130
ds_read_b128 v[120:123], v160 offset:12800
ds_read_b128 v[124:127], v160 offset:13312
ds_read_b128 v[128:131], v161 offset:12800
s_waitcnt lgkmcnt(6)
v_pk_add_f32 v[144:145], v[144:145], v[132:133]
v_pk_add_f32 v[146:147], v[146:147], v[134:135]
v_pk_add_f32 v[148:149], v[148:149], v[136:137]
v_pk_add_f32 v[150:151], v[150:151], v[138:139]
v_pk_add_f32 v[152:153], v[152:153], v[140:141]
v_add_f32 v154, v154, v142
ds_read_b128 v[132:135], v160 offset:15360
ds_read_b128 v[136:139], v160 offset:15872
ds_read_b128 v[140:143], v161 offset:15360
s_waitcnt lgkmcnt(6)
v_pk_add_f32 v[144:145], v[144:145], v[108:109]
v_pk_add_f32 v[146:147], v[146:147], v[110:111]
v_pk_add_f32 v[148:149], v[148:149], v[112:113]
v_pk_add_f32 v[150:151], v[150:151], v[114:115]
v_pk_add_f32 v[152:153], v[152:153], v[116:117]
v_add_f32 v154, v154, v118
ds_read_b128 v[108:111], v160 offset:17920
ds_read_b128 v[112:115], v160 offset:18432
ds_read_b128 v[116:119], v161 offset:17920
s_waitcnt lgkmcnt(6)
v_pk_add_f32 v[144:145], v[144:145], v[120:121]
v_pk_add_f32 v[146:147], v[146:147], v[122:123]
v_pk_add_f32 v[148:149], v[148:149], v[124:125]
v_pk_add_f32 v[150:151], v[150:151], v[126:127]
v_pk_add_f32 v[152:153], v[152:153], v[128:129]
v_add_f32 v154, v154, v130
s_waitcnt lgkmcnt(3)
v_pk_add_f32 v[144:145], v[144:145], v[132:133]
v_pk_add_f32 v[146:147], v[146:147], v[134:135]
v_pk_add_f32 v[148:149], v[148:149], v[136:137]
v_pk_add_f32 v[150:151], v[150:151], v[138:139]
v_pk_add_f32 v[152:153], v[152:153], v[140:141]
v_add_f32 v154, v154, v142
s_waitcnt lgkmcnt(0)
v_pk_add_f32 v[144:145], v[144:145], v[108:109]
v_pk_add_f32 v[146:147], v[146:147], v[110:111]
v_pk_add_f32 v[148:149], v[148:149], v[112:113]
v_pk_add_f32 v[150:151], v[150:151], v[114:115]
v_pk_add_f32 v[152:153], v[152:153], v[116:117]
v_add_f32 v154, v154, v118
v_rcp_f32 v154, v154
s_nop 0
v_mul_f32 v144, v144, v154
v_mul_f32 v145, v145, v154
v_mul_f32 v146, v146, v154
v_mul_f32 v147, v147, v154
v_mul_f32 v148, v148, v154
v_mul_f32 v149, v149, v154
v_mul_f32 v150, v150, v154
v_mul_f32 v151, v151, v154
v_mul_f32 v152, v152, v154
v_mul_f32 v153, v153, v154
v_cvt_pk_bf16_f32 v144, v144, v145
v_cvt_pk_bf16_f32 v145, v146, v147
v_cvt_pk_bf16_f32 v146, v148, v149
v_cvt_pk_bf16_f32 v147, v150, v151
v_cvt_pk_bf16_f32 v155, v152, v153
ds_write_b128 v157, v[144:147] offset:14336
v_lshlrev_b32 v160, 4, v162
v_lshrrev_b32 v161, 1, v163
v_lshl_add_u32 v160, v161, 2, v160
s_mov_b32 exec_lo, 0xffff
s_mov_b32 exec_hi, 0xffff
ds_write_b32 v160, v155 offset:19720
s_mov_b64 exec, 1
v_mov_b32 v160, 60
v_mov_b32 v161, 1
ds_write_b32 v160, v161
s_mov_b64 exec, -1
H3_sk15:
s_mul_i32 s46, s40, 36864
s_add_u32 s46, s46, 0x138c00
s_add_u32 s58, s30, s46
s_addc_u32 s59, s31, 0
global_load_dwordx4 v[108:111], v157, s[58:59] offset:0
global_load_dwordx4 v[112:115], v157, s[58:59] offset:1024
global_load_dwordx4 v[116:119], v157, s[58:59] offset:2048
global_load_dwordx4 v[120:123], v157, s[58:59] offset:3072
s_add_u32 s58, s58, 4096
s_addc_u32 s59, s59, 0
global_load_dwordx4 v[124:127], v157, s[58:59] offset:0
global_load_dwordx4 v[128:131], v157, s[58:59] offset:1024
global_load_dwordx4 v[132:135], v157, s[58:59] offset:2048
global_load_dwordx4 v[136:139], v157, s[58:59] offset:3072
s_add_u32 s58, s58, 4096
s_addc_u32 s59, s59, 0
global_load_dwordx4 v[140:143], v157, s[58:59] offset:0
H3_sp17_re:
ds_read_b32 v159, v167 offset:60
s_waitcnt lgkmcnt(0)
v_cmp_ne_u32 vcc, 1, v159
s_cbranch_vccz H3_sp17_ok
s_add_u32 s52, s52, 1
s_cmp_gt_u32 s52, 200000
s_cbranch_scc1 H3_sp17_ok
s_sleep 4
s_branch H3_sp17_re
H3_sp17_ok:
ds_read_b128 v[144:147], v157 offset:14336
s_waitcnt lgkmcnt(0) vmcnt(0)
s_mul_i32 s46, s40, 294912
s_add_u32 s46, s46, 0xd5c00
s_add_u32 s58, s30, s46
s_addc_u32 s59, s31, 0
s_waitcnt vmcnt(8)
v_mfma_f32_16x16x32_bf16 v[0:3], v[72:75], v[144:147], v[0:3]
global_load_dwordx4 v[72:75], v157, s[58:59] offset:0
s_waitcnt vmcnt(8)
v_mfma_f32_16x16x32_bf16 v[4:7], v[76:79], v[144:147], v[4:7]
global_load_dwordx4 v[76:79], v157, s[58:59] offset:1024
s_waitcnt vmcnt(8)
v_mfma_f32_16x16x32_bf16 v[8:11], v[80:83], v[144:147], v[8:11]
global_load_dwordx4 v[80:83], v157, s[58:59] offset:2048
s_waitcnt vmcnt(8)
v_mfma_f32_16x16x32_bf16 v[12:15], v[84:87], v[144:147], v[12:15]
global_load_dwordx4 v[84:87], v157, s[58:59] offset:3072
s_waitcnt vmcnt(8)
v_mfma_f32_16x16x32_bf16 v[16:19], v[88:91], v[144:147], v[16:19]
s_add_u32 s58, s58, 4096
s_addc_u32 s59, s59, 0
global_load_dwordx4 v[88:91], v157, s[58:59] offset:0
s_waitcnt vmcnt(8)
v_mfma_f32_16x16x32_bf16 v[20:23], v[92:95], v[144:147], v[20:23]
global_load_dwordx4 v[92:95], v157, s[58:59] offset:1024
s_waitcnt vmcnt(8)
v_mfma_f32_16x16x32_bf16 v[24:27], v[96:99], v[144:147], v[24:27]
global_load_dwordx4 v[96:99], v157, s[58:59] offset:2048
s_waitcnt vmcnt(8)
v_mfma_f32_16x16x32_bf16 v[28:31], v[100:103], v[144:147], v[28:31]
global_load_dwordx4 v[100:103], v157, s[58:59] offset:3072
s_waitcnt vmcnt(8)
v_mfma_f32_16x16x32_bf16 v[32:35], v[104:107], v[144:147], v[32:35]
s_add_u32 s58, s58, 4096
s_addc_u32 s59, s59, 0
global_load_dwordx4 v[104:107], v157, s[58:59] offset:0
H3_sp18_re:
ds_read_b32 v159, v167 offset:68
s_waitcnt lgkmcnt(0)
v_cmp_ne_u32 vcc, 1, v159
s_cbranch_vccz H3_sp18_ok
s_add_u32 s52, s52, 1
s_cmp_gt_u32 s52, 200000
s_cbranch_scc1 H3_sp18_ok
s_sleep 4
s_branch H3_sp18_re
H3_sp18_ok:
ds_read_b128 v[144:147], v157 offset:15360
s_waitcnt lgkmcnt(0)
s_mul_i32 s46, s40, 294912
s_add_u32 s46, s46, 0xdec00
s_add_u32 s58, s30, s46
s_addc_u32 s59, s31, 0
s_waitcnt vmcnt(17)
v_mfma_f32_16x16x32_bf16 v[0:3], v[36:39], v[144:147], v[0:3]
global_load_dwordx4 v[36:39], v157, s[58:59] offset:0
s_waitcnt vmcnt(17)
v_mfma_f32_16x16x32_bf16 v[4:7], v[40:43], v[144:147], v[4:7]
global_load_dwordx4 v[40:43], v157, s[58:59] offset:1024
s_waitcnt vmcnt(17)
v_mfma_f32_16x16x32_bf16 v[8:11], v[44:47], v[144:147], v[8:11]
global_load_dwordx4 v[44:47], v157, s[58:59] offset:2048
s_waitcnt vmcnt(17)
v_mfma_f32_16x16x32_bf16 v[12:15], v[48:51], v[144:147], v[12:15]
global_load_dwordx4 v[48:51], v157, s[58:59] offset:3072
s_waitcnt vmcnt(17)
v_mfma_f32_16x16x32_bf16 v[16:19], v[52:55], v[144:147], v[16:19]
s_add_u32 s58, s58, 4096
s_addc_u32 s59, s59, 0
global_load_dwordx4 v[52:55], v157, s[58:59] offset:0
s_waitcnt vmcnt(17)
v_mfma_f32_16x16x32_bf16 v[20:23], v[56:59], v[144:147], v[20:23]
global_load_dwordx4 v[56:59], v157, s[58:59] offset:1024
s_waitcnt vmcnt(17)
v_mfma_f32_16x16x32_bf16 v[24:27], v[60:63], v[144:147], v[24:27]
global_load_dwordx4 v[60:63], v157, s[58:59] offset:2048
s_waitcnt vmcnt(17)
v_mfma_f32_16x16x32_bf16 v[28:31], v[64:67], v[144:147], v[28:31]
global_load_dwordx4 v[64:67], v157, s[58:59] offset:3072
s_waitcnt vmcnt(17)
v_mfma_f32_16x16x32_bf16 v[32:35], v[68:71], v[144:147], v[32:35]
s_add_u32 s58, s58, 4096
s_addc_u32 s59, s59, 0
global_load_dwordx4 v[68:71], v157, s[58:59] offset:0
H3_sp19_re:
ds_read_b32 v159, v167 offset:76
s_waitcnt lgkmcnt(0)
v_cmp_ne_u32 vcc, 1, v159
s_cbranch_vccz H3_sp19_ok
s_add_u32 s52, s52, 1
s_cmp_gt_u32 s52, 200000
s_cbranch_scc1 H3_sp19_ok
s_sleep 4
s_branch H3_sp19_re
H3_sp19_ok:
ds_read_b128 v[144:147], v157 offset:16384
s_waitcnt lgkmcnt(0)
s_mul_i32 s46, s40, 294912
s_add_u32 s46, s46, 0xe7c00
s_add_u32 s58, s30, s46
s_addc_u32 s59, s31, 0
s_waitcnt vmcnt(17)
v_mfma_f32_16x16x32_bf16 v[0:3], v[72:75], v[144:147], v[0:3]
global_load_dwordx4 v[72:75], v157, s[58:59] offset:0
s_waitcnt vmcnt(17)
v_mfma_f32_16x16x32_bf16 v[4:7], v[76:79], v[144:147], v[4:7]
global_load_dwordx4 v[76:79], v157, s[58:59] offset:1024
s_waitcnt vmcnt(17)
v_mfma_f32_16x16x32_bf16 v[8:11], v[80:83], v[144:147], v[8:11]
global_load_dwordx4 v[80:83], v157, s[58:59] offset:2048
s_waitcnt vmcnt(17)
v_mfma_f32_16x16x32_bf16 v[12:15], v[84:87], v[144:147], v[12:15]
global_load_dwordx4 v[84:87], v157, s[58:59] offset:3072
s_waitcnt vmcnt(17)
v_mfma_f32_16x16x32_bf16 v[16:19], v[88:91], v[144:147], v[16:19]
s_add_u32 s58, s58, 4096
s_addc_u32 s59, s59, 0
global_load_dwordx4 v[88:91], v157, s[58:59] offset:0
s_waitcnt vmcnt(17)
v_mfma_f32_16x16x32_bf16 v[20:23], v[92:95], v[144:147], v[20:23]
global_load_dwordx4 v[92:95], v157, s[58:59] offset:1024
s_waitcnt vmcnt(17)
v_mfma_f32_16x16x32_bf16 v[24:27], v[96:99], v[144:147], v[24:27]
global_load_dwordx4 v[96:99], v157, s[58:59] offset:2048
s_waitcnt vmcnt(17)
v_mfma_f32_16x16x32_bf16 v[28:31], v[100:103], v[144:147], v[28:31]
global_load_dwordx4 v[100:103], v157, s[58:59] offset:3072
s_waitcnt vmcnt(17)
v_mfma_f32_16x16x32_bf16 v[32:35], v[104:107], v[144:147], v[32:35]
s_add_u32 s58, s58, 4096
s_addc_u32 s59, s59, 0
global_load_dwordx4 v[104:107], v157, s[58:59] offset:0
H3_sp20_re:
ds_read_b32 v159, v167 offset:84
s_waitcnt lgkmcnt(0)
v_cmp_ne_u32 vcc, 1, v159
s_cbranch_vccz H3_sp20_ok
s_add_u32 s52, s52, 1
s_cmp_gt_u32 s52, 200000
s_cbranch_scc1 H3_sp20_ok
s_sleep 4
s_branch H3_sp20_re
H3_sp20_ok:
ds_read_b128 v[144:147], v157 offset:17408
s_waitcnt lgkmcnt(0)
s_waitcnt vmcnt(17)
v_mfma_f32_16x16x32_bf16 v[0:3], v[36:39], v[144:147], v[0:3]
s_waitcnt vmcnt(16)
v_mfma_f32_16x16x32_bf16 v[4:7], v[40:43], v[144:147], v[4:7]
s_waitcnt vmcnt(15)
v_mfma_f32_16x16x32_bf16 v[8:11], v[44:47], v[144:147], v[8:11]
s_waitcnt vmcnt(14)
v_mfma_f32_16x16x32_bf16 v[12:15], v[48:51], v[144:147], v[12:15]
s_waitcnt vmcnt(13)
v_mfma_f32_16x16x32_bf16 v[16:19], v[52:55], v[144:147], v[16:19]
s_waitcnt vmcnt(12)
v_mfma_f32_16x16x32_bf16 v[20:23], v[56:59], v[144:147], v[20:23]
s_waitcnt vmcnt(11)
v_mfma_f32_16x16x32_bf16 v[24:27], v[60:63], v[144:147], v[24:27]
s_waitcnt vmcnt(10)
v_mfma_f32_16x16x32_bf16 v[28:31], v[64:67], v[144:147], v[28:31]
s_waitcnt vmcnt(9)
v_mfma_f32_16x16x32_bf16 v[32:35], v[68:71], v[144:147], v[32:35]
H3_sp21_re:
ds_read_b32 v159, v167 offset:92
s_waitcnt lgkmcnt(0)
v_cmp_ne_u32 vcc, 1, v159
s_cbranch_vccz H3_sp21_ok
s_add_u32 s52, s52, 1
s_cmp_gt_u32 s52, 200000
s_cbranch_scc1 H3_sp21_ok
s_sleep 0
s_branch H3_sp21_re
H3_sp21_ok:
ds_read_b128 v[144:147], v157 offset:18432
ds_read_b128 v[148:151], v157 offset:19456
s_waitcnt lgkmcnt(0)
s_waitcnt vmcnt(0)
v_mov_b32 v161, 0xfffff000
v_add_u32 v160, 4096, v166
s_cmp_eq_u32 s71, 1
s_cbranch_scc1 H3_stl
v_mfma_f32_16x16x32_bf16 v[0:3], v[72:75], v[144:147], v[0:3]
v_mfma_f32_16x16x32_bf16 v[0:3], v[108:111], v[148:151], v[0:3]
v_mfma_f32_16x16x32_bf16 v[4:7], v[76:79], v[144:147], v[4:7]
v_mfma_f32_16x16x32_bf16 v[4:7], v[112:115], v[148:151], v[4:7]
v_mfma_f32_16x16x32_bf16 v[8:11], v[80:83], v[144:147], v[8:11]
v_mfma_f32_16x16x32_bf16 v[8:11], v[116:119], v[148:151], v[8:11]
s_nop 3
v_and_or_b32 v108, v0, v161, s62
v_and_or_b32 v109, v1, v161, s63
v_and_or_b32 v110, v2, v161, s64
v_and_or_b32 v111, v3, v161, s65
s_mov_b64 exec, s[56:57]
global_store_dwordx4 v166, v[108:111], s[48:49] offset:0 sc1
s_mov_b64 exec, -1
v_mfma_f32_16x16x32_bf16 v[12:15], v[84:87], v[144:147], v[12:15]
v_mfma_f32_16x16x32_bf16 v[12:15], v[120:123], v[148:151], v[12:15]
v_and_or_b32 v112, v4, v161, s62
v_and_or_b32 v113, v5, v161, s63
v_and_or_b32 v114, v6, v161, s64
v_and_or_b32 v115, v7, v161, s65
s_mov_b64 exec, s[56:57]
global_store_dwordx4 v166, v[112:115], s[48:49] offset:512 sc1
s_mov_b64 exec, -1
v_mfma_f32_16x16x32_bf16 v[16:19], v[88:91], v[144:147], v[16:19]
v_mfma_f32_16x16x32_bf16 v[16:19], v[124:127], v[148:151], v[16:19]
v_and_or_b32 v116, v8, v161, s62
v_and_or_b32 v117, v9, v161, s63
v_and_or_b32 v118, v10, v161, s64
v_and_or_b32 v119, v11, v161, s65
s_mov_b64 exec, s[56:57]
global_store_dwordx4 v166, v[116:119], s[48:49] offset:1024 sc1
s_mov_b64 exec, -1
v_mfma_f32_16x16x32_bf16 v[20:23], v[92:95], v[144:147], v[20:23]
v_mfma_f32_16x16x32_bf16 v[20:23], v[128:131], v[148:151], v[20:23]
v_and_or_b32 v120, v12, v161, s62
v_and_or_b32 v121, v13, v161, s63
v_and_or_b32 v122, v14, v161, s64
v_and_or_b32 v123, v15, v161, s65
s_mov_b64 exec, s[56:57]
global_store_dwordx4 v166, v[120:123], s[48:49] offset:1536 sc1
s_mov_b64 exec, -1
v_mfma_f32_16x16x32_bf16 v[24:27], v[96:99], v[144:147], v[24:27]
v_mfma_f32_16x16x32_bf16 v[24:27], v[132:135], v[148:151], v[24:27]
v_and_or_b32 v124, v16, v161, s62
v_and_or_b32 v125, v17, v161, s63
v_and_or_b32 v126, v18, v161, s64
v_and_or_b32 v127, v19, v161, s65
s_mov_b64 exec, s[56:57]
global_store_dwordx4 v166, v[124:127], s[48:49] offset:2048 sc1
s_mov_b64 exec, -1
v_mfma_f32_16x16x32_bf16 v[28:31], v[100:103], v[144:147], v[28:31]
v_mfma_f32_16x16x32_bf16 v[28:31], v[136:139], v[148:151], v[28:31]
v_and_or_b32 v128, v20, v161, s62
v_and_or_b32 v129, v21, v161, s63
v_and_or_b32 v130, v22, v161, s64
v_and_or_b32 v131, v23, v161, s65
s_mov_b64 exec, s[56:57]
global_store_dwordx4 v166, v[128:131], s[48:49] offset:2560 sc1
s_mov_b64 exec, -1
v_mfma_f32_16x16x32_bf16 v[32:35], v[104:107], v[144:147], v[32:35]
v_mfma_f32_16x16x32_bf16 v[32:35], v[140:143], v[148:151], v[32:35]
v_and_or_b32 v132, v24, v161, s62
v_and_or_b32 v133, v25, v161, s63
v_and_or_b32 v134, v26, v161, s64
v_and_or_b32 v135, v27, v161, s65
s_mov_b64 exec, s[56:57]
global_store_dwordx4 v166, v[132:135], s[48:49] offset:3072 sc1
s_mov_b64 exec, -1
v_and_or_b32 v136, v28, v161, s62
v_and_or_b32 v137, v29, v161, s63
v_and_or_b32 v138, v30, v161, s64
v_and_or_b32 v139, v31, v161, s65
s_mov_b64 exec, s[56:57]
global_store_dwordx4 v166, v[136:139], s[48:49] offset:3584 sc1
s_mov_b64 exec, -1
v_and_or_b32 v140, v32, v161, s62
v_and_or_b32 v141, v33, v161, s63
v_and_or_b32 v142, v34, v161, s64
v_and_or_b32 v143, v35, v161, s65
s_mov_b64 exec, s[56:57]
global_store_dwordx4 v160, v[140:143], s[48:49] sc1
s_mov_b64 exec, -1
s_branch H3_std
H3_stl:
v_mfma_f32_16x16x32_bf16 v[0:3], v[72:75], v[144:147], v[0:3]
v_mfma_f32_16x16x32_bf16 v[0:3], v[108:111], v[148:151], v[0:3]
v_mfma_f32_16x16x32_bf16 v[4:7], v[76:79], v[144:147], v[4:7]
v_mfma_f32_16x16x32_bf16 v[4:7], v[112:115], v[148:151], v[4:7]
v_mfma_f32_16x16x32_bf16 v[8:11], v[80:83], v[144:147], v[8:11]
v_mfma_f32_16x16x32_bf16 v[8:11], v[116:119], v[148:151], v[8:11]
s_nop 3
v_and_or_b32 v108, v0, v161, s62
v_and_or_b32 v109, v1, v161, s63
v_and_or_b32 v110, v2, v161, s64
v_and_or_b32 v111, v3, v161, s65
s_mov_b64 exec, s[56:57]
global_store_dwordx4 v166, v[108:111], s[48:49] offset:0
s_mov_b64 exec, -1
v_mfma_f32_16x16x32_bf16 v[12:15], v[84:87], v[144:147], v[12:15]
v_mfma_f32_16x16x32_bf16 v[12:15], v[120:123], v[148:151], v[12:15]
v_and_or_b32 v112, v4, v161, s62
v_and_or_b32 v113, v5, v161, s63
v_and_or_b32 v114, v6, v161, s64
v_and_or_b32 v115, v7, v161, s65
s_mov_b64 exec, s[56:57]
global_store_dwordx4 v166, v[112:115], s[48:49] offset:512
s_mov_b64 exec, -1
v_mfma_f32_16x16x32_bf16 v[16:19], v[88:91], v[144:147], v[16:19]
v_mfma_f32_16x16x32_bf16 v[16:19], v[124:127], v[148:151], v[16:19]
v_and_or_b32 v116, v8, v161, s62
v_and_or_b32 v117, v9, v161, s63
v_and_or_b32 v118, v10, v161, s64
v_and_or_b32 v119, v11, v161, s65
s_mov_b64 exec, s[56:57]
global_store_dwordx4 v166, v[116:119], s[48:49] offset:1024
s_mov_b64 exec, -1
v_mfma_f32_16x16x32_bf16 v[20:23], v[92:95], v[144:147], v[20:23]
v_mfma_f32_16x16x32_bf16 v[20:23], v[128:131], v[148:151], v[20:23]
v_and_or_b32 v120, v12, v161, s62
v_and_or_b32 v121, v13, v161, s63
v_and_or_b32 v122, v14, v161, s64
v_and_or_b32 v123, v15, v161, s65
s_mov_b64 exec, s[56:57]
global_store_dwordx4 v166, v[120:123], s[48:49] offset:1536
s_mov_b64 exec, -1
v_mfma_f32_16x16x32_bf16 v[24:27], v[96:99], v[144:147], v[24:27]
v_mfma_f32_16x16x32_bf16 v[24:27], v[132:135], v[148:151], v[24:27]
v_and_or_b32 v124, v16, v161, s62
v_and_or_b32 v125, v17, v161, s63
v_and_or_b32 v126, v18, v161, s64
v_and_or_b32 v127, v19, v161, s65
s_mov_b64 exec, s[56:57]
global_store_dwordx4 v166, v[124:127], s[48:49] offset:2048
s_mov_b64 exec, -1
v_mfma_f32_16x16x32_bf16 v[28:31], v[100:103], v[144:147], v[28:31]
v_mfma_f32_16x16x32_bf16 v[28:31], v[136:139], v[148:151], v[28:31]
v_and_or_b32 v128, v20, v161, s62
v_and_or_b32 v129, v21, v161, s63
v_and_or_b32 v130, v22, v161, s64
v_and_or_b32 v131, v23, v161, s65
s_mov_b64 exec, s[56:57]
global_store_dwordx4 v166, v[128:131], s[48:49] offset:2560
s_mov_b64 exec, -1
v_mfma_f32_16x16x32_bf16 v[32:35], v[104:107], v[144:147], v[32:35]
v_mfma_f32_16x16x32_bf16 v[32:35], v[140:143], v[148:151], v[32:35]
v_and_or_b32 v132, v24, v161, s62
v_and_or_b32 v133, v25, v161, s63
v_and_or_b32 v134, v26, v161, s64
v_and_or_b32 v135, v27, v161, s65
s_mov_b64 exec, s[56:57]
global_store_dwordx4 v166, v[132:135], s[48:49] offset:3072
s_mov_b64 exec, -1
v_and_or_b32 v136, v28, v161, s62
v_and_or_b32 v137, v29, v161, s63
v_and_or_b32 v138, v30, v161, s64
v_and_or_b32 v139, v31, v161, s65
s_mov_b64 exec, s[56:57]
global_store_dwordx4 v166, v[136:139], s[48:49] offset:3584
s_mov_b64 exec, -1
v_and_or_b32 v140, v32, v161, s62
v_and_or_b32 v141, v33, v161, s63
v_and_or_b32 v142, v34, v161, s64
v_and_or_b32 v143, v35, v161, s65
s_mov_b64 exec, s[56:57]
global_store_dwordx4 v160, v[140:143], s[48:49]
s_mov_b64 exec, -1
H3_std:
s_mov_b64 exec, s[54:55]
s_mov_b32 s52, 0
global_load_dwordx4 v[36:39], v166, s[66:67] offset:0 sc1
global_load_dwordx4 v[40:43], v166, s[66:67] offset:512 sc1
global_load_dwordx4 v[44:47], v166, s[66:67] offset:1024 sc1
global_load_dwordx4 v[48:51], v166, s[66:67] offset:1536 sc1
global_load_dwordx4 v[52:55], v166, s[66:67] offset:2048 sc1
global_load_dwordx4 v[56:59], v166, s[66:67] offset:2560 sc1
global_load_dwordx4 v[60:63], v166, s[66:67] offset:3072 sc1
global_load_dwordx4 v[64:67], v166, s[66:67] offset:3584 sc1
global_load_dwordx4 v[68:71], v160, s[66:67] sc1
ds_write_b128 v156, v[0:3] offset:0
ds_write_b128 v156, v[4:7] offset:64
ds_write_b128 v156, v[8:11] offset:128
ds_write_b128 v156, v[12:15] offset:192
ds_write_b128 v156, v[16:19] offset:256
ds_write_b128 v156, v[20:23] offset:320
ds_write_b128 v156, v[24:27] offset:384
ds_write_b128 v156, v[28:31] offset:448
ds_write_b128 v156, v[32:35] offset:512
H3_poll:
s_waitcnt vmcnt(0)
v_mov_b32 v158, 0
v_bitop3_b32 v158, v36, s62, v158 bitop3:0xbe
v_bitop3_b32 v158, v37, s63, v158 bitop3:0xbe
v_bitop3_b32 v158, v38, s64, v158 bitop3:0xbe
v_bitop3_b32 v158, v39, s65, v158 bitop3:0xbe
v_bitop3_b32 v158, v40, s62, v158 bitop3:0xbe
v_bitop3_b32 v158, v41, s63, v158 bitop3:0xbe
v_bitop3_b32 v158, v42, s64, v158 bitop3:0xbe
v_bitop3_b32 v158, v43, s65, v158 bitop3:0xbe
v_bitop3_b32 v158, v44, s62, v158 bitop3:0xbe
v_bitop3_b32 v158, v45, s63, v158 bitop3:0xbe
v_bitop3_b32 v158, v46, s64, v158 bitop3:0xbe
v_bitop3_b32 v158, v47, s65, v158 bitop3:0xbe
v_bitop3_b32 v158, v48, s62, v158 bitop3:0xbe
v_bitop3_b32 v158, v49, s63, v158 bitop3:0xbe
v_bitop3_b32 v158, v50, s64, v158 bitop3:0xbe
v_bitop3_b32 v158, v51, s65, v158 bitop3:0xbe
v_bitop3_b32 v158, v52, s62, v158 bitop3:0xbe
v_bitop3_b32 v158, v53, s63, v158 bitop3:0xbe
v_bitop3_b32 v158, v54, s64, v158 bitop3:0xbe
v_bitop3_b32 v158, v55, s65, v158 bitop3:0xbe
v_bitop3_b32 v158, v56, s62, v158 bitop3:0xbe
v_bitop3_b32 v158, v57, s63, v158 bitop3:0xbe
v_bitop3_b32 v158, v58, s64, v158 bitop3:0xbe
v_bitop3_b32 v158, v59, s65, v158 bitop3:0xbe
v_bitop3_b32 v158, v60, s62, v158 bitop3:0xbe
v_bitop3_b32 v158, v61, s63, v158 bitop3:0xbe
v_bitop3_b32 v158, v62, s64, v158 bitop3:0xbe
v_bitop3_b32 v158, v63, s65, v158 bitop3:0xbe
v_bitop3_b32 v158, v64, s62, v158 bitop3:0xbe
v_bitop3_b32 v158, v65, s63, v158 bitop3:0xbe
v_bitop3_b32 v158, v66, s64, v158 bitop3:0xbe
v_bitop3_b32 v158, v67, s65, v158 bitop3:0xbe
v_bitop3_b32 v158, v68, s62, v158 bitop3:0xbe
v_bitop3_b32 v158, v69, s63, v158 bitop3:0xbe
v_bitop3_b32 v158, v70, s64, v158 bitop3:0xbe
v_bitop3_b32 v158, v71, s65, v158 bitop3:0xbe
v_and_b32 v158, 0xfff, v158
v_cmp_ne_u32 vcc, 0, v158
s_cbranch_vccz H3_pollok
s_add_u32 s52, s52, 1
s_cmp_gt_u32 s52, 20000
s_cbranch_scc1 H3_pollok
global_load_dwordx4 v[36:39], v166, s[66:67] offset:0 sc1
global_load_dwordx4 v[40:43], v166, s[66:67] offset:512 sc1
global_load_dwordx4 v[44:47], v166, s[66:67] offset:1024 sc1
global_load_dwordx4 v[48:51], v166, s[66:67] offset:1536 sc1
global_load_dwordx4 v[52:55], v166, s[66:67] offset:2048 sc1
global_load_dwordx4 v[56:59], v166, s[66:67] offset:2560 sc1
global_load_dwordx4 v[60:63], v166, s[66:67] offset:3072 sc1
global_load_dwordx4 v[64:67], v166, s[66:67] offset:3584 sc1
global_load_dwordx4 v[68:71], v160, s[66:67] sc1
s_branch H3_poll
H3_pollok:
v_add_u32 v156, 18560, v156
ds_write_b128 v156, v[36:39] offset:0
ds_write_b128 v156, v[40:43] offset:64
ds_write_b128 v156, v[44:47] offset:128
ds_write_b128 v156, v[48:51] offset:192
ds_write_b128 v156, v[52:55] offset:256
ds_write_b128 v156, v[56:59] offset:320
ds_write_b128 v156, v[60:63] offset:384
ds_write_b128 v156, v[64:67] offset:448
ds_write_b128 v156, v[68:71] offset:512
s_mov_b64 exec, -1
s_waitcnt lgkmcnt(0)
s_barrier
s_cmp_eq_u32 s33, 1
s_cbranch_scc1 L_hfin3
s_mov_b32 s33, 1
s_mul_i32 s34, s33, 0x240000
s_add_u32 s34, s34, 0x200000
s_mul_i32 s35, s33, 0x10000
s_add_u32 s35, s35, 0x680000
s_mul_i32 s36, s33, 0x4000
s_add_u32 s36, s36, 0x6a0000
s_mul_i32 s37, s33, 0x14000
s_add_u32 s37, s37, 0x6b0000
s_mul_i32 s38, s33, 0x800
s_add_u32 s38, s38, 0x6d8000
s_mul_i32 s39, s33, 0x900000
s_add_u32 s39, s39, 0xe00000
v_mbcnt_lo_u32_b32 v156, -1, 0
v_mbcnt_hi_u32_b32 v156, -1, v156
v_lshlrev_b32 v157, 4, v156
v_mov_b32 v167, 0
s_add_u32 s46, 0, 0x6dc000
s_add_u32 s48, s30, s46
s_addc_u32 s49, s31, 0
s_load_dwordx2 s[60:61], s[48:49], 0
s_barrier
v_and_b32 v162, 15, v156
v_lshrrev_b32 v163, 4, v156
v_lshrrev_b32 v165, 1, v163
v_lshlrev_b32 v165, 8, v165
v_lshl_add_u32 v165, v162, 4, v165
v_and_b32 v164, 1, v163
v_lshlrev_b32 v164, 10, v164
v_add_u32 v164, v164, v165
v_add_u32 v165, 2048, v165
v_lshrrev_b32 v166, 1, v163
v_lshlrev_b32 v166, 9, v166
v_lshl_add_u32 v166, v162, 4, v166
v_and_b32 v160, 1, v163
v_lshl_add_u32 v166, v160, 3, v166
s_waitcnt lgkmcnt(0)
s_add_u32 s50, s60, 32
s_and_b32 s51, s61, 0xffff
s_lshl_b32 s51, s51, 8
s_mov_b32 s52, 0
H3_pl_re:
v_mov_b32 v158, 158888
ds_read_b32 v159, v158
s_waitcnt lgkmcnt(0)
v_cmp_ne_u32 vcc, 1, v159
s_cbranch_vccz H3_pl_ok
s_add_u32 s52, s52, 1
s_cmp_gt_u32 s52, 200000
s_cbranch_scc1 H3_pl_ok
s_sleep 4
s_branch H3_pl_re
H3_pl_ok:
s_lshr_b32 s41, s2, 1
s_mul_i32 s41, s41, 18432
s_add_u32 s41, s41, s34
s_cmp_eq_u32 s40, 0
s_mov_b32 s46, 0x00ff00ff
s_cselect_b32 s46, 0xff00ff00, s46
s_mov_b32 exec_lo, s46
s_mov_b32 exec_hi, s46
s_add_u32 s46, s41, 3072
s_add_u32 s42, s30, s46
s_addc_u32 s43, s31, 0
s_mov_b32 m0, 23552
s_nop 0
global_load_lds_dwordx4 v157, s[42:43] sc1
s_add_u32 s46, s41, 7168
s_add_u32 s42, s30, s46
s_addc_u32 s43, s31, 0
s_mov_b32 m0, 27648
s_nop 0
global_load_lds_dwordx4 v157, s[42:43] sc1
s_add_u32 s46, s41, 11264
s_add_u32 s42, s30, s46
s_addc_u32 s43, s31, 0
s_mov_b32 m0, 31744
s_nop 0
global_load_lds_dwordx4 v157, s[42:43] sc1
s_add_u32 s46, s41, 15360
s_add_u32 s42, s30, s46
s_addc_u32 s43, s31, 0
s_mov_b32 m0, 35840
s_nop 0
global_load_lds_dwordx4 v157, s[42:43] sc1
s_mov_b64 exec, -1
s_waitcnt vmcnt(0)
s_branch H3_tags
L_hfin3:
s_endpgm
H0_ph0:
s_setprio 3
s_mov_b32 s68, 0x80808080
s_mov_b32 s69, 0x80808080
s_mov_b32 s70, 0x45800000
v_mbcnt_lo_u32_b32 v156, -1, 0
v_mbcnt_hi_u32_b32 v156, -1, v156
v_lshlrev_b32 v157, 4, v156
v_mov_b32 v167, 0
s_and_b32 s40, s2, 1
v_and_b32 v162, 15, v156
v_lshrrev_b32 v163, 4, v156
v_lshrrev_b32 v165, 1, v163
v_lshlrev_b32 v165, 8, v165
v_lshl_add_u32 v165, v162, 4, v165
v_and_b32 v164, 1, v163
v_lshlrev_b32 v164, 10, v164
v_add_u32 v164, v164, v165
v_add_u32 v165, 2048, v165
v_lshrrev_b32 v166, 1, v163
v_lshlrev_b32 v166, 9, v166
v_lshl_add_u32 v166, v162, 4, v166
v_and_b32 v160, 1, v163
v_lshl_add_u32 v166, v160, 3, v166
v_mov_b32 v158, 158872
ds_read_b64 v[148:149], v158
s_waitcnt lgkmcnt(0)
v_readfirstlane_b32 s60, v148
v_readfirstlane_b32 s61, v149
s_mov_b32 s52, 0
H0_qr_re:
v_mov_b32 v158, 158900
ds_read_b32 v159, v158
s_waitcnt lgkmcnt(0)
v_cmp_ne_u32 vcc, 1, v159
s_cbranch_vccz H0_qr_ok
s_add_u32 s52, s52, 1
s_cmp_gt_u32 s52, 200000
s_cbranch_scc1 H0_qr_ok
s_sleep 4
s_branch H0_qr_re
H0_qr_ok:
s_mul_i32 s46, s40, 294912
s_add_u32 s46, s46, 0x0
s_add_u32 s44, s30, s46
s_addc_u32 s45, s31, 0
global_load_dwordx4 v[0:3], v157, s[44:45] offset:0
global_load_dwordx4 v[4:7], v157, s[44:45] offset:1024
global_load_dwordx4 v[8:11], v157, s[44:45] offset:2048
global_load_dwordx4 v[12:15], v157, s[44:45] offset:3072
s_add_u32 s44, s44, 4096
s_addc_u32 s45, s45, 0
global_load_dwordx4 v[16:19], v157, s[44:45] offset:0
global_load_dwordx4 v[20:23], v157, s[44:45] offset:1024
global_load_dwordx4 v[24:27], v157, s[44:45] offset:2048
global_load_dwordx4 v[28:31], v157, s[44:45] offset:3072
s_add_u32 s44, s44, 4096
s_addc_u32 s45, s45, 0
global_load_dwordx4 v[32:35], v157, s[44:45] offset:0
global_load_dwordx4 v[36:39], v157, s[44:45] offset:1024
global_load_dwordx4 v[40:43], v157, s[44:45] offset:2048
global_load_dwordx4 v[44:47], v157, s[44:45] offset:3072
s_add_u32 s44, s44, 4096
s_addc_u32 s45, s45, 0
global_load_dwordx4 v[48:51], v157, s[44:45] offset:0
global_load_dwordx4 v[52:55], v157, s[44:45] offset:1024
global_load_dwordx4 v[56:59], v157, s[44:45] offset:2048
global_load_dwordx4 v[60:63], v157, s[44:45] offset:3072
s_add_u32 s44, s44, 4096
s_addc_u32 s45, s45, 0
global_load_dwordx4 v[64:67], v157, s[44:45] offset:0
global_load_dwordx4 v[68:71], v157, s[44:45] offset:1024
H0_g0w_re:
v_mov_b32 v158, 158868
ds_read_b32 v159, v158
s_waitcnt lgkmcnt(0)
v_cmp_ne_u32 vcc, 1, v159
s_cbranch_vccz H0_g0w_ok
s_add_u32 s52, s52, 1
s_cmp_gt_u32 s52, 200000
s_cbranch_scc1 H0_g0w_ok
s_sleep 1
s_branch H0_g0w_re
H0_g0w_ok:
s_lshr_b32 s41, s2, 1
s_mul_i32 s41, s41, 18432
s_add_u32 s41, s41, s34
s_cmp_eq_u32 s40, 0
s_mov_b32 s46, 0x00ff00ff
s_cselect_b32 s46, 0xff00ff00, s46
s_mov_b32 exec_lo, s46
s_mov_b32 exec_hi, s46
s_add_u32 s46, s41, 0
s_add_u32 s42, s30, s46
s_addc_u32 s43, s31, 0
s_mov_b32 m0, 20480
s_nop 0
global_load_lds_dwordx4 v157, s[42:43]
s_add_u32 s46, s41, 4096
s_add_u32 s42, s30, s46
s_addc_u32 s43, s31, 0
s_mov_b32 m0, 24576
s_nop 0
global_load_lds_dwordx4 v157, s[42:43]
s_add_u32 s46, s41, 8192
s_add_u32 s42, s30, s46
s_addc_u32 s43, s31, 0
s_mov_b32 m0, 28672
s_nop 0
global_load_lds_dwordx4 v157, s[42:43]
s_add_u32 s46, s41, 12288
s_add_u32 s42, s30, s46
s_addc_u32 s43, s31, 0
s_mov_b32 m0, 32768
s_nop 0
global_load_lds_dwordx4 v157, s[42:43]
s_add_u32 s46, s41, 16384
s_add_u32 s42, s30, s46
s_addc_u32 s43, s31, 0
s_mov_b32 m0, 36864
s_nop 0
global_load_lds_dwordx4 v157, s[42:43]
s_mov_b64 exec, -1
v_mov_b32 v159, 1
v_mov_b32 v158, 0
ds_write_b8 v158, v159 offset:528
s_waitcnt vmcnt(0)
s_branch H0_tags
H1_ph0:
s_setprio 3
s_mov_b32 s68, 0x80808080
s_mov_b32 s69, 0x80808080
s_mov_b32 s70, 0x45800000
v_mbcnt_lo_u32_b32 v156, -1, 0
v_mbcnt_hi_u32_b32 v156, -1, v156
v_lshlrev_b32 v157, 4, v156
v_mov_b32 v167, 0
s_and_b32 s40, s2, 1
v_and_b32 v162, 15, v156
v_lshrrev_b32 v163, 4, v156
v_lshrrev_b32 v165, 1, v163
v_lshlrev_b32 v165, 8, v165
v_lshl_add_u32 v165, v162, 4, v165
v_and_b32 v164, 1, v163
v_lshlrev_b32 v164, 10, v164
v_add_u32 v164, v164, v165
v_add_u32 v165, 2048, v165
v_lshrrev_b32 v166, 1, v163
v_lshlrev_b32 v166, 9, v166
v_lshl_add_u32 v166, v162, 4, v166
v_and_b32 v160, 1, v163
v_lshl_add_u32 v166, v160, 3, v166
v_mov_b32 v158, 158872
ds_read_b64 v[148:149], v158
s_waitcnt lgkmcnt(0)
v_readfirstlane_b32 s60, v148
v_readfirstlane_b32 s61, v149
s_mov_b32 s52, 0
s_add_u32 s50, s60, 96
s_and_b32 s51, s61, 0xffff
s_lshl_b32 s51, s51, 8
s_lshr_b32 s46, s2, 1
s_and_b32 s46, s46, 7
s_lshl_b32 s46, s46, 8
s_add_u32 s46, s46, 0x6db800
v_lshl_add_u32 v158, v156, 3, s46
s_mov_b64 exec, 0x3ffff
H1_bq_re:
global_load_dwordx2 v[148:149], v158, s[30:31] sc1
s_waitcnt vmcnt(0)
v_cmp_ne_u64 vcc, s[50:51], v[148:149]
s_cbranch_vccz H1_bq_ok
s_add_u32 s52, s52, 1
s_cmp_gt_u32 s52, 200000
s_cbranch_scc1 H1_bq_ok
s_sleep 2
s_branch H1_bq_re
H1_bq_ok:
s_mov_b64 exec, -1
v_mov_b32 v158, 158900
v_mov_b32 v159, 1
ds_write_b32 v158, v159
s_mul_i32 s46, s40, 294912
s_add_u32 s46, s46, 0x4800
s_add_u32 s44, s30, s46
s_addc_u32 s45, s31, 0
global_load_dwordx4 v[0:3], v157, s[44:45] offset:0
global_load_dwordx4 v[4:7], v157, s[44:45] offset:1024
global_load_dwordx4 v[8:11], v157, s[44:45] offset:2048
global_load_dwordx4 v[12:15], v157, s[44:45] offset:3072
s_add_u32 s44, s44, 4096
s_addc_u32 s45, s45, 0
global_load_dwordx4 v[16:19], v157, s[44:45] offset:0
global_load_dwordx4 v[20:23], v157, s[44:45] offset:1024
global_load_dwordx4 v[24:27], v157, s[44:45] offset:2048
global_load_dwordx4 v[28:31], v157, s[44:45] offset:3072
s_add_u32 s44, s44, 4096
s_addc_u32 s45, s45, 0
global_load_dwordx4 v[32:35], v157, s[44:45] offset:0
global_load_dwordx4 v[36:39], v157, s[44:45] offset:1024
global_load_dwordx4 v[40:43], v157, s[44:45] offset:2048
global_load_dwordx4 v[44:47], v157, s[44:45] offset:3072
s_add_u32 s44, s44, 4096
s_addc_u32 s45, s45, 0
global_load_dwordx4 v[48:51], v157, s[44:45] offset:0
global_load_dwordx4 v[52:55], v157, s[44:45] offset:1024
global_load_dwordx4 v[56:59], v157, s[44:45] offset:2048
global_load_dwordx4 v[60:63], v157, s[44:45] offset:3072
s_add_u32 s44, s44, 4096
s_addc_u32 s45, s45, 0
global_load_dwordx4 v[64:67], v157, s[44:45] offset:0
global_load_dwordx4 v[68:71], v157, s[44:45] offset:1024
H1_g0w_re:
v_mov_b32 v158, 158868
ds_read_b32 v159, v158
s_waitcnt lgkmcnt(0)
v_cmp_ne_u32 vcc, 1, v159
s_cbranch_vccz H1_g0w_ok
s_add_u32 s52, s52, 1
s_cmp_gt_u32 s52, 200000
s_cbranch_scc1 H1_g0w_ok
s_sleep 1
s_branch H1_g0w_re
H1_g0w_ok:
s_lshr_b32 s41, s2, 1
s_mul_i32 s41, s41, 18432
s_add_u32 s41, s41, s34
s_cmp_eq_u32 s40, 0
s_mov_b32 s46, 0x00ff00ff
s_cselect_b32 s46, 0xff00ff00, s46
s_mov_b32 exec_lo, s46
s_mov_b32 exec_hi, s46
s_add_u32 s46, s41, 1024
s_add_u32 s42, s30, s46
s_addc_u32 s43, s31, 0
s_mov_b32 m0, 21504
s_nop 0
global_load_lds_dwordx4 v157, s[42:43]
s_add_u32 s46, s41, 5120
s_add_u32 s42, s30, s46
s_addc_u32 s43, s31, 0
s_mov_b32 m0, 25600
s_nop 0
global_load_lds_dwordx4 v157, s[42:43]
s_add_u32 s46, s41, 9216
s_add_u32 s42, s30, s46
s_addc_u32 s43, s31, 0
s_mov_b32 m0, 29696
s_nop 0
global_load_lds_dwordx4 v157, s[42:43]
s_add_u32 s46, s41, 13312
s_add_u32 s42, s30, s46
s_addc_u32 s43, s31, 0
s_mov_b32 m0, 33792
s_nop 0
global_load_lds_dwordx4 v157, s[42:43]
s_add_u32 s46, s41, 17408
s_add_u32 s42, s30, s46
s_addc_u32 s43, s31, 0
s_mov_b32 m0, 37888
s_nop 0
global_load_lds_dwordx4 v157, s[42:43]
s_mov_b64 exec, -1
v_mov_b32 v159, 1
v_mov_b32 v158, 1
ds_write_b8 v158, v159 offset:528
s_waitcnt vmcnt(0)
s_branch H1_tags
H2_ph0:
s_setprio 3
s_mov_b32 s68, 0x80808080
s_mov_b32 s69, 0x80808080
s_mov_b32 s70, 0x45800000
v_mbcnt_lo_u32_b32 v156, -1, 0
v_mbcnt_hi_u32_b32 v156, -1, v156
v_lshlrev_b32 v157, 4, v156
v_mov_b32 v167, 0
s_and_b32 s40, s2, 1
v_and_b32 v162, 15, v156
v_lshrrev_b32 v163, 4, v156
v_lshrrev_b32 v165, 1, v163
v_lshlrev_b32 v165, 8, v165
v_lshl_add_u32 v165, v162, 4, v165
v_and_b32 v164, 1, v163
v_lshlrev_b32 v164, 10, v164
v_add_u32 v164, v164, v165
v_add_u32 v165, 2048, v165
v_lshrrev_b32 v166, 1, v163
v_lshlrev_b32 v166, 9, v166
v_lshl_add_u32 v166, v162, 4, v166
v_and_b32 v160, 1, v163
v_lshl_add_u32 v166, v160, 3, v166
v_mov_b32 v158, 158872
ds_read_b64 v[148:149], v158
s_waitcnt lgkmcnt(0)
v_readfirstlane_b32 s60, v148
v_readfirstlane_b32 s61, v149
s_mov_b32 s52, 0
H2_qr_re:
v_mov_b32 v158, 158900
ds_read_b32 v159, v158
s_waitcnt lgkmcnt(0)
v_cmp_ne_u32 vcc, 1, v159
s_cbranch_vccz H2_qr_ok
s_add_u32 s52, s52, 1
s_cmp_gt_u32 s52, 200000
s_cbranch_scc1 H2_qr_ok
s_sleep 4
s_branch H2_qr_re
H2_qr_ok:
s_mul_i32 s46, s40, 36864
s_add_u32 s46, s46, 0x90000
s_add_u32 s44, s30, s46
s_addc_u32 s45, s31, 0
global_load_dwordx4 v[0:3], v157, s[44:45] offset:0
global_load_dwordx4 v[4:7], v157, s[44:45] offset:1024
global_load_dwordx4 v[8:11], v157, s[44:45] offset:2048
global_load_dwordx4 v[12:15], v157, s[44:45] offset:3072
s_add_u32 s44, s44, 4096
s_addc_u32 s45, s45, 0
global_load_dwordx4 v[16:19], v157, s[44:45] offset:0
global_load_dwordx4 v[20:23], v157, s[44:45] offset:1024
global_load_dwordx4 v[24:27], v157, s[44:45] offset:2048
global_load_dwordx4 v[28:31], v157, s[44:45] offset:3072
s_add_u32 s44, s44, 4096
s_addc_u32 s45, s45, 0
global_load_dwordx4 v[32:35], v157, s[44:45] offset:0
global_load_dwordx4 v[36:39], v157, s[44:45] offset:1024
global_load_dwordx4 v[40:43], v157, s[44:45] offset:2048
global_load_dwordx4 v[44:47], v157, s[44:45] offset:3072
s_add_u32 s44, s44, 4096
s_addc_u32 s45, s45, 0
global_load_dwordx4 v[48:51], v157, s[44:45] offset:0
global_load_dwordx4 v[52:55], v157, s[44:45] offset:1024
global_load_dwordx4 v[56:59], v157, s[44:45] offset:2048
global_load_dwordx4 v[60:63], v157, s[44:45] offset:3072
s_add_u32 s44, s44, 4096
s_addc_u32 s45, s45, 0
global_load_dwordx4 v[64:67], v157, s[44:45] offset:0
global_load_dwordx4 v[68:71], v157, s[44:45] offset:1024
H2_g0w_re:
v_mov_b32 v158, 158868
ds_read_b32 v159, v158
s_waitcnt lgkmcnt(0)
v_cmp_ne_u32 vcc, 1, v159
s_cbranch_vccz H2_g0w_ok
s_add_u32 s52, s52, 1
s_cmp_gt_u32 s52, 200000
s_cbranch_scc1 H2_g0w_ok
s_sleep 1
s_branch H2_g0w_re
H2_g0w_ok:
s_lshr_b32 s41, s2, 1
s_mul_i32 s41, s41, 18432
s_add_u32 s41, s41, s34
s_cmp_eq_u32 s40, 0
s_mov_b32 s46, 0x00ff00ff
s_cselect_b32 s46, 0xff00ff00, s46
s_mov_b32 exec_lo, s46
s_mov_b32 exec_hi, s46
s_add_u32 s46, s41, 2048
s_add_u32 s42, s30, s46
s_addc_u32 s43, s31, 0
s_mov_b32 m0, 22528
s_nop 0
global_load_lds_dwordx4 v157, s[42:43]
s_add_u32 s46, s41, 6144
s_add_u32 s42, s30, s46
s_addc_u32 s43, s31, 0
s_mov_b32 m0, 26624
s_nop 0
global_load_lds_dwordx4 v157, s[42:43]
s_add_u32 s46, s41, 10240
s_add_u32 s42, s30, s46
s_addc_u32 s43, s31, 0
s_mov_b32 m0, 30720
s_nop 0
global_load_lds_dwordx4 v157, s[42:43]
s_add_u32 s46, s41, 14336
s_add_u32 s42, s30, s46
s_addc_u32 s43, s31, 0
s_mov_b32 m0, 34816
s_nop 0
global_load_lds_dwordx4 v157, s[42:43]
s_mov_b64 exec, -1
v_mov_b32 v159, 1
v_mov_b32 v158, 2
ds_write_b8 v158, v159 offset:528
s_waitcnt vmcnt(0)
s_branch H2_tags
H3_ph0:
s_setprio 3
s_mov_b32 s68, 0x80808080
s_mov_b32 s69, 0x80808080
s_mov_b32 s70, 0x45800000
v_mbcnt_lo_u32_b32 v156, -1, 0
v_mbcnt_hi_u32_b32 v156, -1, v156
v_lshlrev_b32 v157, 4, v156
v_mov_b32 v167, 0
s_and_b32 s40, s2, 1
v_and_b32 v162, 15, v156
v_lshrrev_b32 v163, 4, v156
v_lshrrev_b32 v165, 1, v163
v_lshlrev_b32 v165, 8, v165
v_lshl_add_u32 v165, v162, 4, v165
v_and_b32 v164, 1, v163
v_lshlrev_b32 v164, 10, v164
v_add_u32 v164, v164, v165
v_add_u32 v165, 2048, v165
v_lshrrev_b32 v166, 1, v163
v_lshlrev_b32 v166, 9, v166
v_lshl_add_u32 v166, v162, 4, v166
v_and_b32 v160, 1, v163
v_lshl_add_u32 v166, v160, 3, v166
v_mov_b32 v158, 158872
ds_read_b64 v[148:149], v158
s_waitcnt lgkmcnt(0)
v_readfirstlane_b32 s60, v148
v_readfirstlane_b32 s61, v149
s_mov_b32 s52, 0
H3_qr_re:
v_mov_b32 v158, 158900
ds_read_b32 v159, v158
s_waitcnt lgkmcnt(0)
v_cmp_ne_u32 vcc, 1, v159
s_cbranch_vccz H3_qr_ok
s_add_u32 s52, s52, 1
s_cmp_gt_u32 s52, 200000
s_cbranch_scc1 H3_qr_ok
s_sleep 4
s_branch H3_qr_re
H3_qr_ok:
s_add_u32 s50, s60, 48
s_and_b32 s51, s61, 0xffff
s_lshl_b32 s51, s51, 8
s_mov_b32 s54, s50
s_mov_b32 s55, s51
s_lshr_b32 s50, s2, 1
s_and_b32 s50, s50, 7
s_mul_i32 s50, s50, 2048
s_add_u32 s50, s50, 0x6f0000
v_lshlrev_b32 v158, 4, v156
v_add_u32 v158, s50, v158
s_mov_b32 s52, 0
PH_poll:
global_load_dwordx4 v[8:11], v158, s[30:31] offset:0 sc1
global_load_dwordx4 v[12:15], v158, s[30:31] offset:1024 sc1
v_mov_b32 v159, 0
s_waitcnt vmcnt(0)
v_bitop3_b32 v159, v8, s54, v159 bitop3:0xbe
v_bitop3_b32 v159, v9, s55, v159 bitop3:0xbe
v_bitop3_b32 v159, v10, s54, v159 bitop3:0xbe
v_bitop3_b32 v159, v11, s55, v159 bitop3:0xbe
v_bitop3_b32 v159, v12, s54, v159 bitop3:0xbe
v_bitop3_b32 v159, v13, s55, v159 bitop3:0xbe
v_bitop3_b32 v159, v14, s54, v159 bitop3:0xbe
v_bitop3_b32 v159, v15, s55, v159 bitop3:0xbe
v_cmp_ne_u32 vcc, 0, v159
s_cbranch_vccz PH_ok
s_add_u32 s52, s52, 1
s_cmp_gt_u32 s52, 20000
s_cbranch_scc1 PH_ok
s_branch PH_poll
PH_ok:
v_mov_b32 v158, 158868
v_mov_b32 v159, 1
ds_write_b32 v158, v159
s_lshr_b32 s41, s2, 1
s_mul_i32 s41, s41, 18432
s_add_u32 s41, s41, s34
s_cmp_eq_u32 s40, 0
s_mov_b32 s46, 0x00ff00ff
s_cselect_b32 s46, 0xff00ff00, s46
s_mov_b32 exec_lo, s46
s_mov_b32 exec_hi, s46
s_add_u32 s46, s41, 3072
s_add_u32 s42, s30, s46
s_addc_u32 s43, s31, 0
s_mov_b32 m0, 23552
s_nop 0
global_load_lds_dwordx4 v157, s[42:43]
s_add_u32 s46, s41, 7168
s_add_u32 s42, s30, s46
s_addc_u32 s43, s31, 0
s_mov_b32 m0, 27648
s_nop 0
global_load_lds_dwordx4 v157, s[42:43]
s_add_u32 s46, s41, 11264
s_add_u32 s42, s30, s46
s_addc_u32 s43, s31, 0
s_mov_b32 m0, 31744
s_nop 0
global_load_lds_dwordx4 v157, s[42:43]
s_add_u32 s46, s41, 15360
s_add_u32 s42, s30, s46
s_addc_u32 s43, s31, 0
s_mov_b32 m0, 35840
s_nop 0
global_load_lds_dwordx4 v157, s[42:43]
s_mov_b64 exec, -1
v_mov_b32 v159, 1
v_mov_b32 v158, 3
ds_write_b8 v158, v159 offset:528
s_waitcnt vmcnt(0)
s_branch H3_tags
M_exit:
s_endpgm
.section .rodata,"a"
.p2align 6
.amdhsa_kernel interleave_layers__grouped_kv_mqa__ssm_conv_h3__prompt_kernel
.amdhsa_next_free_vgpr 168
.amdhsa_next_free_sgpr 102
.amdhsa_accum_offset 168
.amdhsa_group_segment_fixed_size 0
.amdhsa_kernarg_size 112
.amdhsa_user_sgpr_count 2
.amdhsa_user_sgpr_kernarg_segment_ptr 1
.amdhsa_system_sgpr_workgroup_id_x 1
.amdhsa_float_denorm_mode_32 3
.end_amdhsa_kernel
.text
```
